```python
import torch

def _softmax(x, axis=-1):
    return torch.softmax(x, dim=axis)
def _gelu(x):
    return torch.nn.functional.gelu(x, approximate="tanh")
def _silu(x):
    return torch.nn.functional.silu(x)
def _sigmoid(x):
    return torch.sigmoid(x)
def _layernorm(x, axis=-1, eps=1e-5):
    m = x.mean(dim=axis, keepdim=True)
    v = x.var(dim=axis, keepdim=True, unbiased=False)
    return (x - m) / torch.sqrt(v + eps)
def _scatter_add(tgt, idx, src, axis=0):
    return tgt.clone().index_add_(axis, idx, src)
def _segment_sum(src, seg, n):
    out = torch.zeros((n,) + src.shape[1:], dtype=src.dtype)
    return out.index_add_(0, seg, src)
def _pad(x, pw):
    flat = tuple(v for pair in reversed(pw) for v in pair)
    return torch.nn.functional.pad(x, flat)

kernel_name = 'standalone__memory_aug_memorizing_tr__prompt'

def setup_inputs():

    _w = (lambda a: (lambda t: t.to(torch.bfloat16) if t.is_floating_point() else t)(torch.as_tensor(a)))
    B, H, S, D = 1, 32, 2048, 192
    M, K = 2048, 2
    return {
        "q": _w((lambda *s: torch.randn(*s, dtype=torch.bfloat16) * 0.8)(B, H, S, D)),
        "k": _w((lambda *s: torch.randn(*s, dtype=torch.bfloat16) * 0.8)(B, H, S, D)),
        "v": _w((lambda *s: torch.randn(*s, dtype=torch.bfloat16) * 0.05)(B, H, S, D)),
        "mem_k": _w((lambda *s: torch.randn(*s, dtype=torch.bfloat16) * 0.8)(B, H, M, D)),
        "mem_v": _w((lambda *s: torch.randn(*s, dtype=torch.bfloat16) * 0.05)(B, H, M, D)),
        "idx": _w(torch.randint(0, M, (B, H, S, K)).to(torch.int64)),
        "gate_bias": _w((lambda *s: torch.randn(*s, dtype=torch.bfloat16) * 0.2)(H)),
    }

def reference(q, k, v, mem_k, mem_v, idx, gate_bias):
    B, H, S, D = q.shape
    K = idx.shape[-1]
    scale = D ** -0.5
    sl = torch.einsum("bhqd,bhkd->bhqk", q, k) * scale
    cm = torch.tril(torch.ones((S, S), dtype=q.dtype))
    sl = torch.where(cm[None, None] > 0, sl, -1e9)
    pl = _softmax(sl, axis=-1)
    ol = torch.einsum("bhqk,bhkd->bhqd", pl, v)
    idx_e = (lambda x, n, axis: torch.repeat_interleave(x, n, dim=axis))(idx.reshape(B, H, S * K)[..., None], D, axis=-1)
    mk = (lambda x, i, axis: torch.take_along_dim(x, i, dim=axis))(mem_k, idx_e, axis=2).reshape(B, H, S, K, D)
    mv = (lambda x, i, axis: torch.take_along_dim(x, i, dim=axis))(mem_v, idx_e, axis=2).reshape(B, H, S, K, D)
    sm = torch.einsum("bhqd,bhqkd->bhqk", q, mk) * scale
    pm = _softmax(sm, axis=-1)
    om = torch.einsum("bhqk,bhqkd->bhqd", pm, mv)
    g = _sigmoid(gate_bias)[None, :, None, None]
    return g * om + (1 - g) * ol
```

```asm
; @launch grid=(256,1,1) block=(256,1,1) lds=163840
.amdgcn_target "amdgcn-amd-amdhsa--gfx950"
.text
.globl standalone__memory_aug_memorizing_tr__prompt_kernel
.p2align 8
.type standalone__memory_aug_memorizing_tr__prompt_kernel,@function
standalone__memory_aug_memorizing_tr__prompt_kernel:
s_cmp_ge_u32 s2, 256
s_cbranch_scc1 L_end
s_load_dwordx16 s[84:99], s[0:1], 0
s_getpc_b64 s[8:9]
L_pc:
s_bfe_u32 s16, s2, 0x40003
s_lshl_b32 s16, s16, 13
v_lshrrev_b32 v2, 2, v0
v_lshl_add_u32 v2, v2, 7, s16
v_min_u32 v2, L_codeend-L_pc-4, v2
v_mov_b32 v3, s9
v_add_co_u32 v2, vcc, s8, v2
s_nop 1
v_addc_co_u32 v3, vcc, 0, v3, vcc
global_load_dword a255, v[2:3], off
v_lshrrev_b32 v252, 6, v0
v_and_b32 v249, 63, v0
v_readfirstlane_b32 s36, v252
s_and_b32 s3, s2, 7
s_lshl_b32 s3, s3, 2
s_bfe_u32 s37, s2, 0x20003
s_add_u32 s3, s3, s37
s_lshr_b32 s37, s2, 5
s_and_b32 s39, s36, 1
v_lshrrev_b32 v253, 3, v249
v_lshrrev_b32 v254, 4, v249
v_and_b32 v255, 7, v249
v_xor_b32 v254, v254, v255
v_lshlrev_b32 v232, 4, v254
v_mul_u32_u24 v248, 384, v253
v_add_u32 v234, v248, v232
v_add_u32 v234, 3072, v234
v_xor_b32 v235, 64, v234
s_lshl_b32 s34, s39, 6
v_xor_b32 v247, s34, v234
s_sub_u32 s34, 15, s37
s_cmp_lt_u32 s36, 2
s_cselect_b32 s34, s34, s37
s_lshl_b32 s34, s34, 1
s_add_u32 s34, s34, s39
s_mul_i32 s35, s3, 786432
s_mul_i32 s44, s36, 3072
s_mul_i32 s45, s34, 24576
s_add_u32 s46, s36, 4
s_mulk_i32 s46, 12288
s_mov_b32 s14, 789504
s_mov_b32 s15, 0x20000
s_mov_b64 s[6:7], s[14:15]
s_mov_b32 m0, s46
s_lshl_b32 s38, s3, 5
s_add_u32 s49, s38, s34
s_lshl_b32 s49, s49, 9
v_lshl_add_u32 v252, v249, 3, s49
v_lshlrev_b32 v253, 1, s3
s_waitcnt lgkmcnt(0)
global_load_dwordx2 v[236:237], v252, s[94:95]
global_load_ushort v240, v253, s[96:97]
s_add_u32 s12, s84, s35
s_addc_u32 s13, s85, 0
s_sub_u32 s12, s12, 3072
s_subb_u32 s13, s13, 0
buffer_load_dwordx4 v234, s[12:15], s45 offen offset:0 nt lds
buffer_load_dwordx4 v235, s[12:15], s45 offen offset:3072 nt lds
s_addk_i32 m0, 896
s_add_u32 s4, s86, s35
s_addc_u32 s5, s87, 0
buffer_load_dwordx4 v234, s[12:15], s45 offen offset:128 nt lds
buffer_load_dwordx4 v235, s[12:15], s45 offen offset:3200 nt lds
s_addk_i32 m0, 896
s_sub_u32 s4, s4, 3072
s_subb_u32 s5, s5, 0
buffer_load_dwordx4 v234, s[12:15], s45 offen offset:256 nt lds
buffer_load_dwordx4 v235, s[12:15], s45 offen offset:3328 nt lds
s_add_u32 m0, s44, 147456
s_mov_b64 s[24:25], s[4:5]
buffer_load_dwordx4 v247, s[4:7], s44 offen offset:0  lds
s_addk_i32 m0, 896
s_mov_b64 s[10:11], s[14:15]
buffer_load_dwordx4 v247, s[4:7], s44 offen offset:128  lds
s_addk_i32 m0, 896
s_nop 0
buffer_load_dwordx4 v247, s[4:7], s44 offen offset:256  lds
v_lshrrev_b32 v252, 2, v249
v_bfe_u32 v248, v252, 1, 1
v_and_b32 v253, 4, v252
v_or_b32 v248, v248, v253
v_lshrrev_b32 v253, 3, v252
v_lshl_add_u32 v248, v253, 1, v248
v_mul_u32_u24 v248, 384, v248
v_and_b32 v253, 1, v252
v_lshl_add_u32 v248, v253, 6, v248
v_and_b32 v254, 3, v249
v_lshl_add_u32 v248, v254, 4, v248
v_and_b32 v250, 15, v249
v_lshrrev_b32 v251, 4, v249
v_lshrrev_b32 v252, 3, v250
v_mul_u32_u24 v252, 3072, v252
v_and_b32 v253, 7, v250
v_lshl_add_u32 v252, v253, 7, v252
v_lshrrev_b32 v254, 1, v250
v_or_b32 v253, 0, v251
v_xor_b32 v253, v253, v254
v_lshl_add_u32 v226, v253, 4, v252
v_or_b32 v253, 4, v251
v_xor_b32 v253, v253, v254
v_lshl_add_u32 v227, v253, 4, v252
s_mov_b32 s72, 0x00300003
s_mov_b32 s73, 0x30000300
s_mov_b32 s74, 0x00c0000c
s_mov_b32 s75, 0xc0000c00
s_mov_b32 s56, 0x000f0000
s_mov_b32 s57, 0x0fff00ff
s_mov_b32 s58, 0x001f0001
s_mov_b32 s59, 0x1fff01ff
s_mov_b32 s60, 0x003f0003
s_mov_b32 s61, 0x3fff03ff
s_mov_b32 s62, 0x007f0007
s_mov_b32 s63, 0x7fff07ff
s_lshl_b32 s82, s37, 2
s_add_u32 s82, s82, s36
s_cmp_eq_u32 s82, 2
s_cselect_b64 s[70:71], -1, 0
s_cselect_b64 s[56:57], s[56:57], 0
s_cselect_b64 s[58:59], s[58:59], 0
s_cselect_b64 s[60:61], s[60:61], 0
s_cselect_b64 s[62:63], s[62:63], 0
v_add_u32 v92, s46, v226
v_add_u32 v93, s46, v227
v_add_u32 v94, 147456, v226
v_add_u32 v95, 147456, v227
v_lshlrev_b32 v255, 4, v249
v_and_b32 v255, 16, v255
v_mov_b32 v48, 15829
v_mov_b32 v49, 14574
v_lshlrev_b32 v48, v255, v48
v_lshlrev_b32 v49, v255, v49
v_mov_b32 v80, 0
v_mov_b32 v81, 0
v_mov_b32 v84, 0
v_mov_b32 v85, 0
v_mov_b32 v88, 0
v_mov_b32 v89, 0
v_cndmask_b32 v82, 0, v48, s[72:73]
v_cndmask_b32 v83, 0, v48, s[74:75]
v_cndmask_b32 v86, 0, v49, s[72:73]
v_cndmask_b32 v87, 0, v49, s[74:75]
s_add_u32 s26, s88, s35
s_addc_u32 s27, s89, 0
s_sub_u32 s26, s26, 3072
s_subb_u32 s27, s27, 0
s_mov_b64 s[8:9], s[26:27]
s_add_u32 s28, s90, s35
s_addc_u32 s29, s91, 0
s_sub_u32 s28, s28, 3072
s_subb_u32 s29, s29, 0
s_add_u32 s30, s92, s35
s_addc_u32 s31, s93, 0
s_sub_u32 s30, s30, 3072
s_subb_u32 s31, s31, 0
s_add_u32 s16, s98, s35
s_addc_u32 s17, s99, 0
s_mov_b32 s18, 786432
s_mov_b32 s19, 0x20000
s_mul_i32 s40, s39, 6144
s_add_u32 s41, s40, 896
s_add_u32 s42, s40, 1792
v_mov_b32 v208, 0
v_mov_b32 v209, 0
v_mov_b32 v210, 0
v_mov_b32 v211, 0
v_bfe_u32 v253, v249, 2, 3
v_lshrrev_b32 v252, 5, v249
v_mul_u32_u24 v252, 3072, v252
v_lshl_add_u32 v252, v253, 7, v252
v_mfma_f32_32x32x16_bf16 a[0:15], v[208:211], v[208:211], 0
v_and_b32 v254, 1, v249
v_lshl_add_u32 v252, v254, 3, v252
v_add_u32 v252, 24576, v252
v_lshrrev_b32 v253, 3, v249
v_and_b32 v254, 2, v249
v_mfma_f32_32x32x16_bf16 a[16:31], v[208:211], v[208:211], 0
v_lshlrev_b32 v254, 1, v254
v_or_b32 v255, 0, v254
v_xor_b32 v255, v255, v253
v_lshl_add_u32 v228, v255, 4, v252
v_or_b32 v255, 1, v254
v_xor_b32 v255, v255, v253
v_mfma_f32_32x32x16_bf16 a[32:47], v[208:211], v[208:211], 0
v_lshl_add_u32 v229, v255, 4, v252
v_or_b32 v255, 2, v254
v_xor_b32 v255, v255, v253
v_lshl_add_u32 v230, v255, 4, v252
v_or_b32 v255, 3, v254
v_xor_b32 v255, v255, v253
v_mfma_f32_32x32x16_bf16 a[48:63], v[208:211], v[208:211], 0
v_lshl_add_u32 v231, v255, 4, v252
v_lshrrev_b32 v252, 3, v249
s_lshl_b32 s38, s39, 6
s_add_u32 s38, s38, 160768
v_lshl_add_u32 v233, v252, 3, s38
v_lshlrev_b32 v252, 2, v250
v_mfma_f32_32x32x16_bf16 a[64:79], v[208:211], v[208:211], 0
v_add_u32 v252, 159744, v252
v_lshrrev_b32 v253, 2, v250
v_mov_b32 v242, 0x40000
v_cmp_eq_u32 vcc, v253, v251
s_nop 1
v_cndmask_b32 v242, v242, v252, vcc
s_mov_b32 s64, 0x22222222
v_mfma_f32_32x32x16_bf16 a[80:95], v[208:211], v[208:211], 0
s_mov_b32 s65, 0x22222222
s_mov_b32 s66, 0x44444444
s_mov_b32 s67, 0x44444444
s_mov_b32 s68, 0x88888888
s_mov_b32 s69, 0x88888888
s_mov_b32 s52, 0x4b800000
s_lshl_b32 s38, s37, 2
s_add_u32 s78, s38, 4
s_lshl_b32 s82, s39, 1
s_add_u32 s38, s38, s82
s_add_u32 s38, s38, 2
s_mov_b32 s47, 4291821568
s_mov_b32 s49, 204523520
s_mov_b32 s79, 210839552
s_cmp_lt_u32 s37, 2
s_cselect_b32 s82, 2, 0
s_cselect_b32 s48, 6291456, 0
s_add_u32 s78, s78, s82
s_add_u32 s49, s49, s48
s_add_u32 s79, s79, s48
s_cmp_lt_u32 s36, 2
s_cselect_b32 s47, 3145728, s47
s_cselect_b32 s49, 12584960, s49
s_cselect_b32 s79, 6318080, s79
s_cselect_b32 s48, 0, s78
v_mul_lo_u32 v252, v249, s47
v_and_b32 v253, 1, v249
v_mul_u32_u24 v253, 12288, v253
v_add_u32 v252, v252, v253
v_add_u32 v238, s49, v252
v_add_u32 v239, s79, v252
v_mov_b32 v254, 267573248
v_cmp_gt_u32 vcc, s48, v249
s_nop 1
v_cndmask_b32 v239, v239, v254, vcc
v_cmp_lt_u32 vcc, 32, v249
s_nop 1
v_cndmask_b32 v239, v239, v254, vcc
v_add_u32 v253, 2, v249
v_cmp_gt_u32 vcc, s48, v253
s_nop 1
v_cndmask_b32 v238, v238, v254, vcc
v_cmp_lt_u32 vcc, 30, v249
s_nop 1
v_cndmask_b32 v238, v238, v254, vcc
s_add_u32 m0, s46, 6144
s_add_u32 s43, s45, 6144
buffer_load_dwordx4 v234, s[12:15], s43 offen offset:0 nt lds
buffer_load_dwordx4 v235, s[12:15], s43 offen offset:3072 nt lds
s_cmp_eq_u32 s37, 0
s_cbranch_scc1 L_cfg0
s_cmp_eq_u32 s37, 1
s_cbranch_scc1 L_cfg1
s_cmp_eq_u32 s37, 2
s_cbranch_scc1 L_cfg2
s_cmp_eq_u32 s37, 3
s_cbranch_scc1 L_cfg3
s_cmp_eq_u32 s37, 4
s_cbranch_scc1 L_cfg4
s_cmp_eq_u32 s37, 5
s_cbranch_scc1 L_cfg5
s_cmp_eq_u32 s37, 6
s_cbranch_scc1 L_cfg6
s_branch L_cfg7
L_cfg0:
s_cmp_eq_u32 s36, 0
s_cbranch_scc1 L_cfg0_0
s_cmp_eq_u32 s36, 1
s_cbranch_scc1 L_cfg0_1
s_cmp_eq_u32 s36, 2
s_cbranch_scc1 L_cfg0_2
s_branch L_cfg0_3
L_cfg0_0:
s_mov_b32 s88, 9451520
v_writelane_b32 v238, s88, 63
s_mov_b32 s88, 110114816
v_writelane_b32 v238, s88, 31
s_mov_b32 s88, 805306368
v_writelane_b32 v238, s88, 32
s_mov_b32 s88, 805319168
v_writelane_b32 v238, s88, 33
s_mov_b32 s88, 805405312
v_writelane_b32 v238, s88, 34
s_mov_b32 s88, 110139392
v_writelane_b32 v239, s88, 33
s_mov_b32 s88, 805331072
v_writelane_b32 v239, s88, 34
s_mov_b32 s88, 1074284416
v_writelane_b32 v239, s88, 0
s_mov_b32 s88, 1074296708
v_writelane_b32 v239, s88, 1
s_mov_b32 s88, 1074135808
v_writelane_b32 v239, s88, 10
s_mov_b32 s88, 1074148100
v_writelane_b32 v239, s88, 11
s_mov_b32 s88, 1074185088
v_writelane_b32 v239, s88, 12
s_mov_b32 s88, 1074197380
v_writelane_b32 v239, s88, 13
s_mov_b32 s88, 1074233600
v_writelane_b32 v239, s88, 14
s_mov_b32 s88, 1074245892
v_writelane_b32 v239, s88, 15
s_mov_b32 s88, 1074282880
v_writelane_b32 v239, s88, 16
s_mov_b32 s88, 1074295172
v_writelane_b32 v239, s88, 17
s_mov_b32 s88, 1074135040
v_writelane_b32 v239, s88, 20
s_mov_b32 s88, 1074147332
v_writelane_b32 v239, s88, 21
s_mov_b32 s88, 1074184320
v_writelane_b32 v239, s88, 22
s_mov_b32 s88, 1074196612
v_writelane_b32 v239, s88, 23
s_mov_b32 s88, 1074233856
v_writelane_b32 v239, s88, 24
s_mov_b32 s88, 1074246148
v_writelane_b32 v239, s88, 25
s_mov_b32 s88, 1074283136
v_writelane_b32 v239, s88, 26
s_mov_b32 s88, 1074295428
v_writelane_b32 v239, s88, 27
s_mov_b32 s88, 25315589
v_writelane_b32 v239, s88, 40
s_mov_b32 s88, 98589
v_writelane_b32 v239, s88, 41
s_mov_b32 s88, 36701215
v_writelane_b32 v239, s88, 42
s_mov_b32 s83, 25315589
s_mov_b32 s35, 5
s_mov_b32 s95, 1089
s_branch L_cfgdone
L_cfg0_1:
s_mov_b32 s88, 9451520
v_writelane_b32 v238, s88, 63
s_mov_b32 s88, 110114816
v_writelane_b32 v238, s88, 31
s_mov_b32 s88, 805306368
v_writelane_b32 v238, s88, 32
s_mov_b32 s88, 805319168
v_writelane_b32 v238, s88, 33
s_mov_b32 s88, 805405312
v_writelane_b32 v238, s88, 34
s_mov_b32 s88, 110139392
v_writelane_b32 v239, s88, 33
s_mov_b32 s88, 805331072
v_writelane_b32 v239, s88, 34
s_mov_b32 s88, 1074284416
v_writelane_b32 v239, s88, 0
s_mov_b32 s88, 1074296708
v_writelane_b32 v239, s88, 1
s_mov_b32 s88, 1074135808
v_writelane_b32 v239, s88, 10
s_mov_b32 s88, 1074148100
v_writelane_b32 v239, s88, 11
s_mov_b32 s88, 1074185088
v_writelane_b32 v239, s88, 12
s_mov_b32 s88, 1074197380
v_writelane_b32 v239, s88, 13
s_mov_b32 s88, 1074233600
v_writelane_b32 v239, s88, 14
s_mov_b32 s88, 1074245892
v_writelane_b32 v239, s88, 15
s_mov_b32 s88, 1074282880
v_writelane_b32 v239, s88, 16
s_mov_b32 s88, 1074295172
v_writelane_b32 v239, s88, 17
s_mov_b32 s88, 1074135040
v_writelane_b32 v239, s88, 20
s_mov_b32 s88, 1074147332
v_writelane_b32 v239, s88, 21
s_mov_b32 s88, 1074184320
v_writelane_b32 v239, s88, 22
s_mov_b32 s88, 1074196612
v_writelane_b32 v239, s88, 23
s_mov_b32 s88, 1074233856
v_writelane_b32 v239, s88, 24
s_mov_b32 s88, 1074246148
v_writelane_b32 v239, s88, 25
s_mov_b32 s88, 1074283136
v_writelane_b32 v239, s88, 26
s_mov_b32 s88, 1074295428
v_writelane_b32 v239, s88, 27
s_mov_b32 s88, 37812485
v_writelane_b32 v239, s88, 40
s_mov_b32 s88, 4317469
v_writelane_b32 v239, s88, 41
s_mov_b32 s88, 36701215
v_writelane_b32 v239, s88, 42
s_mov_b32 s83, 37812485
s_mov_b32 s35, 5
s_mov_b32 s95, 1089
s_branch L_cfgdone
L_cfg0_2:
s_mov_b32 s88, 536970752
v_writelane_b32 v238, s88, 63
s_mov_b32 s88, 536995584
v_writelane_b32 v238, s88, 0
s_mov_b32 s88, 805368960
v_writelane_b32 v238, s88, 1
s_mov_b32 s88, 805393664
v_writelane_b32 v238, s88, 2
s_mov_b32 s88, 805418624
v_writelane_b32 v238, s88, 3
s_mov_b32 s88, 113309696
v_writelane_b32 v238, s88, 31
s_mov_b32 s88, 805356288
v_writelane_b32 v238, s88, 32
s_mov_b32 s88, 805368064
v_writelane_b32 v238, s88, 33
s_mov_b32 s88, 805417344
v_writelane_b32 v238, s88, 34
s_mov_b32 s88, 536983168
v_writelane_b32 v239, s88, 0
s_mov_b32 s88, 805356544
v_writelane_b32 v239, s88, 1
s_mov_b32 s88, 805381504
v_writelane_b32 v239, s88, 2
s_mov_b32 s88, 805406208
v_writelane_b32 v239, s88, 3
s_mov_b32 s88, 805431168
v_writelane_b32 v239, s88, 4
s_mov_b32 s88, 805443328
v_writelane_b32 v239, s88, 5
s_mov_b32 s88, 113334272
v_writelane_b32 v239, s88, 33
s_mov_b32 s88, 805380992
v_writelane_b32 v239, s88, 34
s_mov_b32 s88, 6390035
v_writelane_b32 v239, s88, 41
s_mov_b32 s88, 36701215
v_writelane_b32 v239, s88, 42
s_mov_b32 s83, 0
s_mov_b32 s35, 0
s_mov_b32 s95, 517
s_branch L_cfgdone
L_cfg0_3:
s_mov_b32 s88, 536970752
v_writelane_b32 v238, s88, 63
s_mov_b32 s88, 536995584
v_writelane_b32 v238, s88, 0
s_mov_b32 s88, 805368960
v_writelane_b32 v238, s88, 1
s_mov_b32 s88, 805393664
v_writelane_b32 v238, s88, 2
s_mov_b32 s88, 805418624
v_writelane_b32 v238, s88, 3
s_mov_b32 s88, 113309696
v_writelane_b32 v238, s88, 31
s_mov_b32 s88, 805356288
v_writelane_b32 v238, s88, 32
s_mov_b32 s88, 805368064
v_writelane_b32 v238, s88, 33
s_mov_b32 s88, 805417344
v_writelane_b32 v238, s88, 34
s_mov_b32 s88, 536983168
v_writelane_b32 v239, s88, 0
s_mov_b32 s88, 805356544
v_writelane_b32 v239, s88, 1
s_mov_b32 s88, 805381504
v_writelane_b32 v239, s88, 2
s_mov_b32 s88, 805406208
v_writelane_b32 v239, s88, 3
s_mov_b32 s88, 805431168
v_writelane_b32 v239, s88, 4
s_mov_b32 s88, 805443328
v_writelane_b32 v239, s88, 5
s_mov_b32 s88, 113334272
v_writelane_b32 v239, s88, 33
s_mov_b32 s88, 805380992
v_writelane_b32 v239, s88, 34
s_mov_b32 s88, 1
v_writelane_b32 v239, s88, 40
s_mov_b32 s88, 2220307
v_writelane_b32 v239, s88, 41
s_mov_b32 s88, 36701215
v_writelane_b32 v239, s88, 42
s_mov_b32 s83, 1
s_mov_b32 s35, 1
s_mov_b32 s95, 513
s_branch L_cfgdone
L_cfg1:
s_cmp_eq_u32 s36, 0
s_cbranch_scc1 L_cfg1_0
s_cmp_eq_u32 s36, 1
s_cbranch_scc1 L_cfg1_1
s_cmp_eq_u32 s36, 2
s_cbranch_scc1 L_cfg1_2
s_branch L_cfg1_3
L_cfg1_0:
s_mov_b32 s88, 9451520
v_writelane_b32 v238, s88, 63
s_mov_b32 s88, 110114816
v_writelane_b32 v238, s88, 31
s_mov_b32 s88, 805306368
v_writelane_b32 v238, s88, 32
s_mov_b32 s88, 805319168
v_writelane_b32 v238, s88, 33
s_mov_b32 s88, 805405312
v_writelane_b32 v238, s88, 34
s_mov_b32 s88, 110139392
v_writelane_b32 v239, s88, 33
s_mov_b32 s88, 805331072
v_writelane_b32 v239, s88, 34
s_mov_b32 s88, 1074135808
v_writelane_b32 v239, s88, 14
s_mov_b32 s88, 1074148100
v_writelane_b32 v239, s88, 15
s_mov_b32 s88, 1074185088
v_writelane_b32 v239, s88, 16
s_mov_b32 s88, 1074197380
v_writelane_b32 v239, s88, 17
s_mov_b32 s88, 1074233600
v_writelane_b32 v239, s88, 18
s_mov_b32 s88, 1074245892
v_writelane_b32 v239, s88, 19
s_mov_b32 s88, 1074282880
v_writelane_b32 v239, s88, 20
s_mov_b32 s88, 1074295172
v_writelane_b32 v239, s88, 21
s_mov_b32 s88, 1074135040
v_writelane_b32 v239, s88, 24
s_mov_b32 s88, 1074147332
v_writelane_b32 v239, s88, 25
s_mov_b32 s88, 1074233856
v_writelane_b32 v239, s88, 26
s_mov_b32 s88, 1074246148
v_writelane_b32 v239, s88, 27
s_mov_b32 s88, 25315593
v_writelane_b32 v239, s88, 40
s_mov_b32 s88, 98589
v_writelane_b32 v239, s88, 41
s_mov_b32 s88, 36701215
v_writelane_b32 v239, s88, 42
s_mov_b32 s83, 25315593
s_mov_b32 s35, 9
s_mov_b32 s95, 1057
s_branch L_cfgdone
L_cfg1_1:
s_mov_b32 s88, 9451520
v_writelane_b32 v238, s88, 63
s_mov_b32 s88, 110114816
v_writelane_b32 v238, s88, 31
s_mov_b32 s88, 805306368
v_writelane_b32 v238, s88, 32
s_mov_b32 s88, 805319168
v_writelane_b32 v238, s88, 33
s_mov_b32 s88, 805405312
v_writelane_b32 v238, s88, 34
s_mov_b32 s88, 110139392
v_writelane_b32 v239, s88, 33
s_mov_b32 s88, 805331072
v_writelane_b32 v239, s88, 34
s_mov_b32 s88, 1074135808
v_writelane_b32 v239, s88, 14
s_mov_b32 s88, 1074148100
v_writelane_b32 v239, s88, 15
s_mov_b32 s88, 1074185088
v_writelane_b32 v239, s88, 16
s_mov_b32 s88, 1074197380
v_writelane_b32 v239, s88, 17
s_mov_b32 s88, 1074233600
v_writelane_b32 v239, s88, 18
s_mov_b32 s88, 1074245892
v_writelane_b32 v239, s88, 19
s_mov_b32 s88, 1074282880
v_writelane_b32 v239, s88, 20
s_mov_b32 s88, 1074295172
v_writelane_b32 v239, s88, 21
s_mov_b32 s88, 1074135040
v_writelane_b32 v239, s88, 24
s_mov_b32 s88, 1074147332
v_writelane_b32 v239, s88, 25
s_mov_b32 s88, 1074233856
v_writelane_b32 v239, s88, 26
s_mov_b32 s88, 1074246148
v_writelane_b32 v239, s88, 27
s_mov_b32 s88, 37812489
v_writelane_b32 v239, s88, 40
s_mov_b32 s88, 4317469
v_writelane_b32 v239, s88, 41
s_mov_b32 s88, 36701215
v_writelane_b32 v239, s88, 42
s_mov_b32 s83, 37812489
s_mov_b32 s35, 9
s_mov_b32 s95, 1057
s_branch L_cfgdone
L_cfg1_2:
s_mov_b32 s88, 536921088
v_writelane_b32 v238, s88, 63
s_mov_b32 s88, 536945920
v_writelane_b32 v238, s88, 0
s_mov_b32 s88, 536983168
v_writelane_b32 v238, s88, 2
s_mov_b32 s88, 537008000
v_writelane_b32 v238, s88, 3
s_mov_b32 s88, 805368960
v_writelane_b32 v238, s88, 5
s_mov_b32 s88, 805393664
v_writelane_b32 v238, s88, 6
s_mov_b32 s88, 805418624
v_writelane_b32 v238, s88, 7
s_mov_b32 s88, 113309696
v_writelane_b32 v238, s88, 31
s_mov_b32 s88, 805356288
v_writelane_b32 v238, s88, 32
s_mov_b32 s88, 805368064
v_writelane_b32 v238, s88, 33
s_mov_b32 s88, 805417344
v_writelane_b32 v238, s88, 34
s_mov_b32 s88, 536933504
v_writelane_b32 v239, s88, 0
s_mov_b32 s88, 536958336
v_writelane_b32 v239, s88, 1
s_mov_b32 s88, 536970752
v_writelane_b32 v239, s88, 2
s_mov_b32 s88, 536995584
v_writelane_b32 v239, s88, 3
s_mov_b32 s88, 805356544
v_writelane_b32 v239, s88, 5
s_mov_b32 s88, 805381504
v_writelane_b32 v239, s88, 6
s_mov_b32 s88, 805406208
v_writelane_b32 v239, s88, 7
s_mov_b32 s88, 805431168
v_writelane_b32 v239, s88, 8
s_mov_b32 s88, 805443328
v_writelane_b32 v239, s88, 9
s_mov_b32 s88, 113334272
v_writelane_b32 v239, s88, 33
s_mov_b32 s88, 805380992
v_writelane_b32 v239, s88, 34
s_mov_b32 s88, 1074184320
v_writelane_b32 v239, s88, 24
s_mov_b32 s88, 1074196612
v_writelane_b32 v239, s88, 25
s_mov_b32 s88, 1074283136
v_writelane_b32 v239, s88, 26
s_mov_b32 s88, 1074295428
v_writelane_b32 v239, s88, 27
s_mov_b32 s88, 3
v_writelane_b32 v239, s88, 40
s_mov_b32 s88, 6390039
v_writelane_b32 v239, s88, 41
s_mov_b32 s88, 36701215
v_writelane_b32 v239, s88, 42
s_mov_b32 s83, 3
s_mov_b32 s35, 3
s_mov_b32 s95, 1025
s_branch L_cfgdone
L_cfg1_3:
s_mov_b32 s88, 536921088
v_writelane_b32 v238, s88, 63
s_mov_b32 s88, 536945920
v_writelane_b32 v238, s88, 0
s_mov_b32 s88, 536983168
v_writelane_b32 v238, s88, 2
s_mov_b32 s88, 537008000
v_writelane_b32 v238, s88, 3
s_mov_b32 s88, 805368960
v_writelane_b32 v238, s88, 5
s_mov_b32 s88, 805393664
v_writelane_b32 v238, s88, 6
s_mov_b32 s88, 805418624
v_writelane_b32 v238, s88, 7
s_mov_b32 s88, 113309696
v_writelane_b32 v238, s88, 31
s_mov_b32 s88, 805356288
v_writelane_b32 v238, s88, 32
s_mov_b32 s88, 805368064
v_writelane_b32 v238, s88, 33
s_mov_b32 s88, 805417344
v_writelane_b32 v238, s88, 34
s_mov_b32 s88, 536933504
v_writelane_b32 v239, s88, 0
s_mov_b32 s88, 536958336
v_writelane_b32 v239, s88, 1
s_mov_b32 s88, 536970752
v_writelane_b32 v239, s88, 2
s_mov_b32 s88, 536995584
v_writelane_b32 v239, s88, 3
s_mov_b32 s88, 805356544
v_writelane_b32 v239, s88, 5
s_mov_b32 s88, 805381504
v_writelane_b32 v239, s88, 6
s_mov_b32 s88, 805406208
v_writelane_b32 v239, s88, 7
s_mov_b32 s88, 805431168
v_writelane_b32 v239, s88, 8
s_mov_b32 s88, 805443328
v_writelane_b32 v239, s88, 9
s_mov_b32 s88, 113334272
v_writelane_b32 v239, s88, 33
s_mov_b32 s88, 805380992
v_writelane_b32 v239, s88, 34
s_mov_b32 s88, 1074184320
v_writelane_b32 v239, s88, 24
s_mov_b32 s88, 1074196612
v_writelane_b32 v239, s88, 25
s_mov_b32 s88, 1074283136
v_writelane_b32 v239, s88, 26
s_mov_b32 s88, 1074295428
v_writelane_b32 v239, s88, 27
s_mov_b32 s88, 5
v_writelane_b32 v239, s88, 40
s_mov_b32 s88, 2220311
v_writelane_b32 v239, s88, 41
s_mov_b32 s88, 36701215
v_writelane_b32 v239, s88, 42
s_mov_b32 s83, 5
s_mov_b32 s35, 5
s_mov_b32 s95, 1025
s_branch L_cfgdone
L_cfg2:
s_cmp_eq_u32 s36, 0
s_cbranch_scc1 L_cfg2_0
s_cmp_eq_u32 s36, 1
s_cbranch_scc1 L_cfg2_1
s_cmp_eq_u32 s36, 2
s_cbranch_scc1 L_cfg2_2
s_branch L_cfg2_3
L_cfg2_0:
s_mov_b32 s88, 9451520
v_writelane_b32 v238, s88, 63
s_mov_b32 s88, 805318656
v_writelane_b32 v238, s88, 31
s_mov_b32 s88, 805306880
v_writelane_b32 v238, s88, 32
s_mov_b32 s88, 805405312
v_writelane_b32 v238, s88, 33
s_mov_b32 s88, 805343360
v_writelane_b32 v239, s88, 33
s_mov_b32 s88, 1074135808
v_writelane_b32 v239, s88, 17
s_mov_b32 s88, 1074148100
v_writelane_b32 v239, s88, 18
s_mov_b32 s88, 1074233600
v_writelane_b32 v239, s88, 19
s_mov_b32 s88, 1074245892
v_writelane_b32 v239, s88, 20
s_mov_b32 s88, 1074135040
v_writelane_b32 v239, s88, 24
s_mov_b32 s88, 1074147332
v_writelane_b32 v239, s88, 25
s_mov_b32 s88, 1074233856
v_writelane_b32 v239, s88, 26
s_mov_b32 s88, 1074246148
v_writelane_b32 v239, s88, 27
s_mov_b32 s88, 25315595
v_writelane_b32 v239, s88, 40
s_mov_b32 s88, 98589
v_writelane_b32 v239, s88, 41
s_mov_b32 s88, 1055
v_writelane_b32 v239, s88, 42
s_mov_b32 s83, 25315595
s_mov_b32 s35, 11
s_mov_b32 s95, 1056
s_branch L_cfgdone
L_cfg2_1:
s_mov_b32 s88, 9451520
v_writelane_b32 v238, s88, 63
s_mov_b32 s88, 805318656
v_writelane_b32 v238, s88, 31
s_mov_b32 s88, 805306880
v_writelane_b32 v238, s88, 32
s_mov_b32 s88, 805405312
v_writelane_b32 v238, s88, 33
s_mov_b32 s88, 805343360
v_writelane_b32 v239, s88, 33
s_mov_b32 s88, 1074135808
v_writelane_b32 v239, s88, 17
s_mov_b32 s88, 1074148100
v_writelane_b32 v239, s88, 18
s_mov_b32 s88, 1074233600
v_writelane_b32 v239, s88, 19
s_mov_b32 s88, 1074245892
v_writelane_b32 v239, s88, 20
s_mov_b32 s88, 1074135040
v_writelane_b32 v239, s88, 24
s_mov_b32 s88, 1074147332
v_writelane_b32 v239, s88, 25
s_mov_b32 s88, 1074233856
v_writelane_b32 v239, s88, 26
s_mov_b32 s88, 1074246148
v_writelane_b32 v239, s88, 27
s_mov_b32 s88, 37812491
v_writelane_b32 v239, s88, 40
s_mov_b32 s88, 4317469
v_writelane_b32 v239, s88, 41
s_mov_b32 s88, 1055
v_writelane_b32 v239, s88, 42
s_mov_b32 s83, 37812491
s_mov_b32 s35, 11
s_mov_b32 s95, 1056
s_branch L_cfgdone
L_cfg2_2:
s_mov_b32 s88, 536921088
v_writelane_b32 v238, s88, 63
s_mov_b32 s88, 536970752
v_writelane_b32 v238, s88, 0
s_mov_b32 s88, 536945920
v_writelane_b32 v238, s88, 1
s_mov_b32 s88, 536995584
v_writelane_b32 v238, s88, 2
s_mov_b32 s88, 805356544
v_writelane_b32 v238, s88, 3
s_mov_b32 s88, 805368960
v_writelane_b32 v238, s88, 4
s_mov_b32 s88, 805393664
v_writelane_b32 v238, s88, 6
s_mov_b32 s88, 805418624
v_writelane_b32 v238, s88, 7
s_mov_b32 s88, 805368576
v_writelane_b32 v238, s88, 31
s_mov_b32 s88, 805355776
v_writelane_b32 v238, s88, 32
s_mov_b32 s88, 805417344
v_writelane_b32 v238, s88, 33
s_mov_b32 s88, 536933504
v_writelane_b32 v239, s88, 0
s_mov_b32 s88, 536983168
v_writelane_b32 v239, s88, 1
s_mov_b32 s88, 536958336
v_writelane_b32 v239, s88, 2
s_mov_b32 s88, 537008000
v_writelane_b32 v239, s88, 3
s_mov_b32 s88, 805406208
v_writelane_b32 v239, s88, 5
s_mov_b32 s88, 805381504
v_writelane_b32 v239, s88, 6
s_mov_b32 s88, 805431168
v_writelane_b32 v239, s88, 8
s_mov_b32 s88, 805443328
v_writelane_b32 v239, s88, 9
s_mov_b32 s88, 805393280
v_writelane_b32 v239, s88, 33
s_mov_b32 s88, 1074185088
v_writelane_b32 v239, s88, 17
s_mov_b32 s88, 1074197380
v_writelane_b32 v239, s88, 18
s_mov_b32 s88, 1074282880
v_writelane_b32 v239, s88, 19
s_mov_b32 s88, 1074295172
v_writelane_b32 v239, s88, 20
s_mov_b32 s88, 1074184320
v_writelane_b32 v239, s88, 24
s_mov_b32 s88, 1074196612
v_writelane_b32 v239, s88, 25
s_mov_b32 s88, 1074283136
v_writelane_b32 v239, s88, 26
s_mov_b32 s88, 1074295428
v_writelane_b32 v239, s88, 27
s_mov_b32 s88, 8438019
v_writelane_b32 v239, s88, 40
s_mov_b32 s88, 10560261
v_writelane_b32 v239, s88, 41
s_mov_b32 s88, 7
v_writelane_b32 v239, s88, 42
s_mov_b32 s88, 6390039
v_writelane_b32 v239, s88, 43
s_mov_b32 s88, 1055
v_writelane_b32 v239, s88, 44
s_mov_b32 s83, 8438019
s_mov_b32 s35, 3
s_mov_b32 s95, 1024
s_branch L_cfgdone
L_cfg2_3:
s_mov_b32 s88, 536921088
v_writelane_b32 v238, s88, 63
s_mov_b32 s88, 536970752
v_writelane_b32 v238, s88, 0
s_mov_b32 s88, 536945920
v_writelane_b32 v238, s88, 1
s_mov_b32 s88, 536995584
v_writelane_b32 v238, s88, 2
s_mov_b32 s88, 805356544
v_writelane_b32 v238, s88, 3
s_mov_b32 s88, 805368960
v_writelane_b32 v238, s88, 4
s_mov_b32 s88, 805393664
v_writelane_b32 v238, s88, 6
s_mov_b32 s88, 805418624
v_writelane_b32 v238, s88, 7
s_mov_b32 s88, 805368576
v_writelane_b32 v238, s88, 31
s_mov_b32 s88, 805355776
v_writelane_b32 v238, s88, 32
s_mov_b32 s88, 805417344
v_writelane_b32 v238, s88, 33
s_mov_b32 s88, 536933504
v_writelane_b32 v239, s88, 0
s_mov_b32 s88, 536983168
v_writelane_b32 v239, s88, 1
s_mov_b32 s88, 536958336
v_writelane_b32 v239, s88, 2
s_mov_b32 s88, 537008000
v_writelane_b32 v239, s88, 3
s_mov_b32 s88, 805406208
v_writelane_b32 v239, s88, 5
s_mov_b32 s88, 805381504
v_writelane_b32 v239, s88, 6
s_mov_b32 s88, 805431168
v_writelane_b32 v239, s88, 8
s_mov_b32 s88, 805443328
v_writelane_b32 v239, s88, 9
s_mov_b32 s88, 805393280
v_writelane_b32 v239, s88, 33
s_mov_b32 s88, 1074185088
v_writelane_b32 v239, s88, 17
s_mov_b32 s88, 1074197380
v_writelane_b32 v239, s88, 18
s_mov_b32 s88, 1074282880
v_writelane_b32 v239, s88, 19
s_mov_b32 s88, 1074295172
v_writelane_b32 v239, s88, 20
s_mov_b32 s88, 1074184320
v_writelane_b32 v239, s88, 24
s_mov_b32 s88, 1074196612
v_writelane_b32 v239, s88, 25
s_mov_b32 s88, 1074283136
v_writelane_b32 v239, s88, 26
s_mov_b32 s88, 1074295428
v_writelane_b32 v239, s88, 27
s_mov_b32 s88, 12681475
v_writelane_b32 v239, s88, 40
s_mov_b32 s88, 14803717
v_writelane_b32 v239, s88, 41
s_mov_b32 s88, 9
v_writelane_b32 v239, s88, 42
s_mov_b32 s88, 2220311
v_writelane_b32 v239, s88, 43
s_mov_b32 s88, 1055
v_writelane_b32 v239, s88, 44
s_mov_b32 s83, 12681475
s_mov_b32 s35, 3
s_mov_b32 s95, 1024
s_branch L_cfgdone
L_cfg3:
s_cmp_eq_u32 s36, 0
s_cbranch_scc1 L_cfg3_0
s_cmp_eq_u32 s36, 1
s_cbranch_scc1 L_cfg3_1
s_cmp_eq_u32 s36, 2
s_cbranch_scc1 L_cfg3_2
s_branch L_cfg3_3
L_cfg3_0:
s_mov_b32 s88, 9451520
v_writelane_b32 v238, s88, 63
s_mov_b32 s88, 805318656
v_writelane_b32 v238, s88, 31
s_mov_b32 s88, 805306880
v_writelane_b32 v238, s88, 32
s_mov_b32 s88, 805405312
v_writelane_b32 v238, s88, 33
s_mov_b32 s88, 805343360
v_writelane_b32 v239, s88, 33
s_mov_b32 s88, 1074135808
v_writelane_b32 v239, s88, 20
s_mov_b32 s88, 1074148100
v_writelane_b32 v239, s88, 21
s_mov_b32 s88, 1074185088
v_writelane_b32 v239, s88, 22
s_mov_b32 s88, 1074197380
v_writelane_b32 v239, s88, 23
s_mov_b32 s88, 1074233600
v_writelane_b32 v239, s88, 24
s_mov_b32 s88, 1074245892
v_writelane_b32 v239, s88, 25
s_mov_b32 s88, 1074282880
v_writelane_b32 v239, s88, 26
s_mov_b32 s88, 1074295172
v_writelane_b32 v239, s88, 27
s_mov_b32 s88, 49413
v_writelane_b32 v239, s88, 40
s_mov_b32 s88, 25315599
v_writelane_b32 v239, s88, 41
s_mov_b32 s88, 1055
v_writelane_b32 v239, s88, 42
s_mov_b32 s83, 49413
s_mov_b32 s35, 5
s_mov_b32 s95, 1056
s_branch L_cfgdone
L_cfg3_1:
s_mov_b32 s88, 9451520
v_writelane_b32 v238, s88, 63
s_mov_b32 s88, 805318656
v_writelane_b32 v238, s88, 31
s_mov_b32 s88, 805306880
v_writelane_b32 v238, s88, 32
s_mov_b32 s88, 805405312
v_writelane_b32 v238, s88, 33
s_mov_b32 s88, 805343360
v_writelane_b32 v239, s88, 33
s_mov_b32 s88, 1074135808
v_writelane_b32 v239, s88, 20
s_mov_b32 s88, 1074148100
v_writelane_b32 v239, s88, 21
s_mov_b32 s88, 1074185088
v_writelane_b32 v239, s88, 22
s_mov_b32 s88, 1074197380
v_writelane_b32 v239, s88, 23
s_mov_b32 s88, 1074233600
v_writelane_b32 v239, s88, 24
s_mov_b32 s88, 1074245892
v_writelane_b32 v239, s88, 25
s_mov_b32 s88, 1074282880
v_writelane_b32 v239, s88, 26
s_mov_b32 s88, 1074295172
v_writelane_b32 v239, s88, 27
s_mov_b32 s88, 4268293
v_writelane_b32 v239, s88, 40
s_mov_b32 s88, 37812495
v_writelane_b32 v239, s88, 41
s_mov_b32 s88, 1055
v_writelane_b32 v239, s88, 42
s_mov_b32 s83, 4268293
s_mov_b32 s35, 5
s_mov_b32 s95, 1056
s_branch L_cfgdone
L_cfg3_2:
s_mov_b32 s88, 536920064
v_writelane_b32 v238, s88, 63
s_mov_b32 s88, 536970240
v_writelane_b32 v238, s88, 0
s_mov_b32 s88, 536932480
v_writelane_b32 v238, s88, 1
s_mov_b32 s88, 536982656
v_writelane_b32 v238, s88, 2
s_mov_b32 s88, 536958336
v_writelane_b32 v238, s88, 5
s_mov_b32 s88, 536995584
v_writelane_b32 v238, s88, 6
s_mov_b32 s88, 805356544
v_writelane_b32 v238, s88, 7
s_mov_b32 s88, 805368960
v_writelane_b32 v238, s88, 8
s_mov_b32 s88, 805393664
v_writelane_b32 v238, s88, 10
s_mov_b32 s88, 805418624
v_writelane_b32 v238, s88, 11
s_mov_b32 s88, 805368576
v_writelane_b32 v238, s88, 31
s_mov_b32 s88, 805355776
v_writelane_b32 v238, s88, 32
s_mov_b32 s88, 805417344
v_writelane_b32 v238, s88, 33
s_mov_b32 s88, 536945152
v_writelane_b32 v239, s88, 0
s_mov_b32 s88, 536995328
v_writelane_b32 v239, s88, 1
s_mov_b32 s88, 536957568
v_writelane_b32 v239, s88, 2
s_mov_b32 s88, 537007744
v_writelane_b32 v239, s88, 3
s_mov_b32 s88, 536945920
v_writelane_b32 v239, s88, 5
s_mov_b32 s88, 537008000
v_writelane_b32 v239, s88, 7
s_mov_b32 s88, 805406208
v_writelane_b32 v239, s88, 9
s_mov_b32 s88, 805381504
v_writelane_b32 v239, s88, 10
s_mov_b32 s88, 805431168
v_writelane_b32 v239, s88, 12
s_mov_b32 s88, 805443328
v_writelane_b32 v239, s88, 13
s_mov_b32 s88, 805393280
v_writelane_b32 v239, s88, 33
s_mov_b32 s88, 8487173
v_writelane_b32 v239, s88, 40
s_mov_b32 s88, 10560265
v_writelane_b32 v239, s88, 41
s_mov_b32 s88, 11
v_writelane_b32 v239, s88, 42
s_mov_b32 s88, 6390045
v_writelane_b32 v239, s88, 43
s_mov_b32 s88, 1055
v_writelane_b32 v239, s88, 44
s_mov_b32 s83, 8487173
s_mov_b32 s35, 5
s_mov_b32 s95, 512
s_branch L_cfgdone
L_cfg3_3:
s_mov_b32 s88, 536920064
v_writelane_b32 v238, s88, 63
s_mov_b32 s88, 536970240
v_writelane_b32 v238, s88, 0
s_mov_b32 s88, 536932480
v_writelane_b32 v238, s88, 1
s_mov_b32 s88, 536982656
v_writelane_b32 v238, s88, 2
s_mov_b32 s88, 536958336
v_writelane_b32 v238, s88, 5
s_mov_b32 s88, 536995584
v_writelane_b32 v238, s88, 6
s_mov_b32 s88, 805356544
v_writelane_b32 v238, s88, 7
s_mov_b32 s88, 805368960
v_writelane_b32 v238, s88, 8
s_mov_b32 s88, 805393664
v_writelane_b32 v238, s88, 10
s_mov_b32 s88, 805418624
v_writelane_b32 v238, s88, 11
s_mov_b32 s88, 805368576
v_writelane_b32 v238, s88, 31
s_mov_b32 s88, 805355776
v_writelane_b32 v238, s88, 32
s_mov_b32 s88, 805417344
v_writelane_b32 v238, s88, 33
s_mov_b32 s88, 536945152
v_writelane_b32 v239, s88, 0
s_mov_b32 s88, 536995328
v_writelane_b32 v239, s88, 1
s_mov_b32 s88, 536957568
v_writelane_b32 v239, s88, 2
s_mov_b32 s88, 537007744
v_writelane_b32 v239, s88, 3
s_mov_b32 s88, 536945920
v_writelane_b32 v239, s88, 5
s_mov_b32 s88, 537008000
v_writelane_b32 v239, s88, 7
s_mov_b32 s88, 805406208
v_writelane_b32 v239, s88, 9
s_mov_b32 s88, 805381504
v_writelane_b32 v239, s88, 10
s_mov_b32 s88, 805431168
v_writelane_b32 v239, s88, 12
s_mov_b32 s88, 805443328
v_writelane_b32 v239, s88, 13
s_mov_b32 s88, 805393280
v_writelane_b32 v239, s88, 33
s_mov_b32 s88, 12706053
v_writelane_b32 v239, s88, 40
s_mov_b32 s88, 14803721
v_writelane_b32 v239, s88, 41
s_mov_b32 s88, 13
v_writelane_b32 v239, s88, 42
s_mov_b32 s88, 2220317
v_writelane_b32 v239, s88, 43
s_mov_b32 s88, 1055
v_writelane_b32 v239, s88, 44
s_mov_b32 s83, 12706053
s_mov_b32 s35, 5
s_mov_b32 s95, 512
s_branch L_cfgdone
L_cfg4:
s_cmp_eq_u32 s36, 0
s_cbranch_scc1 L_cfg4_0
s_cmp_eq_u32 s36, 1
s_cbranch_scc1 L_cfg4_1
s_cmp_eq_u32 s36, 2
s_cbranch_scc1 L_cfg4_2
s_branch L_cfg4_3
L_cfg4_0:
s_mov_b32 s88, 9451520
v_writelane_b32 v238, s88, 63
s_mov_b32 s88, 805318656
v_writelane_b32 v238, s88, 31
s_mov_b32 s88, 805306880
v_writelane_b32 v238, s88, 32
s_mov_b32 s88, 805405312
v_writelane_b32 v238, s88, 33
s_mov_b32 s88, 805343360
v_writelane_b32 v239, s88, 33
s_mov_b32 s88, 49415
v_writelane_b32 v239, s88, 40
s_mov_b32 s88, 2147085
v_writelane_b32 v239, s88, 41
s_mov_b32 s88, 25315603
v_writelane_b32 v239, s88, 42
s_mov_b32 s88, 1055
v_writelane_b32 v239, s88, 43
s_mov_b32 s83, 49415
s_mov_b32 s35, 7
s_mov_b32 s95, 544
s_branch L_cfgdone
L_cfg4_1:
s_mov_b32 s88, 9451520
v_writelane_b32 v238, s88, 63
s_mov_b32 s88, 805318656
v_writelane_b32 v238, s88, 31
s_mov_b32 s88, 805306880
v_writelane_b32 v238, s88, 32
s_mov_b32 s88, 805405312
v_writelane_b32 v238, s88, 33
s_mov_b32 s88, 805343360
v_writelane_b32 v239, s88, 33
s_mov_b32 s88, 4268295
v_writelane_b32 v239, s88, 40
s_mov_b32 s88, 6365965
v_writelane_b32 v239, s88, 41
s_mov_b32 s88, 37812499
v_writelane_b32 v239, s88, 42
s_mov_b32 s88, 1055
v_writelane_b32 v239, s88, 43
s_mov_b32 s83, 4268295
s_mov_b32 s35, 7
s_mov_b32 s95, 544
s_branch L_cfgdone
L_cfg4_2:
s_mov_b32 s88, 536920064
v_writelane_b32 v238, s88, 1
s_mov_b32 s88, 536970240
v_writelane_b32 v238, s88, 2
s_mov_b32 s88, 536932480
v_writelane_b32 v238, s88, 3
s_mov_b32 s88, 536982656
v_writelane_b32 v238, s88, 4
s_mov_b32 s88, 536945408
v_writelane_b32 v238, s88, 7
s_mov_b32 s88, 536995584
v_writelane_b32 v238, s88, 8
s_mov_b32 s88, 536932736
v_writelane_b32 v238, s88, 9
s_mov_b32 s88, 536982912
v_writelane_b32 v238, s88, 10
s_mov_b32 s88, 805368960
v_writelane_b32 v238, s88, 13
s_mov_b32 s88, 805393664
v_writelane_b32 v238, s88, 14
s_mov_b32 s88, 805406208
v_writelane_b32 v238, s88, 15
s_mov_b32 s88, 805431168
v_writelane_b32 v238, s88, 16
s_mov_b32 s88, 805368576
v_writelane_b32 v238, s88, 31
s_mov_b32 s88, 805355776
v_writelane_b32 v238, s88, 32
s_mov_b32 s88, 805417344
v_writelane_b32 v238, s88, 33
s_mov_b32 s88, 536945152
v_writelane_b32 v239, s88, 2
s_mov_b32 s88, 536995328
v_writelane_b32 v239, s88, 3
s_mov_b32 s88, 536957568
v_writelane_b32 v239, s88, 4
s_mov_b32 s88, 537007744
v_writelane_b32 v239, s88, 5
s_mov_b32 s88, 536920320
v_writelane_b32 v239, s88, 7
s_mov_b32 s88, 536970496
v_writelane_b32 v239, s88, 8
s_mov_b32 s88, 536957824
v_writelane_b32 v239, s88, 10
s_mov_b32 s88, 537008000
v_writelane_b32 v239, s88, 11
s_mov_b32 s88, 805356544
v_writelane_b32 v239, s88, 13
s_mov_b32 s88, 805381504
v_writelane_b32 v239, s88, 14
s_mov_b32 s88, 805418624
v_writelane_b32 v239, s88, 16
s_mov_b32 s88, 805443328
v_writelane_b32 v239, s88, 17
s_mov_b32 s88, 805393280
v_writelane_b32 v239, s88, 33
s_mov_b32 s88, 8487175
v_writelane_b32 v239, s88, 40
s_mov_b32 s88, 10584845
v_writelane_b32 v239, s88, 41
s_mov_b32 s88, 15
v_writelane_b32 v239, s88, 42
s_mov_b32 s88, 1055
v_writelane_b32 v239, s88, 43
s_mov_b32 s83, 8487175
s_mov_b32 s35, 7
s_mov_b32 s95, 512
s_branch L_cfgdone
L_cfg4_3:
s_mov_b32 s88, 536920064
v_writelane_b32 v238, s88, 1
s_mov_b32 s88, 536970240
v_writelane_b32 v238, s88, 2
s_mov_b32 s88, 536932480
v_writelane_b32 v238, s88, 3
s_mov_b32 s88, 536982656
v_writelane_b32 v238, s88, 4
s_mov_b32 s88, 536945408
v_writelane_b32 v238, s88, 7
s_mov_b32 s88, 536995584
v_writelane_b32 v238, s88, 8
s_mov_b32 s88, 536932736
v_writelane_b32 v238, s88, 9
s_mov_b32 s88, 536982912
v_writelane_b32 v238, s88, 10
s_mov_b32 s88, 805368960
v_writelane_b32 v238, s88, 13
s_mov_b32 s88, 805393664
v_writelane_b32 v238, s88, 14
s_mov_b32 s88, 805406208
v_writelane_b32 v238, s88, 15
s_mov_b32 s88, 805431168
v_writelane_b32 v238, s88, 16
s_mov_b32 s88, 805368576
v_writelane_b32 v238, s88, 31
s_mov_b32 s88, 805355776
v_writelane_b32 v238, s88, 32
s_mov_b32 s88, 805417344
v_writelane_b32 v238, s88, 33
s_mov_b32 s88, 536945152
v_writelane_b32 v239, s88, 2
s_mov_b32 s88, 536995328
v_writelane_b32 v239, s88, 3
s_mov_b32 s88, 536957568
v_writelane_b32 v239, s88, 4
s_mov_b32 s88, 537007744
v_writelane_b32 v239, s88, 5
s_mov_b32 s88, 536920320
v_writelane_b32 v239, s88, 7
s_mov_b32 s88, 536970496
v_writelane_b32 v239, s88, 8
s_mov_b32 s88, 536957824
v_writelane_b32 v239, s88, 10
s_mov_b32 s88, 537008000
v_writelane_b32 v239, s88, 11
s_mov_b32 s88, 805356544
v_writelane_b32 v239, s88, 13
s_mov_b32 s88, 805381504
v_writelane_b32 v239, s88, 14
s_mov_b32 s88, 805418624
v_writelane_b32 v239, s88, 16
s_mov_b32 s88, 805443328
v_writelane_b32 v239, s88, 17
s_mov_b32 s88, 805393280
v_writelane_b32 v239, s88, 33
s_mov_b32 s88, 12706055
v_writelane_b32 v239, s88, 40
s_mov_b32 s88, 14803725
v_writelane_b32 v239, s88, 41
s_mov_b32 s88, 17
v_writelane_b32 v239, s88, 42
s_mov_b32 s88, 1055
v_writelane_b32 v239, s88, 43
s_mov_b32 s83, 12706055
s_mov_b32 s35, 7
s_mov_b32 s95, 512
s_branch L_cfgdone
L_cfg5:
s_cmp_eq_u32 s36, 0
s_cbranch_scc1 L_cfg5_0
s_cmp_eq_u32 s36, 1
s_cbranch_scc1 L_cfg5_1
s_cmp_eq_u32 s36, 2
s_cbranch_scc1 L_cfg5_2
s_branch L_cfg5_3
L_cfg5_0:
s_mov_b32 s88, 9451520
v_writelane_b32 v238, s88, 63
s_mov_b32 s88, 805318656
v_writelane_b32 v238, s88, 31
s_mov_b32 s88, 805306880
v_writelane_b32 v238, s88, 32
s_mov_b32 s88, 805405312
v_writelane_b32 v238, s88, 33
s_mov_b32 s88, 805343360
v_writelane_b32 v239, s88, 33
s_mov_b32 s88, 49419
v_writelane_b32 v239, s88, 40
s_mov_b32 s88, 2147089
v_writelane_b32 v239, s88, 41
s_mov_b32 s88, 25315607
v_writelane_b32 v239, s88, 42
s_mov_b32 s88, 1055
v_writelane_b32 v239, s88, 43
s_mov_b32 s83, 49419
s_mov_b32 s35, 11
s_mov_b32 s95, 544
s_branch L_cfgdone
L_cfg5_1:
s_mov_b32 s88, 9451520
v_writelane_b32 v238, s88, 63
s_mov_b32 s88, 805318656
v_writelane_b32 v238, s88, 31
s_mov_b32 s88, 805306880
v_writelane_b32 v238, s88, 32
s_mov_b32 s88, 805405312
v_writelane_b32 v238, s88, 33
s_mov_b32 s88, 805343360
v_writelane_b32 v239, s88, 33
s_mov_b32 s88, 4268299
v_writelane_b32 v239, s88, 40
s_mov_b32 s88, 6365969
v_writelane_b32 v239, s88, 41
s_mov_b32 s88, 37812503
v_writelane_b32 v239, s88, 42
s_mov_b32 s88, 1055
v_writelane_b32 v239, s88, 43
s_mov_b32 s83, 4268299
s_mov_b32 s35, 11
s_mov_b32 s95, 544
s_branch L_cfgdone
L_cfg5_2:
s_mov_b32 s88, 536920064
v_writelane_b32 v238, s88, 3
s_mov_b32 s88, 536945152
v_writelane_b32 v238, s88, 4
s_mov_b32 s88, 536932480
v_writelane_b32 v238, s88, 6
s_mov_b32 s88, 536957568
v_writelane_b32 v238, s88, 7
s_mov_b32 s88, 536945408
v_writelane_b32 v238, s88, 11
s_mov_b32 s88, 536995584
v_writelane_b32 v238, s88, 12
s_mov_b32 s88, 536932736
v_writelane_b32 v238, s88, 13
s_mov_b32 s88, 536982912
v_writelane_b32 v238, s88, 14
s_mov_b32 s88, 805368960
v_writelane_b32 v238, s88, 17
s_mov_b32 s88, 805393664
v_writelane_b32 v238, s88, 18
s_mov_b32 s88, 805406208
v_writelane_b32 v238, s88, 19
s_mov_b32 s88, 805431168
v_writelane_b32 v238, s88, 20
s_mov_b32 s88, 805368576
v_writelane_b32 v238, s88, 31
s_mov_b32 s88, 805355776
v_writelane_b32 v238, s88, 32
s_mov_b32 s88, 805417344
v_writelane_b32 v238, s88, 33
s_mov_b32 s88, 536970240
v_writelane_b32 v239, s88, 5
s_mov_b32 s88, 536995328
v_writelane_b32 v239, s88, 6
s_mov_b32 s88, 536982656
v_writelane_b32 v239, s88, 8
s_mov_b32 s88, 537007744
v_writelane_b32 v239, s88, 9
s_mov_b32 s88, 536920320
v_writelane_b32 v239, s88, 11
s_mov_b32 s88, 536970496
v_writelane_b32 v239, s88, 12
s_mov_b32 s88, 536957824
v_writelane_b32 v239, s88, 14
s_mov_b32 s88, 537008000
v_writelane_b32 v239, s88, 15
s_mov_b32 s88, 805356544
v_writelane_b32 v239, s88, 17
s_mov_b32 s88, 805381504
v_writelane_b32 v239, s88, 18
s_mov_b32 s88, 805418624
v_writelane_b32 v239, s88, 20
s_mov_b32 s88, 805443328
v_writelane_b32 v239, s88, 21
s_mov_b32 s88, 805393280
v_writelane_b32 v239, s88, 33
s_mov_b32 s88, 8487179
v_writelane_b32 v239, s88, 40
s_mov_b32 s88, 10584849
v_writelane_b32 v239, s88, 41
s_mov_b32 s88, 19
v_writelane_b32 v239, s88, 42
s_mov_b32 s88, 1055
v_writelane_b32 v239, s88, 43
s_mov_b32 s83, 8487179
s_mov_b32 s35, 11
s_mov_b32 s95, 512
s_branch L_cfgdone
L_cfg5_3:
s_mov_b32 s88, 536920064
v_writelane_b32 v238, s88, 3
s_mov_b32 s88, 536945152
v_writelane_b32 v238, s88, 4
s_mov_b32 s88, 536932480
v_writelane_b32 v238, s88, 6
s_mov_b32 s88, 536957568
v_writelane_b32 v238, s88, 7
s_mov_b32 s88, 536945408
v_writelane_b32 v238, s88, 11
s_mov_b32 s88, 536995584
v_writelane_b32 v238, s88, 12
s_mov_b32 s88, 536932736
v_writelane_b32 v238, s88, 13
s_mov_b32 s88, 536982912
v_writelane_b32 v238, s88, 14
s_mov_b32 s88, 805368960
v_writelane_b32 v238, s88, 17
s_mov_b32 s88, 805393664
v_writelane_b32 v238, s88, 18
s_mov_b32 s88, 805406208
v_writelane_b32 v238, s88, 19
s_mov_b32 s88, 805431168
v_writelane_b32 v238, s88, 20
s_mov_b32 s88, 805368576
v_writelane_b32 v238, s88, 31
s_mov_b32 s88, 805355776
v_writelane_b32 v238, s88, 32
s_mov_b32 s88, 805417344
v_writelane_b32 v238, s88, 33
s_mov_b32 s88, 536970240
v_writelane_b32 v239, s88, 5
s_mov_b32 s88, 536995328
v_writelane_b32 v239, s88, 6
s_mov_b32 s88, 536982656
v_writelane_b32 v239, s88, 8
s_mov_b32 s88, 537007744
v_writelane_b32 v239, s88, 9
s_mov_b32 s88, 536920320
v_writelane_b32 v239, s88, 11
s_mov_b32 s88, 536970496
v_writelane_b32 v239, s88, 12
s_mov_b32 s88, 536957824
v_writelane_b32 v239, s88, 14
s_mov_b32 s88, 537008000
v_writelane_b32 v239, s88, 15
s_mov_b32 s88, 805356544
v_writelane_b32 v239, s88, 17
s_mov_b32 s88, 805381504
v_writelane_b32 v239, s88, 18
s_mov_b32 s88, 805418624
v_writelane_b32 v239, s88, 20
s_mov_b32 s88, 805443328
v_writelane_b32 v239, s88, 21
s_mov_b32 s88, 805393280
v_writelane_b32 v239, s88, 33
s_mov_b32 s88, 12706059
v_writelane_b32 v239, s88, 40
s_mov_b32 s88, 14803729
v_writelane_b32 v239, s88, 41
s_mov_b32 s88, 21
v_writelane_b32 v239, s88, 42
s_mov_b32 s88, 1055
v_writelane_b32 v239, s88, 43
s_mov_b32 s83, 12706059
s_mov_b32 s35, 11
s_mov_b32 s95, 512
s_branch L_cfgdone
L_cfg6:
s_cmp_eq_u32 s36, 0
s_cbranch_scc1 L_cfg6_0
s_cmp_eq_u32 s36, 1
s_cbranch_scc1 L_cfg6_1
s_cmp_eq_u32 s36, 2
s_cbranch_scc1 L_cfg6_2
s_branch L_cfg6_3
L_cfg6_0:
s_mov_b32 s88, 9451520
v_writelane_b32 v238, s88, 63
s_mov_b32 s88, 805318656
v_writelane_b32 v238, s88, 31
s_mov_b32 s88, 805306880
v_writelane_b32 v238, s88, 32
s_mov_b32 s88, 805405312
v_writelane_b32 v238, s88, 33
s_mov_b32 s88, 805343360
v_writelane_b32 v239, s88, 33
s_mov_b32 s88, 49421
v_writelane_b32 v239, s88, 40
s_mov_b32 s88, 2147091
v_writelane_b32 v239, s88, 41
s_mov_b32 s88, 25315611
v_writelane_b32 v239, s88, 42
s_mov_b32 s88, 1055
v_writelane_b32 v239, s88, 43
s_mov_b32 s83, 49421
s_mov_b32 s35, 13
s_mov_b32 s95, 544
s_branch L_cfgdone
L_cfg6_1:
s_mov_b32 s88, 9451520
v_writelane_b32 v238, s88, 63
s_mov_b32 s88, 805318656
v_writelane_b32 v238, s88, 31
s_mov_b32 s88, 805306880
v_writelane_b32 v238, s88, 32
s_mov_b32 s88, 805405312
v_writelane_b32 v238, s88, 33
s_mov_b32 s88, 805343360
v_writelane_b32 v239, s88, 33
s_mov_b32 s88, 4268301
v_writelane_b32 v239, s88, 40
s_mov_b32 s88, 6365971
v_writelane_b32 v239, s88, 41
s_mov_b32 s88, 37812507
v_writelane_b32 v239, s88, 42
s_mov_b32 s88, 1055
v_writelane_b32 v239, s88, 43
s_mov_b32 s83, 4268301
s_mov_b32 s35, 13
s_mov_b32 s95, 544
s_branch L_cfgdone
L_cfg6_2:
s_mov_b32 s88, 536920064
v_writelane_b32 v238, s88, 4
s_mov_b32 s88, 536945152
v_writelane_b32 v238, s88, 5
s_mov_b32 s88, 536970240
v_writelane_b32 v238, s88, 6
s_mov_b32 s88, 536995328
v_writelane_b32 v238, s88, 7
s_mov_b32 s88, 536945408
v_writelane_b32 v238, s88, 13
s_mov_b32 s88, 536995584
v_writelane_b32 v238, s88, 14
s_mov_b32 s88, 536932736
v_writelane_b32 v238, s88, 15
s_mov_b32 s88, 536982912
v_writelane_b32 v238, s88, 16
s_mov_b32 s88, 805381504
v_writelane_b32 v238, s88, 20
s_mov_b32 s88, 805393664
v_writelane_b32 v238, s88, 21
s_mov_b32 s88, 805406208
v_writelane_b32 v238, s88, 22
s_mov_b32 s88, 805418624
v_writelane_b32 v238, s88, 23
s_mov_b32 s88, 805368576
v_writelane_b32 v238, s88, 31
s_mov_b32 s88, 805355776
v_writelane_b32 v238, s88, 32
s_mov_b32 s88, 805417344
v_writelane_b32 v238, s88, 33
s_mov_b32 s88, 536932480
v_writelane_b32 v239, s88, 8
s_mov_b32 s88, 536957568
v_writelane_b32 v239, s88, 9
s_mov_b32 s88, 536982656
v_writelane_b32 v239, s88, 10
s_mov_b32 s88, 537007744
v_writelane_b32 v239, s88, 11
s_mov_b32 s88, 536920320
v_writelane_b32 v239, s88, 13
s_mov_b32 s88, 536970496
v_writelane_b32 v239, s88, 14
s_mov_b32 s88, 536957824
v_writelane_b32 v239, s88, 16
s_mov_b32 s88, 537008000
v_writelane_b32 v239, s88, 17
s_mov_b32 s88, 805356544
v_writelane_b32 v239, s88, 19
s_mov_b32 s88, 805368960
v_writelane_b32 v239, s88, 20
s_mov_b32 s88, 805431168
v_writelane_b32 v239, s88, 24
s_mov_b32 s88, 805443328
v_writelane_b32 v239, s88, 25
s_mov_b32 s88, 805393280
v_writelane_b32 v239, s88, 33
s_mov_b32 s88, 8487181
v_writelane_b32 v239, s88, 40
s_mov_b32 s88, 10584851
v_writelane_b32 v239, s88, 41
s_mov_b32 s88, 23
v_writelane_b32 v239, s88, 42
s_mov_b32 s83, 8487181
s_mov_b32 s35, 13
s_mov_b32 s95, 0
s_branch L_cfgdone
L_cfg6_3:
s_mov_b32 s88, 536920064
v_writelane_b32 v238, s88, 4
s_mov_b32 s88, 536945152
v_writelane_b32 v238, s88, 5
s_mov_b32 s88, 536970240
v_writelane_b32 v238, s88, 6
s_mov_b32 s88, 536995328
v_writelane_b32 v238, s88, 7
s_mov_b32 s88, 536945408
v_writelane_b32 v238, s88, 13
s_mov_b32 s88, 536995584
v_writelane_b32 v238, s88, 14
s_mov_b32 s88, 536932736
v_writelane_b32 v238, s88, 15
s_mov_b32 s88, 536982912
v_writelane_b32 v238, s88, 16
s_mov_b32 s88, 805381504
v_writelane_b32 v238, s88, 20
s_mov_b32 s88, 805393664
v_writelane_b32 v238, s88, 21
s_mov_b32 s88, 805406208
v_writelane_b32 v238, s88, 22
s_mov_b32 s88, 805418624
v_writelane_b32 v238, s88, 23
s_mov_b32 s88, 805368576
v_writelane_b32 v238, s88, 31
s_mov_b32 s88, 805355776
v_writelane_b32 v238, s88, 32
s_mov_b32 s88, 805417344
v_writelane_b32 v238, s88, 33
s_mov_b32 s88, 536932480
v_writelane_b32 v239, s88, 8
s_mov_b32 s88, 536957568
v_writelane_b32 v239, s88, 9
s_mov_b32 s88, 536982656
v_writelane_b32 v239, s88, 10
s_mov_b32 s88, 537007744
v_writelane_b32 v239, s88, 11
s_mov_b32 s88, 536920320
v_writelane_b32 v239, s88, 13
s_mov_b32 s88, 536970496
v_writelane_b32 v239, s88, 14
s_mov_b32 s88, 536957824
v_writelane_b32 v239, s88, 16
s_mov_b32 s88, 537008000
v_writelane_b32 v239, s88, 17
s_mov_b32 s88, 805356544
v_writelane_b32 v239, s88, 19
s_mov_b32 s88, 805368960
v_writelane_b32 v239, s88, 20
s_mov_b32 s88, 805431168
v_writelane_b32 v239, s88, 24
s_mov_b32 s88, 805443328
v_writelane_b32 v239, s88, 25
s_mov_b32 s88, 805393280
v_writelane_b32 v239, s88, 33
s_mov_b32 s88, 12706061
v_writelane_b32 v239, s88, 40
s_mov_b32 s88, 14803731
v_writelane_b32 v239, s88, 41
s_mov_b32 s88, 25
v_writelane_b32 v239, s88, 42
s_mov_b32 s83, 12706061
s_mov_b32 s35, 13
s_mov_b32 s95, 0
s_branch L_cfgdone
L_cfg7:
s_cmp_eq_u32 s36, 0
s_cbranch_scc1 L_cfg7_0
s_cmp_eq_u32 s36, 1
s_cbranch_scc1 L_cfg7_1
s_cmp_eq_u32 s36, 2
s_cbranch_scc1 L_cfg7_2
s_branch L_cfg7_3
L_cfg7_0:
s_mov_b32 s88, 9451520
v_writelane_b32 v238, s88, 63
s_mov_b32 s88, 805318656
v_writelane_b32 v238, s88, 31
s_mov_b32 s88, 805306880
v_writelane_b32 v238, s88, 32
s_mov_b32 s88, 805405312
v_writelane_b32 v238, s88, 33
s_mov_b32 s88, 805343360
v_writelane_b32 v239, s88, 33
s_mov_b32 s88, 49423
v_writelane_b32 v239, s88, 40
s_mov_b32 s88, 2147095
v_writelane_b32 v239, s88, 41
s_mov_b32 s88, 31
v_writelane_b32 v239, s88, 42
s_mov_b32 s83, 49423
s_mov_b32 s35, 15
s_mov_b32 s95, 544
s_branch L_cfgdone
L_cfg7_1:
s_mov_b32 s88, 9451520
v_writelane_b32 v238, s88, 63
s_mov_b32 s88, 805318656
v_writelane_b32 v238, s88, 31
s_mov_b32 s88, 805306880
v_writelane_b32 v238, s88, 32
s_mov_b32 s88, 805405312
v_writelane_b32 v238, s88, 33
s_mov_b32 s88, 805343360
v_writelane_b32 v239, s88, 33
s_mov_b32 s88, 4268303
v_writelane_b32 v239, s88, 40
s_mov_b32 s88, 6365975
v_writelane_b32 v239, s88, 41
s_mov_b32 s88, 37812511
v_writelane_b32 v239, s88, 42
s_mov_b32 s88, 33
v_writelane_b32 v239, s88, 43
s_mov_b32 s83, 4268303
s_mov_b32 s35, 15
s_mov_b32 s95, 544
s_branch L_cfgdone
L_cfg7_2:
s_mov_b32 s88, 536920064
v_writelane_b32 v238, s88, 5
s_mov_b32 s88, 536945152
v_writelane_b32 v238, s88, 6
s_mov_b32 s88, 536970240
v_writelane_b32 v238, s88, 7
s_mov_b32 s88, 536995328
v_writelane_b32 v238, s88, 8
s_mov_b32 s88, 536970496
v_writelane_b32 v238, s88, 16
s_mov_b32 s88, 536995584
v_writelane_b32 v238, s88, 17
s_mov_b32 s88, 536932736
v_writelane_b32 v238, s88, 18
s_mov_b32 s88, 536957824
v_writelane_b32 v238, s88, 19
s_mov_b32 s88, 805381504
v_writelane_b32 v238, s88, 24
s_mov_b32 s88, 805393664
v_writelane_b32 v238, s88, 25
s_mov_b32 s88, 805406208
v_writelane_b32 v238, s88, 26
s_mov_b32 s88, 805418624
v_writelane_b32 v238, s88, 27
s_mov_b32 s88, 805368576
v_writelane_b32 v238, s88, 31
s_mov_b32 s88, 805355776
v_writelane_b32 v238, s88, 32
s_mov_b32 s88, 805417344
v_writelane_b32 v238, s88, 33
s_mov_b32 s88, 536932480
v_writelane_b32 v239, s88, 10
s_mov_b32 s88, 536957568
v_writelane_b32 v239, s88, 11
s_mov_b32 s88, 536982656
v_writelane_b32 v239, s88, 12
s_mov_b32 s88, 537007744
v_writelane_b32 v239, s88, 13
s_mov_b32 s88, 536920320
v_writelane_b32 v239, s88, 15
s_mov_b32 s88, 536945408
v_writelane_b32 v239, s88, 16
s_mov_b32 s88, 536982912
v_writelane_b32 v239, s88, 20
s_mov_b32 s88, 537008000
v_writelane_b32 v239, s88, 21
s_mov_b32 s88, 805356544
v_writelane_b32 v239, s88, 23
s_mov_b32 s88, 805368960
v_writelane_b32 v239, s88, 24
s_mov_b32 s88, 805431168
v_writelane_b32 v239, s88, 28
s_mov_b32 s88, 805443328
v_writelane_b32 v239, s88, 29
s_mov_b32 s88, 805393280
v_writelane_b32 v239, s88, 33
s_mov_b32 s88, 8487183
v_writelane_b32 v239, s88, 40
s_mov_b32 s88, 10584855
v_writelane_b32 v239, s88, 41
s_mov_b32 s88, 27
v_writelane_b32 v239, s88, 42
s_mov_b32 s83, 8487183
s_mov_b32 s35, 15
s_mov_b32 s95, 0
s_branch L_cfgdone
L_cfg7_3:
s_mov_b32 s88, 536920064
v_writelane_b32 v238, s88, 5
s_mov_b32 s88, 536945152
v_writelane_b32 v238, s88, 6
s_mov_b32 s88, 536970240
v_writelane_b32 v238, s88, 7
s_mov_b32 s88, 536995328
v_writelane_b32 v238, s88, 8
s_mov_b32 s88, 536970496
v_writelane_b32 v238, s88, 16
s_mov_b32 s88, 536995584
v_writelane_b32 v238, s88, 17
s_mov_b32 s88, 536932736
v_writelane_b32 v238, s88, 18
s_mov_b32 s88, 536957824
v_writelane_b32 v238, s88, 19
s_mov_b32 s88, 805381504
v_writelane_b32 v238, s88, 24
s_mov_b32 s88, 805393664
v_writelane_b32 v238, s88, 25
s_mov_b32 s88, 805406208
v_writelane_b32 v238, s88, 26
s_mov_b32 s88, 805418624
v_writelane_b32 v238, s88, 27
s_mov_b32 s88, 805368576
v_writelane_b32 v238, s88, 31
s_mov_b32 s88, 805355776
v_writelane_b32 v238, s88, 32
s_mov_b32 s88, 805417344
v_writelane_b32 v238, s88, 33
s_mov_b32 s88, 536932480
v_writelane_b32 v239, s88, 10
s_mov_b32 s88, 536957568
v_writelane_b32 v239, s88, 11
s_mov_b32 s88, 536982656
v_writelane_b32 v239, s88, 12
s_mov_b32 s88, 537007744
v_writelane_b32 v239, s88, 13
s_mov_b32 s88, 536920320
v_writelane_b32 v239, s88, 15
s_mov_b32 s88, 536945408
v_writelane_b32 v239, s88, 16
s_mov_b32 s88, 536982912
v_writelane_b32 v239, s88, 20
s_mov_b32 s88, 537008000
v_writelane_b32 v239, s88, 21
s_mov_b32 s88, 805356544
v_writelane_b32 v239, s88, 23
s_mov_b32 s88, 805368960
v_writelane_b32 v239, s88, 24
s_mov_b32 s88, 805431168
v_writelane_b32 v239, s88, 28
s_mov_b32 s88, 805443328
v_writelane_b32 v239, s88, 29
s_mov_b32 s88, 805393280
v_writelane_b32 v239, s88, 33
s_mov_b32 s88, 12706063
v_writelane_b32 v239, s88, 40
s_mov_b32 s88, 14803735
v_writelane_b32 v239, s88, 41
s_mov_b32 s88, 29
v_writelane_b32 v239, s88, 42
s_mov_b32 s83, 12706063
s_mov_b32 s35, 15
s_mov_b32 s95, 0
s_branch L_cfgdone
L_cfgdone:
s_mov_b32 s82, 40
s_lshl_b32 s89, s36, 3
s_mov_b32 s92, 202309635
s_cmp_lt_u32 s37, 2
s_cselect_b32 s92, 252445440, s92
s_lshr_b32 s92, s92, s89
s_and_b32 s92, s92, 0xff
s_lshl_b32 s92, s92, 12
s_mov_b32 s93, 454367241
s_cmp_lt_u32 s37, 2
s_cselect_b32 s93, 454170630, s93
s_lshr_b32 s93, s93, s89
s_and_b32 s93, s93, 0xff
s_lshl_b32 s93, s93, 12
s_mov_b32 s76, 504505350
s_cmp_lt_u32 s37, 2
s_cselect_b32 s76, 504701961, s76
s_lshr_b32 s76, s76, s89
s_and_b32 s76, s76, 0xff
s_lshl_b32 s76, s76, 12
s_mov_b32 s97, 103027230
s_cmp_lt_u32 s37, 2
s_cselect_b32 s97, 153359646, s97
s_lshr_b32 s97, s97, s89
s_and_b32 s97, s97, 0xff
s_lshl_b32 s97, s97, 12
s_mov_b32 s98, 50335500
s_cmp_lt_u32 s37, 2
s_cselect_b32 s98, 199695, s98
s_lshr_b32 s98, s98, s89
s_and_b32 s98, s98, 0xff
s_lshl_b32 s98, s98, 12
s_mov_b32 s94, 33948672
s_cmp_lt_u32 s37, 2
s_cselect_b32 s94, 33948672, s94
s_lshr_b32 s94, s94, s89
s_and_b32 s94, s94, 0xff
s_lshl_b32 s94, s94, 6
s_mov_b32 s34, 63
s_add_u32 m0, s46, 7040
s_add_u32 s43, s45, 6144
buffer_load_dwordx4 v234, s[12:15], s43 offen offset:128 nt lds
buffer_load_dwordx4 v235, s[12:15], s43 offen offset:3200 nt lds
s_waitcnt vmcnt(13)
v_mul_u32_u24 v236, 384, v236
v_mul_u32_u24 v237, 384, v237
v_bfe_u32 v252, v249, 3, 1
v_mul_u32_u24 v253, 3008, v252
v_sub_u32 v253, 3072, v253
v_add_u32 v236, v236, v253
v_add_u32 v237, v237, v253
v_and_b32 v253, 7, v249
v_lshlrev_b32 v253, 3, v253
v_lshl_add_u32 v253, v252, 2, v253
v_lshl_add_u32 v253, v251, 7, v253
s_lshl_b32 s47, s36, 9
s_add_u32 s47, s47, 160768
v_add_u32 v253, s47, v253
ds_write_b32 v253, v236
ds_write_b32 v253, v237 offset:64
v_bfe_u32 v252, v249, 4, 1
v_bfe_u32 v254, v249, 1, 3
v_lshl_add_u32 v252, v252, 4, v254
v_mul_u32_u24 v252, 384, v252
v_add_u32 v252, 3072, v252
v_and_b32 v254, 1, v249
v_lshl_add_u32 v252, v254, 6, v252
v_and_b32 v254, 31, v249
v_lshlrev_b32 v254, 2, v254
v_add_u32 v254, 162816, v254
ds_write_b32 v254, v252
v_lshlrev_b32 v240, 16, v240
v_mul_f32 v240, 0xbfb8aa3b, v240
v_exp_f32 v240, v240
s_nop 0
v_add_f32 v240, 1.0, v240
v_rcp_f32 v240, v240
s_nop 0
v_cvt_pk_bf16_f32 v240, v240, v240
v_and_b32 v240, 0xffff0000, v240
v_sub_f32 v255, 1.0, v240
v_cvt_pk_bf16_f32 v255, v255, v255
v_and_b32 v255, 0xffff0000, v255
v_readfirstlane_b32 s54, v240
v_readfirstlane_b32 s55, v255
s_mov_b32 s84, 0
s_mov_b32 s85, s45
v_add_u32 v241, s40, v234
s_mov_b32 s38, -12288
s_cmp_lt_u32 s36, 2
s_cselect_b32 s38, 12288, s38
s_mul_i32 s77, s39, 49152
s_add_u32 s77, s77, 49152
s_add_u32 m0, s46, 7936
s_add_u32 s43, s45, 6144
buffer_load_dwordx4 v234, s[12:15], s43 offen offset:256 nt lds
buffer_load_dwordx4 v235, s[12:15], s43 offen offset:3328 nt lds
s_waitcnt vmcnt(6)
s_waitcnt vmcnt(63) lgkmcnt(0)
s_barrier
ds_read_b128 v[0:3], v92 offset:0
ds_read_b128 v[4:7], v93 offset:0
ds_read_b128 v[8:11], v92 offset:1024
ds_read_b128 v[12:15], v93 offset:1024
ds_read_b128 v[16:19], v92 offset:2048
ds_read_b128 v[20:23], v93 offset:2048
ds_read_b128 v[96:99], v94 offset:0
ds_read_b128 v[100:103], v95 offset:0
ds_read_b128 v[104:107], v94 offset:1024
ds_read_b128 v[108:111], v95 offset:1024
ds_read_b128 v[112:115], v94 offset:2048
ds_read_b128 v[116:119], v95 offset:2048
ds_read_b128 v[120:123], v94 offset:6144
ds_read_b128 v[124:127], v95 offset:6144
ds_read_b128 v[160:163], v94 offset:7168
s_waitcnt lgkmcnt(14)
v_mfma_f32_16x16x32_bf16 v[48:51], v[82:85], v[0:3], 0
ds_read_b128 v[164:167], v95 offset:7168
v_mov_b32 v243, 0xff800000
v_mfma_f32_16x16x32_bf16 v[48:51], v[86:89], v[0:3], v[48:51]
ds_read_b128 v[168:171], v94 offset:8192
s_add_u32 s43, s44, 12288
v_mfma_f32_16x16x32_bf16 v[52:55], v[80:83], v[0:3], 0
ds_read_b128 v[172:175], v95 offset:8192
s_add_u32 m0, s44, 12288
v_mfma_f32_16x16x32_bf16 v[52:55], v[84:87], v[0:3], v[52:55]
buffer_load_dwordx4 v247, s[4:7], s43 offen offset:0  lds
s_waitcnt lgkmcnt(15)
v_mfma_f32_16x16x32_bf16 v[56:59], v[82:85], v[4:7], 0
s_add_u32 m0, s44, 13184
v_cvt_pk_bf16_f32 v48, v48, v49
v_cvt_pk_bf16_f32 v50, v50, v51
v_mfma_f32_16x16x32_bf16 v[56:59], v[86:89], v[4:7], v[56:59]
buffer_load_dwordx4 v247, s[4:7], s43 offen offset:128  lds
v_mfma_f32_16x16x32_bf16 v[60:63], v[80:83], v[4:7], 0
s_add_u32 m0, s44, 14080
v_cvt_pk_bf16_f32 v52, v52, v53
v_cvt_pk_bf16_f32 v54, v54, v55
v_mfma_f32_16x16x32_bf16 v[60:63], v[84:87], v[4:7], v[60:63]
buffer_load_dwordx4 v247, s[4:7], s43 offen offset:256  lds
v_mfma_f32_16x16x32_bf16 v[64:67], v[82:85], v[8:11], 0
v_accvgpr_write_b32 a96, v48
v_accvgpr_write_b32 a97, v50
v_mfma_f32_16x16x32_bf16 v[64:67], v[86:89], v[8:11], v[64:67]
v_accvgpr_write_b32 a98, v52
v_accvgpr_write_b32 a99, v54
v_mfma_f32_16x16x32_bf16 v[68:71], v[80:83], v[8:11], 0
v_cvt_pk_bf16_f32 v56, v56, v57
v_cvt_pk_bf16_f32 v58, v58, v59
v_mfma_f32_16x16x32_bf16 v[68:71], v[84:87], v[8:11], v[68:71]
v_cvt_pk_bf16_f32 v60, v60, v61
v_cvt_pk_bf16_f32 v62, v62, v63
s_waitcnt lgkmcnt(14)
v_mfma_f32_16x16x32_bf16 v[72:75], v[82:85], v[12:15], 0
v_accvgpr_write_b32 a100, v56
v_accvgpr_write_b32 a101, v58
v_mfma_f32_16x16x32_bf16 v[72:75], v[86:89], v[12:15], v[72:75]
v_accvgpr_write_b32 a102, v60
v_accvgpr_write_b32 a103, v62
v_mfma_f32_16x16x32_bf16 v[76:79], v[80:83], v[12:15], 0
v_cvt_pk_bf16_f32 v64, v64, v65
v_cvt_pk_bf16_f32 v66, v66, v67
v_mfma_f32_16x16x32_bf16 v[76:79], v[84:87], v[12:15], v[76:79]
s_add_u32 m0, s46, 49152
v_cvt_pk_bf16_f32 v68, v68, v69
v_cvt_pk_bf16_f32 v70, v70, v71
s_waitcnt lgkmcnt(13)
v_mfma_f32_16x16x32_bf16 v[48:51], v[82:85], v[16:19], 0
s_add_u32 s43, s45, 12288
v_accvgpr_write_b32 a104, v64
v_accvgpr_write_b32 a105, v66
v_mfma_f32_16x16x32_bf16 v[48:51], v[86:89], v[16:19], v[48:51]
buffer_load_dwordx4 v234, s[12:15], s43 offen offset:0 nt lds
v_mfma_f32_16x16x32_bf16 v[52:55], v[80:83], v[16:19], 0
buffer_load_dwordx4 v235, s[12:15], s43 offen offset:3072 nt lds
v_mfma_f32_16x16x32_bf16 v[52:55], v[84:87], v[16:19], v[52:55]
v_accvgpr_write_b32 a106, v68
v_accvgpr_write_b32 a107, v70
s_waitcnt lgkmcnt(12)
v_mfma_f32_16x16x32_bf16 v[56:59], v[82:85], v[20:23], 0
v_cvt_pk_bf16_f32 v72, v72, v73
v_cvt_pk_bf16_f32 v74, v74, v75
v_mfma_f32_16x16x32_bf16 v[56:59], v[86:89], v[20:23], v[56:59]
v_cvt_pk_bf16_f32 v76, v76, v77
v_cvt_pk_bf16_f32 v78, v78, v79
v_mfma_f32_16x16x32_bf16 v[60:63], v[80:83], v[20:23], 0
v_accvgpr_write_b32 a108, v72
v_accvgpr_write_b32 a109, v74
v_mfma_f32_16x16x32_bf16 v[60:63], v[84:87], v[20:23], v[60:63]
v_accvgpr_write_b32 a110, v76
v_accvgpr_write_b32 a111, v78
s_waitcnt lgkmcnt(11)
v_mfma_f32_16x16x32_bf16 v[128:131], v[96:99], a[96:99], 0
v_cvt_pk_bf16_f32 v48, v48, v49
v_cvt_pk_bf16_f32 v50, v50, v51
s_waitcnt lgkmcnt(10)
v_mfma_f32_16x16x32_bf16 v[128:131], v[100:103], a[100:103], v[128:131]
v_cvt_pk_bf16_f32 v52, v52, v53
v_cvt_pk_bf16_f32 v54, v54, v55
s_waitcnt lgkmcnt(9)
v_mfma_f32_16x16x32_bf16 v[128:131], v[104:107], a[104:107], v[128:131]
v_accvgpr_write_b32 a112, v48
v_accvgpr_write_b32 a113, v50
s_waitcnt lgkmcnt(8)
v_mfma_f32_16x16x32_bf16 v[128:131], v[108:111], a[108:111], v[128:131]
v_accvgpr_write_b32 a114, v52
v_accvgpr_write_b32 a115, v54
v_cvt_pk_bf16_f32 v56, v56, v57
v_cvt_pk_bf16_f32 v58, v58, v59
s_waitcnt lgkmcnt(7)
v_mfma_f32_16x16x32_bf16 v[128:131], v[112:115], a[112:115], v[128:131]
v_cvt_pk_bf16_f32 v60, v60, v61
v_cvt_pk_bf16_f32 v62, v62, v63
v_accvgpr_write_b32 a116, v56
v_accvgpr_write_b32 a117, v58
v_accvgpr_write_b32 a118, v60
v_accvgpr_write_b32 a119, v62
s_add_u32 m0, s46, 50048
s_add_u32 s43, s45, 12288
s_waitcnt lgkmcnt(6)
v_mfma_f32_16x16x32_bf16 v[128:131], v[116:119], a[116:119], v[128:131]
buffer_load_dwordx4 v234, s[12:15], s43 offen offset:128 nt lds
s_waitcnt lgkmcnt(5)
v_mfma_f32_16x16x32_bf16 v[144:147], v[120:123], a[96:99], 0
buffer_load_dwordx4 v235, s[12:15], s43 offen offset:3200 nt lds
s_waitcnt lgkmcnt(4)
v_mfma_f32_16x16x32_bf16 v[144:147], v[124:127], a[100:103], v[144:147]
s_add_u32 m0, s46, 50944
s_add_u32 s43, s45, 12288
s_waitcnt lgkmcnt(3)
v_mfma_f32_16x16x32_bf16 v[144:147], v[160:163], a[104:107], v[144:147]
buffer_load_dwordx4 v234, s[12:15], s43 offen offset:256 nt lds
s_waitcnt lgkmcnt(2)
v_mfma_f32_16x16x32_bf16 v[144:147], v[164:167], a[108:111], v[144:147]
buffer_load_dwordx4 v235, s[12:15], s43 offen offset:3328 nt lds
s_waitcnt lgkmcnt(1)
v_mfma_f32_16x16x32_bf16 v[144:147], v[168:171], a[112:115], v[144:147]
v_cndmask_b32 v128, v128, v243, s[56:57]
v_cndmask_b32 v129, v129, v243, s[58:59]
s_waitcnt lgkmcnt(0)
v_mfma_f32_16x16x32_bf16 v[144:147], v[172:175], a[116:119], v[144:147]
v_cndmask_b32 v130, v130, v243, s[60:61]
v_cndmask_b32 v131, v131, v243, s[62:63]
v_max3_f32 v90, v128, v129, v130
s_nop 4
v_cndmask_b32 v144, v144, v243, s[70:71]
v_cndmask_b32 v145, v145, v243, s[70:71]
v_cndmask_b32 v146, v146, v243, s[70:71]
v_cndmask_b32 v147, v147, v243, s[70:71]
v_max3_f32 v91, v131, v144, v145
v_max3_f32 v90, v90, v146, v147
v_max_f32 v90, v90, v91
v_mov_b32 v91, v90
s_nop 1
v_permlane16_swap_b32 v90, v91
v_max_f32 v90, v90, v91
v_mov_b32 v91, v90
s_nop 1
v_permlane32_swap_b32 v90, v91
v_max_f32 v90, v90, v91
v_sub_f32 v128, v128, v90
v_sub_f32 v129, v129, v90
v_sub_f32 v130, v130, v90
v_sub_f32 v131, v131, v90
v_sub_f32 v144, v144, v90
v_sub_f32 v145, v145, v90
v_sub_f32 v146, v146, v90
v_sub_f32 v147, v147, v90
v_sub_f32 v192, 0, v90
v_sub_f32 v193, 0, v90
v_sub_f32 v194, 0, v90
v_sub_f32 v195, 0, v90
v_exp_f32 v216, v128
v_exp_f32 v217, v129
v_exp_f32 v218, v130
v_exp_f32 v219, v131
v_add_f32 v212, v216, v217
v_cvt_pk_bf16_f32 v176, v216, v217
v_add_f32 v212, v212, v218
v_cvt_pk_bf16_f32 v177, v218, v219
v_add_f32 v212, v212, v219
s_waitcnt vmcnt(9)
ds_read_b128 v[24:27], v92 offset:6144
ds_read_b128 v[28:31], v93 offset:6144
ds_read_b128 v[32:35], v92 offset:7168
ds_read_b128 v[36:39], v93 offset:7168
ds_read_b128 v[40:43], v92 offset:8192
ds_read_b128 v[44:47], v93 offset:8192
s_add_u32 m0, s46, 55296
s_add_u32 s43, s45, 18432
buffer_load_dwordx4 v234, s[12:15], s43 offen offset:0 nt lds
buffer_load_dwordx4 v235, s[12:15], s43 offen offset:3072 nt lds
s_waitcnt lgkmcnt(5)
v_mfma_f32_16x16x32_bf16 v[48:51], v[82:85], v[24:27], 0
v_mfma_f32_16x16x32_bf16 v[48:51], v[86:89], v[24:27], v[48:51]
v_mfma_f32_16x16x32_bf16 v[52:55], v[80:83], v[24:27], 0
v_mfma_f32_16x16x32_bf16 v[52:55], v[84:87], v[24:27], v[52:55]
s_waitcnt lgkmcnt(4)
v_mfma_f32_16x16x32_bf16 v[56:59], v[82:85], v[28:31], 0
s_nop 3
v_cvt_pk_bf16_f32 v48, v48, v49
v_cvt_pk_bf16_f32 v50, v50, v51
v_mfma_f32_16x16x32_bf16 v[56:59], v[86:89], v[28:31], v[56:59]
v_accvgpr_write_b32 a120, v48
v_accvgpr_write_b32 a121, v50
v_mfma_f32_16x16x32_bf16 v[60:63], v[80:83], v[28:31], 0
v_cvt_pk_bf16_f32 v52, v52, v53
v_cvt_pk_bf16_f32 v54, v54, v55
v_mfma_f32_16x16x32_bf16 v[60:63], v[84:87], v[28:31], v[60:63]
v_accvgpr_write_b32 a122, v52
v_accvgpr_write_b32 a123, v54
s_waitcnt lgkmcnt(3)
v_mfma_f32_16x16x32_bf16 v[64:67], v[82:85], v[32:35], 0
v_cvt_pk_bf16_f32 v56, v56, v57
v_cvt_pk_bf16_f32 v58, v58, v59
v_mfma_f32_16x16x32_bf16 v[64:67], v[86:89], v[32:35], v[64:67]
v_accvgpr_write_b32 a124, v56
v_accvgpr_write_b32 a125, v58
v_mfma_f32_16x16x32_bf16 v[68:71], v[80:83], v[32:35], 0
v_cvt_pk_bf16_f32 v60, v60, v61
v_cvt_pk_bf16_f32 v62, v62, v63
v_mfma_f32_16x16x32_bf16 v[68:71], v[84:87], v[32:35], v[68:71]
v_accvgpr_write_b32 a126, v60
v_accvgpr_write_b32 a127, v62
s_waitcnt lgkmcnt(2)
v_mfma_f32_16x16x32_bf16 v[72:75], v[82:85], v[36:39], 0
v_cvt_pk_bf16_f32 v64, v64, v65
v_cvt_pk_bf16_f32 v66, v66, v67
v_mfma_f32_16x16x32_bf16 v[72:75], v[86:89], v[36:39], v[72:75]
s_add_u32 m0, s46, 56192
v_accvgpr_write_b32 a128, v64
v_accvgpr_write_b32 a129, v66
v_mfma_f32_16x16x32_bf16 v[76:79], v[80:83], v[36:39], 0
s_add_u32 s43, s45, 18432
v_cvt_pk_bf16_f32 v68, v68, v69
v_cvt_pk_bf16_f32 v70, v70, v71
v_mfma_f32_16x16x32_bf16 v[76:79], v[84:87], v[36:39], v[76:79]
buffer_load_dwordx4 v234, s[12:15], s43 offen offset:128 nt lds
s_waitcnt lgkmcnt(1)
v_mfma_f32_16x16x32_bf16 v[48:51], v[82:85], v[40:43], 0
buffer_load_dwordx4 v235, s[12:15], s43 offen offset:3200 nt lds
v_mfma_f32_16x16x32_bf16 v[48:51], v[86:89], v[40:43], v[48:51]
v_accvgpr_write_b32 a130, v68
v_accvgpr_write_b32 a131, v70
v_mfma_f32_16x16x32_bf16 v[52:55], v[80:83], v[40:43], 0
v_cvt_pk_bf16_f32 v72, v72, v73
v_cvt_pk_bf16_f32 v74, v74, v75
v_mfma_f32_16x16x32_bf16 v[52:55], v[84:87], v[40:43], v[52:55]
v_cvt_pk_bf16_f32 v76, v76, v77
v_cvt_pk_bf16_f32 v78, v78, v79
s_waitcnt lgkmcnt(0)
v_mfma_f32_16x16x32_bf16 v[56:59], v[82:85], v[44:47], 0
v_accvgpr_write_b32 a132, v72
v_accvgpr_write_b32 a133, v74
v_mfma_f32_16x16x32_bf16 v[56:59], v[86:89], v[44:47], v[56:59]
v_accvgpr_write_b32 a134, v76
v_accvgpr_write_b32 a135, v78
v_mfma_f32_16x16x32_bf16 v[60:63], v[80:83], v[44:47], 0
v_cvt_pk_bf16_f32 v48, v48, v49
v_cvt_pk_bf16_f32 v50, v50, v51
v_mfma_f32_16x16x32_bf16 v[60:63], v[84:87], v[44:47], v[60:63]
v_cvt_pk_bf16_f32 v52, v52, v53
v_cvt_pk_bf16_f32 v54, v54, v55
v_mfma_f32_16x16x32_bf16 v[132:135], v[96:99], a[120:123], 0
v_accvgpr_write_b32 a136, v48
v_accvgpr_write_b32 a137, v50
v_mfma_f32_16x16x32_bf16 v[132:135], v[100:103], a[124:127], v[132:135]
v_accvgpr_write_b32 a138, v52
v_accvgpr_write_b32 a139, v54
v_mfma_f32_16x16x32_bf16 v[132:135], v[104:107], a[128:131], v[132:135]
v_cvt_pk_bf16_f32 v56, v56, v57
v_cvt_pk_bf16_f32 v58, v58, v59
v_mfma_f32_16x16x32_bf16 v[132:135], v[108:111], a[132:135], v[132:135]
v_cvt_pk_bf16_f32 v60, v60, v61
v_cvt_pk_bf16_f32 v62, v62, v63
v_mfma_f32_16x16x32_bf16 v[132:135], v[112:115], a[136:139], v[132:135]
v_accvgpr_write_b32 a140, v56
s_add_u32 m0, s46, 57088
s_add_u32 s43, s45, 18432
v_accvgpr_write_b32 a141, v58
buffer_load_dwordx4 v234, s[12:15], s43 offen offset:256 nt lds
buffer_load_dwordx4 v235, s[12:15], s43 offen offset:3328 nt lds
v_accvgpr_write_b32 a142, v60
v_accvgpr_write_b32 a143, v62
s_nop 1
v_mfma_f32_16x16x32_bf16 v[132:135], v[116:119], a[140:143], v[132:135]
v_mfma_f32_16x16x32_bf16 v[148:151], v[120:123], a[120:123], 0
v_mfma_f32_16x16x32_bf16 v[148:151], v[124:127], a[124:127], v[148:151]
v_mfma_f32_16x16x32_bf16 v[148:151], v[160:163], a[128:131], v[148:151]
s_nop 4
v_max3_f32 v90, v132, v133, v134
v_mfma_f32_16x16x32_bf16 v[148:151], v[164:167], a[132:135], v[148:151]
v_mfma_f32_16x16x32_bf16 v[148:151], v[168:171], a[136:139], v[148:151]
v_mfma_f32_16x16x32_bf16 v[148:151], v[172:175], a[140:143], v[148:151]
s_nop 7
v_cndmask_b32 v148, v148, v243, s[56:57]
v_cndmask_b32 v149, v149, v243, s[58:59]
v_cndmask_b32 v150, v150, v243, s[60:61]
v_cndmask_b32 v151, v151, v243, s[62:63]
v_max3_f32 v91, v135, v148, v149
v_max3_f32 v90, v90, v150, v151
s_mov_b32 s56, 0x000f0000
v_max_f32 v90, v90, v91
s_mov_b32 s57, 0x0fff00ff
v_mov_b32 v91, v90
s_mov_b32 s58, 0x001f0001
s_mov_b32 s59, 0x1fff01ff
s_mov_b32 s60, 0x003f0003
s_mov_b32 s61, 0x3fff03ff
s_mov_b32 s62, 0x007f0007
s_mov_b32 s63, 0x7fff07ff
v_permlane16_swap_b32 v90, v91
v_max_f32 v90, v90, v91
v_mov_b32 v91, v90
s_nop 1
v_permlane32_swap_b32 v90, v91
v_max_f32 v90, v90, v91
v_sub_f32 v132, v132, v90
v_sub_f32 v133, v133, v90
v_sub_f32 v134, v134, v90
v_sub_f32 v135, v135, v90
v_sub_f32 v148, v148, v90
v_sub_f32 v149, v149, v90
v_sub_f32 v150, v150, v90
v_sub_f32 v151, v151, v90
v_sub_f32 v196, 0, v90
v_sub_f32 v197, 0, v90
v_sub_f32 v198, 0, v90
v_sub_f32 v199, 0, v90
v_exp_f32 v216, v132
v_exp_f32 v217, v133
v_exp_f32 v218, v134
v_exp_f32 v219, v135
v_add_f32 v213, v216, v217
v_cvt_pk_bf16_f32 v180, v216, v217
v_add_f32 v213, v213, v218
v_cvt_pk_bf16_f32 v181, v218, v219
v_add_f32 v213, v213, v219
s_add_u32 s79, s40, 49152
s_cmp_eq_u32 s37, 0
s_cselect_b32 s79, s79, 0x30000
s_cmp_lt_u32 s36, 2
s_cselect_b32 s79, s40, s79
s_cselect_b32 s47, 12288, 0
s_cselect_b64 s[4:5], s[24:25], s[28:29]
s_cselect_b64 s[8:9], s[26:27], s[28:29]
s_movk_i32 s86, 1280
s_cselect_b32 s86, 2048, s86
s_movk_i32 s88, 1024
s_cselect_b32 s88, 2048, s88
s_movk_i32 s89, 1408
s_cselect_b32 s89, 2048, s89
v_add_u32 v244, s86, v233
v_add_u32 v246, s88, v233
v_add_u32 v236, s89, v233
ds_read_b64 v[244:245], v244
ds_read_b64 v[246:247], v246
ds_read_b64 v[236:237], v236
v_bfe_u32 v225, v249, 1, 1
v_bfe_u32 v224, v249, 4, 1
v_lshl_add_u32 v225, v224, 2, v225
v_lshrrev_b32 v224, 5, v249
v_lshl_add_u32 v225, v224, 1, v225
v_mul_u32_u24 v225, 416, v225
v_and_b32 v224, 1, v249
v_lshl_add_u32 v225, v224, 6, v225
v_and_b32 v224, 12, v249
v_lshl_add_u32 v225, v224, 1, v225
v_lshrrev_b32 v224, 4, v249
v_mul_u32_u24 v224, 1536, v224
v_lshl_add_u32 v224, v249, 3, v224
s_waitcnt vmcnt(12)
s_waitcnt vmcnt(63) lgkmcnt(0)
s_barrier
ds_read_b128 a[192:195], v226 offset:12288
ds_read_b128 a[196:199], v227 offset:12288
ds_read_b128 a[200:203], v226 offset:13312
ds_read_b128 a[204:207], v227 offset:13312
ds_read_b128 a[208:211], v226 offset:14336
ds_read_b128 a[212:215], v227 offset:14336
ds_read_b128 a[216:219], v226 offset:18432
ds_read_b128 a[220:223], v227 offset:18432
ds_read_b128 a[224:227], v226 offset:19456
ds_read_b128 a[228:231], v227 offset:19456
ds_read_b128 a[232:235], v226 offset:20480
ds_read_b128 a[236:239], v227 offset:20480
v_xor_b32 v244, v232, v244
v_xor_b32 v245, v232, v245
v_xor_b32 v246, v232, v246
v_xor_b32 v247, v232, v247
v_xor_b32 v236, v232, v236
v_xor_b32 v237, v232, v237
s_waitcnt vmcnt(6)
ds_read_b128 v[0:3], v92 offset:49152
ds_read_b128 v[4:7], v93 offset:49152
ds_read_b128 v[8:11], v92 offset:50176
ds_read_b128 v[12:15], v93 offset:50176
s_mul_i32 s49, s47, 0
ds_read_b128 v[16:19], v92 offset:51200
s_add_u32 m0, s79, 24576
ds_read_b128 v[20:23], v93 offset:51200
buffer_load_dwordx4 v244, s[8:11], s49 offen offset:0  lds
buffer_load_dwordx4 v245, s[8:11], s49 offen offset:3072  lds
s_add_u32 m0, s79, 25472
s_nop 0
buffer_load_dwordx4 v244, s[8:11], s49 offen offset:128  lds
buffer_load_dwordx4 v245, s[8:11], s49 offen offset:3200  lds
s_waitcnt lgkmcnt(5)
v_mfma_f32_16x16x32_bf16 v[48:51], v[82:85], v[0:3], 0
s_add_u32 m0, s79, 26368
s_nop 0
buffer_load_dwordx4 v244, s[8:11], s49 offen offset:256  lds
v_mfma_f32_16x16x32_bf16 v[48:51], v[86:89], v[0:3], v[48:51]
buffer_load_dwordx4 v245, s[8:11], s49 offen offset:3328  lds
v_mfma_f32_16x16x32_bf16 v[52:55], v[80:83], v[0:3], 0
v_mfma_f32_16x16x32_bf16 v[52:55], v[84:87], v[0:3], v[52:55]
s_waitcnt lgkmcnt(4)
v_mfma_f32_16x16x32_bf16 v[56:59], v[82:85], v[4:7], 0
s_nop 2
v_cvt_pk_bf16_f32 v48, v48, v49
v_cvt_pk_bf16_f32 v50, v50, v51
v_mfma_f32_16x16x32_bf16 v[56:59], v[86:89], v[4:7], v[56:59]
v_accvgpr_write_b32 a144, v48
v_accvgpr_write_b32 a145, v50
v_mfma_f32_16x16x32_bf16 v[60:63], v[80:83], v[4:7], 0
v_cvt_pk_bf16_f32 v52, v52, v53
v_cvt_pk_bf16_f32 v54, v54, v55
v_mfma_f32_16x16x32_bf16 v[60:63], v[84:87], v[4:7], v[60:63]
v_accvgpr_write_b32 a146, v52
v_accvgpr_write_b32 a147, v54
s_waitcnt lgkmcnt(3)
v_mfma_f32_16x16x32_bf16 v[64:67], v[82:85], v[8:11], 0
v_cvt_pk_bf16_f32 v56, v56, v57
v_cvt_pk_bf16_f32 v58, v58, v59
v_mfma_f32_16x16x32_bf16 v[64:67], v[86:89], v[8:11], v[64:67]
v_accvgpr_write_b32 a148, v56
v_accvgpr_write_b32 a149, v58
v_mfma_f32_16x16x32_bf16 v[68:71], v[80:83], v[8:11], 0
v_cvt_pk_bf16_f32 v60, v60, v61
v_cvt_pk_bf16_f32 v62, v62, v63
v_mfma_f32_16x16x32_bf16 v[68:71], v[84:87], v[8:11], v[68:71]
v_accvgpr_write_b32 a150, v60
v_accvgpr_write_b32 a151, v62
s_waitcnt lgkmcnt(2)
v_mfma_f32_16x16x32_bf16 v[72:75], v[82:85], v[12:15], 0
v_cvt_pk_bf16_f32 v64, v64, v65
v_cvt_pk_bf16_f32 v66, v66, v67
v_mfma_f32_16x16x32_bf16 v[72:75], v[86:89], v[12:15], v[72:75]
v_accvgpr_write_b32 a152, v64
v_accvgpr_write_b32 a153, v66
v_mfma_f32_16x16x32_bf16 v[76:79], v[80:83], v[12:15], 0
v_cvt_pk_bf16_f32 v68, v68, v69
v_cvt_pk_bf16_f32 v70, v70, v71
v_mfma_f32_16x16x32_bf16 v[76:79], v[84:87], v[12:15], v[76:79]
v_accvgpr_write_b32 a154, v68
v_accvgpr_write_b32 a155, v70
s_waitcnt lgkmcnt(1)
v_mfma_f32_16x16x32_bf16 v[48:51], v[82:85], v[16:19], 0
v_cvt_pk_bf16_f32 v72, v72, v73
v_cvt_pk_bf16_f32 v74, v74, v75
v_mfma_f32_16x16x32_bf16 v[48:51], v[86:89], v[16:19], v[48:51]
v_accvgpr_write_b32 a156, v72
v_accvgpr_write_b32 a157, v74
v_mfma_f32_16x16x32_bf16 v[52:55], v[80:83], v[16:19], 0
v_cvt_pk_bf16_f32 v76, v76, v77
v_cvt_pk_bf16_f32 v78, v78, v79
v_mfma_f32_16x16x32_bf16 v[52:55], v[84:87], v[16:19], v[52:55]
v_accvgpr_write_b32 a158, v76
v_accvgpr_write_b32 a159, v78
s_waitcnt lgkmcnt(0)
v_mfma_f32_16x16x32_bf16 v[56:59], v[82:85], v[20:23], 0
v_cvt_pk_bf16_f32 v48, v48, v49
v_cvt_pk_bf16_f32 v50, v50, v51
v_mfma_f32_16x16x32_bf16 v[56:59], v[86:89], v[20:23], v[56:59]
v_accvgpr_write_b32 a160, v48
v_accvgpr_write_b32 a161, v50
v_mfma_f32_16x16x32_bf16 v[60:63], v[80:83], v[20:23], 0
v_cvt_pk_bf16_f32 v52, v52, v53
v_cvt_pk_bf16_f32 v54, v54, v55
v_mfma_f32_16x16x32_bf16 v[60:63], v[84:87], v[20:23], v[60:63]
v_accvgpr_write_b32 a162, v52
v_accvgpr_write_b32 a163, v54
v_mfma_f32_16x16x32_bf16 v[136:139], v[96:99], a[144:147], 0
v_cvt_pk_bf16_f32 v56, v56, v57
v_cvt_pk_bf16_f32 v58, v58, v59
v_mfma_f32_16x16x32_bf16 v[136:139], v[100:103], a[148:151], v[136:139]
v_accvgpr_write_b32 a164, v56
v_accvgpr_write_b32 a165, v58
v_mfma_f32_16x16x32_bf16 v[136:139], v[104:107], a[152:155], v[136:139]
s_mul_i32 s49, s47, 2
v_cvt_pk_bf16_f32 v60, v60, v61
v_cvt_pk_bf16_f32 v62, v62, v63
v_mfma_f32_16x16x32_bf16 v[136:139], v[108:111], a[156:159], v[136:139]
s_add_u32 m0, s79, 0
v_accvgpr_write_b32 a166, v60
v_accvgpr_write_b32 a167, v62
v_mfma_f32_16x16x32_bf16 v[136:139], v[112:115], a[160:163], v[136:139]
buffer_load_dwordx4 v246, s[4:7], s49 offen offset:0  lds
v_mfma_f32_16x16x32_bf16 v[136:139], v[116:119], a[164:167], v[136:139]
buffer_load_dwordx4 v247, s[4:7], s49 offen offset:3072  lds
v_mfma_f32_16x16x32_bf16 v[152:155], v[120:123], a[144:147], 0
s_add_u32 m0, s79, 896
s_nop 0
buffer_load_dwordx4 v246, s[4:7], s49 offen offset:128  lds
v_mfma_f32_16x16x32_bf16 v[152:155], v[124:127], a[148:151], v[152:155]
buffer_load_dwordx4 v247, s[4:7], s49 offen offset:3200  lds
v_mfma_f32_16x16x32_bf16 v[152:155], v[160:163], a[152:155], v[152:155]
s_add_u32 m0, s79, 1792
v_max3_f32 v90, v136, v137, v138
buffer_load_dwordx4 v246, s[4:7], s49 offen offset:256  lds
v_mfma_f32_16x16x32_bf16 v[152:155], v[164:167], a[156:159], v[152:155]
buffer_load_dwordx4 v247, s[4:7], s49 offen offset:3328  lds
v_mfma_f32_16x16x32_bf16 v[152:155], v[168:171], a[160:163], v[152:155]
v_mfma_f32_16x16x32_bf16 v[152:155], v[172:175], a[164:167], v[152:155]
s_nop 7
v_max3_f32 v91, v139, v152, v153
v_max3_f32 v90, v90, v154, v155
v_max_f32 v90, v90, v91
v_mov_b32 v91, v90
s_nop 1
v_permlane16_swap_b32 v90, v91
v_max_f32 v90, v90, v91
v_mov_b32 v91, v90
s_nop 1
v_permlane32_swap_b32 v90, v91
v_max_f32 v90, v90, v91
v_sub_f32 v136, v136, v90
v_sub_f32 v137, v137, v90
v_sub_f32 v138, v138, v90
v_sub_f32 v139, v139, v90
v_sub_f32 v152, v152, v90
v_sub_f32 v153, v153, v90
v_sub_f32 v154, v154, v90
v_sub_f32 v155, v155, v90
v_sub_f32 v200, 0, v90
v_sub_f32 v201, 0, v90
v_sub_f32 v202, 0, v90
v_sub_f32 v203, 0, v90
v_exp_f32 v216, v136
v_exp_f32 v217, v137
v_exp_f32 v218, v138
v_exp_f32 v219, v139
v_add_f32 v214, v216, v217
v_cvt_pk_bf16_f32 v184, v216, v217
v_add_f32 v214, v214, v218
v_cvt_pk_bf16_f32 v185, v218, v219
v_add_f32 v214, v214, v219
s_waitcnt vmcnt(16)
ds_read_b128 v[24:27], v92 offset:55296
ds_read_b128 v[28:31], v93 offset:55296
s_waitcnt lgkmcnt(1)
v_mfma_f32_16x16x32_bf16 v[48:51], v[82:85], v[24:27], 0
v_mfma_f32_16x16x32_bf16 v[48:51], v[86:89], v[24:27], v[48:51]
v_mfma_f32_16x16x32_bf16 v[52:55], v[80:83], v[24:27], 0
v_mfma_f32_16x16x32_bf16 v[52:55], v[84:87], v[24:27], v[52:55]
s_waitcnt lgkmcnt(0)
v_mfma_f32_16x16x32_bf16 v[56:59], v[82:85], v[28:31], 0
s_nop 3
v_cvt_pk_bf16_f32 v48, v48, v49
v_cvt_pk_bf16_f32 v50, v50, v51
v_mfma_f32_16x16x32_bf16 v[56:59], v[86:89], v[28:31], v[56:59]
v_accvgpr_write_b32 a168, v48
v_accvgpr_write_b32 a169, v50
v_mfma_f32_16x16x32_bf16 v[60:63], v[80:83], v[28:31], 0
v_cvt_pk_bf16_f32 v52, v52, v53
v_cvt_pk_bf16_f32 v54, v54, v55
v_mfma_f32_16x16x32_bf16 v[60:63], v[84:87], v[28:31], v[60:63]
v_accvgpr_write_b32 a170, v52
v_accvgpr_write_b32 a171, v54
v_cvt_pk_bf16_f32 v56, v56, v57
v_cvt_pk_bf16_f32 v58, v58, v59
v_accvgpr_write_b32 a172, v56
v_accvgpr_write_b32 a173, v58
s_nop 1
v_cvt_pk_bf16_f32 v60, v60, v61
v_cvt_pk_bf16_f32 v62, v62, v63
v_accvgpr_write_b32 a174, v60
v_accvgpr_write_b32 a175, v62
s_waitcnt vmcnt(14)
v_mfma_f32_16x16x32_bf16 v[140:143], v[96:99], a[168:171], 0
ds_read_b128 v[32:35], v92 offset:56320
v_mfma_f32_16x16x32_bf16 v[156:159], v[120:123], a[168:171], 0
ds_read_b128 v[36:39], v93 offset:56320
v_mfma_f32_16x16x32_bf16 v[140:143], v[100:103], a[172:175], v[140:143]
v_mfma_f32_16x16x32_bf16 v[156:159], v[124:127], a[172:175], v[156:159]
s_waitcnt lgkmcnt(1)
v_mfma_f32_16x16x32_bf16 v[64:67], v[82:85], v[32:35], 0
v_mfma_f32_16x16x32_bf16 v[64:67], v[86:89], v[32:35], v[64:67]
v_mfma_f32_16x16x32_bf16 v[68:71], v[80:83], v[32:35], 0
v_mfma_f32_16x16x32_bf16 v[68:71], v[84:87], v[32:35], v[68:71]
s_waitcnt lgkmcnt(0)
v_mfma_f32_16x16x32_bf16 v[72:75], v[82:85], v[36:39], 0
s_nop 3
v_cvt_pk_bf16_f32 v64, v64, v65
v_cvt_pk_bf16_f32 v66, v66, v67
v_mfma_f32_16x16x32_bf16 v[72:75], v[86:89], v[36:39], v[72:75]
v_accvgpr_write_b32 a176, v64
v_accvgpr_write_b32 a177, v66
v_mfma_f32_16x16x32_bf16 v[76:79], v[80:83], v[36:39], 0
v_cvt_pk_bf16_f32 v68, v68, v69
v_cvt_pk_bf16_f32 v70, v70, v71
v_mfma_f32_16x16x32_bf16 v[76:79], v[84:87], v[36:39], v[76:79]
v_accvgpr_write_b32 a178, v68
v_accvgpr_write_b32 a179, v70
v_cvt_pk_bf16_f32 v72, v72, v73
v_cvt_pk_bf16_f32 v74, v74, v75
v_accvgpr_write_b32 a180, v72
v_accvgpr_write_b32 a181, v74
s_nop 1
v_cvt_pk_bf16_f32 v76, v76, v77
v_cvt_pk_bf16_f32 v78, v78, v79
v_accvgpr_write_b32 a182, v76
v_accvgpr_write_b32 a183, v78
s_waitcnt vmcnt(12)
v_mfma_f32_16x16x32_bf16 v[140:143], v[104:107], a[176:179], v[140:143]
ds_read_b128 v[40:43], v92 offset:57344
v_mfma_f32_16x16x32_bf16 v[156:159], v[160:163], a[176:179], v[156:159]
ds_read_b128 v[44:47], v93 offset:57344
v_mfma_f32_16x16x32_bf16 v[140:143], v[108:111], a[180:183], v[140:143]
v_mfma_f32_16x16x32_bf16 v[156:159], v[164:167], a[180:183], v[156:159]
s_waitcnt lgkmcnt(1)
v_mfma_f32_16x16x32_bf16 v[48:51], v[82:85], v[40:43], 0
v_mfma_f32_16x16x32_bf16 v[48:51], v[86:89], v[40:43], v[48:51]
v_mfma_f32_16x16x32_bf16 v[52:55], v[80:83], v[40:43], 0
v_mfma_f32_16x16x32_bf16 v[52:55], v[84:87], v[40:43], v[52:55]
s_waitcnt lgkmcnt(0)
v_mfma_f32_16x16x32_bf16 v[56:59], v[82:85], v[44:47], 0
s_nop 3
v_cvt_pk_bf16_f32 v48, v48, v49
v_cvt_pk_bf16_f32 v50, v50, v51
v_mfma_f32_16x16x32_bf16 v[56:59], v[86:89], v[44:47], v[56:59]
v_accvgpr_write_b32 a184, v48
v_accvgpr_write_b32 a185, v50
v_mfma_f32_16x16x32_bf16 v[60:63], v[80:83], v[44:47], 0
v_cvt_pk_bf16_f32 v52, v52, v53
v_cvt_pk_bf16_f32 v54, v54, v55
v_mfma_f32_16x16x32_bf16 v[60:63], v[84:87], v[44:47], v[60:63]
v_accvgpr_write_b32 a186, v52
v_accvgpr_write_b32 a187, v54
s_nop 1
v_mfma_f32_16x16x32_bf16 v[140:143], v[112:115], a[184:187], v[140:143]
v_cvt_pk_bf16_f32 v56, v56, v57
v_cvt_pk_bf16_f32 v58, v58, v59
v_mfma_f32_16x16x32_bf16 v[156:159], v[168:171], a[184:187], v[156:159]
v_accvgpr_write_b32 a188, v56
v_accvgpr_write_b32 a189, v58
v_cvt_pk_bf16_f32 v60, v60, v61
v_cvt_pk_bf16_f32 v62, v62, v63
v_accvgpr_write_b32 a190, v60
v_accvgpr_write_b32 a191, v62
s_nop 1
v_mfma_f32_16x16x32_bf16 v[140:143], v[116:119], a[188:191], v[140:143]
v_mfma_f32_16x16x32_bf16 v[156:159], v[172:175], a[188:191], v[156:159]
s_mul_i32 s49, s47, 1
s_add_u32 m0, s79, 36864
s_nop 0
buffer_load_dwordx4 v236, s[8:11], s49 offen offset:0  lds
buffer_load_dwordx4 v237, s[8:11], s49 offen offset:3072  lds
s_add_u32 m0, s79, 37760
v_mfma_f32_32x32x16_bf16 v[0:15], a[0:3], a[0:3], 0
buffer_load_dwordx4 v236, s[8:11], s49 offen offset:128  lds
buffer_load_dwordx4 v237, s[8:11], s49 offen offset:3200  lds
v_mfma_f32_32x32x16_bf16 v[16:31], a[0:3], a[0:3], 0
v_max3_f32 v249, v140, v141, v142
v_max3_f32 v250, v143, v156, v157
v_max3_f32 v249, v249, v158, v159
v_max_f32 v249, v249, v250
s_add_u32 m0, s79, 38656
v_mfma_f32_32x32x16_bf16 v[32:47], a[0:3], a[0:3], 0
buffer_load_dwordx4 v236, s[8:11], s49 offen offset:256  lds
buffer_load_dwordx4 v237, s[8:11], s49 offen offset:3328  lds
v_mov_b32 v250, v249
s_nop 1
v_permlane16_swap_b32 v249, v250
v_max_f32 v249, v249, v250
v_mfma_f32_32x32x16_bf16 v[48:63], a[0:3], a[0:3], 0
s_mov_b32 s70, 0xfff
s_mov_b32 s71, 0xff000
v_readlane_b32 s47, v238, s34
v_mov_b32 v250, v249
s_nop 1
v_permlane32_swap_b32 v249, v250
v_max_f32 v249, v249, v250
v_mfma_f32_32x32x16_bf16 v[64:79], a[0:3], a[0:3], 0
s_and_b32 s49, s47, s70
s_and_b32 s44, s47, s71
s_lshr_b32 s43, s47, 8
s_and_b32 s43, s43, s71
s_bitcmp1_b32 s47, 28
s_cselect_b64 s[50:51], s[30:31], s[28:29]
s_bitcmp1_b32 s47, 29
s_cselect_b64 s[4:5], s[50:51], s[24:25]
v_sub_f32 v140, v140, v249
v_sub_f32 v141, v141, v249
v_sub_f32 v142, v142, v249
v_sub_f32 v143, v143, v249
v_sub_f32 v156, v156, v249
v_sub_f32 v157, v157, v249
v_mfma_f32_32x32x16_bf16 v[80:95], a[0:3], a[0:3], 0
v_sub_f32 v158, v158, v249
v_sub_f32 v159, v159, v249
v_sub_f32 v204, 0, v249
v_sub_f32 v205, 0, v249
v_sub_f32 v206, 0, v249
v_sub_f32 v207, 0, v249
v_add_u32 v234, s49, v233
ds_read_b64 v[234:235], v234
v_exp_f32 v216, v140
v_exp_f32 v217, v141
v_exp_f32 v218, v142
v_exp_f32 v219, v143
v_add_f32 v215, v216, v217
v_add_f32 v215, v215, v218
v_cvt_pk_bf16_f32 v188, v216, v217
v_add_f32 v215, v215, v219
v_cvt_pk_bf16_f32 v189, v218, v219
s_mov_b32 s34, 0
s_mov_b32 s45, 12288
s_mov_b32 s46, 36864
s_mov_b64 s[12:13], s[28:29]
s_cmp_lg_u32 s37, 0
s_cbranch_scc1 L_go
s_cmp_lt_u32 s36, 2
s_cbranch_scc1 L_go
ds_read_b64 v[250:251], v233 offset:1152
s_add_u32 m0, s40, 61440
s_waitcnt lgkmcnt(0)
v_xor_b32 v250, v232, v250
v_xor_b32 v251, v232, v251
buffer_load_dwordx4 v250, s[12:15], 0 offen offset:0  lds
buffer_load_dwordx4 v251, s[12:15], 0 offen offset:3072  lds
s_addk_i32 m0, 896
s_nop 0
buffer_load_dwordx4 v250, s[12:15], 0 offen offset:128  lds
buffer_load_dwordx4 v251, s[12:15], 0 offen offset:3200  lds
s_addk_i32 m0, 896
s_nop 0
buffer_load_dwordx4 v250, s[12:15], 0 offen offset:256  lds
buffer_load_dwordx4 v251, s[12:15], 0 offen offset:3328  lds
L_go:
s_cmp_lt_u32 s37, 2
s_cselect_b32 s39, 63, 34
s_bitcmp1_b32 s95, 2
s_cbranch_scc1 L_diag2
s_cmp_ge_u32 s36, 2
s_cbranch_scc1 L_loop0
s_bitcmp1_b32 s95, 6
s_cbranch_scc1 L_loopb0
.p2align 6
L_loopc0:
v_mfma_f32_16x16x32_bf16 v[96:99], a[212:215], a[116:119], v[192:195]
v_exp_f32 v216, v144
v_mfma_f32_16x16x32_bf16 v[96:99], a[208:211], a[112:115], v[96:99]
v_exp_f32 v217, v145
v_mfma_f32_16x16x32_bf16 v[96:99], a[204:207], a[108:111], v[96:99]
v_add_f32 v212, v212, v216
v_cvt_pk_bf16_f32 v178, v216, v217
v_mfma_f32_16x16x32_bf16 v[96:99], a[200:203], a[104:107], v[96:99]
v_exp_f32 v218, v146
v_mfma_f32_16x16x32_bf16 v[96:99], a[196:199], a[100:103], v[96:99]
v_add_f32 v212, v212, v217
v_mfma_f32_16x16x32_bf16 v[96:99], a[192:195], a[96:99], v[96:99]
v_add_f32 v212, v212, v218
v_mfma_f32_16x16x32_bf16 v[100:103], a[192:195], a[120:123], v[196:199]
s_waitcnt vmcnt(12) lgkmcnt(0)
s_barrier
v_mfma_f32_16x16x32_bf16 v[100:103], a[196:199], a[124:127], v[100:103]
v_exp_f32 v219, v147
v_mfma_f32_16x16x32_bf16 v[100:103], a[200:203], a[128:131], v[100:103]
ds_read_b64_tr_b16 a[240:241], v228 offset:0
v_mfma_f32_16x16x32_bf16 v[100:103], a[204:207], a[132:135], v[100:103]
v_add_f32 v212, v212, v219
v_cvt_pk_bf16_f32 v179, v218, v219
v_mfma_f32_16x16x32_bf16 v[100:103], a[208:211], a[136:139], v[100:103]
v_exp_f32 v220, v148
v_mfma_f32_16x16x32_bf16 v[100:103], a[212:215], a[140:143], v[100:103]
ds_read_b64_tr_b16 a[242:243], v228 offset:6144
v_add_f32 v213, v213, v220
v_mfma_f32_16x16x32_bf16 v[104:107], a[212:215], a[164:167], v[200:203]
s_add_u32 m0, s44, s40
v_exp_f32 v221, v149
v_mfma_f32_16x16x32_bf16 v[104:107], a[208:211], a[160:163], v[104:107]
ds_read_b64_tr_b16 a[244:245], v229 offset:0
v_add_f32 v213, v213, v221
v_mfma_f32_16x16x32_bf16 v[104:107], a[204:207], a[156:159], v[104:107]
buffer_load_dwordx4 v241, s[4:7], s43 offen offset:0  lds
v_mfma_f32_16x16x32_bf16 v[104:107], a[200:203], a[152:155], v[104:107]
v_exp_f32 v222, v150
v_mfma_f32_16x16x32_bf16 v[104:107], a[196:199], a[148:151], v[104:107]
ds_read_b64_tr_b16 a[246:247], v229 offset:6144
v_cvt_pk_bf16_f32 v182, v220, v221
v_mfma_f32_16x16x32_bf16 v[104:107], a[192:195], a[144:147], v[104:107]
ds_read_b64_tr_b16 a[248:249], v230 offset:0
v_add_f32 v213, v213, v222
v_mfma_f32_16x16x32_bf16 v[108:111], a[192:195], a[168:171], v[204:207]
v_exp_f32 v223, v151
v_mfma_f32_16x16x32_bf16 v[108:111], a[196:199], a[172:175], v[108:111]
ds_read_b64_tr_b16 a[250:251], v230 offset:6144
v_add_f32 v213, v213, v223
v_mfma_f32_16x16x32_bf16 v[108:111], a[200:203], a[176:179], v[108:111]
v_exp_f32 v216, v152
v_mfma_f32_16x16x32_bf16 v[108:111], a[204:207], a[180:183], v[108:111]
ds_read_b64_tr_b16 a[252:253], v231 offset:0
v_cvt_pk_bf16_f32 v183, v222, v223
v_mfma_f32_16x16x32_bf16 v[108:111], a[208:211], a[184:187], v[108:111]
v_exp_f32 v217, v153
v_mfma_f32_16x16x32_bf16 v[108:111], a[212:215], a[188:191], v[108:111]
ds_read_b64_tr_b16 a[254:255], v231 offset:6144
v_add_f32 v214, v214, v216
v_mfma_f32_16x16x32_bf16 v[112:115], a[236:239], a[116:119], v[192:195]
buffer_load_dwordx4 v237, s[4:7], s43 offen offset:3072  lds
v_mfma_f32_16x16x32_bf16 v[112:115], a[232:235], a[112:115], v[112:115]
v_exp_f32 v218, v154
v_mfma_f32_16x16x32_bf16 v[112:115], a[228:231], a[108:111], v[112:115]
ds_read_b64_tr_b16 a[192:193], v228 offset:1024
v_add_f32 v214, v214, v217
v_mfma_f32_16x16x32_bf16 v[112:115], a[224:227], a[104:107], v[112:115]
v_exp_f32 v219, v155
v_mfma_f32_16x16x32_bf16 v[112:115], a[220:223], a[100:103], v[112:115]
ds_read_b64_tr_b16 a[194:195], v228 offset:7168
v_cvt_pk_bf16_f32 v186, v216, v217
v_mfma_f32_16x16x32_bf16 v[112:115], a[216:219], a[96:99], v[112:115]
ds_read_b64_tr_b16 a[196:197], v229 offset:1024
v_add_f32 v214, v214, v218
v_mfma_f32_16x16x32_bf16 v[116:119], a[216:219], a[120:123], v[196:199]
v_exp_f32 v220, v156
v_mfma_f32_16x16x32_bf16 v[116:119], a[220:223], a[124:127], v[116:119]
ds_read_b64_tr_b16 a[198:199], v229 offset:7168
v_add_f32 v214, v214, v219
v_mfma_f32_16x16x32_bf16 v[116:119], a[224:227], a[128:131], v[116:119]
s_add_u32 s45, s45, s38
v_exp_f32 v221, v157
v_mfma_f32_16x16x32_bf16 v[116:119], a[228:231], a[132:135], v[116:119]
ds_read_b64_tr_b16 a[200:201], v230 offset:1024
v_cvt_pk_bf16_f32 v187, v218, v219
v_mfma_f32_16x16x32_bf16 v[116:119], a[232:235], a[136:139], v[116:119]
s_add_u32 m0, s44, s41
v_exp_f32 v222, v158
v_mfma_f32_16x16x32_bf16 v[116:119], a[236:239], a[140:143], v[116:119]
buffer_load_dwordx4 v241, s[4:7], s43 offen offset:128  lds
v_mfma_f32_16x16x32_bf16 v[120:123], a[236:239], a[164:167], v[200:203]
ds_read_b64_tr_b16 a[202:203], v230 offset:7168
v_add_f32 v215, v215, v220
v_mfma_f32_16x16x32_bf16 v[120:123], a[232:235], a[160:163], v[120:123]
s_addk_i32 s46, -12288
v_exp_f32 v223, v159
v_mfma_f32_16x16x32_bf16 v[120:123], a[228:231], a[156:159], v[120:123]
ds_read_b64_tr_b16 a[204:205], v231 offset:1024
v_add_f32 v215, v215, v221
v_mfma_f32_16x16x32_bf16 v[120:123], a[224:227], a[152:155], v[120:123]
ds_read_b64_tr_b16 a[206:207], v231 offset:7168
v_cvt_pk_bf16_f32 v190, v220, v221
v_mfma_f32_16x16x32_bf16 v[120:123], a[220:223], a[148:151], v[120:123]
ds_read_b64_tr_b16 a[208:209], v228 offset:2048
v_add_f32 v215, v215, v222
v_mfma_f32_16x16x32_bf16 v[120:123], a[216:219], a[144:147], v[120:123]
s_waitcnt lgkmcnt(7)
v_add_f32 v215, v215, v223
v_cvt_pk_bf16_f32 v191, v222, v223
v_mfma_f32_16x16x32_bf16 v[124:127], a[216:219], a[168:171], v[204:207]
ds_read_b64_tr_b16 a[210:211], v228 offset:8192
v_mfma_f32_16x16x32_bf16 v[124:127], a[220:223], a[172:175], v[124:127]
buffer_load_dwordx4 v237, s[4:7], s43 offen offset:3200  lds
v_mfma_f32_16x16x32_bf16 v[124:127], a[224:227], a[176:179], v[124:127]
ds_read_b64_tr_b16 a[212:213], v229 offset:2048
v_max3_f32 v240, v212, v213, v214
v_mfma_f32_16x16x32_bf16 v[124:127], a[228:231], a[180:183], v[124:127]
v_max_f32 v240, v240, v215
v_mfma_f32_16x16x32_bf16 v[124:127], a[232:235], a[184:187], v[124:127]
ds_read_b64_tr_b16 a[214:215], v229 offset:8192
v_cmp_lt_f32 vcc, s52, v240
v_mfma_f32_16x16x32_bf16 v[124:127], a[236:239], a[188:191], v[124:127]
s_cbranch_vccnz L_stub4
L_back4:
v_mfma_f32_16x16x32_bf16 v[0:3], v[176:179], a[240:243], v[0:3]
ds_read_b64_tr_b16 a[216:217], v230 offset:2048
v_add_f32 v208, v208, v212
v_mfma_f32_16x16x32_bf16 v[4:7], v[176:179], a[244:247], v[4:7]
v_exp_f32 v216, v96
v_mfma_f32_16x16x32_bf16 v[52:55], v[180:183], a[244:247], v[52:55]
ds_read_b64_tr_b16 a[218:219], v230 offset:8192
v_add_f32 v209, v209, v213
v_mfma_f32_16x16x32_bf16 v[48:51], v[180:183], a[240:243], v[48:51]
s_add_u32 m0, s44, s42
v_exp_f32 v217, v97
v_mfma_f32_16x16x32_bf16 a[0:3], v[184:187], a[240:243], a[0:3]
ds_read_b64_tr_b16 a[220:221], v231 offset:2048
v_add_f32 v210, v210, v214
v_mfma_f32_16x16x32_bf16 a[4:7], v[184:187], a[244:247], a[4:7]
buffer_load_dwordx4 v241, s[4:7], s43 offen offset:256  lds
v_mfma_f32_16x16x32_bf16 a[52:55], v[188:191], a[244:247], a[52:55]
v_exp_f32 v218, v98
v_mfma_f32_16x16x32_bf16 a[48:51], v[188:191], a[240:243], a[48:51]
ds_read_b64_tr_b16 a[222:223], v231 offset:8192
v_add_f32 v211, v211, v215
v_mfma_f32_16x16x32_bf16 a[56:59], v[188:191], a[248:251], a[56:59]
v_add_f32 v212, v216, v217
v_cvt_pk_bf16_f32 v160, v216, v217
v_mfma_f32_16x16x32_bf16 a[60:63], v[188:191], a[252:255], a[60:63]
v_exp_f32 v219, v99
v_mfma_f32_16x16x32_bf16 a[12:15], v[184:187], a[252:255], a[12:15]
v_add_f32 v212, v212, v218
v_cvt_pk_bf16_f32 v161, v218, v219
v_mfma_f32_16x16x32_bf16 a[8:11], v[184:187], a[248:251], a[8:11]
v_exp_f32 v220, v100
v_mfma_f32_16x16x32_bf16 v[56:59], v[180:183], a[248:251], v[56:59]
v_exp_f32 v221, v101
v_mfma_f32_16x16x32_bf16 v[60:63], v[180:183], a[252:255], v[60:63]
buffer_load_dwordx4 v237, s[4:7], s43 offen offset:3328  lds
v_mfma_f32_16x16x32_bf16 v[12:15], v[176:179], a[252:255], v[12:15]
v_exp_f32 v222, v102
v_mfma_f32_16x16x32_bf16 v[8:11], v[176:179], a[248:251], v[8:11]
v_add_f32 v212, v212, v219
v_add_f32 v213, v220, v221
v_mfma_f32_16x16x32_bf16 v[16:19], v[176:179], a[192:195], v[16:19]
s_waitcnt vmcnt(12) lgkmcnt(0)
s_barrier
v_mfma_f32_16x16x32_bf16 v[20:23], v[176:179], a[196:199], v[20:23]
s_add_u32 m0, s46, s40
v_exp_f32 v223, v103
v_mfma_f32_16x16x32_bf16 v[68:71], v[180:183], a[196:199], v[68:71]
ds_read_b128 a[224:227], v226 offset:0
v_cvt_pk_bf16_f32 v164, v220, v221
v_mfma_f32_16x16x32_bf16 v[64:67], v[180:183], a[192:195], v[64:67]
buffer_load_dwordx4 v241, s[8:11], s45 offen offset:0  lds
v_mfma_f32_16x16x32_bf16 a[16:19], v[184:187], a[192:195], a[16:19]
v_exp_f32 v216, v104
v_mfma_f32_16x16x32_bf16 a[20:23], v[184:187], a[196:199], a[20:23]
ds_read_b128 a[228:231], v227 offset:0
v_add_f32 v213, v213, v222
v_mfma_f32_16x16x32_bf16 a[68:71], v[188:191], a[196:199], a[68:71]
ds_read_b128 a[232:235], v226 offset:1024
v_add_f32 v213, v213, v223
v_mfma_f32_16x16x32_bf16 a[64:67], v[188:191], a[192:195], a[64:67]
s_add_u32 s43, s43, s38
v_cvt_pk_bf16_f32 v165, v222, v223
v_mfma_f32_16x16x32_bf16 a[72:75], v[188:191], a[200:203], a[72:75]
v_exp_f32 v217, v105
v_mfma_f32_16x16x32_bf16 a[76:79], v[188:191], a[204:207], a[76:79]
buffer_load_dwordx4 v237, s[8:11], s45 offen offset:3072  lds
v_mfma_f32_16x16x32_bf16 a[28:31], v[184:187], a[204:207], a[28:31]
ds_read_b128 a[236:239], v227 offset:1024
v_add_f32 v214, v216, v217
v_mfma_f32_16x16x32_bf16 a[24:27], v[184:187], a[200:203], a[24:27]
s_addk_i32 s44, -12288
v_exp_f32 v218, v106
v_mfma_f32_16x16x32_bf16 v[72:75], v[180:183], a[200:203], v[72:75]
ds_read_b128 a[240:243], v226 offset:2048
v_cvt_pk_bf16_f32 v168, v216, v217
v_mfma_f32_16x16x32_bf16 v[76:79], v[180:183], a[204:207], v[76:79]
ds_read_b128 a[244:247], v227 offset:2048
v_add_f32 v214, v214, v218
v_mfma_f32_16x16x32_bf16 v[28:31], v[176:179], a[204:207], v[28:31]
s_add_u32 m0, s46, s41
v_exp_f32 v219, v107
v_mfma_f32_16x16x32_bf16 v[24:27], v[176:179], a[200:203], v[24:27]
buffer_load_dwordx4 v241, s[8:11], s45 offen offset:128  lds
v_mfma_f32_16x16x32_bf16 v[32:35], v[176:179], a[208:211], v[32:35]
ds_read_b128 a[248:251], v226 offset:6144
v_add_f32 v214, v214, v219
v_mfma_f32_16x16x32_bf16 v[36:39], v[176:179], a[212:215], v[36:39]
buffer_load_dwordx4 v237, s[8:11], s45 offen offset:3200  lds
v_mfma_f32_16x16x32_bf16 v[84:87], v[180:183], a[212:215], v[84:87]
s_add_u32 m0, s46, s42
v_exp_f32 v220, v108
v_mfma_f32_16x16x32_bf16 v[80:83], v[180:183], a[208:211], v[80:83]
ds_read_b128 a[252:255], v227 offset:6144
v_cvt_pk_bf16_f32 v169, v218, v219
v_mfma_f32_16x16x32_bf16 a[32:35], v[184:187], a[208:211], a[32:35]
ds_read_b128 a[192:195], v226 offset:7168
v_mfma_f32_16x16x32_bf16 a[36:39], v[184:187], a[212:215], a[36:39]
v_exp_f32 v221, v109
v_mfma_f32_16x16x32_bf16 a[84:87], v[188:191], a[212:215], a[84:87]
buffer_load_dwordx4 v241, s[8:11], s45 offen offset:256  lds
v_mfma_f32_16x16x32_bf16 a[80:83], v[188:191], a[208:211], a[80:83]
ds_read_b128 a[196:199], v227 offset:7168
v_add_f32 v215, v220, v221
v_mfma_f32_16x16x32_bf16 a[88:91], v[188:191], a[216:219], a[88:91]
s_add_u32 s34, s34, 1
v_exp_f32 v222, v110
v_mfma_f32_16x16x32_bf16 a[92:95], v[188:191], a[220:223], a[92:95]
ds_read_b128 a[200:203], v226 offset:8192
v_cvt_pk_bf16_f32 v172, v220, v221
v_mfma_f32_16x16x32_bf16 a[44:47], v[184:187], a[220:223], a[44:47]
buffer_load_dwordx4 v237, s[8:11], s45 offen offset:3328  lds
v_mfma_f32_16x16x32_bf16 a[40:43], v[184:187], a[216:219], a[40:43]
ds_read_b128 a[204:207], v227 offset:8192
v_add_f32 v215, v215, v222
v_mfma_f32_16x16x32_bf16 v[88:91], v[180:183], a[216:219], v[88:91]
s_waitcnt lgkmcnt(6)
v_exp_f32 v223, v111
v_mfma_f32_16x16x32_bf16 v[92:95], v[180:183], a[220:223], v[92:95]
s_cmp_eq_u32 s34, s35
v_add_f32 v215, v215, v223
v_mfma_f32_16x16x32_bf16 v[44:47], v[176:179], a[220:223], v[44:47]
v_cvt_pk_bf16_f32 v173, v222, v223
v_mfma_f32_16x16x32_bf16 v[40:43], v[176:179], a[216:219], v[40:43]
s_cbranch_scc1 L_exit
L_loopc1:
v_mfma_f32_16x16x32_bf16 v[128:131], a[244:247], a[116:119], v[192:195]
v_exp_f32 v216, v112
v_mfma_f32_16x16x32_bf16 v[128:131], a[240:243], a[112:115], v[128:131]
v_exp_f32 v217, v113
v_mfma_f32_16x16x32_bf16 v[128:131], a[236:239], a[108:111], v[128:131]
v_add_f32 v212, v212, v216
v_cvt_pk_bf16_f32 v162, v216, v217
v_mfma_f32_16x16x32_bf16 v[128:131], a[232:235], a[104:107], v[128:131]
v_exp_f32 v218, v114
v_mfma_f32_16x16x32_bf16 v[128:131], a[228:231], a[100:103], v[128:131]
v_add_f32 v212, v212, v217
v_mfma_f32_16x16x32_bf16 v[128:131], a[224:227], a[96:99], v[128:131]
v_add_f32 v212, v212, v218
v_mfma_f32_16x16x32_bf16 v[132:135], a[224:227], a[120:123], v[196:199]
s_waitcnt vmcnt(12) lgkmcnt(0)
s_barrier
v_mfma_f32_16x16x32_bf16 v[132:135], a[228:231], a[124:127], v[132:135]
v_exp_f32 v219, v115
v_mfma_f32_16x16x32_bf16 v[132:135], a[232:235], a[128:131], v[132:135]
ds_read_b64_tr_b16 a[208:209], v228 offset:12288
v_mfma_f32_16x16x32_bf16 v[132:135], a[236:239], a[132:135], v[132:135]
v_add_f32 v212, v212, v219
v_cvt_pk_bf16_f32 v163, v218, v219
v_mfma_f32_16x16x32_bf16 v[132:135], a[240:243], a[136:139], v[132:135]
v_exp_f32 v220, v116
v_mfma_f32_16x16x32_bf16 v[132:135], a[244:247], a[140:143], v[132:135]
ds_read_b64_tr_b16 a[210:211], v228 offset:18432
v_add_f32 v213, v213, v220
v_mfma_f32_16x16x32_bf16 v[136:139], a[244:247], a[164:167], v[200:203]
s_add_u32 m0, s44, s40
v_exp_f32 v221, v117
v_mfma_f32_16x16x32_bf16 v[136:139], a[240:243], a[160:163], v[136:139]
ds_read_b64_tr_b16 a[212:213], v229 offset:12288
v_add_f32 v213, v213, v221
v_mfma_f32_16x16x32_bf16 v[136:139], a[236:239], a[156:159], v[136:139]
buffer_load_dwordx4 v241, s[4:7], s43 offen offset:0  lds
v_mfma_f32_16x16x32_bf16 v[136:139], a[232:235], a[152:155], v[136:139]
v_exp_f32 v222, v118
v_mfma_f32_16x16x32_bf16 v[136:139], a[228:231], a[148:151], v[136:139]
ds_read_b64_tr_b16 a[214:215], v229 offset:18432
v_cvt_pk_bf16_f32 v166, v220, v221
v_mfma_f32_16x16x32_bf16 v[136:139], a[224:227], a[144:147], v[136:139]
ds_read_b64_tr_b16 a[216:217], v230 offset:12288
v_add_f32 v213, v213, v222
v_mfma_f32_16x16x32_bf16 v[140:143], a[224:227], a[168:171], v[204:207]
v_exp_f32 v223, v119
v_mfma_f32_16x16x32_bf16 v[140:143], a[228:231], a[172:175], v[140:143]
ds_read_b64_tr_b16 a[218:219], v230 offset:18432
v_add_f32 v213, v213, v223
v_mfma_f32_16x16x32_bf16 v[140:143], a[232:235], a[176:179], v[140:143]
v_exp_f32 v216, v120
v_mfma_f32_16x16x32_bf16 v[140:143], a[236:239], a[180:183], v[140:143]
ds_read_b64_tr_b16 a[220:221], v231 offset:12288
v_cvt_pk_bf16_f32 v167, v222, v223
v_mfma_f32_16x16x32_bf16 v[140:143], a[240:243], a[184:187], v[140:143]
v_exp_f32 v217, v121
v_mfma_f32_16x16x32_bf16 v[140:143], a[244:247], a[188:191], v[140:143]
ds_read_b64_tr_b16 a[222:223], v231 offset:18432
v_add_f32 v214, v214, v216
v_mfma_f32_16x16x32_bf16 v[144:147], a[204:207], a[116:119], v[192:195]
buffer_load_dwordx4 v237, s[4:7], s43 offen offset:3072  lds
v_mfma_f32_16x16x32_bf16 v[144:147], a[200:203], a[112:115], v[144:147]
v_exp_f32 v218, v122
v_mfma_f32_16x16x32_bf16 v[144:147], a[196:199], a[108:111], v[144:147]
ds_read_b64_tr_b16 a[224:225], v228 offset:13312
v_add_f32 v214, v214, v217
v_mfma_f32_16x16x32_bf16 v[144:147], a[192:195], a[104:107], v[144:147]
v_exp_f32 v219, v123
v_mfma_f32_16x16x32_bf16 v[144:147], a[252:255], a[100:103], v[144:147]
ds_read_b64_tr_b16 a[226:227], v228 offset:19456
v_cvt_pk_bf16_f32 v170, v216, v217
v_mfma_f32_16x16x32_bf16 v[144:147], a[248:251], a[96:99], v[144:147]
ds_read_b64_tr_b16 a[228:229], v229 offset:13312
v_add_f32 v214, v214, v218
v_mfma_f32_16x16x32_bf16 v[148:151], a[248:251], a[120:123], v[196:199]
v_exp_f32 v220, v124
v_mfma_f32_16x16x32_bf16 v[148:151], a[252:255], a[124:127], v[148:151]
ds_read_b64_tr_b16 a[230:231], v229 offset:19456
v_add_f32 v214, v214, v219
v_mfma_f32_16x16x32_bf16 v[148:151], a[192:195], a[128:131], v[148:151]
s_add_u32 s45, s45, s38
v_exp_f32 v221, v125
v_mfma_f32_16x16x32_bf16 v[148:151], a[196:199], a[132:135], v[148:151]
ds_read_b64_tr_b16 a[232:233], v230 offset:13312
v_cvt_pk_bf16_f32 v171, v218, v219
v_mfma_f32_16x16x32_bf16 v[148:151], a[200:203], a[136:139], v[148:151]
s_add_u32 m0, s44, s41
v_exp_f32 v222, v126
v_mfma_f32_16x16x32_bf16 v[148:151], a[204:207], a[140:143], v[148:151]
buffer_load_dwordx4 v241, s[4:7], s43 offen offset:128  lds
v_mfma_f32_16x16x32_bf16 v[152:155], a[204:207], a[164:167], v[200:203]
ds_read_b64_tr_b16 a[234:235], v230 offset:19456
v_add_f32 v215, v215, v220
v_mfma_f32_16x16x32_bf16 v[152:155], a[200:203], a[160:163], v[152:155]
s_addk_i32 s46, 12288
v_exp_f32 v223, v127
v_mfma_f32_16x16x32_bf16 v[152:155], a[196:199], a[156:159], v[152:155]
ds_read_b64_tr_b16 a[236:237], v231 offset:13312
v_add_f32 v215, v215, v221
v_mfma_f32_16x16x32_bf16 v[152:155], a[192:195], a[152:155], v[152:155]
ds_read_b64_tr_b16 a[238:239], v231 offset:19456
v_cvt_pk_bf16_f32 v174, v220, v221
v_mfma_f32_16x16x32_bf16 v[152:155], a[252:255], a[148:151], v[152:155]
ds_read_b64_tr_b16 a[240:241], v228 offset:14336
v_add_f32 v215, v215, v222
v_mfma_f32_16x16x32_bf16 v[152:155], a[248:251], a[144:147], v[152:155]
s_waitcnt lgkmcnt(7)
v_add_f32 v215, v215, v223
v_cvt_pk_bf16_f32 v175, v222, v223
v_mfma_f32_16x16x32_bf16 v[156:159], a[248:251], a[168:171], v[204:207]
ds_read_b64_tr_b16 a[242:243], v228 offset:20480
v_mfma_f32_16x16x32_bf16 v[156:159], a[252:255], a[172:175], v[156:159]
buffer_load_dwordx4 v237, s[4:7], s43 offen offset:3200  lds
v_mfma_f32_16x16x32_bf16 v[156:159], a[192:195], a[176:179], v[156:159]
ds_read_b64_tr_b16 a[244:245], v229 offset:14336
v_max3_f32 v240, v212, v213, v214
v_mfma_f32_16x16x32_bf16 v[156:159], a[196:199], a[180:183], v[156:159]
v_max_f32 v240, v240, v215
v_mfma_f32_16x16x32_bf16 v[156:159], a[200:203], a[184:187], v[156:159]
ds_read_b64_tr_b16 a[246:247], v229 offset:20480
v_cmp_lt_f32 vcc, s52, v240
v_mfma_f32_16x16x32_bf16 v[156:159], a[204:207], a[188:191], v[156:159]
s_cbranch_vccnz L_stub5
L_back5:
v_mfma_f32_16x16x32_bf16 v[0:3], v[160:163], a[208:211], v[0:3]
ds_read_b64_tr_b16 a[248:249], v230 offset:14336
v_add_f32 v208, v208, v212
v_mfma_f32_16x16x32_bf16 v[4:7], v[160:163], a[212:215], v[4:7]
v_exp_f32 v216, v128
v_mfma_f32_16x16x32_bf16 v[52:55], v[164:167], a[212:215], v[52:55]
ds_read_b64_tr_b16 a[250:251], v230 offset:20480
v_add_f32 v209, v209, v213
v_mfma_f32_16x16x32_bf16 v[48:51], v[164:167], a[208:211], v[48:51]
s_add_u32 m0, s44, s42
v_exp_f32 v217, v129
v_mfma_f32_16x16x32_bf16 a[0:3], v[168:171], a[208:211], a[0:3]
ds_read_b64_tr_b16 a[252:253], v231 offset:14336
v_add_f32 v210, v210, v214
v_mfma_f32_16x16x32_bf16 a[4:7], v[168:171], a[212:215], a[4:7]
buffer_load_dwordx4 v241, s[4:7], s43 offen offset:256  lds
v_mfma_f32_16x16x32_bf16 a[52:55], v[172:175], a[212:215], a[52:55]
v_exp_f32 v218, v130
v_mfma_f32_16x16x32_bf16 a[48:51], v[172:175], a[208:211], a[48:51]
ds_read_b64_tr_b16 a[254:255], v231 offset:20480
v_add_f32 v211, v211, v215
v_mfma_f32_16x16x32_bf16 a[56:59], v[172:175], a[216:219], a[56:59]
v_add_f32 v212, v216, v217
v_cvt_pk_bf16_f32 v176, v216, v217
v_mfma_f32_16x16x32_bf16 a[60:63], v[172:175], a[220:223], a[60:63]
v_exp_f32 v219, v131
v_mfma_f32_16x16x32_bf16 a[12:15], v[168:171], a[220:223], a[12:15]
v_add_f32 v212, v212, v218
v_cvt_pk_bf16_f32 v177, v218, v219
v_mfma_f32_16x16x32_bf16 a[8:11], v[168:171], a[216:219], a[8:11]
v_exp_f32 v220, v132
v_mfma_f32_16x16x32_bf16 v[56:59], v[164:167], a[216:219], v[56:59]
v_exp_f32 v221, v133
v_mfma_f32_16x16x32_bf16 v[60:63], v[164:167], a[220:223], v[60:63]
buffer_load_dwordx4 v237, s[4:7], s43 offen offset:3328  lds
v_mfma_f32_16x16x32_bf16 v[12:15], v[160:163], a[220:223], v[12:15]
v_exp_f32 v222, v134
v_mfma_f32_16x16x32_bf16 v[8:11], v[160:163], a[216:219], v[8:11]
v_add_f32 v212, v212, v219
v_add_f32 v213, v220, v221
v_mfma_f32_16x16x32_bf16 v[16:19], v[160:163], a[224:227], v[16:19]
s_waitcnt vmcnt(12) lgkmcnt(0)
s_barrier
v_mfma_f32_16x16x32_bf16 v[20:23], v[160:163], a[228:231], v[20:23]
s_add_u32 m0, s46, s40
v_exp_f32 v223, v135
v_mfma_f32_16x16x32_bf16 v[68:71], v[164:167], a[228:231], v[68:71]
ds_read_b128 a[192:195], v226 offset:12288
v_cvt_pk_bf16_f32 v180, v220, v221
v_mfma_f32_16x16x32_bf16 v[64:67], v[164:167], a[224:227], v[64:67]
buffer_load_dwordx4 v241, s[8:11], s45 offen offset:0  lds
v_mfma_f32_16x16x32_bf16 a[16:19], v[168:171], a[224:227], a[16:19]
v_exp_f32 v216, v136
v_mfma_f32_16x16x32_bf16 a[20:23], v[168:171], a[228:231], a[20:23]
ds_read_b128 a[196:199], v227 offset:12288
v_add_f32 v213, v213, v222
v_mfma_f32_16x16x32_bf16 a[68:71], v[172:175], a[228:231], a[68:71]
ds_read_b128 a[200:203], v226 offset:13312
v_add_f32 v213, v213, v223
v_mfma_f32_16x16x32_bf16 a[64:67], v[172:175], a[224:227], a[64:67]
s_add_u32 s43, s43, s38
v_cvt_pk_bf16_f32 v181, v222, v223
v_mfma_f32_16x16x32_bf16 a[72:75], v[172:175], a[232:235], a[72:75]
v_exp_f32 v217, v137
v_mfma_f32_16x16x32_bf16 a[76:79], v[172:175], a[236:239], a[76:79]
buffer_load_dwordx4 v237, s[8:11], s45 offen offset:3072  lds
v_mfma_f32_16x16x32_bf16 a[28:31], v[168:171], a[236:239], a[28:31]
ds_read_b128 a[204:207], v227 offset:13312
v_add_f32 v214, v216, v217
v_mfma_f32_16x16x32_bf16 a[24:27], v[168:171], a[232:235], a[24:27]
s_addk_i32 s44, 12288
v_exp_f32 v218, v138
v_mfma_f32_16x16x32_bf16 v[72:75], v[164:167], a[232:235], v[72:75]
ds_read_b128 a[208:211], v226 offset:14336
v_cvt_pk_bf16_f32 v184, v216, v217
v_mfma_f32_16x16x32_bf16 v[76:79], v[164:167], a[236:239], v[76:79]
ds_read_b128 a[212:215], v227 offset:14336
v_add_f32 v214, v214, v218
v_mfma_f32_16x16x32_bf16 v[28:31], v[160:163], a[236:239], v[28:31]
s_add_u32 m0, s46, s41
v_exp_f32 v219, v139
v_mfma_f32_16x16x32_bf16 v[24:27], v[160:163], a[232:235], v[24:27]
buffer_load_dwordx4 v241, s[8:11], s45 offen offset:128  lds
v_mfma_f32_16x16x32_bf16 v[32:35], v[160:163], a[240:243], v[32:35]
ds_read_b128 a[216:219], v226 offset:18432
v_add_f32 v214, v214, v219
v_mfma_f32_16x16x32_bf16 v[36:39], v[160:163], a[244:247], v[36:39]
buffer_load_dwordx4 v237, s[8:11], s45 offen offset:3200  lds
v_mfma_f32_16x16x32_bf16 v[84:87], v[164:167], a[244:247], v[84:87]
s_add_u32 m0, s46, s42
v_exp_f32 v220, v140
v_mfma_f32_16x16x32_bf16 v[80:83], v[164:167], a[240:243], v[80:83]
ds_read_b128 a[220:223], v227 offset:18432
v_cvt_pk_bf16_f32 v185, v218, v219
v_mfma_f32_16x16x32_bf16 a[32:35], v[168:171], a[240:243], a[32:35]
ds_read_b128 a[224:227], v226 offset:19456
v_mfma_f32_16x16x32_bf16 a[36:39], v[168:171], a[244:247], a[36:39]
v_exp_f32 v221, v141
v_mfma_f32_16x16x32_bf16 a[84:87], v[172:175], a[244:247], a[84:87]
buffer_load_dwordx4 v241, s[8:11], s45 offen offset:256  lds
v_mfma_f32_16x16x32_bf16 a[80:83], v[172:175], a[240:243], a[80:83]
ds_read_b128 a[228:231], v227 offset:19456
v_add_f32 v215, v220, v221
v_mfma_f32_16x16x32_bf16 a[88:91], v[172:175], a[248:251], a[88:91]
s_add_u32 s34, s34, 1
v_exp_f32 v222, v142
v_mfma_f32_16x16x32_bf16 a[92:95], v[172:175], a[252:255], a[92:95]
ds_read_b128 a[232:235], v226 offset:20480
v_cvt_pk_bf16_f32 v188, v220, v221
v_mfma_f32_16x16x32_bf16 a[44:47], v[168:171], a[252:255], a[44:47]
buffer_load_dwordx4 v237, s[8:11], s45 offen offset:3328  lds
v_mfma_f32_16x16x32_bf16 a[40:43], v[168:171], a[248:251], a[40:43]
ds_read_b128 a[236:239], v227 offset:20480
v_add_f32 v215, v215, v222
v_mfma_f32_16x16x32_bf16 v[88:91], v[164:167], a[248:251], v[88:91]
s_waitcnt lgkmcnt(6)
v_exp_f32 v223, v143
v_mfma_f32_16x16x32_bf16 v[92:95], v[164:167], a[252:255], v[92:95]
v_add_f32 v215, v215, v223
v_mfma_f32_16x16x32_bf16 v[44:47], v[160:163], a[252:255], v[44:47]
v_cvt_pk_bf16_f32 v189, v222, v223
v_mfma_f32_16x16x32_bf16 v[40:43], v[160:163], a[248:251], v[40:43]
s_branch L_loopc0
.p2align 6
L_loopb0:
v_mfma_f32_16x16x32_bf16 v[96:99], a[212:215], a[116:119], v[192:195]
v_exp_f32 v216, v144
v_mfma_f32_16x16x32_bf16 v[96:99], a[208:211], a[112:115], v[96:99]
v_exp_f32 v217, v145
v_mfma_f32_16x16x32_bf16 v[96:99], a[204:207], a[108:111], v[96:99]
v_readlane_b32 s48, v239, s34
v_add_f32 v212, v212, v216
v_mfma_f32_16x16x32_bf16 v[96:99], a[200:203], a[104:107], v[96:99]
s_and_b32 s79, s48, s70
v_exp_f32 v218, v146
v_mfma_f32_16x16x32_bf16 v[96:99], a[196:199], a[100:103], v[96:99]
v_add_f32 v212, v212, v217
v_cvt_pk_bf16_f32 v178, v216, v217
v_mfma_f32_16x16x32_bf16 v[96:99], a[192:195], a[96:99], v[96:99]
v_add_f32 v212, v212, v218
v_add_u32 v236, s79, v233
v_mfma_f32_16x16x32_bf16 v[100:103], a[192:195], a[120:123], v[196:199]
s_waitcnt vmcnt(12) lgkmcnt(0)
s_barrier
v_mfma_f32_16x16x32_bf16 v[100:103], a[196:199], a[124:127], v[100:103]
v_exp_f32 v219, v147
v_mfma_f32_16x16x32_bf16 v[100:103], a[200:203], a[128:131], v[100:103]
ds_read_b32 v236, v236
v_add_f32 v212, v212, v219
v_mfma_f32_16x16x32_bf16 v[100:103], a[204:207], a[132:135], v[100:103]
ds_read_b64_tr_b16 a[240:241], v228 offset:0
v_cvt_pk_bf16_f32 v179, v218, v219
v_mfma_f32_16x16x32_bf16 v[100:103], a[208:211], a[136:139], v[100:103]
s_add_u32 m0, s44, s40
v_exp_f32 v220, v148
v_mfma_f32_16x16x32_bf16 v[100:103], a[212:215], a[140:143], v[100:103]
buffer_load_dwordx4 v241, s[4:7], s43 offen offset:0  lds
v_mfma_f32_16x16x32_bf16 v[104:107], a[212:215], a[164:167], v[200:203]
ds_read_b64_tr_b16 a[242:243], v228 offset:6144
v_add_f32 v213, v213, v220
v_mfma_f32_16x16x32_bf16 v[104:107], a[208:211], a[160:163], v[104:107]
s_and_b32 s47, s48, s71
v_exp_f32 v221, v149
v_mfma_f32_16x16x32_bf16 v[104:107], a[204:207], a[156:159], v[104:107]
ds_read_b64_tr_b16 a[244:245], v229 offset:0
v_add_f32 v213, v213, v221
v_mfma_f32_16x16x32_bf16 v[104:107], a[200:203], a[152:155], v[104:107]
v_exp_f32 v222, v150
v_mfma_f32_16x16x32_bf16 v[104:107], a[196:199], a[148:151], v[104:107]
ds_read_b64_tr_b16 a[246:247], v229 offset:6144
v_cvt_pk_bf16_f32 v182, v220, v221
v_mfma_f32_16x16x32_bf16 v[104:107], a[192:195], a[144:147], v[104:107]
ds_read_b64_tr_b16 a[248:249], v230 offset:0
v_add_f32 v213, v213, v222
v_mfma_f32_16x16x32_bf16 v[108:111], a[192:195], a[168:171], v[204:207]
buffer_load_dwordx4 v237, s[4:7], s43 offen offset:3072  lds
v_mfma_f32_16x16x32_bf16 v[108:111], a[196:199], a[172:175], v[108:111]
s_and_b32 s49, s48, 4
v_exp_f32 v223, v151
v_mfma_f32_16x16x32_bf16 v[108:111], a[200:203], a[176:179], v[108:111]
ds_read_b64_tr_b16 a[250:251], v230 offset:6144
v_add_f32 v213, v213, v223
v_mfma_f32_16x16x32_bf16 v[108:111], a[204:207], a[180:183], v[108:111]
s_mulk_i32 s49, 768
v_exp_f32 v216, v152
v_mfma_f32_16x16x32_bf16 v[108:111], a[208:211], a[184:187], v[108:111]
ds_read_b64_tr_b16 a[252:253], v231 offset:0
v_cvt_pk_bf16_f32 v183, v222, v223
v_mfma_f32_16x16x32_bf16 v[108:111], a[212:215], a[188:191], v[108:111]
s_add_u32 m0, s44, s41
v_exp_f32 v217, v153
v_mfma_f32_16x16x32_bf16 v[112:115], a[236:239], a[116:119], v[192:195]
ds_read_b64_tr_b16 a[254:255], v231 offset:6144
v_add_f32 v214, v214, v216
v_mfma_f32_16x16x32_bf16 v[112:115], a[232:235], a[112:115], v[112:115]
s_bitcmp1_b32 s48, 30
v_exp_f32 v218, v154
v_mfma_f32_16x16x32_bf16 v[112:115], a[228:231], a[108:111], v[112:115]
buffer_load_dwordx4 v241, s[4:7], s43 offen offset:128  lds
v_mfma_f32_16x16x32_bf16 v[112:115], a[224:227], a[104:107], v[112:115]
ds_read_b64_tr_b16 a[192:193], v228 offset:1024
v_add_f32 v214, v214, v217
v_mfma_f32_16x16x32_bf16 v[112:115], a[220:223], a[100:103], v[112:115]
s_cselect_b32 s47, s47, s6
v_exp_f32 v219, v155
v_mfma_f32_16x16x32_bf16 v[112:115], a[216:219], a[96:99], v[112:115]
ds_read_b64_tr_b16 a[194:195], v228 offset:7168
v_cvt_pk_bf16_f32 v186, v216, v217
v_mfma_f32_16x16x32_bf16 v[116:119], a[216:219], a[120:123], v[196:199]
ds_read_b64_tr_b16 a[196:197], v229 offset:1024
v_add_f32 v214, v214, v218
v_mfma_f32_16x16x32_bf16 v[116:119], a[220:223], a[124:127], v[116:119]
s_lshr_b32 s47, s47, 2
v_exp_f32 v220, v156
v_mfma_f32_16x16x32_bf16 v[116:119], a[224:227], a[128:131], v[116:119]
ds_read_b64_tr_b16 a[198:199], v229 offset:7168
v_add_f32 v214, v214, v219
v_mfma_f32_16x16x32_bf16 v[116:119], a[228:231], a[132:135], v[116:119]
s_add_u32 s45, s45, s38
v_exp_f32 v221, v157
v_mfma_f32_16x16x32_bf16 v[116:119], a[232:235], a[136:139], v[116:119]
buffer_load_dwordx4 v237, s[4:7], s43 offen offset:3200  lds
v_mfma_f32_16x16x32_bf16 v[116:119], a[236:239], a[140:143], v[116:119]
ds_read_b64_tr_b16 a[200:201], v230 offset:1024
v_cvt_pk_bf16_f32 v187, v218, v219
v_mfma_f32_16x16x32_bf16 v[120:123], a[236:239], a[164:167], v[200:203]
s_addk_i32 s46, -12288
v_exp_f32 v222, v158
v_mfma_f32_16x16x32_bf16 v[120:123], a[232:235], a[160:163], v[120:123]
ds_read_b64_tr_b16 a[202:203], v230 offset:7168
v_add_f32 v215, v215, v220
v_mfma_f32_16x16x32_bf16 v[120:123], a[228:231], a[156:159], v[120:123]
s_add_u32 m0, s44, s42
v_exp_f32 v223, v159
v_mfma_f32_16x16x32_bf16 v[120:123], a[224:227], a[152:155], v[120:123]
ds_read_b64_tr_b16 a[204:205], v231 offset:1024
v_add_f32 v215, v215, v221
v_mfma_f32_16x16x32_bf16 v[120:123], a[220:223], a[148:151], v[120:123]
ds_read_b64_tr_b16 a[206:207], v231 offset:7168
v_cvt_pk_bf16_f32 v190, v220, v221
v_mfma_f32_16x16x32_bf16 v[120:123], a[216:219], a[144:147], v[120:123]
s_waitcnt lgkmcnt(6)
v_add_f32 v215, v215, v222
v_cvt_pk_bf16_f32 v191, v222, v223
v_mfma_f32_16x16x32_bf16 v[124:127], a[216:219], a[168:171], v[204:207]
buffer_load_dwordx4 v241, s[4:7], s43 offen offset:256  lds
v_mfma_f32_16x16x32_bf16 v[124:127], a[220:223], a[172:175], v[124:127]
ds_read_b64_tr_b16 a[208:209], v228 offset:2048
v_add_f32 v215, v215, v223
v_mfma_f32_16x16x32_bf16 v[124:127], a[224:227], a[176:179], v[124:127]
ds_read_b64_tr_b16 a[210:211], v228 offset:8192
v_max3_f32 v240, v212, v213, v214
v_mfma_f32_16x16x32_bf16 v[124:127], a[228:231], a[180:183], v[124:127]
ds_read_b64_tr_b16 a[212:213], v229 offset:2048
v_max_f32 v240, v240, v215
v_mfma_f32_16x16x32_bf16 v[124:127], a[232:235], a[184:187], v[124:127]
ds_read_b64_tr_b16 a[214:215], v229 offset:8192
v_cmp_lt_f32 vcc, s52, v240
v_mfma_f32_16x16x32_bf16 v[124:127], a[236:239], a[188:191], v[124:127]
buffer_load_dwordx4 v237, s[4:7], s43 offen offset:3328  lds
s_cbranch_vccnz L_stub2
L_back2:
v_mfma_f32_16x16x32_bf16 v[0:3], v[176:179], a[240:243], v[0:3]
ds_read_b64_tr_b16 a[216:217], v230 offset:2048
v_add_f32 v208, v208, v212
v_mfma_f32_16x16x32_bf16 v[4:7], v[176:179], a[244:247], v[4:7]
s_add_u32 m0, s47, s40
v_exp_f32 v216, v96
v_mfma_f32_16x16x32_bf16 v[52:55], v[180:183], a[244:247], v[52:55]
ds_read_b64_tr_b16 a[218:219], v230 offset:8192
v_add_f32 v209, v209, v213
v_mfma_f32_16x16x32_bf16 v[48:51], v[180:183], a[240:243], v[48:51]
v_exp_f32 v217, v97
v_mfma_f32_16x16x32_bf16 a[0:3], v[184:187], a[240:243], a[0:3]
ds_read_b64_tr_b16 a[220:221], v231 offset:2048
v_add_f32 v210, v210, v214
v_mfma_f32_16x16x32_bf16 a[4:7], v[184:187], a[244:247], a[4:7]
v_exp_f32 v218, v98
v_mfma_f32_16x16x32_bf16 a[52:55], v[188:191], a[244:247], a[52:55]
ds_read_b64_tr_b16 a[222:223], v231 offset:8192
v_add_f32 v211, v211, v215
v_mfma_f32_16x16x32_bf16 a[48:51], v[188:191], a[240:243], a[48:51]
v_xor_b32 v236, v232, v236
v_add_f32 v212, v216, v217
v_mfma_f32_16x16x32_bf16 a[56:59], v[188:191], a[248:251], a[56:59]
buffer_load_dwordx4 v236, s[12:15], s49 offen offset:0  lds
v_mfma_f32_16x16x32_bf16 a[60:63], v[188:191], a[252:255], a[60:63]
s_add_u32 m0, s47, s41
v_cvt_pk_bf16_f32 v160, v216, v217
v_add_f32 v212, v212, v218
v_mfma_f32_16x16x32_bf16 a[12:15], v[184:187], a[252:255], a[12:15]
buffer_load_dwordx4 v236, s[12:15], s49 offen offset:128  lds
v_mfma_f32_16x16x32_bf16 a[8:11], v[184:187], a[248:251], a[8:11]
s_add_u32 m0, s47, s42
v_exp_f32 v219, v99
v_mfma_f32_16x16x32_bf16 v[56:59], v[180:183], a[248:251], v[56:59]
buffer_load_dwordx4 v236, s[12:15], s49 offen offset:256  lds
v_mfma_f32_16x16x32_bf16 v[60:63], v[180:183], a[252:255], v[60:63]
v_exp_f32 v220, v100
v_mfma_f32_16x16x32_bf16 v[12:15], v[176:179], a[252:255], v[12:15]
v_exp_f32 v221, v101
v_mfma_f32_16x16x32_bf16 v[8:11], v[176:179], a[248:251], v[8:11]
v_exp_f32 v222, v102
v_mfma_f32_16x16x32_bf16 v[16:19], v[176:179], a[192:195], v[16:19]
s_waitcnt vmcnt(15) lgkmcnt(0)
s_barrier
v_mfma_f32_16x16x32_bf16 v[20:23], v[176:179], a[196:199], v[20:23]
v_add_f32 v212, v212, v219
v_cvt_pk_bf16_f32 v161, v218, v219
v_mfma_f32_16x16x32_bf16 v[68:71], v[180:183], a[196:199], v[68:71]
v_exp_f32 v223, v103
v_mfma_f32_16x16x32_bf16 v[64:67], v[180:183], a[192:195], v[64:67]
ds_read_b128 a[224:227], v226 offset:0
v_add_f32 v213, v220, v221
v_mfma_f32_16x16x32_bf16 a[16:19], v[184:187], a[192:195], a[16:19]
s_add_u32 m0, s46, s40
v_cvt_pk_bf16_f32 v164, v220, v221
v_add_f32 v213, v213, v222
v_mfma_f32_16x16x32_bf16 a[20:23], v[184:187], a[196:199], a[20:23]
v_exp_f32 v216, v104
v_mfma_f32_16x16x32_bf16 a[68:71], v[188:191], a[196:199], a[68:71]
ds_read_b128 a[228:231], v227 offset:0
v_add_f32 v213, v213, v223
v_mfma_f32_16x16x32_bf16 a[64:67], v[188:191], a[192:195], a[64:67]
buffer_load_dwordx4 v241, s[8:11], s45 offen offset:0  lds
v_mfma_f32_16x16x32_bf16 a[72:75], v[188:191], a[200:203], a[72:75]
ds_read_b128 a[232:235], v226 offset:1024
v_cvt_pk_bf16_f32 v165, v222, v223
v_mfma_f32_16x16x32_bf16 a[76:79], v[188:191], a[204:207], a[76:79]
s_add_u32 s43, s43, s38
v_exp_f32 v217, v105
v_mfma_f32_16x16x32_bf16 a[28:31], v[184:187], a[204:207], a[28:31]
ds_read_b128 a[236:239], v227 offset:1024
v_add_f32 v214, v216, v217
v_mfma_f32_16x16x32_bf16 a[24:27], v[184:187], a[200:203], a[24:27]
buffer_load_dwordx4 v237, s[8:11], s45 offen offset:3072  lds
v_mfma_f32_16x16x32_bf16 v[72:75], v[180:183], a[200:203], v[72:75]
s_addk_i32 s44, -12288
v_exp_f32 v218, v106
v_mfma_f32_16x16x32_bf16 v[76:79], v[180:183], a[204:207], v[76:79]
ds_read_b128 a[240:243], v226 offset:2048
v_cvt_pk_bf16_f32 v168, v216, v217
v_mfma_f32_16x16x32_bf16 v[28:31], v[176:179], a[204:207], v[28:31]
ds_read_b128 a[244:247], v227 offset:2048
v_add_f32 v214, v214, v218
v_mfma_f32_16x16x32_bf16 v[24:27], v[176:179], a[200:203], v[24:27]
s_add_u32 m0, s46, s41
v_exp_f32 v219, v107
v_mfma_f32_16x16x32_bf16 v[32:35], v[176:179], a[208:211], v[32:35]
buffer_load_dwordx4 v241, s[8:11], s45 offen offset:128  lds
v_mfma_f32_16x16x32_bf16 v[36:39], v[176:179], a[212:215], v[36:39]
ds_read_b128 a[248:251], v226 offset:6144
v_add_f32 v214, v214, v219
v_mfma_f32_16x16x32_bf16 v[84:87], v[180:183], a[212:215], v[84:87]
v_exp_f32 v220, v108
v_mfma_f32_16x16x32_bf16 v[80:83], v[180:183], a[208:211], v[80:83]
ds_read_b128 a[252:255], v227 offset:6144
v_cvt_pk_bf16_f32 v169, v218, v219
v_mfma_f32_16x16x32_bf16 a[32:35], v[184:187], a[208:211], a[32:35]
buffer_load_dwordx4 v237, s[8:11], s45 offen offset:3200  lds
v_mfma_f32_16x16x32_bf16 a[36:39], v[184:187], a[212:215], a[36:39]
ds_read_b128 a[192:195], v226 offset:7168
s_add_u32 m0, s46, s42
v_mfma_f32_16x16x32_bf16 a[84:87], v[188:191], a[212:215], a[84:87]
s_add_u32 s34, s34, 1
v_exp_f32 v221, v109
v_mfma_f32_16x16x32_bf16 a[80:83], v[188:191], a[208:211], a[80:83]
ds_read_b128 a[196:199], v227 offset:7168
v_add_f32 v215, v220, v221
v_mfma_f32_16x16x32_bf16 a[88:91], v[188:191], a[216:219], a[88:91]
buffer_load_dwordx4 v241, s[8:11], s45 offen offset:256  lds
v_mfma_f32_16x16x32_bf16 a[92:95], v[188:191], a[220:223], a[92:95]
s_waitcnt lgkmcnt(4)
v_exp_f32 v222, v110
v_mfma_f32_16x16x32_bf16 a[44:47], v[184:187], a[220:223], a[44:47]
ds_read_b128 a[200:203], v226 offset:8192
v_cvt_pk_bf16_f32 v172, v220, v221
v_mfma_f32_16x16x32_bf16 a[40:43], v[184:187], a[216:219], a[40:43]
ds_read_b128 a[204:207], v227 offset:8192
v_add_f32 v215, v215, v222
v_mfma_f32_16x16x32_bf16 v[88:91], v[180:183], a[216:219], v[88:91]
s_cmp_eq_u32 s34, s35
v_exp_f32 v223, v111
v_mfma_f32_16x16x32_bf16 v[92:95], v[180:183], a[220:223], v[92:95]
buffer_load_dwordx4 v237, s[8:11], s45 offen offset:3328  lds
v_mfma_f32_16x16x32_bf16 v[44:47], v[176:179], a[220:223], v[44:47]
v_add_f32 v215, v215, v223
v_cvt_pk_bf16_f32 v173, v222, v223
v_mfma_f32_16x16x32_bf16 v[40:43], v[176:179], a[216:219], v[40:43]
s_cbranch_scc1 L_exit
L_loopb1:
v_mfma_f32_16x16x32_bf16 v[128:131], a[244:247], a[116:119], v[192:195]
v_exp_f32 v216, v112
v_mfma_f32_16x16x32_bf16 v[128:131], a[240:243], a[112:115], v[128:131]
v_exp_f32 v217, v113
v_mfma_f32_16x16x32_bf16 v[128:131], a[236:239], a[108:111], v[128:131]
v_readlane_b32 s48, v239, s34
v_add_f32 v212, v212, v216
v_mfma_f32_16x16x32_bf16 v[128:131], a[232:235], a[104:107], v[128:131]
s_and_b32 s79, s48, s70
v_exp_f32 v218, v114
v_mfma_f32_16x16x32_bf16 v[128:131], a[228:231], a[100:103], v[128:131]
v_add_f32 v212, v212, v217
v_cvt_pk_bf16_f32 v162, v216, v217
v_mfma_f32_16x16x32_bf16 v[128:131], a[224:227], a[96:99], v[128:131]
v_add_f32 v212, v212, v218
v_add_u32 v236, s79, v233
v_mfma_f32_16x16x32_bf16 v[132:135], a[224:227], a[120:123], v[196:199]
s_waitcnt vmcnt(12) lgkmcnt(0)
s_barrier
v_mfma_f32_16x16x32_bf16 v[132:135], a[228:231], a[124:127], v[132:135]
v_exp_f32 v219, v115
v_mfma_f32_16x16x32_bf16 v[132:135], a[232:235], a[128:131], v[132:135]
ds_read_b32 v236, v236
v_add_f32 v212, v212, v219
v_mfma_f32_16x16x32_bf16 v[132:135], a[236:239], a[132:135], v[132:135]
ds_read_b64_tr_b16 a[208:209], v228 offset:12288
v_cvt_pk_bf16_f32 v163, v218, v219
v_mfma_f32_16x16x32_bf16 v[132:135], a[240:243], a[136:139], v[132:135]
s_add_u32 m0, s44, s40
v_exp_f32 v220, v116
v_mfma_f32_16x16x32_bf16 v[132:135], a[244:247], a[140:143], v[132:135]
buffer_load_dwordx4 v241, s[4:7], s43 offen offset:0  lds
v_mfma_f32_16x16x32_bf16 v[136:139], a[244:247], a[164:167], v[200:203]
ds_read_b64_tr_b16 a[210:211], v228 offset:18432
v_add_f32 v213, v213, v220
v_mfma_f32_16x16x32_bf16 v[136:139], a[240:243], a[160:163], v[136:139]
s_and_b32 s47, s48, s71
v_exp_f32 v221, v117
v_mfma_f32_16x16x32_bf16 v[136:139], a[236:239], a[156:159], v[136:139]
ds_read_b64_tr_b16 a[212:213], v229 offset:12288
v_add_f32 v213, v213, v221
v_mfma_f32_16x16x32_bf16 v[136:139], a[232:235], a[152:155], v[136:139]
v_exp_f32 v222, v118
v_mfma_f32_16x16x32_bf16 v[136:139], a[228:231], a[148:151], v[136:139]
ds_read_b64_tr_b16 a[214:215], v229 offset:18432
v_cvt_pk_bf16_f32 v166, v220, v221
v_mfma_f32_16x16x32_bf16 v[136:139], a[224:227], a[144:147], v[136:139]
ds_read_b64_tr_b16 a[216:217], v230 offset:12288
v_add_f32 v213, v213, v222
v_mfma_f32_16x16x32_bf16 v[140:143], a[224:227], a[168:171], v[204:207]
buffer_load_dwordx4 v237, s[4:7], s43 offen offset:3072  lds
v_mfma_f32_16x16x32_bf16 v[140:143], a[228:231], a[172:175], v[140:143]
s_and_b32 s49, s48, 4
v_exp_f32 v223, v119
v_mfma_f32_16x16x32_bf16 v[140:143], a[232:235], a[176:179], v[140:143]
ds_read_b64_tr_b16 a[218:219], v230 offset:18432
v_add_f32 v213, v213, v223
v_mfma_f32_16x16x32_bf16 v[140:143], a[236:239], a[180:183], v[140:143]
s_mulk_i32 s49, 768
v_exp_f32 v216, v120
v_mfma_f32_16x16x32_bf16 v[140:143], a[240:243], a[184:187], v[140:143]
ds_read_b64_tr_b16 a[220:221], v231 offset:12288
v_cvt_pk_bf16_f32 v167, v222, v223
v_mfma_f32_16x16x32_bf16 v[140:143], a[244:247], a[188:191], v[140:143]
s_add_u32 m0, s44, s41
v_exp_f32 v217, v121
v_mfma_f32_16x16x32_bf16 v[144:147], a[204:207], a[116:119], v[192:195]
ds_read_b64_tr_b16 a[222:223], v231 offset:18432
v_add_f32 v214, v214, v216
v_mfma_f32_16x16x32_bf16 v[144:147], a[200:203], a[112:115], v[144:147]
s_bitcmp1_b32 s48, 30
v_exp_f32 v218, v122
v_mfma_f32_16x16x32_bf16 v[144:147], a[196:199], a[108:111], v[144:147]
buffer_load_dwordx4 v241, s[4:7], s43 offen offset:128  lds
v_mfma_f32_16x16x32_bf16 v[144:147], a[192:195], a[104:107], v[144:147]
ds_read_b64_tr_b16 a[224:225], v228 offset:13312
v_add_f32 v214, v214, v217
v_mfma_f32_16x16x32_bf16 v[144:147], a[252:255], a[100:103], v[144:147]
s_cselect_b32 s47, s47, s6
v_exp_f32 v219, v123
v_mfma_f32_16x16x32_bf16 v[144:147], a[248:251], a[96:99], v[144:147]
ds_read_b64_tr_b16 a[226:227], v228 offset:19456
v_cvt_pk_bf16_f32 v170, v216, v217
v_mfma_f32_16x16x32_bf16 v[148:151], a[248:251], a[120:123], v[196:199]
ds_read_b64_tr_b16 a[228:229], v229 offset:13312
v_add_f32 v214, v214, v218
v_mfma_f32_16x16x32_bf16 v[148:151], a[252:255], a[124:127], v[148:151]
s_lshr_b32 s47, s47, 2
v_exp_f32 v220, v124
v_mfma_f32_16x16x32_bf16 v[148:151], a[192:195], a[128:131], v[148:151]
ds_read_b64_tr_b16 a[230:231], v229 offset:19456
v_add_f32 v214, v214, v219
v_mfma_f32_16x16x32_bf16 v[148:151], a[196:199], a[132:135], v[148:151]
s_add_u32 s45, s45, s38
v_exp_f32 v221, v125
v_mfma_f32_16x16x32_bf16 v[148:151], a[200:203], a[136:139], v[148:151]
buffer_load_dwordx4 v237, s[4:7], s43 offen offset:3200  lds
v_mfma_f32_16x16x32_bf16 v[148:151], a[204:207], a[140:143], v[148:151]
ds_read_b64_tr_b16 a[232:233], v230 offset:13312
v_cvt_pk_bf16_f32 v171, v218, v219
v_mfma_f32_16x16x32_bf16 v[152:155], a[204:207], a[164:167], v[200:203]
s_addk_i32 s46, 12288
v_exp_f32 v222, v126
v_mfma_f32_16x16x32_bf16 v[152:155], a[200:203], a[160:163], v[152:155]
ds_read_b64_tr_b16 a[234:235], v230 offset:19456
v_add_f32 v215, v215, v220
v_mfma_f32_16x16x32_bf16 v[152:155], a[196:199], a[156:159], v[152:155]
s_add_u32 m0, s44, s42
v_exp_f32 v223, v127
v_mfma_f32_16x16x32_bf16 v[152:155], a[192:195], a[152:155], v[152:155]
ds_read_b64_tr_b16 a[236:237], v231 offset:13312
v_add_f32 v215, v215, v221
v_mfma_f32_16x16x32_bf16 v[152:155], a[252:255], a[148:151], v[152:155]
ds_read_b64_tr_b16 a[238:239], v231 offset:19456
v_cvt_pk_bf16_f32 v174, v220, v221
v_mfma_f32_16x16x32_bf16 v[152:155], a[248:251], a[144:147], v[152:155]
s_waitcnt lgkmcnt(6)
v_add_f32 v215, v215, v222
v_cvt_pk_bf16_f32 v175, v222, v223
v_mfma_f32_16x16x32_bf16 v[156:159], a[248:251], a[168:171], v[204:207]
buffer_load_dwordx4 v241, s[4:7], s43 offen offset:256  lds
v_mfma_f32_16x16x32_bf16 v[156:159], a[252:255], a[172:175], v[156:159]
ds_read_b64_tr_b16 a[240:241], v228 offset:14336
v_add_f32 v215, v215, v223
v_mfma_f32_16x16x32_bf16 v[156:159], a[192:195], a[176:179], v[156:159]
ds_read_b64_tr_b16 a[242:243], v228 offset:20480
v_max3_f32 v240, v212, v213, v214
v_mfma_f32_16x16x32_bf16 v[156:159], a[196:199], a[180:183], v[156:159]
ds_read_b64_tr_b16 a[244:245], v229 offset:14336
v_max_f32 v240, v240, v215
v_mfma_f32_16x16x32_bf16 v[156:159], a[200:203], a[184:187], v[156:159]
ds_read_b64_tr_b16 a[246:247], v229 offset:20480
v_cmp_lt_f32 vcc, s52, v240
v_mfma_f32_16x16x32_bf16 v[156:159], a[204:207], a[188:191], v[156:159]
buffer_load_dwordx4 v237, s[4:7], s43 offen offset:3328  lds
s_cbranch_vccnz L_stub3
L_back3:
v_mfma_f32_16x16x32_bf16 v[0:3], v[160:163], a[208:211], v[0:3]
ds_read_b64_tr_b16 a[248:249], v230 offset:14336
v_add_f32 v208, v208, v212
v_mfma_f32_16x16x32_bf16 v[4:7], v[160:163], a[212:215], v[4:7]
s_add_u32 m0, s47, s40
v_exp_f32 v216, v128
v_mfma_f32_16x16x32_bf16 v[52:55], v[164:167], a[212:215], v[52:55]
ds_read_b64_tr_b16 a[250:251], v230 offset:20480
v_add_f32 v209, v209, v213
v_mfma_f32_16x16x32_bf16 v[48:51], v[164:167], a[208:211], v[48:51]
v_exp_f32 v217, v129
v_mfma_f32_16x16x32_bf16 a[0:3], v[168:171], a[208:211], a[0:3]
ds_read_b64_tr_b16 a[252:253], v231 offset:14336
v_add_f32 v210, v210, v214
v_mfma_f32_16x16x32_bf16 a[4:7], v[168:171], a[212:215], a[4:7]
v_exp_f32 v218, v130
v_mfma_f32_16x16x32_bf16 a[52:55], v[172:175], a[212:215], a[52:55]
ds_read_b64_tr_b16 a[254:255], v231 offset:20480
v_add_f32 v211, v211, v215
v_mfma_f32_16x16x32_bf16 a[48:51], v[172:175], a[208:211], a[48:51]
v_xor_b32 v236, v232, v236
v_add_f32 v212, v216, v217
v_mfma_f32_16x16x32_bf16 a[56:59], v[172:175], a[216:219], a[56:59]
buffer_load_dwordx4 v236, s[12:15], s49 offen offset:0  lds
v_mfma_f32_16x16x32_bf16 a[60:63], v[172:175], a[220:223], a[60:63]
s_add_u32 m0, s47, s41
v_cvt_pk_bf16_f32 v176, v216, v217
v_add_f32 v212, v212, v218
v_mfma_f32_16x16x32_bf16 a[12:15], v[168:171], a[220:223], a[12:15]
buffer_load_dwordx4 v236, s[12:15], s49 offen offset:128  lds
v_mfma_f32_16x16x32_bf16 a[8:11], v[168:171], a[216:219], a[8:11]
s_add_u32 m0, s47, s42
v_exp_f32 v219, v131
v_mfma_f32_16x16x32_bf16 v[56:59], v[164:167], a[216:219], v[56:59]
buffer_load_dwordx4 v236, s[12:15], s49 offen offset:256  lds
v_mfma_f32_16x16x32_bf16 v[60:63], v[164:167], a[220:223], v[60:63]
v_exp_f32 v220, v132
v_mfma_f32_16x16x32_bf16 v[12:15], v[160:163], a[220:223], v[12:15]
v_exp_f32 v221, v133
v_mfma_f32_16x16x32_bf16 v[8:11], v[160:163], a[216:219], v[8:11]
v_exp_f32 v222, v134
v_mfma_f32_16x16x32_bf16 v[16:19], v[160:163], a[224:227], v[16:19]
s_waitcnt vmcnt(15) lgkmcnt(0)
s_barrier
v_mfma_f32_16x16x32_bf16 v[20:23], v[160:163], a[228:231], v[20:23]
v_add_f32 v212, v212, v219
v_cvt_pk_bf16_f32 v177, v218, v219
v_mfma_f32_16x16x32_bf16 v[68:71], v[164:167], a[228:231], v[68:71]
v_exp_f32 v223, v135
v_mfma_f32_16x16x32_bf16 v[64:67], v[164:167], a[224:227], v[64:67]
ds_read_b128 a[192:195], v226 offset:12288
v_add_f32 v213, v220, v221
v_mfma_f32_16x16x32_bf16 a[16:19], v[168:171], a[224:227], a[16:19]
s_add_u32 m0, s46, s40
v_cvt_pk_bf16_f32 v180, v220, v221
v_add_f32 v213, v213, v222
v_mfma_f32_16x16x32_bf16 a[20:23], v[168:171], a[228:231], a[20:23]
v_exp_f32 v216, v136
v_mfma_f32_16x16x32_bf16 a[68:71], v[172:175], a[228:231], a[68:71]
ds_read_b128 a[196:199], v227 offset:12288
v_add_f32 v213, v213, v223
v_mfma_f32_16x16x32_bf16 a[64:67], v[172:175], a[224:227], a[64:67]
buffer_load_dwordx4 v241, s[8:11], s45 offen offset:0  lds
v_mfma_f32_16x16x32_bf16 a[72:75], v[172:175], a[232:235], a[72:75]
ds_read_b128 a[200:203], v226 offset:13312
v_cvt_pk_bf16_f32 v181, v222, v223
v_mfma_f32_16x16x32_bf16 a[76:79], v[172:175], a[236:239], a[76:79]
s_add_u32 s43, s43, s38
v_exp_f32 v217, v137
v_mfma_f32_16x16x32_bf16 a[28:31], v[168:171], a[236:239], a[28:31]
ds_read_b128 a[204:207], v227 offset:13312
v_add_f32 v214, v216, v217
v_mfma_f32_16x16x32_bf16 a[24:27], v[168:171], a[232:235], a[24:27]
buffer_load_dwordx4 v237, s[8:11], s45 offen offset:3072  lds
v_mfma_f32_16x16x32_bf16 v[72:75], v[164:167], a[232:235], v[72:75]
s_addk_i32 s44, 12288
v_exp_f32 v218, v138
v_mfma_f32_16x16x32_bf16 v[76:79], v[164:167], a[236:239], v[76:79]
ds_read_b128 a[208:211], v226 offset:14336
v_cvt_pk_bf16_f32 v184, v216, v217
v_mfma_f32_16x16x32_bf16 v[28:31], v[160:163], a[236:239], v[28:31]
ds_read_b128 a[212:215], v227 offset:14336
v_add_f32 v214, v214, v218
v_mfma_f32_16x16x32_bf16 v[24:27], v[160:163], a[232:235], v[24:27]
s_add_u32 m0, s46, s41
v_exp_f32 v219, v139
v_mfma_f32_16x16x32_bf16 v[32:35], v[160:163], a[240:243], v[32:35]
buffer_load_dwordx4 v241, s[8:11], s45 offen offset:128  lds
v_mfma_f32_16x16x32_bf16 v[36:39], v[160:163], a[244:247], v[36:39]
ds_read_b128 a[216:219], v226 offset:18432
v_add_f32 v214, v214, v219
v_mfma_f32_16x16x32_bf16 v[84:87], v[164:167], a[244:247], v[84:87]
v_exp_f32 v220, v140
v_mfma_f32_16x16x32_bf16 v[80:83], v[164:167], a[240:243], v[80:83]
ds_read_b128 a[220:223], v227 offset:18432
v_cvt_pk_bf16_f32 v185, v218, v219
v_mfma_f32_16x16x32_bf16 a[32:35], v[168:171], a[240:243], a[32:35]
buffer_load_dwordx4 v237, s[8:11], s45 offen offset:3200  lds
v_mfma_f32_16x16x32_bf16 a[36:39], v[168:171], a[244:247], a[36:39]
ds_read_b128 a[224:227], v226 offset:19456
s_add_u32 m0, s46, s42
v_mfma_f32_16x16x32_bf16 a[84:87], v[172:175], a[244:247], a[84:87]
s_add_u32 s34, s34, 1
v_exp_f32 v221, v141
v_mfma_f32_16x16x32_bf16 a[80:83], v[172:175], a[240:243], a[80:83]
ds_read_b128 a[228:231], v227 offset:19456
v_add_f32 v215, v220, v221
v_mfma_f32_16x16x32_bf16 a[88:91], v[172:175], a[248:251], a[88:91]
buffer_load_dwordx4 v241, s[8:11], s45 offen offset:256  lds
v_mfma_f32_16x16x32_bf16 a[92:95], v[172:175], a[252:255], a[92:95]
s_waitcnt lgkmcnt(4)
v_exp_f32 v222, v142
v_mfma_f32_16x16x32_bf16 a[44:47], v[168:171], a[252:255], a[44:47]
ds_read_b128 a[232:235], v226 offset:20480
v_cvt_pk_bf16_f32 v188, v220, v221
v_mfma_f32_16x16x32_bf16 a[40:43], v[168:171], a[248:251], a[40:43]
ds_read_b128 a[236:239], v227 offset:20480
v_add_f32 v215, v215, v222
v_mfma_f32_16x16x32_bf16 v[88:91], v[164:167], a[248:251], v[88:91]
v_exp_f32 v223, v143
v_mfma_f32_16x16x32_bf16 v[92:95], v[164:167], a[252:255], v[92:95]
buffer_load_dwordx4 v237, s[8:11], s45 offen offset:3328  lds
v_mfma_f32_16x16x32_bf16 v[44:47], v[160:163], a[252:255], v[44:47]
v_add_f32 v215, v215, v223
v_cvt_pk_bf16_f32 v189, v222, v223
v_mfma_f32_16x16x32_bf16 v[40:43], v[160:163], a[248:251], v[40:43]
s_branch L_loopb0
.p2align 6
L_loop0:
v_mfma_f32_16x16x32_bf16 v[96:99], a[212:215], a[116:119], v[192:195]
v_exp_f32 v216, v144
v_mfma_f32_16x16x32_bf16 v[96:99], a[208:211], a[112:115], v[96:99]
v_exp_f32 v217, v145
v_mfma_f32_16x16x32_bf16 v[96:99], a[204:207], a[108:111], v[96:99]
v_readlane_b32 s48, v239, s34
v_add_f32 v212, v212, v216
v_mfma_f32_16x16x32_bf16 v[96:99], a[200:203], a[104:107], v[96:99]
v_exp_f32 v218, v146
v_mfma_f32_16x16x32_bf16 v[96:99], a[196:199], a[100:103], v[96:99]
v_exp_f32 v219, v147
v_mfma_f32_16x16x32_bf16 v[96:99], a[192:195], a[96:99], v[96:99]
s_and_b32 s79, s48, s70
v_add_f32 v212, v212, v217
v_cvt_pk_bf16_f32 v178, v216, v217
v_mfma_f32_16x16x32_bf16 v[100:103], a[192:195], a[120:123], v[196:199]
s_waitcnt vmcnt(12) lgkmcnt(0)
s_barrier
v_mfma_f32_16x16x32_bf16 v[100:103], a[196:199], a[124:127], v[100:103]
v_exp_f32 v220, v148
v_mfma_f32_16x16x32_bf16 v[100:103], a[200:203], a[128:131], v[100:103]
ds_read_b64_tr_b16 a[240:241], v228 offset:0
v_add_f32 v212, v212, v218
v_mfma_f32_16x16x32_bf16 v[100:103], a[204:207], a[132:135], v[100:103]
s_add_u32 m0, s44, s40
v_add_f32 v212, v212, v219
v_cvt_pk_bf16_f32 v179, v218, v219
v_mfma_f32_16x16x32_bf16 v[100:103], a[208:211], a[136:139], v[100:103]
ds_read_b64_tr_b16 a[242:243], v228 offset:6144
v_add_f32 v213, v213, v220
v_mfma_f32_16x16x32_bf16 v[100:103], a[212:215], a[140:143], v[100:103]
s_and_b32 s46, s48, s71
v_add_u32 v234, v232, v234
v_xor_b32 v235, v232, v235
v_mfma_f32_16x16x32_bf16 v[104:107], a[212:215], a[164:167], v[200:203]
buffer_load_dwordx4 v234, s[4:7], s43 offen offset:0  lds
v_mfma_f32_16x16x32_bf16 v[104:107], a[208:211], a[160:163], v[104:107]
s_lshr_b32 s45, s48, 8
v_exp_f32 v221, v149
v_mfma_f32_16x16x32_bf16 v[104:107], a[204:207], a[156:159], v[104:107]
ds_read_b64_tr_b16 a[244:245], v229 offset:0
v_add_f32 v213, v213, v221
v_mfma_f32_16x16x32_bf16 v[104:107], a[200:203], a[152:155], v[104:107]
v_exp_f32 v222, v150
v_mfma_f32_16x16x32_bf16 v[104:107], a[196:199], a[148:151], v[104:107]
ds_read_b64_tr_b16 a[246:247], v229 offset:6144
v_cvt_pk_bf16_f32 v182, v220, v221
v_mfma_f32_16x16x32_bf16 v[104:107], a[192:195], a[144:147], v[104:107]
s_and_b32 s45, s45, s71
v_exp_f32 v223, v151
v_mfma_f32_16x16x32_bf16 v[108:111], a[192:195], a[168:171], v[204:207]
ds_read_b64_tr_b16 a[248:249], v230 offset:0
v_add_f32 v213, v213, v222
v_mfma_f32_16x16x32_bf16 v[108:111], a[196:199], a[172:175], v[108:111]
ds_read_b64_tr_b16 a[250:251], v230 offset:6144
v_add_f32 v213, v213, v223
v_mfma_f32_16x16x32_bf16 v[108:111], a[200:203], a[176:179], v[108:111]
v_exp_f32 v216, v152
v_mfma_f32_16x16x32_bf16 v[108:111], a[204:207], a[180:183], v[108:111]
buffer_load_dwordx4 v235, s[4:7], s43 offen offset:3072  lds
v_mfma_f32_16x16x32_bf16 v[108:111], a[208:211], a[184:187], v[108:111]
ds_read_b64_tr_b16 a[252:253], v231 offset:0
v_cvt_pk_bf16_f32 v183, v222, v223
v_mfma_f32_16x16x32_bf16 v[108:111], a[212:215], a[188:191], v[108:111]
s_bitcmp1_b32 s48, 28
v_exp_f32 v217, v153
v_mfma_f32_16x16x32_bf16 v[112:115], a[236:239], a[116:119], v[192:195]
ds_read_b64_tr_b16 a[254:255], v231 offset:6144
v_add_f32 v214, v214, v216
v_mfma_f32_16x16x32_bf16 v[112:115], a[232:235], a[112:115], v[112:115]
s_cselect_b64 s[50:51], s[30:31], s[28:29]
v_exp_f32 v218, v154
v_mfma_f32_16x16x32_bf16 v[112:115], a[228:231], a[108:111], v[112:115]
ds_read_b64_tr_b16 a[192:193], v228 offset:1024
v_add_f32 v214, v214, v217
v_mfma_f32_16x16x32_bf16 v[112:115], a[224:227], a[104:107], v[112:115]
ds_read_b64_tr_b16 a[194:195], v228 offset:7168
v_cvt_pk_bf16_f32 v186, v216, v217
v_mfma_f32_16x16x32_bf16 v[112:115], a[220:223], a[100:103], v[112:115]
s_add_u32 m0, s44, s41
v_exp_f32 v219, v155
v_mfma_f32_16x16x32_bf16 v[112:115], a[216:219], a[96:99], v[112:115]
ds_read_b64_tr_b16 a[196:197], v229 offset:1024
v_add_f32 v214, v214, v218
v_mfma_f32_16x16x32_bf16 v[116:119], a[216:219], a[120:123], v[196:199]
buffer_load_dwordx4 v234, s[4:7], s43 offen offset:128  lds
v_mfma_f32_16x16x32_bf16 v[116:119], a[220:223], a[124:127], v[116:119]
s_bitcmp1_b32 s48, 29
v_exp_f32 v220, v156
v_mfma_f32_16x16x32_bf16 v[116:119], a[224:227], a[128:131], v[116:119]
ds_read_b64_tr_b16 a[198:199], v229 offset:7168
v_add_f32 v214, v214, v219
v_mfma_f32_16x16x32_bf16 v[116:119], a[228:231], a[132:135], v[116:119]
ds_read_b64_tr_b16 a[200:201], v230 offset:1024
v_cvt_pk_bf16_f32 v187, v218, v219
v_mfma_f32_16x16x32_bf16 v[116:119], a[232:235], a[136:139], v[116:119]
s_cselect_b64 s[8:9], s[50:51], s[26:27]
v_exp_f32 v221, v157
v_mfma_f32_16x16x32_bf16 v[116:119], a[236:239], a[140:143], v[116:119]
ds_read_b64_tr_b16 a[202:203], v230 offset:7168
v_add_f32 v215, v215, v220
v_mfma_f32_16x16x32_bf16 v[120:123], a[236:239], a[164:167], v[200:203]
v_exp_f32 v222, v158
v_mfma_f32_16x16x32_bf16 v[120:123], a[232:235], a[160:163], v[120:123]
ds_read_b64_tr_b16 a[204:205], v231 offset:1024
v_add_f32 v215, v215, v221
v_mfma_f32_16x16x32_bf16 v[120:123], a[228:231], a[156:159], v[120:123]
v_cvt_pk_bf16_f32 v190, v220, v221
v_add_f32 v215, v215, v222
v_mfma_f32_16x16x32_bf16 v[120:123], a[224:227], a[152:155], v[120:123]
s_waitcnt lgkmcnt(5)
v_exp_f32 v223, v159
v_mfma_f32_16x16x32_bf16 v[120:123], a[220:223], a[148:151], v[120:123]
buffer_load_dwordx4 v235, s[4:7], s43 offen offset:3200  lds
v_mfma_f32_16x16x32_bf16 v[120:123], a[216:219], a[144:147], v[120:123]
ds_read_b64_tr_b16 a[206:207], v231 offset:7168
v_add_u32 v236, s79, v233
v_mfma_f32_16x16x32_bf16 v[124:127], a[216:219], a[168:171], v[204:207]
ds_read_b64_tr_b16 a[208:209], v228 offset:2048
v_add_f32 v215, v215, v223
v_mfma_f32_16x16x32_bf16 v[124:127], a[220:223], a[172:175], v[124:127]
ds_read_b64 v[236:237], v236
v_cvt_pk_bf16_f32 v191, v222, v223
v_mfma_f32_16x16x32_bf16 v[124:127], a[224:227], a[176:179], v[124:127]
ds_read_b64_tr_b16 a[210:211], v228 offset:8192
v_max3_f32 v240, v212, v213, v214
v_mfma_f32_16x16x32_bf16 v[124:127], a[228:231], a[180:183], v[124:127]
ds_read_b64_tr_b16 a[212:213], v229 offset:2048
v_max_f32 v240, v240, v215
v_mfma_f32_16x16x32_bf16 v[124:127], a[232:235], a[184:187], v[124:127]
ds_read_b64_tr_b16 a[214:215], v229 offset:8192
v_cmp_lt_f32 vcc, s52, v240
v_mfma_f32_16x16x32_bf16 v[124:127], a[236:239], a[188:191], v[124:127]
s_add_u32 m0, s44, s42
s_cbranch_vccnz L_stub0
L_back0:
v_mfma_f32_16x16x32_bf16 v[0:3], v[176:179], a[240:243], v[0:3]
buffer_load_dwordx4 v234, s[4:7], s43 offen offset:256  lds
v_mfma_f32_16x16x32_bf16 v[4:7], v[176:179], a[244:247], v[4:7]
ds_read_b64_tr_b16 a[216:217], v230 offset:2048
v_add_f32 v208, v208, v212
v_mfma_f32_16x16x32_bf16 v[52:55], v[180:183], a[244:247], v[52:55]
v_exp_f32 v216, v96
v_mfma_f32_16x16x32_bf16 v[48:51], v[180:183], a[240:243], v[48:51]
ds_read_b64_tr_b16 a[218:219], v230 offset:8192
v_add_f32 v209, v209, v213
v_mfma_f32_16x16x32_bf16 a[0:3], v[184:187], a[240:243], a[0:3]
v_add_f32 v210, v210, v214
v_add_f32 v211, v211, v215
v_mfma_f32_16x16x32_bf16 a[4:7], v[184:187], a[244:247], a[4:7]
v_exp_f32 v217, v97
v_mfma_f32_16x16x32_bf16 a[52:55], v[188:191], a[244:247], a[52:55]
ds_read_b64_tr_b16 a[220:221], v231 offset:2048
v_add_f32 v212, v216, v217
v_mfma_f32_16x16x32_bf16 a[48:51], v[188:191], a[240:243], a[48:51]
v_exp_f32 v218, v98
v_mfma_f32_16x16x32_bf16 a[56:59], v[188:191], a[248:251], a[56:59]
ds_read_b64_tr_b16 a[222:223], v231 offset:8192
v_cvt_pk_bf16_f32 v160, v216, v217
v_mfma_f32_16x16x32_bf16 a[60:63], v[188:191], a[252:255], a[60:63]
v_exp_f32 v219, v99
v_mfma_f32_16x16x32_bf16 a[12:15], v[184:187], a[252:255], a[12:15]
v_add_f32 v212, v212, v218
v_cvt_pk_bf16_f32 v161, v218, v219
v_mfma_f32_16x16x32_bf16 a[8:11], v[184:187], a[248:251], a[8:11]
buffer_load_dwordx4 v235, s[4:7], s43 offen offset:3328  lds
v_mfma_f32_16x16x32_bf16 v[56:59], v[180:183], a[248:251], v[56:59]
v_exp_f32 v220, v100
v_mfma_f32_16x16x32_bf16 v[60:63], v[180:183], a[252:255], v[60:63]
v_add_f32 v212, v212, v219
v_readlane_b32 s47, v238, s34
v_mfma_f32_16x16x32_bf16 v[12:15], v[176:179], a[252:255], v[12:15]
v_exp_f32 v221, v101
v_mfma_f32_16x16x32_bf16 v[8:11], v[176:179], a[248:251], v[8:11]
v_exp_f32 v222, v102
v_mfma_f32_16x16x32_bf16 v[16:19], v[176:179], a[192:195], v[16:19]
s_waitcnt vmcnt(12) lgkmcnt(0)
s_barrier
v_mfma_f32_16x16x32_bf16 v[20:23], v[176:179], a[196:199], v[20:23]
s_and_b32 s49, s47, s70
v_add_f32 v213, v220, v221
v_cvt_pk_bf16_f32 v164, v220, v221
v_mfma_f32_16x16x32_bf16 v[68:71], v[180:183], a[196:199], v[68:71]
ds_read_b128 a[224:227], v226 offset:0
v_add_f32 v213, v213, v222
v_mfma_f32_16x16x32_bf16 v[64:67], v[180:183], a[192:195], v[64:67]
s_add_u32 m0, s46, s40
v_exp_f32 v223, v103
v_mfma_f32_16x16x32_bf16 a[16:19], v[184:187], a[192:195], a[16:19]
ds_read_b128 a[228:231], v227 offset:0
v_add_u32 v236, v232, v236
v_mfma_f32_16x16x32_bf16 a[20:23], v[184:187], a[196:199], a[20:23]
buffer_load_dwordx4 v236, s[8:11], s45 offen offset:0  lds
v_mfma_f32_16x16x32_bf16 a[68:71], v[188:191], a[196:199], a[68:71]
s_and_b32 s44, s47, s71
v_xor_b32 v237, v232, v237
v_add_f32 v213, v213, v223
v_mfma_f32_16x16x32_bf16 a[64:67], v[188:191], a[192:195], a[64:67]
s_lshr_b32 s43, s47, 8
v_exp_f32 v216, v104
v_mfma_f32_16x16x32_bf16 a[72:75], v[188:191], a[200:203], a[72:75]
ds_read_b128 a[232:235], v226 offset:1024
v_cvt_pk_bf16_f32 v165, v222, v223
v_mfma_f32_16x16x32_bf16 a[76:79], v[188:191], a[204:207], a[76:79]
buffer_load_dwordx4 v237, s[8:11], s45 offen offset:3072  lds
v_mfma_f32_16x16x32_bf16 a[28:31], v[184:187], a[204:207], a[28:31]
s_and_b32 s43, s43, s71
v_exp_f32 v217, v105
v_mfma_f32_16x16x32_bf16 a[24:27], v[184:187], a[200:203], a[24:27]
ds_read_b128 a[236:239], v227 offset:1024
v_add_f32 v214, v216, v217
v_mfma_f32_16x16x32_bf16 v[72:75], v[180:183], a[200:203], v[72:75]
ds_read_b128 a[240:243], v226 offset:2048
v_cvt_pk_bf16_f32 v168, v216, v217
v_mfma_f32_16x16x32_bf16 v[76:79], v[180:183], a[204:207], v[76:79]
s_add_u32 m0, s46, s41
v_exp_f32 v218, v106
v_mfma_f32_16x16x32_bf16 v[28:31], v[176:179], a[204:207], v[28:31]
buffer_load_dwordx4 v236, s[8:11], s45 offen offset:128  lds
v_mfma_f32_16x16x32_bf16 v[24:27], v[176:179], a[200:203], v[24:27]
ds_read_b128 a[244:247], v227 offset:2048
v_add_f32 v214, v214, v218
v_mfma_f32_16x16x32_bf16 v[32:35], v[176:179], a[208:211], v[32:35]
s_bitcmp1_b32 s47, 28
v_exp_f32 v219, v107
v_mfma_f32_16x16x32_bf16 v[36:39], v[176:179], a[212:215], v[36:39]
ds_read_b128 a[248:251], v226 offset:6144
v_add_f32 v214, v214, v219
v_mfma_f32_16x16x32_bf16 v[84:87], v[180:183], a[212:215], v[84:87]
buffer_load_dwordx4 v237, s[8:11], s45 offen offset:3200  lds
v_mfma_f32_16x16x32_bf16 v[80:83], v[180:183], a[208:211], v[80:83]
s_cselect_b64 s[50:51], s[30:31], s[28:29]
v_exp_f32 v220, v108
v_mfma_f32_16x16x32_bf16 a[32:35], v[184:187], a[208:211], a[32:35]
ds_read_b128 a[252:255], v227 offset:6144
v_cvt_pk_bf16_f32 v169, v218, v219
v_mfma_f32_16x16x32_bf16 a[36:39], v[184:187], a[212:215], a[36:39]
s_bitcmp1_b32 s47, 29
v_exp_f32 v221, v109
v_mfma_f32_16x16x32_bf16 a[84:87], v[188:191], a[212:215], a[84:87]
ds_read_b128 a[192:195], v226 offset:7168
v_add_f32 v215, v220, v221
v_mfma_f32_16x16x32_bf16 a[80:83], v[188:191], a[208:211], a[80:83]
ds_read_b128 a[196:199], v227 offset:7168
v_cvt_pk_bf16_f32 v172, v220, v221
v_mfma_f32_16x16x32_bf16 a[88:91], v[188:191], a[216:219], a[88:91]
s_cselect_b64 s[4:5], s[50:51], s[24:25]
v_exp_f32 v222, v110
v_mfma_f32_16x16x32_bf16 a[92:95], v[188:191], a[220:223], a[92:95]
s_add_u32 m0, s46, s42
v_add_u32 v234, s49, v233
v_add_f32 v215, v215, v222
v_mfma_f32_16x16x32_bf16 a[44:47], v[184:187], a[220:223], a[44:47]
buffer_load_dwordx4 v236, s[8:11], s45 offen offset:256  lds
v_mfma_f32_16x16x32_bf16 a[40:43], v[184:187], a[216:219], a[40:43]
ds_read_b64 v[234:235], v234
ds_read_b128 a[200:203], v226 offset:8192
v_mfma_f32_16x16x32_bf16 v[88:91], v[180:183], a[216:219], v[88:91]
s_add_u32 s34, s34, 1
v_exp_f32 v223, v111
v_mfma_f32_16x16x32_bf16 v[92:95], v[180:183], a[220:223], v[92:95]
buffer_load_dwordx4 v237, s[8:11], s45 offen offset:3328  lds
v_mfma_f32_16x16x32_bf16 v[44:47], v[176:179], a[220:223], v[44:47]
ds_read_b128 a[204:207], v227 offset:8192
v_add_f32 v215, v215, v223
v_mfma_f32_16x16x32_bf16 v[40:43], v[176:179], a[216:219], v[40:43]
s_waitcnt lgkmcnt(7)
v_cvt_pk_bf16_f32 v173, v222, v223
s_cmp_eq_u32 s34, s35
s_cbranch_scc1 L_exit
L_loop1:
v_mfma_f32_16x16x32_bf16 v[128:131], a[244:247], a[116:119], v[192:195]
v_exp_f32 v216, v112
v_mfma_f32_16x16x32_bf16 v[128:131], a[240:243], a[112:115], v[128:131]
v_exp_f32 v217, v113
v_mfma_f32_16x16x32_bf16 v[128:131], a[236:239], a[108:111], v[128:131]
v_readlane_b32 s48, v239, s34
v_add_f32 v212, v212, v216
v_mfma_f32_16x16x32_bf16 v[128:131], a[232:235], a[104:107], v[128:131]
v_exp_f32 v218, v114
v_mfma_f32_16x16x32_bf16 v[128:131], a[228:231], a[100:103], v[128:131]
v_exp_f32 v219, v115
v_mfma_f32_16x16x32_bf16 v[128:131], a[224:227], a[96:99], v[128:131]
s_and_b32 s79, s48, s70
v_add_f32 v212, v212, v217
v_cvt_pk_bf16_f32 v162, v216, v217
v_mfma_f32_16x16x32_bf16 v[132:135], a[224:227], a[120:123], v[196:199]
s_waitcnt vmcnt(12) lgkmcnt(0)
s_barrier
v_mfma_f32_16x16x32_bf16 v[132:135], a[228:231], a[124:127], v[132:135]
v_exp_f32 v220, v116
v_mfma_f32_16x16x32_bf16 v[132:135], a[232:235], a[128:131], v[132:135]
ds_read_b64_tr_b16 a[208:209], v228 offset:12288
v_add_f32 v212, v212, v218
v_mfma_f32_16x16x32_bf16 v[132:135], a[236:239], a[132:135], v[132:135]
s_add_u32 m0, s44, s40
v_add_f32 v212, v212, v219
v_cvt_pk_bf16_f32 v163, v218, v219
v_mfma_f32_16x16x32_bf16 v[132:135], a[240:243], a[136:139], v[132:135]
ds_read_b64_tr_b16 a[210:211], v228 offset:18432
v_add_f32 v213, v213, v220
v_mfma_f32_16x16x32_bf16 v[132:135], a[244:247], a[140:143], v[132:135]
s_and_b32 s46, s48, s71
v_add_u32 v234, v232, v234
v_xor_b32 v235, v232, v235
v_mfma_f32_16x16x32_bf16 v[136:139], a[244:247], a[164:167], v[200:203]
buffer_load_dwordx4 v234, s[4:7], s43 offen offset:0  lds
v_mfma_f32_16x16x32_bf16 v[136:139], a[240:243], a[160:163], v[136:139]
s_lshr_b32 s45, s48, 8
v_exp_f32 v221, v117
v_mfma_f32_16x16x32_bf16 v[136:139], a[236:239], a[156:159], v[136:139]
ds_read_b64_tr_b16 a[212:213], v229 offset:12288
v_add_f32 v213, v213, v221
v_mfma_f32_16x16x32_bf16 v[136:139], a[232:235], a[152:155], v[136:139]
v_exp_f32 v222, v118
v_mfma_f32_16x16x32_bf16 v[136:139], a[228:231], a[148:151], v[136:139]
ds_read_b64_tr_b16 a[214:215], v229 offset:18432
v_cvt_pk_bf16_f32 v166, v220, v221
v_mfma_f32_16x16x32_bf16 v[136:139], a[224:227], a[144:147], v[136:139]
s_and_b32 s45, s45, s71
v_exp_f32 v223, v119
v_mfma_f32_16x16x32_bf16 v[140:143], a[224:227], a[168:171], v[204:207]
ds_read_b64_tr_b16 a[216:217], v230 offset:12288
v_add_f32 v213, v213, v222
v_mfma_f32_16x16x32_bf16 v[140:143], a[228:231], a[172:175], v[140:143]
ds_read_b64_tr_b16 a[218:219], v230 offset:18432
v_add_f32 v213, v213, v223
v_mfma_f32_16x16x32_bf16 v[140:143], a[232:235], a[176:179], v[140:143]
v_exp_f32 v216, v120
v_mfma_f32_16x16x32_bf16 v[140:143], a[236:239], a[180:183], v[140:143]
buffer_load_dwordx4 v235, s[4:7], s43 offen offset:3072  lds
v_mfma_f32_16x16x32_bf16 v[140:143], a[240:243], a[184:187], v[140:143]
ds_read_b64_tr_b16 a[220:221], v231 offset:12288
v_cvt_pk_bf16_f32 v167, v222, v223
v_mfma_f32_16x16x32_bf16 v[140:143], a[244:247], a[188:191], v[140:143]
s_bitcmp1_b32 s48, 28
v_exp_f32 v217, v121
v_mfma_f32_16x16x32_bf16 v[144:147], a[204:207], a[116:119], v[192:195]
ds_read_b64_tr_b16 a[222:223], v231 offset:18432
v_add_f32 v214, v214, v216
v_mfma_f32_16x16x32_bf16 v[144:147], a[200:203], a[112:115], v[144:147]
s_cselect_b64 s[50:51], s[30:31], s[28:29]
v_exp_f32 v218, v122
v_mfma_f32_16x16x32_bf16 v[144:147], a[196:199], a[108:111], v[144:147]
ds_read_b64_tr_b16 a[224:225], v228 offset:13312
v_add_f32 v214, v214, v217
v_mfma_f32_16x16x32_bf16 v[144:147], a[192:195], a[104:107], v[144:147]
ds_read_b64_tr_b16 a[226:227], v228 offset:19456
v_cvt_pk_bf16_f32 v170, v216, v217
v_mfma_f32_16x16x32_bf16 v[144:147], a[252:255], a[100:103], v[144:147]
s_add_u32 m0, s44, s41
v_exp_f32 v219, v123
v_mfma_f32_16x16x32_bf16 v[144:147], a[248:251], a[96:99], v[144:147]
ds_read_b64_tr_b16 a[228:229], v229 offset:13312
v_add_f32 v214, v214, v218
v_mfma_f32_16x16x32_bf16 v[148:151], a[248:251], a[120:123], v[196:199]
buffer_load_dwordx4 v234, s[4:7], s43 offen offset:128  lds
v_mfma_f32_16x16x32_bf16 v[148:151], a[252:255], a[124:127], v[148:151]
s_bitcmp1_b32 s48, 29
v_exp_f32 v220, v124
v_mfma_f32_16x16x32_bf16 v[148:151], a[192:195], a[128:131], v[148:151]
ds_read_b64_tr_b16 a[230:231], v229 offset:19456
v_add_f32 v214, v214, v219
v_mfma_f32_16x16x32_bf16 v[148:151], a[196:199], a[132:135], v[148:151]
ds_read_b64_tr_b16 a[232:233], v230 offset:13312
v_cvt_pk_bf16_f32 v171, v218, v219
v_mfma_f32_16x16x32_bf16 v[148:151], a[200:203], a[136:139], v[148:151]
s_cselect_b64 s[8:9], s[50:51], s[26:27]
v_exp_f32 v221, v125
v_mfma_f32_16x16x32_bf16 v[148:151], a[204:207], a[140:143], v[148:151]
ds_read_b64_tr_b16 a[234:235], v230 offset:19456
v_add_f32 v215, v215, v220
v_mfma_f32_16x16x32_bf16 v[152:155], a[204:207], a[164:167], v[200:203]
v_exp_f32 v222, v126
v_mfma_f32_16x16x32_bf16 v[152:155], a[200:203], a[160:163], v[152:155]
ds_read_b64_tr_b16 a[236:237], v231 offset:13312
v_add_f32 v215, v215, v221
v_mfma_f32_16x16x32_bf16 v[152:155], a[196:199], a[156:159], v[152:155]
v_cvt_pk_bf16_f32 v174, v220, v221
v_add_f32 v215, v215, v222
v_mfma_f32_16x16x32_bf16 v[152:155], a[192:195], a[152:155], v[152:155]
s_waitcnt lgkmcnt(5)
v_exp_f32 v223, v127
v_mfma_f32_16x16x32_bf16 v[152:155], a[252:255], a[148:151], v[152:155]
buffer_load_dwordx4 v235, s[4:7], s43 offen offset:3200  lds
v_mfma_f32_16x16x32_bf16 v[152:155], a[248:251], a[144:147], v[152:155]
ds_read_b64_tr_b16 a[238:239], v231 offset:19456
v_add_u32 v236, s79, v233
v_mfma_f32_16x16x32_bf16 v[156:159], a[248:251], a[168:171], v[204:207]
ds_read_b64_tr_b16 a[240:241], v228 offset:14336
v_add_f32 v215, v215, v223
v_mfma_f32_16x16x32_bf16 v[156:159], a[252:255], a[172:175], v[156:159]
ds_read_b64 v[236:237], v236
v_cvt_pk_bf16_f32 v175, v222, v223
v_mfma_f32_16x16x32_bf16 v[156:159], a[192:195], a[176:179], v[156:159]
ds_read_b64_tr_b16 a[242:243], v228 offset:20480
v_max3_f32 v240, v212, v213, v214
v_mfma_f32_16x16x32_bf16 v[156:159], a[196:199], a[180:183], v[156:159]
ds_read_b64_tr_b16 a[244:245], v229 offset:14336
v_max_f32 v240, v240, v215
v_mfma_f32_16x16x32_bf16 v[156:159], a[200:203], a[184:187], v[156:159]
ds_read_b64_tr_b16 a[246:247], v229 offset:20480
v_cmp_lt_f32 vcc, s52, v240
v_mfma_f32_16x16x32_bf16 v[156:159], a[204:207], a[188:191], v[156:159]
s_add_u32 m0, s44, s42
s_cbranch_vccnz L_stub1
L_back1:
v_mfma_f32_16x16x32_bf16 v[0:3], v[160:163], a[208:211], v[0:3]
buffer_load_dwordx4 v234, s[4:7], s43 offen offset:256  lds
v_mfma_f32_16x16x32_bf16 v[4:7], v[160:163], a[212:215], v[4:7]
ds_read_b64_tr_b16 a[248:249], v230 offset:14336
v_add_f32 v208, v208, v212
v_mfma_f32_16x16x32_bf16 v[52:55], v[164:167], a[212:215], v[52:55]
v_exp_f32 v216, v128
v_mfma_f32_16x16x32_bf16 v[48:51], v[164:167], a[208:211], v[48:51]
ds_read_b64_tr_b16 a[250:251], v230 offset:20480
v_add_f32 v209, v209, v213
v_mfma_f32_16x16x32_bf16 a[0:3], v[168:171], a[208:211], a[0:3]
v_add_f32 v210, v210, v214
v_add_f32 v211, v211, v215
v_mfma_f32_16x16x32_bf16 a[4:7], v[168:171], a[212:215], a[4:7]
v_exp_f32 v217, v129
v_mfma_f32_16x16x32_bf16 a[52:55], v[172:175], a[212:215], a[52:55]
ds_read_b64_tr_b16 a[252:253], v231 offset:14336
v_add_f32 v212, v216, v217
v_mfma_f32_16x16x32_bf16 a[48:51], v[172:175], a[208:211], a[48:51]
v_exp_f32 v218, v130
v_mfma_f32_16x16x32_bf16 a[56:59], v[172:175], a[216:219], a[56:59]
ds_read_b64_tr_b16 a[254:255], v231 offset:20480
v_cvt_pk_bf16_f32 v176, v216, v217
v_mfma_f32_16x16x32_bf16 a[60:63], v[172:175], a[220:223], a[60:63]
v_exp_f32 v219, v131
v_mfma_f32_16x16x32_bf16 a[12:15], v[168:171], a[220:223], a[12:15]
v_add_f32 v212, v212, v218
v_cvt_pk_bf16_f32 v177, v218, v219
v_mfma_f32_16x16x32_bf16 a[8:11], v[168:171], a[216:219], a[8:11]
buffer_load_dwordx4 v235, s[4:7], s43 offen offset:3328  lds
v_mfma_f32_16x16x32_bf16 v[56:59], v[164:167], a[216:219], v[56:59]
v_exp_f32 v220, v132
v_mfma_f32_16x16x32_bf16 v[60:63], v[164:167], a[220:223], v[60:63]
v_add_f32 v212, v212, v219
v_readlane_b32 s47, v238, s34
v_mfma_f32_16x16x32_bf16 v[12:15], v[160:163], a[220:223], v[12:15]
v_exp_f32 v221, v133
v_mfma_f32_16x16x32_bf16 v[8:11], v[160:163], a[216:219], v[8:11]
v_exp_f32 v222, v134
v_mfma_f32_16x16x32_bf16 v[16:19], v[160:163], a[224:227], v[16:19]
s_waitcnt vmcnt(12) lgkmcnt(0)
s_barrier
v_mfma_f32_16x16x32_bf16 v[20:23], v[160:163], a[228:231], v[20:23]
s_and_b32 s49, s47, s70
v_add_f32 v213, v220, v221
v_cvt_pk_bf16_f32 v180, v220, v221
v_mfma_f32_16x16x32_bf16 v[68:71], v[164:167], a[228:231], v[68:71]
ds_read_b128 a[192:195], v226 offset:12288
v_add_f32 v213, v213, v222
v_mfma_f32_16x16x32_bf16 v[64:67], v[164:167], a[224:227], v[64:67]
s_add_u32 m0, s46, s40
v_exp_f32 v223, v135
v_mfma_f32_16x16x32_bf16 a[16:19], v[168:171], a[224:227], a[16:19]
ds_read_b128 a[196:199], v227 offset:12288
v_add_u32 v236, v232, v236
v_mfma_f32_16x16x32_bf16 a[20:23], v[168:171], a[228:231], a[20:23]
buffer_load_dwordx4 v236, s[8:11], s45 offen offset:0  lds
v_mfma_f32_16x16x32_bf16 a[68:71], v[172:175], a[228:231], a[68:71]
s_and_b32 s44, s47, s71
v_xor_b32 v237, v232, v237
v_add_f32 v213, v213, v223
v_mfma_f32_16x16x32_bf16 a[64:67], v[172:175], a[224:227], a[64:67]
s_lshr_b32 s43, s47, 8
v_exp_f32 v216, v136
v_mfma_f32_16x16x32_bf16 a[72:75], v[172:175], a[232:235], a[72:75]
ds_read_b128 a[200:203], v226 offset:13312
v_cvt_pk_bf16_f32 v181, v222, v223
v_mfma_f32_16x16x32_bf16 a[76:79], v[172:175], a[236:239], a[76:79]
buffer_load_dwordx4 v237, s[8:11], s45 offen offset:3072  lds
v_mfma_f32_16x16x32_bf16 a[28:31], v[168:171], a[236:239], a[28:31]
s_and_b32 s43, s43, s71
v_exp_f32 v217, v137
v_mfma_f32_16x16x32_bf16 a[24:27], v[168:171], a[232:235], a[24:27]
ds_read_b128 a[204:207], v227 offset:13312
v_add_f32 v214, v216, v217
v_mfma_f32_16x16x32_bf16 v[72:75], v[164:167], a[232:235], v[72:75]
ds_read_b128 a[208:211], v226 offset:14336
v_cvt_pk_bf16_f32 v184, v216, v217
v_mfma_f32_16x16x32_bf16 v[76:79], v[164:167], a[236:239], v[76:79]
s_add_u32 m0, s46, s41
v_exp_f32 v218, v138
v_mfma_f32_16x16x32_bf16 v[28:31], v[160:163], a[236:239], v[28:31]
buffer_load_dwordx4 v236, s[8:11], s45 offen offset:128  lds
v_mfma_f32_16x16x32_bf16 v[24:27], v[160:163], a[232:235], v[24:27]
ds_read_b128 a[212:215], v227 offset:14336
v_add_f32 v214, v214, v218
v_mfma_f32_16x16x32_bf16 v[32:35], v[160:163], a[240:243], v[32:35]
s_bitcmp1_b32 s47, 28
v_exp_f32 v219, v139
v_mfma_f32_16x16x32_bf16 v[36:39], v[160:163], a[244:247], v[36:39]
ds_read_b128 a[216:219], v226 offset:18432
v_add_f32 v214, v214, v219
v_mfma_f32_16x16x32_bf16 v[84:87], v[164:167], a[244:247], v[84:87]
buffer_load_dwordx4 v237, s[8:11], s45 offen offset:3200  lds
v_mfma_f32_16x16x32_bf16 v[80:83], v[164:167], a[240:243], v[80:83]
s_cselect_b64 s[50:51], s[30:31], s[28:29]
v_exp_f32 v220, v140
v_mfma_f32_16x16x32_bf16 a[32:35], v[168:171], a[240:243], a[32:35]
ds_read_b128 a[220:223], v227 offset:18432
v_cvt_pk_bf16_f32 v185, v218, v219
v_mfma_f32_16x16x32_bf16 a[36:39], v[168:171], a[244:247], a[36:39]
s_bitcmp1_b32 s47, 29
v_exp_f32 v221, v141
v_mfma_f32_16x16x32_bf16 a[84:87], v[172:175], a[244:247], a[84:87]
ds_read_b128 a[224:227], v226 offset:19456
v_add_f32 v215, v220, v221
v_mfma_f32_16x16x32_bf16 a[80:83], v[172:175], a[240:243], a[80:83]
ds_read_b128 a[228:231], v227 offset:19456
v_cvt_pk_bf16_f32 v188, v220, v221
v_mfma_f32_16x16x32_bf16 a[88:91], v[172:175], a[248:251], a[88:91]
s_cselect_b64 s[4:5], s[50:51], s[24:25]
v_exp_f32 v222, v142
v_mfma_f32_16x16x32_bf16 a[92:95], v[172:175], a[252:255], a[92:95]
s_add_u32 m0, s46, s42
v_add_u32 v234, s49, v233
v_add_f32 v215, v215, v222
v_mfma_f32_16x16x32_bf16 a[44:47], v[168:171], a[252:255], a[44:47]
buffer_load_dwordx4 v236, s[8:11], s45 offen offset:256  lds
v_mfma_f32_16x16x32_bf16 a[40:43], v[168:171], a[248:251], a[40:43]
ds_read_b64 v[234:235], v234
ds_read_b128 a[232:235], v226 offset:20480
v_mfma_f32_16x16x32_bf16 v[88:91], v[164:167], a[248:251], v[88:91]
s_add_u32 s34, s34, 1
v_exp_f32 v223, v143
v_mfma_f32_16x16x32_bf16 v[92:95], v[164:167], a[252:255], v[92:95]
buffer_load_dwordx4 v237, s[8:11], s45 offen offset:3328  lds
v_mfma_f32_16x16x32_bf16 v[44:47], v[160:163], a[252:255], v[44:47]
ds_read_b128 a[236:239], v227 offset:20480
v_add_f32 v215, v215, v223
v_mfma_f32_16x16x32_bf16 v[40:43], v[160:163], a[248:251], v[40:43]
s_waitcnt lgkmcnt(7)
v_cvt_pk_bf16_f32 v189, v222, v223
s_cmp_eq_u32 s34, s39
s_cbranch_scc0 L_loop0
L_last:
s_lshl_b32 s86, s36, 8
s_add_u32 s88, s86, 160768
s_sub_u32 s89, 161536, s86
s_add_u32 s50, s86, 161792
s_mov_b32 s90, 0xffff0000
s_mov_b32 s91, 0xffff0000
v_exp_f32 v216, v144
v_exp_f32 v217, v145
v_exp_f32 v218, v146
v_exp_f32 v219, v147
v_add_f32 v212, v212, v216
v_add_f32 v212, v212, v217
v_cvt_pk_bf16_f32 v178, v216, v217
v_exp_f32 v220, v148
s_waitcnt vmcnt(12) lgkmcnt(0)
s_barrier
ds_read_b64_tr_b16 a[240:241], v228 offset:0
ds_read_b64_tr_b16 a[242:243], v228 offset:6144
ds_read_b64_tr_b16 a[244:245], v229 offset:0
ds_read_b64_tr_b16 a[246:247], v229 offset:6144
v_add_u32 v234, v232, v234
v_xor_b32 v235, v232, v235
v_exp_f32 v221, v149
v_add_f32 v212, v212, v218
v_add_f32 v212, v212, v219
v_cvt_pk_bf16_f32 v179, v218, v219
v_exp_f32 v222, v150
ds_read_b64_tr_b16 a[248:249], v230 offset:0
ds_read_b64_tr_b16 a[250:251], v230 offset:6144
ds_read_b64_tr_b16 a[252:253], v231 offset:0
ds_read_b64_tr_b16 a[254:255], v231 offset:6144
v_exp_f32 v223, v151
v_add_f32 v213, v213, v220
v_add_f32 v213, v213, v221
v_cvt_pk_bf16_f32 v182, v220, v221
s_add_u32 m0, s44, s40
v_exp_f32 v216, v152
buffer_load_dwordx4 v234, s[4:7], s43 offen offset:0  lds
ds_read_b64_tr_b16 a[192:193], v228 offset:1024
ds_read_b64_tr_b16 a[194:195], v228 offset:7168
ds_read_b64_tr_b16 a[196:197], v229 offset:1024
ds_read_b64_tr_b16 a[198:199], v229 offset:7168
v_exp_f32 v217, v153
v_add_f32 v213, v213, v222
v_add_f32 v213, v213, v223
v_cvt_pk_bf16_f32 v183, v222, v223
v_exp_f32 v218, v154
buffer_load_dwordx4 v235, s[4:7], s43 offen offset:3072  lds
ds_read_b64_tr_b16 a[200:201], v230 offset:1024
ds_read_b64_tr_b16 a[202:203], v230 offset:7168
ds_read_b64_tr_b16 a[204:205], v231 offset:1024
ds_read_b64_tr_b16 a[206:207], v231 offset:7168
v_exp_f32 v219, v155
v_add_f32 v214, v214, v216
v_add_f32 v214, v214, v217
v_cvt_pk_bf16_f32 v186, v216, v217
s_add_u32 m0, s44, s41
v_exp_f32 v220, v156
buffer_load_dwordx4 v234, s[4:7], s43 offen offset:128  lds
ds_read_b64_tr_b16 a[208:209], v228 offset:2048
ds_read_b64_tr_b16 a[210:211], v228 offset:8192
ds_read_b64_tr_b16 a[212:213], v229 offset:2048
ds_read_b64_tr_b16 a[214:215], v229 offset:8192
v_exp_f32 v221, v157
v_add_f32 v214, v214, v218
v_add_f32 v214, v214, v219
v_cvt_pk_bf16_f32 v187, v218, v219
v_exp_f32 v222, v158
buffer_load_dwordx4 v235, s[4:7], s43 offen offset:3200  lds
ds_read_b64_tr_b16 a[216:217], v230 offset:2048
ds_read_b64_tr_b16 a[218:219], v230 offset:8192
ds_read_b64_tr_b16 a[220:221], v231 offset:2048
ds_read_b64_tr_b16 a[222:223], v231 offset:8192
v_exp_f32 v223, v159
v_add_f32 v215, v215, v220
v_add_f32 v215, v215, v221
v_cvt_pk_bf16_f32 v190, v220, v221
v_add_f32 v215, v215, v222
v_add_f32 v215, v215, v223
s_add_u32 m0, s44, s42
v_cvt_pk_bf16_f32 v191, v222, v223
buffer_load_dwordx4 v234, s[4:7], s43 offen offset:256  lds
v_mbcnt_lo_u32_b32 v255, -1, 0
v_mbcnt_hi_u32_b32 v255, -1, v255
v_and_b32 v251, 31, v255
v_lshlrev_b32 v251, 2, v251
v_max3_f32 v240, v212, v213, v214
v_max_f32 v240, v240, v215
buffer_load_dwordx4 v235, s[4:7], s43 offen offset:3328  lds
v_add_u32 v250, s88, v251
v_add_u32 v251, s89, v251
v_lshlrev_b32 v255, 4, v255
v_add_u32 v249, s76, v255
v_cmp_lt_f32 vcc, s52, v240
s_waitcnt lgkmcnt(0)
s_cbranch_vccnz L_stub17
L_back17:
v_mfma_f32_16x16x32_bf16 a[0:3], v[184:187], a[240:243], a[0:3]
v_add_f32 v210, v210, v214
v_add_f32 v211, v211, v215
v_mfma_f32_16x16x32_bf16 a[4:7], v[184:187], a[244:247], a[4:7]
v_cndmask_b32 v240, v200, v204, s[90:91]
v_add_f32 v208, v208, v212
v_mfma_f32_16x16x32_bf16 a[8:11], v[184:187], a[248:251], a[8:11]
v_permlane16_swap_b32 v210, v211
v_mfma_f32_16x16x32_bf16 a[12:15], v[184:187], a[252:255], a[12:15]
v_add_f32 v210, v210, v211
v_add_f32 v209, v209, v213
v_mfma_f32_16x16x32_bf16 a[16:19], v[184:187], a[192:195], a[16:19]
v_mov_b32 v211, v210
v_cndmask_b32 v252, v192, v196, s[90:91]
v_mfma_f32_16x16x32_bf16 a[20:23], v[184:187], a[196:199], a[20:23]
v_permlane32_swap_b32 v210, v211
v_mfma_f32_16x16x32_bf16 a[24:27], v[184:187], a[200:203], a[24:27]
v_add_f32 v210, v210, v211
v_add_u32 v152, s94, v242
v_mfma_f32_16x16x32_bf16 a[28:31], v[184:187], a[204:207], a[28:31]
ds_write2_b32 v250, v240, v210 offset0:0 offset1:32
v_mfma_f32_16x16x32_bf16 a[32:35], v[184:187], a[208:211], a[32:35]
v_permlane16_swap_b32 v208, v209
v_mfma_f32_16x16x32_bf16 a[36:39], v[184:187], a[212:215], a[36:39]
s_sub_u32 s86, s92, s84
v_add_f32 v208, v208, v209
v_lshlrev_b32 v153, 2, v242
v_mfma_f32_16x16x32_bf16 a[40:43], v[184:187], a[216:219], a[40:43]
s_addk_i32 s86, -24576
v_mov_b32 v209, v208
v_mfma_f32_16x16x32_bf16 a[44:47], v[184:187], a[220:223], a[44:47]
ds_read_b32 v144, v152 offset:0
ds_read_b32 v148, v152 offset:64
v_mfma_f32_16x16x32_bf16 a[48:51], v[188:191], a[240:243], a[48:51]
s_sub_u32 s89, s93, s84
v_permlane32_swap_b32 v208, v209
v_mfma_f32_16x16x32_bf16 a[52:55], v[188:191], a[244:247], a[52:55]
s_addk_i32 s89, -24576
v_add_f32 v208, v208, v209
v_and_b32 v153, 16, v153
v_mfma_f32_16x16x32_bf16 a[56:59], v[188:191], a[248:251], a[56:59]
v_add_u32 v120, s86, v228
v_add_u32 v121, s86, v229
v_mfma_f32_16x16x32_bf16 a[60:63], v[188:191], a[252:255], a[60:63]
v_add_u32 v122, s86, v230
v_add_u32 v123, s86, v231
v_mfma_f32_16x16x32_bf16 a[64:67], v[188:191], a[192:195], a[64:67]
v_mov_b32 v152, 0xffff
v_lshlrev_b32 v153, v153, v152
v_mfma_f32_16x16x32_bf16 a[68:71], v[188:191], a[196:199], a[68:71]
s_waitcnt vmcnt(12) lgkmcnt(0)
s_barrier
v_mfma_f32_16x16x32_bf16 a[72:75], v[188:191], a[200:203], a[72:75]
ds_read2_b32 v[216:217], v251 offset0:0 offset1:32
v_mfma_f32_16x16x32_bf16 a[76:79], v[188:191], a[204:207], a[76:79]
ds_read_b64_tr_b16 a[96:97], v120 offset:0
ds_read_b64_tr_b16 a[98:99], v120 offset:6144
v_mfma_f32_16x16x32_bf16 a[80:83], v[188:191], a[208:211], a[80:83]
ds_read_b64_tr_b16 a[100:101], v121 offset:0
ds_read_b64_tr_b16 a[102:103], v121 offset:6144
v_mfma_f32_16x16x32_bf16 a[84:87], v[188:191], a[212:215], a[84:87]
ds_read_b64_tr_b16 a[104:105], v122 offset:0
ds_read_b64_tr_b16 a[106:107], v122 offset:6144
v_mfma_f32_16x16x32_bf16 a[88:91], v[188:191], a[216:219], a[88:91]
ds_read_b64_tr_b16 a[108:109], v123 offset:0
ds_read_b64_tr_b16 a[110:111], v123 offset:6144
v_mfma_f32_16x16x32_bf16 a[92:95], v[188:191], a[220:223], a[92:95]
ds_read_b64_tr_b16 a[112:113], v120 offset:1024
ds_read_b64_tr_b16 a[114:115], v120 offset:7168
v_mfma_f32_16x16x32_bf16 v[0:3], v[176:179], a[240:243], v[0:3]
ds_read_b64_tr_b16 a[116:117], v121 offset:1024
ds_read_b64_tr_b16 a[118:119], v121 offset:7168
v_mfma_f32_16x16x32_bf16 v[4:7], v[176:179], a[244:247], v[4:7]
ds_read_b64_tr_b16 a[120:121], v122 offset:1024
ds_read_b64_tr_b16 a[122:123], v122 offset:7168
v_mfma_f32_16x16x32_bf16 v[8:11], v[176:179], a[248:251], v[8:11]
ds_read_b64_tr_b16 a[124:125], v123 offset:1024
ds_read_b64_tr_b16 a[126:127], v123 offset:7168
v_mfma_f32_16x16x32_bf16 v[12:15], v[176:179], a[252:255], v[12:15]
ds_read_b64_tr_b16 a[128:129], v120 offset:2048
ds_read_b64_tr_b16 a[130:131], v120 offset:8192
v_mfma_f32_16x16x32_bf16 v[16:19], v[176:179], a[192:195], v[16:19]
ds_read_b64_tr_b16 a[132:133], v121 offset:2048
ds_read_b64_tr_b16 a[134:135], v121 offset:8192
v_mfma_f32_16x16x32_bf16 v[20:23], v[176:179], a[196:199], v[20:23]
ds_read_b64_tr_b16 a[136:137], v122 offset:2048
ds_read_b64_tr_b16 a[138:139], v122 offset:8192
v_mfma_f32_16x16x32_bf16 v[24:27], v[176:179], a[200:203], v[24:27]
ds_read_b64_tr_b16 a[140:141], v123 offset:2048
ds_read_b64_tr_b16 a[142:143], v123 offset:8192
v_mfma_f32_16x16x32_bf16 v[28:31], v[176:179], a[204:207], v[28:31]
ds_write_b128 v249, a[0:3] offset:0
v_mfma_f32_16x16x32_bf16 v[32:35], v[176:179], a[208:211], v[32:35]
v_exp_f32 v145, -|v144|
v_mfma_f32_16x16x32_bf16 v[36:39], v[176:179], a[212:215], v[36:39]
v_exp_f32 v149, -|v148|
v_mfma_f32_16x16x32_bf16 v[40:43], v[176:179], a[216:219], v[40:43]
ds_write_b128 v249, a[4:7] offset:1024
v_mfma_f32_16x16x32_bf16 v[44:47], v[176:179], a[220:223], v[44:47]
v_add_f32 v146, 1.0, v145
v_add_f32 v150, 1.0, v149
v_mfma_f32_16x16x32_bf16 v[48:51], v[180:183], a[240:243], v[48:51]
v_rcp_f32 v146, v146
v_mfma_f32_16x16x32_bf16 v[52:55], v[180:183], a[244:247], v[52:55]
ds_write_b128 v249, a[8:11] offset:2048
v_mfma_f32_16x16x32_bf16 v[56:59], v[180:183], a[248:251], v[56:59]
v_rcp_f32 v150, v150
v_mfma_f32_16x16x32_bf16 v[60:63], v[180:183], a[252:255], v[60:63]
s_waitcnt lgkmcnt(15)
v_min_f32 v218, v252, v216
v_sub_f32 v244, v218, v252
v_mfma_f32_16x16x32_bf16 v[64:67], v[180:183], a[192:195], v[64:67]
ds_write_b128 v249, a[12:15] offset:3072
v_mfma_f32_16x16x32_bf16 v[68:71], v[180:183], a[196:199], v[68:71]
v_sub_f32 v246, v218, v216
v_mul_f32 v146, s54, v146
v_mfma_f32_16x16x32_bf16 v[72:75], v[180:183], a[200:203], v[72:75]
v_exp_f32 v244, v244
v_mfma_f32_16x16x32_bf16 v[76:79], v[180:183], a[204:207], v[76:79]
ds_write_b128 v249, a[16:19] offset:4096
v_mfma_f32_16x16x32_bf16 v[80:83], v[180:183], a[208:211], v[80:83]
v_exp_f32 v246, v246
v_mfma_f32_16x16x32_bf16 v[84:87], v[180:183], a[212:215], v[84:87]
v_mul_f32 v218, v244, v208
v_fma_f32 v218, v246, v217, v218
v_mfma_f32_16x16x32_bf16 v[88:91], v[180:183], a[216:219], v[88:91]
ds_write_b128 v249, a[20:23] offset:5120
v_mfma_f32_16x16x32_bf16 v[92:95], v[180:183], a[220:223], v[92:95]
v_mul_f32 v150, s54, v150
v_mul_f32 v145, v145, v146
v_rcp_f32 v218, v218
ds_write_b128 v249, a[24:27] offset:6144
s_sub_u32 s87, 15, s37
s_mul_i32 s87, s87, 49152
s_mov_b32 s88, -24576
v_mul_f32 v149, v149, v150
v_cvt_pk_bf16_f32 v146, v146, v146
v_cvt_pk_bf16_f32 v150, v150, v150
v_cvt_pk_bf16_f32 v145, v145, v145
v_mul_f32 v218, s55, v218
v_mul_f32 v244, v244, v218
ds_write_b128 v249, a[28:31] offset:7168
s_cmp_lt_u32 s36, 2
s_cselect_b32 s96, 0, 86016
s_cselect_b32 s88, 24576, s88
s_mul_i32 s88, s88, s36
s_add_u32 s87, s87, s96
v_cvt_pk_bf16_f32 v149, v149, v149
v_and_b32 v146, v153, v146
v_and_b32 v150, v153, v150
v_and_b32 v145, v153, v145
v_mul_f32 v246, v246, v218
v_bfe_u32 v245, v255, 2, 7
ds_write_b128 v249, a[32:35] offset:8192
v_and_b32 v149, v153, v149
v_cmp_le_f32 vcc, 0, v144
s_nop 1
v_cndmask_b32 v144, v145, v146, vcc
v_add_u32 v124, s89, v228
v_cndmask_b32 v147, v146, v145, vcc
v_cndmask_b32 v112, 0, v144, s[72:73]
v_cndmask_b32 v113, 0, v144, s[74:75]
ds_write_b128 v249, a[36:39] offset:9216
v_add_u32 v245, s50, v245
v_lshrrev_b32 v247, 4, v255
v_and_b32 v247, 48, v247
v_add_u32 v247, s50, v247
v_cndmask_b32 v114, 0, v147, s[72:73]
v_cndmask_b32 v115, 0, v147, s[74:75]
v_cmp_le_f32 vcc, 0, v148
s_nop 1
v_cndmask_b32 v148, v149, v150, vcc
ds_write_b128 v249, a[40:43] offset:10240
v_cndmask_b32 v151, v150, v149, vcc
v_cndmask_b32 v116, 0, v148, s[72:73]
v_add_u32 v125, s89, v229
v_cndmask_b32 v117, 0, v148, s[74:75]
v_cndmask_b32 v118, 0, v151, s[72:73]
v_cndmask_b32 v119, 0, v151, s[74:75]
ds_write_b128 v249, a[44:47] offset:11264
ds_write2_b32 v245, v244, v246 offset0:0 offset1:32
ds_read_b128 v[208:211], v247 offset:0
ds_read_b128 v[212:215], v247 offset:64
ds_read_b128 v[232:235], v247 offset:128
ds_read_b128 v[236:239], v247 offset:192
v_add_u32 v126, s89, v230
v_add_u32 v127, s89, v231
v_add_u32 v250, s92, v255
s_add_u32 s87, s87, s88
s_add_u32 s88, s87, 6144
s_add_u32 s34, s34, 1
L_final:
s_waitcnt vmcnt(0) lgkmcnt(0)
s_barrier
ds_read_b64_tr_b16 a[144:145], v124 offset:0
ds_read_b64_tr_b16 a[146:147], v124 offset:6144
ds_read_b64_tr_b16 a[148:149], v125 offset:0
ds_read_b64_tr_b16 a[150:151], v125 offset:6144
ds_read_b64_tr_b16 a[152:153], v126 offset:0
ds_read_b64_tr_b16 a[154:155], v126 offset:6144
ds_read_b64_tr_b16 a[156:157], v127 offset:0
ds_read_b64_tr_b16 a[158:159], v127 offset:6144
ds_read_b64_tr_b16 a[160:161], v124 offset:1024
ds_read_b64_tr_b16 a[162:163], v124 offset:7168
ds_read_b64_tr_b16 a[164:165], v125 offset:1024
ds_read_b64_tr_b16 a[166:167], v125 offset:7168
ds_read_b64_tr_b16 a[168:169], v126 offset:1024
ds_read_b64_tr_b16 a[170:171], v126 offset:7168
ds_read_b64_tr_b16 a[172:173], v127 offset:1024
ds_read_b64_tr_b16 a[174:175], v127 offset:7168
ds_read_b64_tr_b16 a[176:177], v124 offset:2048
ds_read_b64_tr_b16 a[178:179], v124 offset:8192
ds_read_b64_tr_b16 a[180:181], v125 offset:2048
ds_read_b64_tr_b16 a[182:183], v125 offset:8192
ds_read_b64_tr_b16 a[184:185], v126 offset:2048
ds_read_b64_tr_b16 a[186:187], v126 offset:8192
ds_read_b64_tr_b16 a[188:189], v127 offset:2048
ds_read_b64_tr_b16 a[190:191], v127 offset:8192
ds_write_b128 v250, a[48:51] offset:0
v_pk_mul_f32 v[0:1], v[0:1], v[208:209]
v_pk_mul_f32 v[2:3], v[2:3], v[210:211]
v_pk_mul_f32 v[4:5], v[4:5], v[208:209]
v_pk_mul_f32 v[6:7], v[6:7], v[210:211]
v_pk_mul_f32 v[8:9], v[8:9], v[208:209]
v_pk_mul_f32 v[10:11], v[10:11], v[210:211]
v_pk_mul_f32 v[12:13], v[12:13], v[208:209]
v_pk_mul_f32 v[14:15], v[14:15], v[210:211]
ds_write_b128 v250, a[52:55] offset:1024
v_pk_mul_f32 v[16:17], v[16:17], v[208:209]
v_pk_mul_f32 v[18:19], v[18:19], v[210:211]
v_pk_mul_f32 v[20:21], v[20:21], v[208:209]
v_pk_mul_f32 v[22:23], v[22:23], v[210:211]
v_pk_mul_f32 v[24:25], v[24:25], v[208:209]
v_pk_mul_f32 v[26:27], v[26:27], v[210:211]
v_pk_mul_f32 v[28:29], v[28:29], v[208:209]
v_pk_mul_f32 v[30:31], v[30:31], v[210:211]
ds_write_b128 v250, a[56:59] offset:2048
v_pk_mul_f32 v[32:33], v[32:33], v[208:209]
v_pk_mul_f32 v[34:35], v[34:35], v[210:211]
v_pk_mul_f32 v[36:37], v[36:37], v[208:209]
v_pk_mul_f32 v[38:39], v[38:39], v[210:211]
v_pk_mul_f32 v[40:41], v[40:41], v[208:209]
v_pk_mul_f32 v[42:43], v[42:43], v[210:211]
v_pk_mul_f32 v[44:45], v[44:45], v[208:209]
v_pk_mul_f32 v[46:47], v[46:47], v[210:211]
ds_write_b128 v250, a[60:63] offset:3072
v_pk_mul_f32 v[48:49], v[48:49], v[212:213]
v_pk_mul_f32 v[50:51], v[50:51], v[214:215]
v_pk_mul_f32 v[52:53], v[52:53], v[212:213]
v_pk_mul_f32 v[54:55], v[54:55], v[214:215]
v_pk_mul_f32 v[56:57], v[56:57], v[212:213]
v_pk_mul_f32 v[58:59], v[58:59], v[214:215]
v_pk_mul_f32 v[60:61], v[60:61], v[212:213]
v_pk_mul_f32 v[62:63], v[62:63], v[214:215]
ds_write_b128 v250, a[64:67] offset:4096
v_pk_mul_f32 v[64:65], v[64:65], v[212:213]
v_pk_mul_f32 v[66:67], v[66:67], v[214:215]
v_pk_mul_f32 v[68:69], v[68:69], v[212:213]
v_pk_mul_f32 v[70:71], v[70:71], v[214:215]
v_pk_mul_f32 v[72:73], v[72:73], v[212:213]
v_pk_mul_f32 v[74:75], v[74:75], v[214:215]
v_pk_mul_f32 v[76:77], v[76:77], v[212:213]
v_pk_mul_f32 v[78:79], v[78:79], v[214:215]
ds_write_b128 v250, a[68:71] offset:5120
v_pk_mul_f32 v[80:81], v[80:81], v[212:213]
v_pk_mul_f32 v[82:83], v[82:83], v[214:215]
v_pk_mul_f32 v[84:85], v[84:85], v[212:213]
v_pk_mul_f32 v[86:87], v[86:87], v[214:215]
v_pk_mul_f32 v[88:89], v[88:89], v[212:213]
v_pk_mul_f32 v[90:91], v[90:91], v[214:215]
v_pk_mul_f32 v[92:93], v[92:93], v[212:213]
v_pk_mul_f32 v[94:95], v[94:95], v[214:215]
v_mfma_f32_16x16x32_bf16 v[0:3], v[112:115], a[96:99], v[0:3]
ds_write_b128 v250, a[72:75] offset:6144
v_mfma_f32_16x16x32_bf16 v[4:7], v[112:115], a[100:103], v[4:7]
v_add_u32 v216, s97, v255
v_add_u32 v217, s98, v255
v_mfma_f32_16x16x32_bf16 v[8:11], v[112:115], a[104:107], v[8:11]
ds_write_b128 v250, a[76:79] offset:7168
v_mfma_f32_16x16x32_bf16 v[12:15], v[112:115], a[108:111], v[12:15]
v_add_u32 v218, s97, v224
v_add_u32 v219, s97, v225
v_mfma_f32_16x16x32_bf16 v[16:19], v[112:115], a[112:115], v[16:19]
ds_write_b128 v250, a[80:83] offset:8192
v_mfma_f32_16x16x32_bf16 v[20:23], v[112:115], a[116:119], v[20:23]
v_add_u32 v220, s98, v224
v_add_u32 v221, s98, v225
v_mfma_f32_16x16x32_bf16 v[24:27], v[112:115], a[120:123], v[24:27]
ds_write_b128 v250, a[84:87] offset:9216
v_mfma_f32_16x16x32_bf16 v[28:31], v[112:115], a[124:127], v[28:31]
v_mfma_f32_16x16x32_bf16 v[32:35], v[112:115], a[128:131], v[32:35]
ds_write_b128 v250, a[88:91] offset:10240
v_mfma_f32_16x16x32_bf16 v[36:39], v[112:115], a[132:135], v[36:39]
v_mfma_f32_16x16x32_bf16 v[40:43], v[112:115], a[136:139], v[40:43]
ds_write_b128 v250, a[92:95] offset:11264
v_mfma_f32_16x16x32_bf16 v[44:47], v[112:115], a[140:143], v[44:47]
s_waitcnt lgkmcnt(15)
v_mfma_f32_16x16x32_bf16 v[48:51], v[116:119], a[144:147], v[48:51]
ds_read_b128 v[96:99], v216 offset:0
v_mfma_f32_16x16x32_bf16 v[52:55], v[116:119], a[148:151], v[52:55]
ds_read_b128 v[100:103], v216 offset:1024
v_mfma_f32_16x16x32_bf16 v[56:59], v[116:119], a[152:155], v[56:59]
ds_read_b128 v[104:107], v216 offset:2048
v_mfma_f32_16x16x32_bf16 v[60:63], v[116:119], a[156:159], v[60:63]
ds_read_b128 v[108:111], v216 offset:3072
v_mfma_f32_16x16x32_bf16 v[64:67], v[116:119], a[160:163], v[64:67]
ds_read_b128 v[128:131], v216 offset:4096
v_mfma_f32_16x16x32_bf16 v[68:71], v[116:119], a[164:167], v[68:71]
ds_read_b128 v[132:135], v216 offset:5120
v_mfma_f32_16x16x32_bf16 v[72:75], v[116:119], a[168:171], v[72:75]
ds_read_b128 v[136:139], v216 offset:6144
v_mfma_f32_16x16x32_bf16 v[76:79], v[116:119], a[172:175], v[76:79]
ds_read_b128 v[140:143], v216 offset:7168
v_mfma_f32_16x16x32_bf16 v[80:83], v[116:119], a[176:179], v[80:83]
ds_read_b128 v[144:147], v216 offset:8192
v_mfma_f32_16x16x32_bf16 v[84:87], v[116:119], a[180:183], v[84:87]
ds_read_b128 v[148:151], v216 offset:9216
s_waitcnt lgkmcnt(15)
v_mfma_f32_16x16x32_bf16 v[88:91], v[116:119], a[184:187], v[88:91]
ds_read_b128 v[152:155], v216 offset:10240
v_mfma_f32_16x16x32_bf16 v[92:95], v[116:119], a[188:191], v[92:95]
ds_read_b128 v[156:159], v216 offset:11264
s_waitcnt vmcnt(63) lgkmcnt(12)
s_barrier
ds_read_b128 v[160:163], v217 offset:0
ds_read_b128 v[164:167], v217 offset:1024
ds_read_b128 v[168:171], v217 offset:2048
ds_read_b128 v[172:175], v217 offset:3072
ds_read_b128 v[176:179], v217 offset:4096
ds_read_b128 v[180:183], v217 offset:5120
s_waitcnt lgkmcnt(6)
v_pk_fma_f32 v[0:1], v[96:97], v[232:233], v[0:1]
v_pk_fma_f32 v[2:3], v[98:99], v[234:235], v[2:3]
v_pk_fma_f32 v[4:5], v[100:101], v[232:233], v[4:5]
v_pk_fma_f32 v[6:7], v[102:103], v[234:235], v[6:7]
v_pk_fma_f32 v[8:9], v[104:105], v[232:233], v[8:9]
v_pk_fma_f32 v[10:11], v[106:107], v[234:235], v[10:11]
v_pk_fma_f32 v[12:13], v[108:109], v[232:233], v[12:13]
v_pk_fma_f32 v[14:15], v[110:111], v[234:235], v[14:15]
v_pk_fma_f32 v[16:17], v[128:129], v[232:233], v[16:17]
v_pk_fma_f32 v[18:19], v[130:131], v[234:235], v[18:19]
v_pk_fma_f32 v[20:21], v[132:133], v[232:233], v[20:21]
v_pk_fma_f32 v[22:23], v[134:135], v[234:235], v[22:23]
ds_read_b128 v[184:187], v217 offset:6144
ds_read_b128 v[188:191], v217 offset:7168
ds_read_b128 v[192:195], v217 offset:8192
ds_read_b128 v[196:199], v217 offset:9216
ds_read_b128 v[200:203], v217 offset:10240
ds_read_b128 v[204:207], v217 offset:11264
v_pk_fma_f32 v[24:25], v[136:137], v[232:233], v[24:25]
v_pk_fma_f32 v[26:27], v[138:139], v[234:235], v[26:27]
v_pk_fma_f32 v[28:29], v[140:141], v[232:233], v[28:29]
v_pk_fma_f32 v[30:31], v[142:143], v[234:235], v[30:31]
v_pk_fma_f32 v[32:33], v[144:145], v[232:233], v[32:33]
v_pk_fma_f32 v[34:35], v[146:147], v[234:235], v[34:35]
v_pk_fma_f32 v[36:37], v[148:149], v[232:233], v[36:37]
v_pk_fma_f32 v[38:39], v[150:151], v[234:235], v[38:39]
v_pk_fma_f32 v[40:41], v[152:153], v[232:233], v[40:41]
v_pk_fma_f32 v[42:43], v[154:155], v[234:235], v[42:43]
v_pk_fma_f32 v[44:45], v[156:157], v[232:233], v[44:45]
v_pk_fma_f32 v[46:47], v[158:159], v[234:235], v[46:47]
v_cvt_pk_bf16_f32 v0, v0, v4
v_cvt_pk_bf16_f32 v4, v1, v5
v_cvt_pk_bf16_f32 v1, v8, v12
v_cvt_pk_bf16_f32 v5, v9, v13
v_cvt_pk_bf16_f32 v2, v2, v6
v_cvt_pk_bf16_f32 v6, v3, v7
v_cvt_pk_bf16_f32 v3, v10, v14
v_cvt_pk_bf16_f32 v7, v11, v15
ds_write_b64 v218, v[0:1] offset:0
ds_write_b64 v218, v[4:5] offset:416
ds_write_b64 v218, v[2:3] offset:832
ds_write_b64 v218, v[6:7] offset:1248
v_cvt_pk_bf16_f32 v16, v16, v20
v_cvt_pk_bf16_f32 v20, v17, v21
v_cvt_pk_bf16_f32 v17, v24, v28
v_cvt_pk_bf16_f32 v21, v25, v29
v_cvt_pk_bf16_f32 v18, v18, v22
v_cvt_pk_bf16_f32 v22, v19, v23
v_cvt_pk_bf16_f32 v19, v26, v30
v_cvt_pk_bf16_f32 v23, v27, v31
ds_write_b64 v218, v[16:17] offset:128
ds_write_b64 v218, v[20:21] offset:544
ds_write_b64 v218, v[18:19] offset:960
ds_write_b64 v218, v[22:23] offset:1376
v_cvt_pk_bf16_f32 v32, v32, v36
v_cvt_pk_bf16_f32 v36, v33, v37
v_cvt_pk_bf16_f32 v33, v40, v44
v_cvt_pk_bf16_f32 v37, v41, v45
v_cvt_pk_bf16_f32 v34, v34, v38
v_cvt_pk_bf16_f32 v38, v35, v39
v_cvt_pk_bf16_f32 v35, v42, v46
v_cvt_pk_bf16_f32 v39, v43, v47
ds_write_b64 v218, v[32:33] offset:256
ds_write_b64 v218, v[36:37] offset:672
ds_write_b64 v218, v[34:35] offset:1088
ds_write_b64 v218, v[38:39] offset:1504
s_waitcnt lgkmcnt(12)
v_pk_fma_f32 v[48:49], v[160:161], v[236:237], v[48:49]
v_pk_fma_f32 v[50:51], v[162:163], v[238:239], v[50:51]
v_pk_fma_f32 v[52:53], v[164:165], v[236:237], v[52:53]
v_pk_fma_f32 v[54:55], v[166:167], v[238:239], v[54:55]
v_pk_fma_f32 v[56:57], v[168:169], v[236:237], v[56:57]
v_pk_fma_f32 v[58:59], v[170:171], v[238:239], v[58:59]
v_pk_fma_f32 v[60:61], v[172:173], v[236:237], v[60:61]
v_pk_fma_f32 v[62:63], v[174:175], v[238:239], v[62:63]
v_pk_fma_f32 v[64:65], v[176:177], v[236:237], v[64:65]
v_pk_fma_f32 v[66:67], v[178:179], v[238:239], v[66:67]
v_pk_fma_f32 v[68:69], v[180:181], v[236:237], v[68:69]
v_pk_fma_f32 v[70:71], v[182:183], v[238:239], v[70:71]
ds_read_b64_tr_b16 v[96:97], v219 offset:0
ds_read_b64_tr_b16 v[98:99], v219 offset:32
ds_read_b64_tr_b16 v[100:101], v219 offset:3328
ds_read_b64_tr_b16 v[102:103], v219 offset:3360
ds_read_b64_tr_b16 v[104:105], v219 offset:128
ds_read_b64_tr_b16 v[106:107], v219 offset:160
ds_read_b64_tr_b16 v[108:109], v219 offset:3456
ds_read_b64_tr_b16 v[110:111], v219 offset:3488
ds_read_b64_tr_b16 v[128:129], v219 offset:256
ds_read_b64_tr_b16 v[130:131], v219 offset:288
ds_read_b64_tr_b16 v[132:133], v219 offset:3584
ds_read_b64_tr_b16 v[134:135], v219 offset:3616
v_pk_fma_f32 v[72:73], v[184:185], v[236:237], v[72:73]
v_pk_fma_f32 v[74:75], v[186:187], v[238:239], v[74:75]
v_pk_fma_f32 v[76:77], v[188:189], v[236:237], v[76:77]
v_pk_fma_f32 v[78:79], v[190:191], v[238:239], v[78:79]
v_pk_fma_f32 v[80:81], v[192:193], v[236:237], v[80:81]
v_pk_fma_f32 v[82:83], v[194:195], v[238:239], v[82:83]
v_pk_fma_f32 v[84:85], v[196:197], v[236:237], v[84:85]
v_pk_fma_f32 v[86:87], v[198:199], v[238:239], v[86:87]
v_pk_fma_f32 v[88:89], v[200:201], v[236:237], v[88:89]
v_pk_fma_f32 v[90:91], v[202:203], v[238:239], v[90:91]
v_pk_fma_f32 v[92:93], v[204:205], v[236:237], v[92:93]
v_pk_fma_f32 v[94:95], v[206:207], v[238:239], v[94:95]
v_cvt_pk_bf16_f32 v48, v48, v52
v_cvt_pk_bf16_f32 v52, v49, v53
v_cvt_pk_bf16_f32 v49, v56, v60
v_cvt_pk_bf16_f32 v53, v57, v61
v_cvt_pk_bf16_f32 v50, v50, v54
v_cvt_pk_bf16_f32 v54, v51, v55
v_cvt_pk_bf16_f32 v51, v58, v62
v_cvt_pk_bf16_f32 v55, v59, v63
s_waitcnt lgkmcnt(0)
buffer_store_dwordx4 v[96:99], v248, s[16:19], s87 offen offset:0
ds_write_b64 v220, v[48:49] offset:0
ds_write_b64 v220, v[52:53] offset:416
ds_write_b64 v220, v[50:51] offset:832
ds_write_b64 v220, v[54:55] offset:1248
buffer_store_dwordx4 v[100:103], v248, s[16:19], s87 offen offset:3072
v_cvt_pk_bf16_f32 v64, v64, v68
v_cvt_pk_bf16_f32 v68, v65, v69
v_cvt_pk_bf16_f32 v65, v72, v76
v_cvt_pk_bf16_f32 v69, v73, v77
v_cvt_pk_bf16_f32 v66, v66, v70
v_cvt_pk_bf16_f32 v70, v67, v71
v_cvt_pk_bf16_f32 v67, v74, v78
v_cvt_pk_bf16_f32 v71, v75, v79
buffer_store_dwordx4 v[104:107], v248, s[16:19], s87 offen offset:128
ds_write_b64 v220, v[64:65] offset:128
ds_write_b64 v220, v[68:69] offset:544
ds_write_b64 v220, v[66:67] offset:960
ds_write_b64 v220, v[70:71] offset:1376
buffer_store_dwordx4 v[108:111], v248, s[16:19], s87 offen offset:3200
v_cvt_pk_bf16_f32 v80, v80, v84
v_cvt_pk_bf16_f32 v84, v81, v85
v_cvt_pk_bf16_f32 v81, v88, v92
v_cvt_pk_bf16_f32 v85, v89, v93
v_cvt_pk_bf16_f32 v82, v82, v86
v_cvt_pk_bf16_f32 v86, v83, v87
v_cvt_pk_bf16_f32 v83, v90, v94
v_cvt_pk_bf16_f32 v87, v91, v95
buffer_store_dwordx4 v[128:131], v248, s[16:19], s87 offen offset:256
ds_write_b64 v220, v[80:81] offset:256
ds_write_b64 v220, v[84:85] offset:672
ds_write_b64 v220, v[82:83] offset:1088
ds_write_b64 v220, v[86:87] offset:1504
buffer_store_dwordx4 v[132:135], v248, s[16:19], s87 offen offset:3328
ds_read_b64_tr_b16 v[160:161], v221 offset:0
ds_read_b64_tr_b16 v[162:163], v221 offset:32
ds_read_b64_tr_b16 v[164:165], v221 offset:3328
ds_read_b64_tr_b16 v[166:167], v221 offset:3360
ds_read_b64_tr_b16 v[168:169], v221 offset:128
ds_read_b64_tr_b16 v[170:171], v221 offset:160
ds_read_b64_tr_b16 v[172:173], v221 offset:3456
ds_read_b64_tr_b16 v[174:175], v221 offset:3488
ds_read_b64_tr_b16 v[176:177], v221 offset:256
ds_read_b64_tr_b16 v[178:179], v221 offset:288
ds_read_b64_tr_b16 v[180:181], v221 offset:3584
ds_read_b64_tr_b16 v[182:183], v221 offset:3616
s_waitcnt lgkmcnt(0)
buffer_store_dwordx4 v[160:163], v248, s[16:19], s88 offen offset:0
buffer_store_dwordx4 v[164:167], v248, s[16:19], s88 offen offset:3072
buffer_store_dwordx4 v[168:171], v248, s[16:19], s88 offen offset:128
buffer_store_dwordx4 v[172:175], v248, s[16:19], s88 offen offset:3200
buffer_store_dwordx4 v[176:179], v248, s[16:19], s88 offen offset:256
buffer_store_dwordx4 v[180:183], v248, s[16:19], s88 offen offset:3328
L_end:
s_endpgm
L_exit:
s_bitcmp1_b32 s83, 8
s_cbranch_scc1 L_exa
s_lshr_b32 s35, s83, 20
s_bitcmp1_b32 s83, 10
s_mov_b32 s83, 0
s_cbranch_scc1 L_loop1
s_cmp_eq_u32 s34, 35
s_cbranch_scc1 L_last1
v_mfma_f32_16x16x32_bf16 v[128:131], a[244:247], a[116:119], v[192:195]
v_exp_f32 v216, v112
v_mfma_f32_16x16x32_bf16 v[128:131], a[240:243], a[112:115], v[128:131]
v_exp_f32 v217, v113
v_mfma_f32_16x16x32_bf16 v[128:131], a[236:239], a[108:111], v[128:131]
v_readlane_b32 s48, v239, s34
v_mov_b32 v243, 0xff800000
v_mfma_f32_16x16x32_bf16 v[128:131], a[232:235], a[104:107], v[128:131]
v_exp_f32 v218, v114
v_mfma_f32_16x16x32_bf16 v[128:131], a[228:231], a[100:103], v[128:131]
v_add_f32 v212, v212, v216
v_cvt_pk_bf16_f32 v162, v216, v217
v_mfma_f32_16x16x32_bf16 v[128:131], a[224:227], a[96:99], v[128:131]
s_and_b32 s79, s48, s70
v_exp_f32 v219, v115
v_mfma_f32_16x16x32_bf16 v[132:135], a[224:227], a[120:123], v[196:199]
s_waitcnt vmcnt(12) lgkmcnt(0)
s_barrier
v_mfma_f32_16x16x32_bf16 v[132:135], a[228:231], a[124:127], v[132:135]
v_add_f32 v212, v212, v217
v_cvt_pk_bf16_f32 v163, v218, v219
v_mfma_f32_16x16x32_bf16 v[132:135], a[232:235], a[128:131], v[132:135]
s_add_u32 m0, s44, s40
v_exp_f32 v220, v116
v_mfma_f32_16x16x32_bf16 v[132:135], a[236:239], a[132:135], v[132:135]
ds_read_b64_tr_b16 a[208:209], v228 offset:12288
v_add_f32 v212, v212, v218
v_mfma_f32_16x16x32_bf16 v[132:135], a[240:243], a[136:139], v[132:135]
ds_read_b64_tr_b16 a[210:211], v228 offset:18432
v_add_f32 v212, v212, v219
v_mfma_f32_16x16x32_bf16 v[132:135], a[244:247], a[140:143], v[132:135]
s_and_b32 s46, s48, s71
v_add_f32 v213, v213, v220
v_add_u32 v234, v232, v234
v_mfma_f32_16x16x32_bf16 v[136:139], a[244:247], a[164:167], v[200:203]
buffer_load_dwordx4 v234, s[4:7], s43 offen offset:0  lds
v_mfma_f32_16x16x32_bf16 v[136:139], a[240:243], a[160:163], v[136:139]
s_lshr_b32 s45, s48, 8
v_xor_b32 v235, v232, v235
v_cndmask_b32 v128, v128, v243, s[56:57]
v_mfma_f32_16x16x32_bf16 v[136:139], a[236:239], a[156:159], v[136:139]
v_exp_f32 v221, v117
v_mfma_f32_16x16x32_bf16 v[136:139], a[232:235], a[152:155], v[136:139]
ds_read_b64_tr_b16 a[212:213], v229 offset:12288
v_cndmask_b32 v129, v129, v243, s[58:59]
v_mfma_f32_16x16x32_bf16 v[136:139], a[228:231], a[148:151], v[136:139]
v_cndmask_b32 v130, v130, v243, s[60:61]
v_cndmask_b32 v131, v131, v243, s[62:63]
v_mfma_f32_16x16x32_bf16 v[136:139], a[224:227], a[144:147], v[136:139]
s_and_b32 s45, s45, s71
v_exp_f32 v222, v118
v_mfma_f32_16x16x32_bf16 v[140:143], a[224:227], a[168:171], v[204:207]
ds_read_b64_tr_b16 a[214:215], v229 offset:18432
v_add_f32 v213, v213, v221
v_mfma_f32_16x16x32_bf16 v[140:143], a[228:231], a[172:175], v[140:143]
v_cvt_pk_bf16_f32 v166, v220, v221
v_add_f32 v213, v213, v222
v_mfma_f32_16x16x32_bf16 v[140:143], a[232:235], a[176:179], v[140:143]
v_exp_f32 v223, v119
v_mfma_f32_16x16x32_bf16 v[140:143], a[236:239], a[180:183], v[140:143]
ds_read_b64_tr_b16 a[216:217], v230 offset:12288
v_add_f32 v213, v213, v223
v_mfma_f32_16x16x32_bf16 v[140:143], a[240:243], a[184:187], v[140:143]
ds_read_b64_tr_b16 a[218:219], v230 offset:18432
v_cvt_pk_bf16_f32 v167, v222, v223
v_mfma_f32_16x16x32_bf16 v[140:143], a[244:247], a[188:191], v[140:143]
buffer_load_dwordx4 v235, s[4:7], s43 offen offset:3072  lds
v_exp_f32 v216, v120
s_bitcmp1_b32 s48, 28
ds_read_b64_tr_b16 a[220:221], v231 offset:12288
ds_read_b64_tr_b16 a[222:223], v231 offset:18432
ds_read_b64_tr_b16 a[224:225], v228 offset:13312
v_add_f32 v214, v214, v216
s_cselect_b64 s[50:51], s[30:31], s[28:29]
v_exp_f32 v217, v121
v_exp_f32 v218, v122
v_mov_b32 v144, 0xff800000
v_add_f32 v214, v214, v217
v_cvt_pk_bf16_f32 v170, v216, v217
v_mov_b32 v145, 0xff800000
v_mov_b32 v146, 0xff800000
v_mov_b32 v147, 0xff800000
v_add_f32 v214, v214, v218
v_exp_f32 v219, v123
s_add_u32 m0, s44, s41
s_bitcmp1_b32 s48, 29
v_mfma_f32_16x16x32_bf16 v[148:151], a[248:251], a[120:123], v[196:199]
ds_read_b64_tr_b16 a[226:227], v228 offset:19456
v_add_f32 v214, v214, v219
v_mfma_f32_16x16x32_bf16 v[148:151], a[252:255], a[124:127], v[148:151]
ds_read_b64_tr_b16 a[228:229], v229 offset:13312
v_cvt_pk_bf16_f32 v171, v218, v219
v_mfma_f32_16x16x32_bf16 v[148:151], a[192:195], a[128:131], v[148:151]
buffer_load_dwordx4 v234, s[4:7], s43 offen offset:128  lds
v_mfma_f32_16x16x32_bf16 v[148:151], a[196:199], a[132:135], v[148:151]
s_cselect_b64 s[8:9], s[50:51], s[26:27]
v_exp_f32 v220, v124
v_mfma_f32_16x16x32_bf16 v[148:151], a[200:203], a[136:139], v[148:151]
ds_read_b64_tr_b16 a[230:231], v229 offset:19456
v_add_f32 v215, v215, v220
v_mfma_f32_16x16x32_bf16 v[148:151], a[204:207], a[140:143], v[148:151]
ds_read_b64_tr_b16 a[232:233], v230 offset:13312
ds_read_b64_tr_b16 a[234:235], v230 offset:19456
v_mfma_f32_16x16x32_bf16 v[152:155], a[204:207], a[164:167], v[200:203]
v_exp_f32 v221, v125
v_mfma_f32_16x16x32_bf16 v[152:155], a[200:203], a[160:163], v[152:155]
v_exp_f32 v222, v126
v_mfma_f32_16x16x32_bf16 v[152:155], a[196:199], a[156:159], v[152:155]
ds_read_b64_tr_b16 a[236:237], v231 offset:13312
v_add_f32 v215, v215, v221
v_mfma_f32_16x16x32_bf16 v[152:155], a[192:195], a[152:155], v[152:155]
s_waitcnt lgkmcnt(5)
v_cvt_pk_bf16_f32 v174, v220, v221
v_add_f32 v215, v215, v222
v_mfma_f32_16x16x32_bf16 v[152:155], a[252:255], a[148:151], v[152:155]
v_exp_f32 v223, v127
v_mfma_f32_16x16x32_bf16 v[152:155], a[248:251], a[144:147], v[152:155]
buffer_load_dwordx4 v235, s[4:7], s43 offen offset:3200  lds
v_mfma_f32_16x16x32_bf16 v[156:159], a[248:251], a[168:171], v[204:207]
ds_read_b64_tr_b16 a[238:239], v231 offset:19456
v_add_u32 v236, s79, v233
v_mfma_f32_16x16x32_bf16 v[156:159], a[252:255], a[172:175], v[156:159]
ds_read_b64_tr_b16 a[240:241], v228 offset:14336
v_add_f32 v215, v215, v223
v_mfma_f32_16x16x32_bf16 v[156:159], a[192:195], a[176:179], v[156:159]
ds_read_b64 v[236:237], v236
v_cvt_pk_bf16_f32 v175, v222, v223
v_mfma_f32_16x16x32_bf16 v[156:159], a[196:199], a[180:183], v[156:159]
ds_read_b64_tr_b16 a[242:243], v228 offset:20480
v_cndmask_b32 v148, v148, v243, s[56:57]
v_mfma_f32_16x16x32_bf16 v[156:159], a[200:203], a[184:187], v[156:159]
ds_read_b64_tr_b16 a[244:245], v229 offset:14336
v_cndmask_b32 v149, v149, v243, s[58:59]
v_mfma_f32_16x16x32_bf16 v[156:159], a[204:207], a[188:191], v[156:159]
s_add_u32 m0, s44, s42
v_cndmask_b32 v150, v150, v243, s[60:61]
v_cndmask_b32 v151, v151, v243, s[62:63]
v_max3_f32 v240, v212, v213, v214
ds_read_b64_tr_b16 a[246:247], v229 offset:20480
v_max_f32 v240, v240, v215
v_cmp_lt_f32 vcc, s52, v240
s_nop 0
s_cbranch_vccnz L_stub8
L_back8:
v_mfma_f32_16x16x32_bf16 v[0:3], v[160:163], a[208:211], v[0:3]
buffer_load_dwordx4 v234, s[4:7], s43 offen offset:256  lds
v_mfma_f32_16x16x32_bf16 v[4:7], v[160:163], a[212:215], v[4:7]
ds_read_b64_tr_b16 a[248:249], v230 offset:14336
v_add_f32 v208, v208, v212
v_mfma_f32_16x16x32_bf16 v[52:55], v[164:167], a[212:215], v[52:55]
v_exp_f32 v216, v128
v_mfma_f32_16x16x32_bf16 v[48:51], v[164:167], a[208:211], v[48:51]
ds_read_b64_tr_b16 a[250:251], v230 offset:20480
v_add_f32 v209, v209, v213
v_mfma_f32_16x16x32_bf16 a[0:3], v[168:171], a[208:211], a[0:3]
v_add_f32 v210, v210, v214
v_add_f32 v211, v211, v215
v_mfma_f32_16x16x32_bf16 a[4:7], v[168:171], a[212:215], a[4:7]
v_exp_f32 v217, v129
v_mfma_f32_16x16x32_bf16 a[52:55], v[172:175], a[212:215], a[52:55]
ds_read_b64_tr_b16 a[252:253], v231 offset:14336
v_add_f32 v212, v216, v217
v_mfma_f32_16x16x32_bf16 a[48:51], v[172:175], a[208:211], a[48:51]
v_exp_f32 v218, v130
v_mfma_f32_16x16x32_bf16 a[56:59], v[172:175], a[216:219], a[56:59]
ds_read_b64_tr_b16 a[254:255], v231 offset:20480
v_cvt_pk_bf16_f32 v176, v216, v217
v_mfma_f32_16x16x32_bf16 a[60:63], v[172:175], a[220:223], a[60:63]
v_exp_f32 v219, v131
v_mfma_f32_16x16x32_bf16 a[12:15], v[168:171], a[220:223], a[12:15]
v_add_f32 v212, v212, v218
v_cvt_pk_bf16_f32 v177, v218, v219
v_mfma_f32_16x16x32_bf16 a[8:11], v[168:171], a[216:219], a[8:11]
buffer_load_dwordx4 v235, s[4:7], s43 offen offset:3328  lds
v_mfma_f32_16x16x32_bf16 v[56:59], v[164:167], a[216:219], v[56:59]
v_exp_f32 v220, v132
v_mfma_f32_16x16x32_bf16 v[60:63], v[164:167], a[220:223], v[60:63]
v_add_f32 v212, v212, v219
v_readlane_b32 s47, v238, s34
v_mfma_f32_16x16x32_bf16 v[12:15], v[160:163], a[220:223], v[12:15]
v_exp_f32 v221, v133
v_mfma_f32_16x16x32_bf16 v[8:11], v[160:163], a[216:219], v[8:11]
s_and_b32 s49, s47, s70
v_exp_f32 v222, v134
v_mfma_f32_16x16x32_bf16 v[16:19], v[160:163], a[224:227], v[16:19]
s_waitcnt vmcnt(12) lgkmcnt(0)
s_barrier
v_mfma_f32_16x16x32_bf16 v[20:23], v[160:163], a[228:231], v[20:23]
ds_read_b128 a[192:195], v226 offset:12288
v_add_f32 v213, v220, v221
v_mfma_f32_16x16x32_bf16 v[68:71], v[164:167], a[228:231], v[68:71]
s_add_u32 m0, s46, s40
v_cvt_pk_bf16_f32 v180, v220, v221
v_add_f32 v213, v213, v222
v_mfma_f32_16x16x32_bf16 v[64:67], v[164:167], a[224:227], v[64:67]
s_and_b32 s44, s47, s71
v_exp_f32 v223, v135
v_mfma_f32_16x16x32_bf16 a[16:19], v[168:171], a[224:227], a[16:19]
ds_read_b128 a[196:199], v227 offset:12288
v_add_u32 v236, v232, v236
v_mfma_f32_16x16x32_bf16 a[20:23], v[168:171], a[228:231], a[20:23]
buffer_load_dwordx4 v236, s[8:11], s45 offen offset:0  lds
v_mfma_f32_16x16x32_bf16 a[68:71], v[172:175], a[228:231], a[68:71]
s_lshr_b32 s43, s47, 8
v_xor_b32 v237, v232, v237
v_add_f32 v213, v213, v223
v_mfma_f32_16x16x32_bf16 a[64:67], v[172:175], a[224:227], a[64:67]
s_and_b32 s43, s43, s71
v_exp_f32 v216, v136
v_mfma_f32_16x16x32_bf16 a[72:75], v[172:175], a[232:235], a[72:75]
ds_read_b128 a[200:203], v226 offset:13312
v_cvt_pk_bf16_f32 v181, v222, v223
v_mfma_f32_16x16x32_bf16 a[76:79], v[172:175], a[236:239], a[76:79]
buffer_load_dwordx4 v237, s[8:11], s45 offen offset:3072  lds
v_mfma_f32_16x16x32_bf16 a[28:31], v[168:171], a[236:239], a[28:31]
s_add_u32 m0, s46, s41
v_exp_f32 v217, v137
v_mfma_f32_16x16x32_bf16 a[24:27], v[168:171], a[232:235], a[24:27]
ds_read_b128 a[204:207], v227 offset:13312
v_add_f32 v214, v216, v217
v_mfma_f32_16x16x32_bf16 v[72:75], v[164:167], a[232:235], v[72:75]
ds_read_b128 a[208:211], v226 offset:14336
v_cvt_pk_bf16_f32 v184, v216, v217
v_mfma_f32_16x16x32_bf16 v[76:79], v[164:167], a[236:239], v[76:79]
s_bitcmp1_b32 s47, 28
v_exp_f32 v218, v138
v_mfma_f32_16x16x32_bf16 v[28:31], v[160:163], a[236:239], v[28:31]
buffer_load_dwordx4 v236, s[8:11], s45 offen offset:128  lds
v_mfma_f32_16x16x32_bf16 v[24:27], v[160:163], a[232:235], v[24:27]
ds_read_b128 a[212:215], v227 offset:14336
v_add_f32 v214, v214, v218
v_mfma_f32_16x16x32_bf16 v[32:35], v[160:163], a[240:243], v[32:35]
s_cselect_b64 s[50:51], s[30:31], s[28:29]
v_exp_f32 v219, v139
v_mfma_f32_16x16x32_bf16 v[36:39], v[160:163], a[244:247], v[36:39]
ds_read_b128 a[216:219], v226 offset:18432
v_add_f32 v214, v214, v219
v_mfma_f32_16x16x32_bf16 v[84:87], v[164:167], a[244:247], v[84:87]
buffer_load_dwordx4 v237, s[8:11], s45 offen offset:3200  lds
v_mfma_f32_16x16x32_bf16 v[80:83], v[164:167], a[240:243], v[80:83]
s_bitcmp1_b32 s47, 29
v_exp_f32 v220, v140
v_mfma_f32_16x16x32_bf16 a[32:35], v[168:171], a[240:243], a[32:35]
ds_read_b128 a[220:223], v227 offset:18432
v_cvt_pk_bf16_f32 v185, v218, v219
v_mfma_f32_16x16x32_bf16 a[36:39], v[168:171], a[244:247], a[36:39]
s_cselect_b64 s[4:5], s[50:51], s[24:25]
v_exp_f32 v221, v141
v_mfma_f32_16x16x32_bf16 a[84:87], v[172:175], a[244:247], a[84:87]
ds_read_b128 a[224:227], v226 offset:19456
v_add_f32 v215, v220, v221
v_mfma_f32_16x16x32_bf16 a[80:83], v[172:175], a[240:243], a[80:83]
ds_read_b128 a[228:231], v227 offset:19456
v_cvt_pk_bf16_f32 v188, v220, v221
v_mfma_f32_16x16x32_bf16 a[88:91], v[172:175], a[248:251], a[88:91]
s_add_u32 m0, s46, s42
v_exp_f32 v222, v142
v_mfma_f32_16x16x32_bf16 a[92:95], v[172:175], a[252:255], a[92:95]
buffer_load_dwordx4 v236, s[8:11], s45 offen offset:256  lds
v_mfma_f32_16x16x32_bf16 a[44:47], v[168:171], a[252:255], a[44:47]
s_add_u32 s34, s34, 1
v_add_u32 v234, s49, v233
v_add_f32 v215, v215, v222
v_mfma_f32_16x16x32_bf16 a[40:43], v[168:171], a[248:251], a[40:43]
ds_read_b64 v[234:235], v234
ds_read_b128 a[232:235], v226 offset:20480
v_mfma_f32_16x16x32_bf16 v[88:91], v[164:167], a[248:251], v[88:91]
s_waitcnt lgkmcnt(6)
v_exp_f32 v223, v143
v_mfma_f32_16x16x32_bf16 v[92:95], v[164:167], a[252:255], v[92:95]
buffer_load_dwordx4 v237, s[8:11], s45 offen offset:3328  lds
v_mfma_f32_16x16x32_bf16 v[44:47], v[160:163], a[252:255], v[44:47]
ds_read_b128 a[236:239], v227 offset:20480
v_add_f32 v215, v215, v223
v_mfma_f32_16x16x32_bf16 v[40:43], v[160:163], a[248:251], v[40:43]
s_cmp_lt_u32 s36, 2
v_cvt_pk_bf16_f32 v189, v222, v223
s_cbranch_scc1 L_d1x
L_diag2:
v_mfma_f32_16x16x32_bf16 v[104:107], a[212:215], a[164:167], v[200:203]
v_exp_f32 v216, v144
v_readlane_b32 s48, v239, s34
v_mov_b32 v243, 0xff800000
v_exp_f32 v217, v145
v_mfma_f32_16x16x32_bf16 v[104:107], a[208:211], a[160:163], v[104:107]
v_add_f32 v212, v212, v216
v_cvt_pk_bf16_f32 v178, v216, v217
v_add_f32 v212, v212, v217
v_exp_f32 v218, v146
v_mfma_f32_16x16x32_bf16 v[104:107], a[204:207], a[156:159], v[104:107]
s_and_b32 s79, s48, s70
v_add_f32 v212, v212, v218
v_exp_f32 v219, v147
v_exp_f32 v220, v148
v_mfma_f32_16x16x32_bf16 v[104:107], a[200:203], a[152:155], v[104:107]
s_waitcnt vmcnt(30) lgkmcnt(0)
s_barrier
v_add_f32 v212, v212, v219
v_cvt_pk_bf16_f32 v179, v218, v219
v_add_f32 v213, v213, v220
v_mfma_f32_16x16x32_bf16 v[104:107], a[196:199], a[148:151], v[104:107]
s_add_u32 m0, s44, s40
v_add_u32 v234, v232, v234
v_xor_b32 v235, v232, v235
s_and_b32 s46, s48, s71
ds_read_b64_tr_b16 a[240:241], v228 offset:0
v_mfma_f32_16x16x32_bf16 v[104:107], a[192:195], a[144:147], v[104:107]
buffer_load_dwordx4 v234, s[4:7], s43 offen offset:0  lds
ds_read_b64_tr_b16 a[242:243], v228 offset:6144
v_exp_f32 v221, v149
v_mfma_f32_16x16x32_bf16 v[108:111], a[192:195], a[168:171], v[204:207]
ds_read_b64_tr_b16 a[244:245], v229 offset:0
v_add_f32 v213, v213, v221
v_cvt_pk_bf16_f32 v182, v220, v221
v_mbcnt_lo_u32_b32 v251, -1, 0
s_lshr_b32 s45, s48, 8
v_mfma_f32_16x16x32_bf16 v[108:111], a[196:199], a[172:175], v[108:111]
ds_read_b64_tr_b16 a[246:247], v229 offset:6144
v_mbcnt_hi_u32_b32 v251, -1, v251
v_exp_f32 v222, v150
v_add_u32 v253, s77, v224
v_mfma_f32_16x16x32_bf16 v[108:111], a[200:203], a[176:179], v[108:111]
ds_read_b64_tr_b16 a[248:249], v230 offset:0
v_add_u32 v254, s77, v225
v_lshlrev_b32 v255, 4, v251
v_add_f32 v213, v213, v222
v_exp_f32 v223, v151
v_mfma_f32_16x16x32_bf16 v[108:111], a[204:207], a[180:183], v[108:111]
s_and_b32 s45, s45, s71
v_add_f32 v213, v213, v223
v_cvt_pk_bf16_f32 v183, v222, v223
v_exp_f32 v216, v152
v_mfma_f32_16x16x32_bf16 v[108:111], a[208:211], a[184:187], v[108:111]
ds_read_b64_tr_b16 a[250:251], v230 offset:6144
buffer_load_dwordx4 v235, s[4:7], s43 offen offset:3072  lds
v_add_f32 v214, v214, v216
s_bitcmp1_b32 s48, 28
s_cselect_b64 s[50:51], s[30:31], s[28:29]
v_mfma_f32_16x16x32_bf16 v[108:111], a[212:215], a[188:191], v[108:111]
ds_read_b64_tr_b16 a[252:253], v231 offset:0
ds_read_b64_tr_b16 a[254:255], v231 offset:6144
v_exp_f32 v217, v153
v_cndmask_b32 v104, v104, v243, s[56:57]
v_cndmask_b32 v105, v105, v243, s[58:59]
v_cndmask_b32 v106, v106, v243, s[60:61]
v_add_f32 v214, v214, v217
v_cvt_pk_bf16_f32 v186, v216, v217
v_cndmask_b32 v107, v107, v243, s[62:63]
v_mfma_f32_16x16x32_bf16 v[124:127], a[216:219], a[168:171], v[204:207]
ds_read_b64_tr_b16 a[192:193], v228 offset:1024
ds_read_b64_tr_b16 a[194:195], v228 offset:7168
v_exp_f32 v218, v154
v_exp_f32 v219, v155
s_add_u32 m0, s44, s41
v_add_f32 v214, v214, v218
v_add_f32 v214, v214, v219
v_mfma_f32_16x16x32_bf16 v[124:127], a[220:223], a[172:175], v[124:127]
ds_read_b64_tr_b16 a[196:197], v229 offset:1024
buffer_load_dwordx4 v234, s[4:7], s43 offen offset:128  lds
v_cvt_pk_bf16_f32 v187, v218, v219
s_bitcmp1_b32 s48, 29
s_cselect_b64 s[8:9], s[50:51], s[26:27]
v_exp_f32 v220, v156
v_mov_b32 v120, 0xff800000
v_mov_b32 v121, 0xff800000
v_mfma_f32_16x16x32_bf16 v[124:127], a[224:227], a[176:179], v[124:127]
ds_read_b64_tr_b16 a[198:199], v229 offset:7168
ds_read_b64_tr_b16 a[200:201], v230 offset:1024
v_mov_b32 v122, 0xff800000
v_mov_b32 v123, 0xff800000
v_add_f32 v215, v215, v220
v_exp_f32 v221, v157
ds_read_b64_tr_b16 a[202:203], v230 offset:7168
v_mfma_f32_16x16x32_bf16 v[124:127], a[228:231], a[180:183], v[124:127]
ds_read_b64_tr_b16 a[204:205], v231 offset:1024
v_add_f32 v215, v215, v221
v_cvt_pk_bf16_f32 v190, v220, v221
v_exp_f32 v222, v158
v_add_u32 v236, s79, v233
v_exp_f32 v223, v159
v_add_f32 v215, v215, v222
v_mfma_f32_16x16x32_bf16 v[124:127], a[232:235], a[184:187], v[124:127]
buffer_load_dwordx4 v235, s[4:7], s43 offen offset:3200  lds
ds_read_b64_tr_b16 a[206:207], v231 offset:7168
ds_read_b64_tr_b16 a[208:209], v228 offset:2048
v_add_f32 v215, v215, v223
v_cvt_pk_bf16_f32 v191, v222, v223
ds_read_b64 v[236:237], v236
v_mfma_f32_16x16x32_bf16 v[124:127], a[236:239], a[188:191], v[124:127]
ds_read_b64_tr_b16 a[210:211], v228 offset:8192
s_waitcnt lgkmcnt(9)
v_max3_f32 v240, v212, v213, v214
ds_read_b64_tr_b16 a[212:213], v229 offset:2048
v_max_f32 v240, v240, v215
v_cmp_lt_f32 vcc, s52, v240
s_add_u32 m0, s44, s42
ds_read_b64_tr_b16 a[214:215], v229 offset:8192
s_cbranch_vccnz L_stub9
L_back9:
v_add_f32 v208, v208, v212
v_mfma_f32_16x16x32_bf16 v[0:3], v[176:179], a[240:243], v[0:3]
buffer_load_dwordx4 v234, s[4:7], s43 offen offset:256  lds
v_mfma_f32_16x16x32_bf16 v[4:7], v[176:179], a[244:247], v[4:7]
ds_read_b64_tr_b16 a[216:217], v230 offset:2048
v_add_f32 v209, v209, v213
v_mfma_f32_16x16x32_bf16 v[52:55], v[180:183], a[244:247], v[52:55]
v_exp_f32 v216, v104
v_mfma_f32_16x16x32_bf16 v[48:51], v[180:183], a[240:243], v[48:51]
ds_read_b64_tr_b16 a[218:219], v230 offset:8192
v_add_f32 v210, v210, v214
v_mfma_f32_16x16x32_bf16 a[0:3], v[184:187], a[240:243], a[0:3]
v_add_f32 v211, v211, v215
v_mov_b32 v170, 0
v_mfma_f32_16x16x32_bf16 a[4:7], v[184:187], a[244:247], a[4:7]
v_exp_f32 v217, v105
v_mfma_f32_16x16x32_bf16 a[52:55], v[188:191], a[244:247], a[52:55]
ds_read_b64_tr_b16 a[220:221], v231 offset:2048
v_cndmask_b32 v124, v124, v243, s[56:57]
v_mfma_f32_16x16x32_bf16 a[48:51], v[188:191], a[240:243], a[48:51]
ds_read_b64_tr_b16 a[222:223], v231 offset:8192
v_mov_b32 v171, 0
v_mfma_f32_16x16x32_bf16 a[56:59], v[188:191], a[248:251], a[56:59]
v_cndmask_b32 v125, v125, v243, s[58:59]
v_cndmask_b32 v126, v126, v243, s[60:61]
v_mfma_f32_16x16x32_bf16 a[60:63], v[188:191], a[252:255], a[60:63]
v_cndmask_b32 v127, v127, v243, s[62:63]
v_mov_b32 v212, 0
v_mfma_f32_16x16x32_bf16 a[12:15], v[184:187], a[252:255], a[12:15]
v_mov_b32 v213, 0
v_add_f32 v214, v216, v217
v_mfma_f32_16x16x32_bf16 a[8:11], v[184:187], a[248:251], a[8:11]
v_exp_f32 v218, v106
v_mfma_f32_16x16x32_bf16 v[56:59], v[180:183], a[248:251], v[56:59]
v_cvt_pk_bf16_f32 v168, v216, v217
v_add_f32 v214, v214, v218
v_mfma_f32_16x16x32_bf16 v[60:63], v[180:183], a[252:255], v[60:63]
buffer_load_dwordx4 v235, s[4:7], s43 offen offset:3328  lds
v_mfma_f32_16x16x32_bf16 v[12:15], v[176:179], a[252:255], v[12:15]
v_exp_f32 v219, v107
v_mfma_f32_16x16x32_bf16 v[8:11], v[176:179], a[248:251], v[8:11]
v_exp_f32 v220, v108
v_mfma_f32_16x16x32_bf16 v[16:19], v[176:179], a[192:195], v[16:19]
s_waitcnt vmcnt(36) lgkmcnt(0)
s_barrier
v_mfma_f32_16x16x32_bf16 v[20:23], v[176:179], a[196:199], v[20:23]
v_add_f32 v214, v214, v219
v_cvt_pk_bf16_f32 v169, v218, v219
v_mfma_f32_16x16x32_bf16 v[68:71], v[180:183], a[196:199], v[68:71]
v_readlane_b32 s47, v238, s34
v_add_u32 v236, v232, v236
v_mfma_f32_16x16x32_bf16 v[64:67], v[180:183], a[192:195], v[64:67]
s_and_b32 s49, s47, s70
v_exp_f32 v221, v109
v_mfma_f32_16x16x32_bf16 a[16:19], v[184:187], a[192:195], a[16:19]
s_add_u32 m0, s46, s40
v_permlane16_swap_b32 v208, v209
v_mfma_f32_16x16x32_bf16 a[20:23], v[184:187], a[196:199], a[20:23]
buffer_load_dwordx4 v236, s[8:11], s45 offen offset:0  lds
v_mfma_f32_16x16x32_bf16 a[68:71], v[188:191], a[196:199], a[68:71]
s_and_b32 s44, s47, s71
v_xor_b32 v237, v232, v237
v_add_f32 v215, v220, v221
v_mfma_f32_16x16x32_bf16 a[64:67], v[188:191], a[192:195], a[64:67]
s_lshr_b32 s43, s47, 8
v_exp_f32 v222, v110
v_mfma_f32_16x16x32_bf16 a[72:75], v[188:191], a[200:203], a[72:75]
s_and_b32 s43, s43, s71
v_cvt_pk_bf16_f32 v172, v220, v221
v_add_f32 v208, v208, v209
v_mfma_f32_16x16x32_bf16 a[76:79], v[188:191], a[204:207], a[76:79]
buffer_load_dwordx4 v237, s[8:11], s45 offen offset:3072  lds
v_mfma_f32_16x16x32_bf16 a[28:31], v[184:187], a[204:207], a[28:31]
v_exp_f32 v223, v111
v_mfma_f32_16x16x32_bf16 a[24:27], v[184:187], a[200:203], a[24:27]
s_add_u32 m0, s46, s41
v_add_f32 v215, v215, v222
v_mov_b32 v209, v208
v_mfma_f32_16x16x32_bf16 v[72:75], v[180:183], a[200:203], v[72:75]
s_bitcmp1_b32 s47, 28
v_permlane32_swap_b32 v208, v209
v_mfma_f32_16x16x32_bf16 v[76:79], v[180:183], a[204:207], v[76:79]
s_cselect_b64 s[50:51], s[30:31], s[28:29]
v_exp_f32 v216, v124
v_mfma_f32_16x16x32_bf16 v[28:31], v[176:179], a[204:207], v[28:31]
buffer_load_dwordx4 v236, s[8:11], s45 offen offset:128  lds
v_mfma_f32_16x16x32_bf16 v[24:27], v[176:179], a[200:203], v[24:27]
v_add_f32 v215, v215, v223
v_cvt_pk_bf16_f32 v173, v222, v223
v_mfma_f32_16x16x32_bf16 v[32:35], v[176:179], a[208:211], v[32:35]
s_bitcmp1_b32 s47, 29
v_add_f32 v208, v208, v209
v_add_f32 v215, v215, v216
v_mfma_f32_16x16x32_bf16 v[36:39], v[176:179], a[212:215], v[36:39]
s_cselect_b64 s[4:5], s[50:51], s[24:25]
v_rcp_f32 v244, v208
v_mfma_f32_16x16x32_bf16 v[84:87], v[180:183], a[212:215], v[84:87]
v_exp_f32 v217, v125
v_mfma_f32_16x16x32_bf16 v[80:83], v[180:183], a[208:211], v[80:83]
buffer_load_dwordx4 v237, s[8:11], s45 offen offset:3200  lds
v_mfma_f32_16x16x32_bf16 a[32:35], v[184:187], a[208:211], a[32:35]
s_add_u32 m0, s46, s42
v_exp_f32 v218, v126
v_mfma_f32_16x16x32_bf16 a[36:39], v[184:187], a[212:215], a[36:39]
v_add_f32 v215, v215, v217
v_cvt_pk_bf16_f32 v174, v216, v217
v_mfma_f32_16x16x32_bf16 a[84:87], v[188:191], a[212:215], a[84:87]
s_add_u32 s34, s34, 1
v_mul_f32 v244, s55, v244
v_add_f32 v215, v215, v218
v_mfma_f32_16x16x32_bf16 a[80:83], v[188:191], a[208:211], a[80:83]
buffer_load_dwordx4 v236, s[8:11], s45 offen offset:256  lds
v_mfma_f32_16x16x32_bf16 a[88:91], v[188:191], a[216:219], a[88:91]
v_exp_f32 v219, v127
v_mfma_f32_16x16x32_bf16 a[92:95], v[188:191], a[220:223], a[92:95]
v_add_u32 v234, s49, v233
v_add_f32 v215, v215, v219
v_mfma_f32_16x16x32_bf16 a[44:47], v[184:187], a[220:223], a[44:47]
ds_read_b64 v[234:235], v234
v_cvt_pk_bf16_f32 v175, v218, v219
v_mfma_f32_16x16x32_bf16 a[40:43], v[184:187], a[216:219], a[40:43]
buffer_load_dwordx4 v237, s[8:11], s45 offen offset:3328  lds
v_mfma_f32_16x16x32_bf16 v[88:91], v[180:183], a[216:219], v[88:91]
s_bitcmp1_b32 s95, 0
v_mfma_f32_16x16x32_bf16 v[92:95], v[180:183], a[220:223], v[92:95]
v_mfma_f32_16x16x32_bf16 v[44:47], v[176:179], a[220:223], v[44:47]
v_mfma_f32_16x16x32_bf16 v[40:43], v[176:179], a[216:219], v[40:43]
s_cbranch_scc1 L_wf
v_max_f32 v240, v214, v215
v_cmp_lt_f32 vcc, s52, v240
s_nop 0
s_cbranch_vccnz L_stub10
L_back10:
v_add_f32 v210, v210, v214
v_add_f32 v211, v211, v215
s_lshl_b32 s88, s36, 8
s_add_u32 s86, s77, -24576
v_add_u32 v144, s88, v242
ds_read_b32 v128, v144 offset:0
ds_read_b32 v132, v144 offset:64
ds_read_b32 v136, v144 offset:128
ds_read_b32 v140, v144 offset:192
s_waitcnt vmcnt(42) lgkmcnt(4)
s_barrier
v_add_u32 v234, v232, v234
v_xor_b32 v235, v232, v235
ds_read_b64_tr_b16 a[208:209], v228 offset:12288
ds_read_b64_tr_b16 a[210:211], v228 offset:18432
ds_read_b64_tr_b16 a[212:213], v229 offset:12288
ds_read_b64_tr_b16 a[214:215], v229 offset:18432
ds_read_b64_tr_b16 a[216:217], v230 offset:12288
ds_read_b64_tr_b16 a[218:219], v230 offset:18432
ds_read_b64_tr_b16 a[220:221], v231 offset:12288
ds_read_b64_tr_b16 a[222:223], v231 offset:18432
ds_read_b64_tr_b16 a[224:225], v228 offset:13312
ds_read_b64_tr_b16 a[226:227], v228 offset:19456
ds_read_b64_tr_b16 a[228:229], v229 offset:13312
ds_read_b64_tr_b16 a[230:231], v229 offset:19456
ds_read_b64_tr_b16 a[232:233], v230 offset:13312
ds_read_b64_tr_b16 a[234:235], v230 offset:19456
ds_read_b64_tr_b16 a[236:237], v231 offset:13312
ds_read_b64_tr_b16 a[238:239], v231 offset:19456
ds_read_b64_tr_b16 a[240:241], v228 offset:14336
ds_read_b64_tr_b16 a[242:243], v228 offset:20480
ds_read_b64_tr_b16 a[244:245], v229 offset:14336
ds_read_b64_tr_b16 a[246:247], v229 offset:20480
ds_read_b64_tr_b16 a[248:249], v230 offset:14336
ds_read_b64_tr_b16 a[250:251], v230 offset:20480
ds_read_b64_tr_b16 a[252:253], v231 offset:14336
ds_read_b64_tr_b16 a[254:255], v231 offset:20480
s_add_u32 m0, s44, s40
s_nop 0
buffer_load_dwordx4 v234, s[4:7], s43 offen offset:0  lds
buffer_load_dwordx4 v235, s[4:7], s43 offen offset:3072  lds
v_permlane16_swap_b32 v210, v211
v_readlane_b32 s48, v239, s34
v_add_f32 v210, v210, v211
v_mov_b32 v211, v210
v_lshlrev_b32 v145, 2, v242
v_and_b32 v145, 16, v145
v_mov_b32 v144, 0xffff
v_lshlrev_b32 v145, v145, v144
s_waitcnt lgkmcnt(15)
v_mfma_f32_16x16x32_bf16 a[0:3], v[168:171], a[208:211], a[0:3]
v_permlane32_swap_b32 v210, v211
v_mfma_f32_16x16x32_bf16 a[48:51], v[172:175], a[208:211], a[48:51]
v_exp_f32 v129, -|v128|
s_and_b32 s79, s48, s70
s_and_b32 s46, s48, s71
s_lshr_b32 s45, s48, 8
s_and_b32 s45, s45, s71
s_bitcmp1_b32 s48, 28
s_cselect_b64 s[50:51], s[30:31], s[28:29]
s_bitcmp1_b32 s48, 29
s_cselect_b64 s[8:9], s[50:51], s[26:27]
v_mfma_f32_16x16x32_bf16 a[52:55], v[172:175], a[212:215], a[52:55]
v_exp_f32 v133, -|v132|
v_mfma_f32_16x16x32_bf16 a[4:7], v[168:171], a[212:215], a[4:7]
v_add_f32 v210, v210, v211
v_mfma_f32_16x16x32_bf16 a[8:11], v[168:171], a[216:219], a[8:11]
v_exp_f32 v137, -|v136|
v_mfma_f32_16x16x32_bf16 a[56:59], v[172:175], a[216:219], a[56:59]
s_add_u32 m0, s44, s41
v_exp_f32 v141, -|v140|
buffer_load_dwordx4 v234, s[4:7], s43 offen offset:128  lds
buffer_load_dwordx4 v235, s[4:7], s43 offen offset:3200  lds
v_mfma_f32_16x16x32_bf16 a[60:63], v[172:175], a[220:223], a[60:63]
v_rcp_f32 v246, v210
v_mfma_f32_16x16x32_bf16 a[12:15], v[168:171], a[220:223], a[12:15]
v_add_f32 v130, 1.0, v129
v_add_f32 v134, 1.0, v133
s_waitcnt lgkmcnt(12)
v_mfma_f32_16x16x32_bf16 a[16:19], v[168:171], a[224:227], a[16:19]
v_add_f32 v138, 1.0, v137
v_add_f32 v142, 1.0, v141
v_mfma_f32_16x16x32_bf16 a[64:67], v[172:175], a[224:227], a[64:67]
v_mul_f32 v246, s55, v246
v_mfma_f32_16x16x32_bf16 a[68:71], v[172:175], a[228:231], a[68:71]
v_rcp_f32 v130, v130
v_mfma_f32_16x16x32_bf16 a[20:23], v[168:171], a[228:231], a[20:23]
v_rcp_f32 v134, v134
v_add_u32 v236, s79, v233
ds_read_b64 v[236:237], v236
s_waitcnt lgkmcnt(9)
v_mfma_f32_16x16x32_bf16 a[24:27], v[168:171], a[232:235], a[24:27]
v_mfma_f32_16x16x32_bf16 a[72:75], v[172:175], a[232:235], a[72:75]
v_rcp_f32 v138, v138
v_mfma_f32_16x16x32_bf16 a[76:79], v[172:175], a[236:239], a[76:79]
v_rcp_f32 v142, v142
v_mfma_f32_16x16x32_bf16 a[28:31], v[168:171], a[236:239], a[28:31]
s_waitcnt lgkmcnt(5)
v_mfma_f32_16x16x32_bf16 a[32:35], v[168:171], a[240:243], a[32:35]
v_mul_f32 v130, s54, v130
v_mul_f32 v134, s54, v134
v_mfma_f32_16x16x32_bf16 a[80:83], v[172:175], a[240:243], a[80:83]
v_mul_f32 v138, s54, v138
v_mul_f32 v142, s54, v142
v_mfma_f32_16x16x32_bf16 a[84:87], v[172:175], a[244:247], a[84:87]
v_mul_f32 v129, v129, v130
v_mul_f32 v133, v133, v134
v_mfma_f32_16x16x32_bf16 a[36:39], v[168:171], a[244:247], a[36:39]
v_mul_f32 v137, v137, v138
v_mul_f32 v141, v141, v142
s_waitcnt lgkmcnt(1)
v_mfma_f32_16x16x32_bf16 a[40:43], v[168:171], a[248:251], a[40:43]
s_add_u32 m0, s44, s42
v_cvt_pk_bf16_f32 v130, v130, v130
buffer_load_dwordx4 v234, s[4:7], s43 offen offset:256  lds
buffer_load_dwordx4 v235, s[4:7], s43 offen offset:3328  lds
v_cvt_pk_bf16_f32 v134, v134, v134
v_mfma_f32_16x16x32_bf16 a[88:91], v[172:175], a[248:251], a[88:91]
v_cvt_pk_bf16_f32 v138, v138, v138
v_cvt_pk_bf16_f32 v142, v142, v142
v_mfma_f32_16x16x32_bf16 a[92:95], v[172:175], a[252:255], a[92:95]
v_cvt_pk_bf16_f32 v129, v129, v129
v_cvt_pk_bf16_f32 v133, v133, v133
v_mfma_f32_16x16x32_bf16 a[44:47], v[168:171], a[252:255], a[44:47]
v_cvt_pk_bf16_f32 v137, v137, v137
v_cvt_pk_bf16_f32 v141, v141, v141
v_and_b32 v130, v145, v130
v_and_b32 v134, v145, v134
v_and_b32 v138, v145, v138
v_and_b32 v142, v145, v142
v_and_b32 v129, v145, v129
v_and_b32 v133, v145, v133
v_and_b32 v137, v145, v137
v_and_b32 v141, v145, v141
v_cmp_le_f32 vcc, 0, v128
s_nop 1
v_cndmask_b32 v128, v129, v130, vcc
v_cndmask_b32 v131, v130, v129, vcc
v_cndmask_b32 v192, 0, v128, s[72:73]
v_cndmask_b32 v193, 0, v128, s[74:75]
v_cndmask_b32 v194, 0, v131, s[72:73]
v_cndmask_b32 v195, 0, v131, s[74:75]
v_cmp_le_f32 vcc, 0, v132
v_readlane_b32 s47, v238, s34
s_nop 0
v_cndmask_b32 v132, v133, v134, vcc
v_cndmask_b32 v135, v134, v133, vcc
v_cndmask_b32 v196, 0, v132, s[72:73]
v_cndmask_b32 v197, 0, v132, s[74:75]
v_cndmask_b32 v198, 0, v135, s[72:73]
v_cndmask_b32 v199, 0, v135, s[74:75]
v_cmp_le_f32 vcc, 0, v136
s_nop 1
v_cndmask_b32 v136, v137, v138, vcc
v_cndmask_b32 v139, v138, v137, vcc
v_cndmask_b32 v200, 0, v136, s[72:73]
v_cndmask_b32 v201, 0, v136, s[74:75]
v_cndmask_b32 v202, 0, v139, s[72:73]
v_cndmask_b32 v203, 0, v139, s[74:75]
v_cmp_le_f32 vcc, 0, v140
s_nop 1
v_cndmask_b32 v140, v141, v142, vcc
v_cndmask_b32 v143, v142, v141, vcc
v_cndmask_b32 v204, 0, v140, s[72:73]
v_cndmask_b32 v205, 0, v140, s[74:75]
v_cndmask_b32 v206, 0, v143, s[72:73]
v_cndmask_b32 v207, 0, v143, s[74:75]
v_bfe_u32 v245, v255, 2, 7
v_add_u32 v245, 163456, v245
v_lshrrev_b32 v247, 4, v255
v_and_b32 v247, 48, v247
v_add_u32 v247, 163456, v247
ds_write2_b32 v245, v244, v246 offset0:0 offset1:32
s_waitcnt vmcnt(36) lgkmcnt(1)
s_barrier
v_add_u32 v236, v232, v236
v_xor_b32 v237, v232, v237
ds_read_b128 v[216:219], v247 offset:0
ds_read_b128 v[220:223], v247 offset:64
ds_read_b128 v[208:211], v247 offset:128
ds_read_b128 v[212:215], v247 offset:192
s_add_u32 m0, s46, s40
s_nop 0
buffer_load_dwordx4 v236, s[8:11], s45 offen offset:0  lds
buffer_load_dwordx4 v237, s[8:11], s45 offen offset:3072  lds
v_add_u32 v249, s86, v228
v_add_u32 v250, s86, v229
v_add_u32 v251, s86, v230
v_add_u32 v252, s86, v231
v_add_u32 v226, 49152, v226
v_add_u32 v227, 49152, v227
v_add_u32 v228, 49152, v228
s_and_b32 s49, s47, s70
s_and_b32 s44, s47, s71
s_lshr_b32 s43, s47, 8
s_and_b32 s43, s43, s71
s_bitcmp1_b32 s47, 28
s_cselect_b64 s[50:51], s[30:31], s[28:29]
s_bitcmp1_b32 s47, 29
s_cselect_b64 s[4:5], s[50:51], s[24:25]
s_add_u32 s34, s34, 1
v_add_u32 v229, 49152, v229
v_add_u32 v230, 49152, v230
v_add_u32 v231, 49152, v231
s_mov_b32 s84, 49152
s_waitcnt lgkmcnt(0)
v_pk_mul_f32 v[0:1], v[0:1], v[216:217]
v_pk_mul_f32 v[2:3], v[2:3], v[218:219]
v_pk_mul_f32 v[4:5], v[4:5], v[216:217]
v_pk_mul_f32 v[6:7], v[6:7], v[218:219]
v_pk_mul_f32 v[8:9], v[8:9], v[216:217]
v_pk_mul_f32 v[10:11], v[10:11], v[218:219]
s_add_u32 m0, s46, s41
v_pk_mul_f32 v[12:13], v[12:13], v[216:217]
buffer_load_dwordx4 v236, s[8:11], s45 offen offset:128  lds
buffer_load_dwordx4 v237, s[8:11], s45 offen offset:3200  lds
v_pk_mul_f32 v[14:15], v[14:15], v[218:219]
v_pk_mul_f32 v[16:17], v[16:17], v[216:217]
v_pk_mul_f32 v[18:19], v[18:19], v[218:219]
v_pk_mul_f32 v[20:21], v[20:21], v[216:217]
v_pk_mul_f32 v[22:23], v[22:23], v[218:219]
v_pk_mul_f32 v[24:25], v[24:25], v[216:217]
v_pk_mul_f32 v[26:27], v[26:27], v[218:219]
v_pk_mul_f32 v[28:29], v[28:29], v[216:217]
v_pk_mul_f32 v[30:31], v[30:31], v[218:219]
v_pk_mul_f32 v[32:33], v[32:33], v[216:217]
v_add_u32 v234, s49, v233
ds_read_b64 v[234:235], v234
v_pk_mul_f32 v[34:35], v[34:35], v[218:219]
v_pk_mul_f32 v[36:37], v[36:37], v[216:217]
v_pk_mul_f32 v[38:39], v[38:39], v[218:219]
v_pk_mul_f32 v[40:41], v[40:41], v[216:217]
v_pk_mul_f32 v[42:43], v[42:43], v[218:219]
v_pk_mul_f32 v[44:45], v[44:45], v[216:217]
v_pk_mul_f32 v[46:47], v[46:47], v[218:219]
v_pk_mul_f32 v[48:49], v[48:49], v[220:221]
v_pk_mul_f32 v[50:51], v[50:51], v[222:223]
v_pk_mul_f32 v[52:53], v[52:53], v[220:221]
v_pk_mul_f32 v[54:55], v[54:55], v[222:223]
v_pk_mul_f32 v[56:57], v[56:57], v[220:221]
v_pk_mul_f32 v[58:59], v[58:59], v[222:223]
v_pk_mul_f32 v[60:61], v[60:61], v[220:221]
v_pk_mul_f32 v[62:63], v[62:63], v[222:223]
s_add_u32 m0, s46, s42
v_pk_mul_f32 v[64:65], v[64:65], v[220:221]
buffer_load_dwordx4 v236, s[8:11], s45 offen offset:256  lds
buffer_load_dwordx4 v237, s[8:11], s45 offen offset:3328  lds
v_pk_mul_f32 v[66:67], v[66:67], v[222:223]
v_pk_mul_f32 v[68:69], v[68:69], v[220:221]
v_pk_mul_f32 v[70:71], v[70:71], v[222:223]
s_cmp_lg_u32 s36, 3
s_cbranch_scc1 L_qh1
v_add_u32 v243, 147456, v255
ds_read_b128 a[96:99], v243 offset:0
ds_read_b128 a[100:103], v243 offset:1024
ds_read_b128 a[104:107], v243 offset:2048
ds_read_b128 a[108:111], v243 offset:3072
ds_read_b128 a[112:115], v243 offset:4096
ds_read_b128 a[116:119], v243 offset:5120
ds_read_b128 a[120:123], v243 offset:6144
ds_read_b128 a[124:127], v243 offset:7168
ds_read_b128 a[128:131], v243 offset:8192
ds_read_b128 a[132:135], v243 offset:9216
ds_read_b128 a[136:139], v243 offset:10240
ds_read_b128 a[140:143], v243 offset:11264
s_waitcnt lgkmcnt(0)
L_qh1:
ds_read_b64_tr_b16 a[192:193], v249 offset:0
ds_read_b64_tr_b16 a[194:195], v249 offset:6144
ds_read_b64_tr_b16 a[196:197], v250 offset:0
ds_read_b64_tr_b16 a[198:199], v250 offset:6144
ds_read_b64_tr_b16 a[200:201], v251 offset:0
ds_read_b64_tr_b16 a[202:203], v251 offset:6144
ds_read_b64_tr_b16 a[204:205], v252 offset:0
ds_read_b64_tr_b16 a[206:207], v252 offset:6144
ds_read_b64_tr_b16 a[208:209], v249 offset:1024
ds_read_b64_tr_b16 a[210:211], v249 offset:7168
ds_read_b64_tr_b16 a[212:213], v250 offset:1024
ds_read_b64_tr_b16 a[214:215], v250 offset:7168
ds_read_b64_tr_b16 a[216:217], v251 offset:1024
ds_read_b64_tr_b16 a[218:219], v251 offset:7168
ds_read_b64_tr_b16 a[220:221], v252 offset:1024
ds_read_b64_tr_b16 a[222:223], v252 offset:7168
ds_read_b64_tr_b16 a[224:225], v249 offset:2048
ds_read_b64_tr_b16 a[226:227], v249 offset:8192
ds_read_b64_tr_b16 a[228:229], v250 offset:2048
ds_read_b64_tr_b16 a[230:231], v250 offset:8192
ds_read_b64_tr_b16 a[232:233], v251 offset:2048
ds_read_b64_tr_b16 a[234:235], v251 offset:8192
ds_read_b64_tr_b16 a[236:237], v252 offset:2048
ds_read_b64_tr_b16 a[238:239], v252 offset:8192
v_pk_mul_f32 v[72:73], v[72:73], v[220:221]
v_pk_mul_f32 v[74:75], v[74:75], v[222:223]
v_pk_mul_f32 v[76:77], v[76:77], v[220:221]
v_pk_mul_f32 v[78:79], v[78:79], v[222:223]
v_pk_mul_f32 v[80:81], v[80:81], v[220:221]
v_pk_mul_f32 v[82:83], v[82:83], v[222:223]
v_pk_mul_f32 v[84:85], v[84:85], v[220:221]
v_pk_mul_f32 v[86:87], v[86:87], v[222:223]
v_pk_mul_f32 v[88:89], v[88:89], v[220:221]
v_pk_mul_f32 v[90:91], v[90:91], v[222:223]
v_pk_mul_f32 v[92:93], v[92:93], v[220:221]
v_pk_mul_f32 v[94:95], v[94:95], v[222:223]
s_waitcnt lgkmcnt(0)
s_waitcnt vmcnt(36) lgkmcnt(15)
s_barrier
v_add_u32 v234, v232, v234
s_add_u32 m0, s44, s40
v_xor_b32 v235, v232, v235
buffer_load_dwordx4 v234, s[4:7], s43 offen offset:0  lds
buffer_load_dwordx4 v235, s[4:7], s43 offen offset:3072  lds
v_mfma_f32_16x16x32_bf16 v[0:3], v[192:195], a[192:195], v[0:3]
ds_read_b64_tr_b16 a[240:241], v249 offset:12288
ds_read_b64_tr_b16 a[242:243], v249 offset:18432
v_mfma_f32_16x16x32_bf16 v[4:7], v[192:195], a[196:199], v[4:7]
ds_read_b64_tr_b16 a[244:245], v250 offset:12288
ds_read_b64_tr_b16 a[246:247], v250 offset:18432
v_readlane_b32 s48, v239, s34
v_mfma_f32_16x16x32_bf16 v[8:11], v[192:195], a[200:203], v[8:11]
ds_read_b64_tr_b16 a[248:249], v251 offset:12288
ds_read_b64_tr_b16 a[250:251], v251 offset:18432
v_mfma_f32_16x16x32_bf16 v[12:15], v[192:195], a[204:207], v[12:15]
ds_read_b64_tr_b16 a[252:253], v252 offset:12288
ds_read_b64_tr_b16 a[254:255], v252 offset:18432
v_mfma_f32_16x16x32_bf16 v[16:19], v[192:195], a[208:211], v[16:19]
ds_read_b64_tr_b16 a[192:193], v249 offset:13312
ds_read_b64_tr_b16 a[194:195], v249 offset:19456
v_mfma_f32_16x16x32_bf16 v[20:23], v[192:195], a[212:215], v[20:23]
ds_read_b64_tr_b16 a[196:197], v250 offset:13312
ds_read_b64_tr_b16 a[198:199], v250 offset:19456
s_and_b32 s79, s48, s70
s_and_b32 s46, s48, s71
s_lshr_b32 s45, s48, 8
s_and_b32 s45, s45, s71
s_bitcmp1_b32 s48, 28
s_cselect_b64 s[50:51], s[30:31], s[28:29]
s_bitcmp1_b32 s48, 29
s_cselect_b64 s[8:9], s[50:51], s[26:27]
v_mfma_f32_16x16x32_bf16 v[24:27], v[192:195], a[216:219], v[24:27]
ds_read_b64_tr_b16 a[200:201], v251 offset:13312
ds_read_b64_tr_b16 a[202:203], v251 offset:19456
v_mfma_f32_16x16x32_bf16 v[28:31], v[192:195], a[220:223], v[28:31]
ds_read_b64_tr_b16 a[204:205], v252 offset:13312
ds_read_b64_tr_b16 a[206:207], v252 offset:19456
v_mfma_f32_16x16x32_bf16 v[32:35], v[192:195], a[224:227], v[32:35]
ds_read_b64_tr_b16 a[208:209], v249 offset:14336
ds_read_b64_tr_b16 a[210:211], v249 offset:20480
v_mfma_f32_16x16x32_bf16 v[36:39], v[192:195], a[228:231], v[36:39]
ds_read_b64_tr_b16 a[212:213], v250 offset:14336
ds_read_b64_tr_b16 a[214:215], v250 offset:20480
s_add_u32 m0, s44, s41
s_nop 0
buffer_load_dwordx4 v234, s[4:7], s43 offen offset:128  lds
buffer_load_dwordx4 v235, s[4:7], s43 offen offset:3200  lds
v_mfma_f32_16x16x32_bf16 v[40:43], v[192:195], a[232:235], v[40:43]
ds_read_b64_tr_b16 a[216:217], v251 offset:14336
ds_read_b64_tr_b16 a[218:219], v251 offset:20480
v_mfma_f32_16x16x32_bf16 v[44:47], v[192:195], a[236:239], v[44:47]
ds_read_b64_tr_b16 a[220:221], v252 offset:14336
ds_read_b64_tr_b16 a[222:223], v252 offset:20480
s_waitcnt lgkmcnt(15)
v_mfma_f32_16x16x32_bf16 v[48:51], v[196:199], a[240:243], v[48:51]
v_accvgpr_read_b32 v144, a48
v_accvgpr_read_b32 v145, a49
v_mfma_f32_16x16x32_bf16 v[52:55], v[196:199], a[244:247], v[52:55]
v_accvgpr_read_b32 v146, a50
v_accvgpr_read_b32 v147, a51
v_mfma_f32_16x16x32_bf16 v[56:59], v[196:199], a[248:251], v[56:59]
v_accvgpr_read_b32 v148, a52
v_accvgpr_read_b32 v149, a53
v_add_u32 v236, s79, v233
ds_read_b64 v[236:237], v236
v_mfma_f32_16x16x32_bf16 v[60:63], v[196:199], a[252:255], v[60:63]
v_accvgpr_read_b32 v150, a54
v_accvgpr_read_b32 v151, a55
s_waitcnt lgkmcnt(9)
v_mfma_f32_16x16x32_bf16 v[64:67], v[196:199], a[192:195], v[64:67]
v_accvgpr_read_b32 v152, a56
v_accvgpr_read_b32 v153, a57
v_mfma_f32_16x16x32_bf16 v[68:71], v[196:199], a[196:199], v[68:71]
v_accvgpr_read_b32 v154, a58
v_accvgpr_read_b32 v155, a59
v_mfma_f32_16x16x32_bf16 v[72:75], v[196:199], a[200:203], v[72:75]
v_accvgpr_read_b32 v156, a60
v_accvgpr_read_b32 v157, a61
v_mfma_f32_16x16x32_bf16 v[76:79], v[196:199], a[204:207], v[76:79]
v_accvgpr_read_b32 v158, a62
v_accvgpr_read_b32 v159, a63
s_waitcnt lgkmcnt(1)
v_mfma_f32_16x16x32_bf16 v[80:83], v[196:199], a[208:211], v[80:83]
v_accvgpr_read_b32 v160, a64
v_accvgpr_read_b32 v161, a65
v_mfma_f32_16x16x32_bf16 v[84:87], v[196:199], a[212:215], v[84:87]
v_accvgpr_read_b32 v162, a66
v_accvgpr_read_b32 v163, a67
v_mfma_f32_16x16x32_bf16 v[88:91], v[196:199], a[216:219], v[88:91]
v_accvgpr_read_b32 v164, a68
v_accvgpr_read_b32 v165, a69
v_mfma_f32_16x16x32_bf16 v[92:95], v[196:199], a[220:223], v[92:95]
v_accvgpr_read_b32 v166, a70
s_add_u32 m0, s44, s42
v_accvgpr_read_b32 v167, a71
buffer_load_dwordx4 v234, s[4:7], s43 offen offset:256  lds
buffer_load_dwordx4 v235, s[4:7], s43 offen offset:3328  lds
v_pk_mul_f32 v[144:145], v[144:145], v[212:213]
v_pk_mul_f32 v[146:147], v[146:147], v[214:215]
v_pk_mul_f32 v[148:149], v[148:149], v[212:213]
v_pk_mul_f32 v[150:151], v[150:151], v[214:215]
v_pk_mul_f32 v[152:153], v[152:153], v[212:213]
v_pk_mul_f32 v[154:155], v[154:155], v[214:215]
v_pk_mul_f32 v[156:157], v[156:157], v[212:213]
v_pk_mul_f32 v[158:159], v[158:159], v[214:215]
v_pk_mul_f32 v[160:161], v[160:161], v[212:213]
v_pk_mul_f32 v[162:163], v[162:163], v[214:215]
v_pk_mul_f32 v[164:165], v[164:165], v[212:213]
s_waitcnt lgkmcnt(1)
v_accvgpr_read_b32 v168, a72
v_accvgpr_read_b32 v169, a73
v_pk_mul_f32 v[166:167], v[166:167], v[214:215]
v_accvgpr_read_b32 v170, a74
v_accvgpr_read_b32 v171, a75
v_pk_mul_f32 v[168:169], v[168:169], v[212:213]
v_accvgpr_read_b32 v172, a76
v_accvgpr_read_b32 v173, a77
v_pk_mul_f32 v[170:171], v[170:171], v[214:215]
v_accvgpr_read_b32 v174, a78
v_accvgpr_read_b32 v175, a79
v_pk_mul_f32 v[172:173], v[172:173], v[212:213]
v_accvgpr_read_b32 v176, a80
v_accvgpr_read_b32 v177, a81
v_pk_mul_f32 v[174:175], v[174:175], v[214:215]
v_accvgpr_read_b32 v178, a82
v_accvgpr_read_b32 v179, a83
v_pk_mul_f32 v[176:177], v[176:177], v[212:213]
v_readlane_b32 s47, v238, s34
v_accvgpr_read_b32 v180, a84
v_accvgpr_read_b32 v181, a85
v_pk_mul_f32 v[178:179], v[178:179], v[214:215]
v_accvgpr_read_b32 v182, a86
v_accvgpr_read_b32 v183, a87
v_pk_mul_f32 v[180:181], v[180:181], v[212:213]
v_accvgpr_read_b32 v184, a88
v_accvgpr_read_b32 v185, a89
v_pk_mul_f32 v[182:183], v[182:183], v[214:215]
v_accvgpr_read_b32 v186, a90
v_accvgpr_read_b32 v187, a91
v_pk_mul_f32 v[184:185], v[184:185], v[212:213]
v_accvgpr_read_b32 v188, a92
v_accvgpr_read_b32 v189, a93
v_pk_mul_f32 v[186:187], v[186:187], v[214:215]
v_accvgpr_read_b32 v190, a94
v_accvgpr_read_b32 v191, a95
v_pk_mul_f32 v[188:189], v[188:189], v[212:213]
v_accvgpr_read_b32 v96, a0
v_accvgpr_read_b32 v97, a1
v_pk_mul_f32 v[190:191], v[190:191], v[214:215]
v_accvgpr_read_b32 v98, a2
v_accvgpr_read_b32 v99, a3
v_pk_mul_f32 v[96:97], v[96:97], v[208:209]
v_accvgpr_read_b32 v100, a4
v_accvgpr_read_b32 v101, a5
v_pk_mul_f32 v[98:99], v[98:99], v[210:211]
v_accvgpr_read_b32 v102, a6
v_accvgpr_read_b32 v103, a7
v_pk_mul_f32 v[100:101], v[100:101], v[208:209]
s_waitcnt vmcnt(12) lgkmcnt(0)
s_barrier
v_add_u32 v236, v232, v236
v_xor_b32 v237, v232, v237
v_accvgpr_read_b32 v104, a8
v_accvgpr_read_b32 v105, a9
s_add_u32 m0, s46, s40
v_pk_mul_f32 v[102:103], v[102:103], v[210:211]
buffer_load_dwordx4 v236, s[8:11], s45 offen offset:0  lds
buffer_load_dwordx4 v237, s[8:11], s45 offen offset:3072  lds
v_accvgpr_read_b32 v106, a10
v_accvgpr_read_b32 v107, a11
v_pk_mul_f32 v[104:105], v[104:105], v[208:209]
v_accvgpr_read_b32 v108, a12
v_accvgpr_read_b32 v109, a13
v_pk_mul_f32 v[106:107], v[106:107], v[210:211]
v_accvgpr_read_b32 v110, a14
v_accvgpr_read_b32 v111, a15
v_pk_mul_f32 v[108:109], v[108:109], v[208:209]
v_accvgpr_read_b32 v112, a16
v_accvgpr_read_b32 v113, a17
s_and_b32 s49, s47, s70
s_and_b32 s44, s47, s71
s_lshr_b32 s43, s47, 8
s_and_b32 s43, s43, s71
s_bitcmp1_b32 s47, 28
s_cselect_b64 s[50:51], s[30:31], s[28:29]
s_bitcmp1_b32 s47, 29
s_cselect_b64 s[4:5], s[50:51], s[24:25]
s_add_u32 s34, s34, 1
v_pk_mul_f32 v[110:111], v[110:111], v[210:211]
v_accvgpr_read_b32 v114, a18
v_accvgpr_read_b32 v115, a19
v_pk_mul_f32 v[112:113], v[112:113], v[208:209]
v_accvgpr_read_b32 v116, a20
v_accvgpr_read_b32 v117, a21
v_pk_mul_f32 v[114:115], v[114:115], v[210:211]
v_accvgpr_read_b32 v118, a22
v_accvgpr_read_b32 v119, a23
v_pk_mul_f32 v[116:117], v[116:117], v[208:209]
s_add_u32 m0, s46, s41
v_accvgpr_read_b32 v120, a24
buffer_load_dwordx4 v236, s[8:11], s45 offen offset:128  lds
buffer_load_dwordx4 v237, s[8:11], s45 offen offset:3200  lds
v_accvgpr_read_b32 v121, a25
v_pk_mul_f32 v[118:119], v[118:119], v[210:211]
v_accvgpr_read_b32 v122, a26
v_accvgpr_read_b32 v123, a27
v_pk_mul_f32 v[120:121], v[120:121], v[208:209]
v_accvgpr_read_b32 v124, a28
v_accvgpr_read_b32 v125, a29
v_pk_mul_f32 v[122:123], v[122:123], v[210:211]
v_accvgpr_read_b32 v126, a30
v_accvgpr_read_b32 v127, a31
v_add_u32 v234, s49, v233
ds_read_b64 v[234:235], v234
v_pk_mul_f32 v[124:125], v[124:125], v[208:209]
v_accvgpr_read_b32 v128, a32
v_accvgpr_read_b32 v129, a33
v_pk_mul_f32 v[126:127], v[126:127], v[210:211]
v_accvgpr_read_b32 v130, a34
v_accvgpr_read_b32 v131, a35
v_pk_mul_f32 v[128:129], v[128:129], v[208:209]
v_accvgpr_read_b32 v132, a36
v_accvgpr_read_b32 v133, a37
v_pk_mul_f32 v[130:131], v[130:131], v[210:211]
v_accvgpr_read_b32 v134, a38
v_accvgpr_read_b32 v135, a39
v_pk_mul_f32 v[132:133], v[132:133], v[208:209]
v_accvgpr_read_b32 v136, a40
ds_read_b64_tr_b16 a[224:225], v249 offset:24576
ds_read_b64_tr_b16 a[226:227], v249 offset:30720
ds_read_b64_tr_b16 a[228:229], v250 offset:24576
ds_read_b64_tr_b16 a[230:231], v250 offset:30720
ds_read_b64_tr_b16 a[232:233], v251 offset:24576
ds_read_b64_tr_b16 a[234:235], v251 offset:30720
ds_read_b64_tr_b16 a[236:237], v252 offset:24576
ds_read_b64_tr_b16 a[238:239], v252 offset:30720
ds_read_b64_tr_b16 a[240:241], v249 offset:25600
ds_read_b64_tr_b16 a[242:243], v249 offset:31744
ds_read_b64_tr_b16 a[244:245], v250 offset:25600
ds_read_b64_tr_b16 a[246:247], v250 offset:31744
ds_read_b64_tr_b16 a[248:249], v251 offset:25600
ds_read_b64_tr_b16 a[250:251], v251 offset:31744
ds_read_b64_tr_b16 a[252:253], v252 offset:25600
ds_read_b64_tr_b16 a[254:255], v252 offset:31744
ds_read_b64_tr_b16 a[192:193], v249 offset:26624
ds_read_b64_tr_b16 a[194:195], v249 offset:32768
ds_read_b64_tr_b16 a[196:197], v250 offset:26624
ds_read_b64_tr_b16 a[198:199], v250 offset:32768
ds_read_b64_tr_b16 a[200:201], v251 offset:26624
ds_read_b64_tr_b16 a[202:203], v251 offset:32768
ds_read_b64_tr_b16 a[204:205], v252 offset:26624
ds_read_b64_tr_b16 a[206:207], v252 offset:32768
s_add_u32 m0, s46, s42
s_nop 0
buffer_load_dwordx4 v236, s[8:11], s45 offen offset:256  lds
buffer_load_dwordx4 v237, s[8:11], s45 offen offset:3328  lds
v_accvgpr_read_b32 v137, a41
v_pk_mul_f32 v[134:135], v[134:135], v[210:211]
v_accvgpr_read_b32 v138, a42
v_accvgpr_read_b32 v139, a43
v_pk_mul_f32 v[136:137], v[136:137], v[208:209]
v_accvgpr_read_b32 v140, a44
v_accvgpr_read_b32 v141, a45
v_pk_mul_f32 v[138:139], v[138:139], v[210:211]
v_accvgpr_read_b32 v142, a46
v_accvgpr_read_b32 v143, a47
v_pk_mul_f32 v[140:141], v[140:141], v[208:209]
v_pk_mul_f32 v[142:143], v[142:143], v[210:211]
s_waitcnt lgkmcnt(15)
v_mfma_f32_16x16x32_bf16 v[144:147], v[204:207], a[224:227], v[144:147]
ds_read_b64_tr_b16 a[208:209], v249 offset:36864
ds_read_b64_tr_b16 a[210:211], v249 offset:43008
v_mfma_f32_16x16x32_bf16 v[148:151], v[204:207], a[228:231], v[148:151]
ds_read_b64_tr_b16 a[212:213], v250 offset:36864
ds_read_b64_tr_b16 a[214:215], v250 offset:43008
v_mfma_f32_16x16x32_bf16 v[152:155], v[204:207], a[232:235], v[152:155]
ds_read_b64_tr_b16 a[216:217], v251 offset:36864
ds_read_b64_tr_b16 a[218:219], v251 offset:43008
v_mfma_f32_16x16x32_bf16 v[156:159], v[204:207], a[236:239], v[156:159]
ds_read_b64_tr_b16 a[220:221], v252 offset:36864
ds_read_b64_tr_b16 a[222:223], v252 offset:43008
s_waitcnt vmcnt(36) lgkmcnt(15)
s_barrier
v_add_u32 v234, v232, v234
v_xor_b32 v235, v232, v235
v_mfma_f32_16x16x32_bf16 v[160:163], v[204:207], a[240:243], v[160:163]
ds_read_b64_tr_b16 a[224:225], v249 offset:37888
ds_read_b64_tr_b16 a[226:227], v249 offset:44032
s_add_u32 m0, s44, s40
s_nop 0
buffer_load_dwordx4 v234, s[4:7], s43 offen offset:0  lds
buffer_load_dwordx4 v235, s[4:7], s43 offen offset:3072  lds
v_mfma_f32_16x16x32_bf16 v[164:167], v[204:207], a[244:247], v[164:167]
ds_read_b64_tr_b16 a[228:229], v250 offset:37888
ds_read_b64_tr_b16 a[230:231], v250 offset:44032
v_mfma_f32_16x16x32_bf16 v[168:171], v[204:207], a[248:251], v[168:171]
ds_read_b64_tr_b16 a[232:233], v251 offset:37888
ds_read_b64_tr_b16 a[234:235], v251 offset:44032
v_mfma_f32_16x16x32_bf16 v[172:175], v[204:207], a[252:255], v[172:175]
ds_read_b64_tr_b16 a[236:237], v252 offset:37888
ds_read_b64_tr_b16 a[238:239], v252 offset:44032
s_waitcnt lgkmcnt(15)
v_mfma_f32_16x16x32_bf16 v[176:179], v[204:207], a[192:195], v[176:179]
ds_read_b64_tr_b16 a[240:241], v249 offset:38912
ds_read_b64_tr_b16 a[242:243], v249 offset:45056
v_mfma_f32_16x16x32_bf16 v[180:183], v[204:207], a[196:199], v[180:183]
ds_read_b64_tr_b16 a[244:245], v250 offset:38912
ds_read_b64_tr_b16 a[246:247], v250 offset:45056
v_mfma_f32_16x16x32_bf16 v[184:187], v[204:207], a[200:203], v[184:187]
ds_read_b64_tr_b16 a[248:249], v251 offset:38912
ds_read_b64_tr_b16 a[250:251], v251 offset:45056
v_mfma_f32_16x16x32_bf16 v[188:191], v[204:207], a[204:207], v[188:191]
ds_read_b64_tr_b16 a[252:253], v252 offset:38912
ds_read_b64_tr_b16 a[254:255], v252 offset:45056
v_readlane_b32 s48, v239, s34
s_waitcnt lgkmcnt(15)
v_mfma_f32_16x16x32_bf16 v[96:99], v[200:203], a[208:211], v[96:99]
v_cvt_pk_bf16_f32 v0, v0, v4
v_cvt_pk_bf16_f32 v4, v1, v5
v_mfma_f32_16x16x32_bf16 v[100:103], v[200:203], a[212:215], v[100:103]
v_cvt_pk_bf16_f32 v1, v8, v12
v_cvt_pk_bf16_f32 v5, v9, v13
v_mfma_f32_16x16x32_bf16 v[104:107], v[200:203], a[216:219], v[104:107]
v_cvt_pk_bf16_f32 v2, v2, v6
s_and_b32 s79, s48, s70
s_and_b32 s46, s48, s71
s_lshr_b32 s45, s48, 8
s_and_b32 s45, s45, s71
s_bitcmp1_b32 s48, 28
s_cselect_b64 s[50:51], s[30:31], s[28:29]
s_bitcmp1_b32 s48, 29
s_cselect_b64 s[8:9], s[50:51], s[26:27]
v_cvt_pk_bf16_f32 v6, v3, v7
v_mfma_f32_16x16x32_bf16 v[108:111], v[200:203], a[220:223], v[108:111]
v_cvt_pk_bf16_f32 v3, v10, v14
v_cvt_pk_bf16_f32 v7, v11, v15
s_waitcnt lgkmcnt(8)
v_mfma_f32_16x16x32_bf16 v[112:115], v[200:203], a[224:227], v[112:115]
v_cvt_pk_bf16_f32 v16, v16, v20
v_cvt_pk_bf16_f32 v20, v17, v21
v_mfma_f32_16x16x32_bf16 v[116:119], v[200:203], a[228:231], v[116:119]
v_cvt_pk_bf16_f32 v17, v24, v28
v_cvt_pk_bf16_f32 v21, v25, v29
v_mfma_f32_16x16x32_bf16 v[120:123], v[200:203], a[232:235], v[120:123]
s_add_u32 m0, s44, s41
v_cvt_pk_bf16_f32 v18, v18, v22
buffer_load_dwordx4 v234, s[4:7], s43 offen offset:128  lds
buffer_load_dwordx4 v235, s[4:7], s43 offen offset:3200  lds
v_cvt_pk_bf16_f32 v22, v19, v23
v_mfma_f32_16x16x32_bf16 v[124:127], v[200:203], a[236:239], v[124:127]
v_cvt_pk_bf16_f32 v19, v26, v30
v_cvt_pk_bf16_f32 v23, v27, v31
s_waitcnt lgkmcnt(0)
v_mfma_f32_16x16x32_bf16 v[128:131], v[200:203], a[240:243], v[128:131]
v_cvt_pk_bf16_f32 v32, v32, v36
v_cvt_pk_bf16_f32 v36, v33, v37
v_mfma_f32_16x16x32_bf16 v[132:135], v[200:203], a[244:247], v[132:135]
v_cvt_pk_bf16_f32 v33, v40, v44
v_cvt_pk_bf16_f32 v37, v41, v45
v_mfma_f32_16x16x32_bf16 v[136:139], v[200:203], a[248:251], v[136:139]
v_cvt_pk_bf16_f32 v34, v34, v38
v_cvt_pk_bf16_f32 v38, v35, v39
v_mfma_f32_16x16x32_bf16 v[140:143], v[200:203], a[252:255], v[140:143]
v_cvt_pk_bf16_f32 v35, v42, v46
v_cvt_pk_bf16_f32 v39, v43, v47
v_add_u32 v236, s79, v233
ds_read_b64 v[236:237], v236
s_add_u32 s32, s85, 0
ds_write_b64 v253, v[0:1] offset:36864
ds_write_b64 v253, v[4:5] offset:37280
ds_write_b64 v253, v[2:3] offset:37696
ds_write_b64 v253, v[6:7] offset:38112
ds_write_b64 v253, v[16:17] offset:36992
ds_write_b64 v253, v[20:21] offset:37408
s_add_u32 m0, s44, s42
ds_write_b64 v253, v[18:19] offset:37824
buffer_load_dwordx4 v234, s[4:7], s43 offen offset:256  lds
buffer_load_dwordx4 v235, s[4:7], s43 offen offset:3328  lds
ds_write_b64 v253, v[22:23] offset:38240
ds_write_b64 v253, v[32:33] offset:37120
ds_write_b64 v253, v[36:37] offset:37536
ds_write_b64 v253, v[34:35] offset:37952
ds_write_b64 v253, v[38:39] offset:38368
v_readlane_b32 s47, v238, s34
ds_read_b64_tr_b16 v[0:1], v254 offset:36864
ds_read_b64_tr_b16 v[2:3], v254 offset:36896
ds_read_b64_tr_b16 v[8:9], v254 offset:40192
ds_read_b64_tr_b16 v[10:11], v254 offset:40224
ds_read_b64_tr_b16 v[16:17], v254 offset:36992
ds_read_b64_tr_b16 v[18:19], v254 offset:37024
ds_read_b64_tr_b16 v[24:25], v254 offset:40320
ds_read_b64_tr_b16 v[26:27], v254 offset:40352
ds_read_b64_tr_b16 v[32:33], v254 offset:37120
ds_read_b64_tr_b16 v[34:35], v254 offset:37152
ds_read_b64_tr_b16 v[40:41], v254 offset:40448
ds_read_b64_tr_b16 v[42:43], v254 offset:40480
s_add_u32 s33, s85, 6144
v_cvt_pk_bf16_f32 v48, v48, v52
v_cvt_pk_bf16_f32 v52, v49, v53
v_cvt_pk_bf16_f32 v49, v56, v60
v_cvt_pk_bf16_f32 v53, v57, v61
v_cvt_pk_bf16_f32 v50, v50, v54
v_cvt_pk_bf16_f32 v54, v51, v55
s_waitcnt lgkmcnt(0)
buffer_store_dwordx4 v[0:3], v248, s[16:19], s32 offen offset:0
v_cvt_pk_bf16_f32 v51, v58, v62
v_cvt_pk_bf16_f32 v55, v59, v63
s_waitcnt vmcnt(13) lgkmcnt(15)
s_barrier
v_add_u32 v236, v232, v236
v_xor_b32 v237, v232, v237
v_cvt_pk_bf16_f32 v64, v64, v68
v_cvt_pk_bf16_f32 v68, v65, v69
s_add_u32 m0, s46, s40
buffer_store_dwordx4 v[8:11], v248, s[16:19], s32 offen offset:3072
buffer_load_dwordx4 v236, s[8:11], s45 offen offset:0  lds
buffer_load_dwordx4 v237, s[8:11], s45 offen offset:3072  lds
v_cvt_pk_bf16_f32 v65, v72, v76
v_cvt_pk_bf16_f32 v69, v73, v77
v_cvt_pk_bf16_f32 v66, v66, v70
v_cvt_pk_bf16_f32 v70, v67, v71
buffer_store_dwordx4 v[16:19], v248, s[16:19], s32 offen offset:128
s_and_b32 s49, s47, s70
s_and_b32 s44, s47, s71
s_lshr_b32 s43, s47, 8
s_and_b32 s43, s43, s71
s_bitcmp1_b32 s47, 28
s_cselect_b64 s[50:51], s[30:31], s[28:29]
s_bitcmp1_b32 s47, 29
s_cselect_b64 s[4:5], s[50:51], s[24:25]
s_add_u32 s34, s34, 1
v_cvt_pk_bf16_f32 v67, v74, v78
v_cvt_pk_bf16_f32 v71, v75, v79
v_cvt_pk_bf16_f32 v80, v80, v84
v_cvt_pk_bf16_f32 v84, v81, v85
s_add_u32 m0, s46, s41
buffer_store_dwordx4 v[24:27], v248, s[16:19], s32 offen offset:3200
buffer_load_dwordx4 v236, s[8:11], s45 offen offset:128  lds
buffer_load_dwordx4 v237, s[8:11], s45 offen offset:3200  lds
v_cvt_pk_bf16_f32 v81, v88, v92
v_cvt_pk_bf16_f32 v85, v89, v93
v_cvt_pk_bf16_f32 v82, v82, v86
buffer_store_dwordx4 v[32:35], v248, s[16:19], s32 offen offset:256
v_add_u32 v234, s49, v233
ds_read_b64 v[234:235], v234
v_cvt_pk_bf16_f32 v86, v83, v87
v_cvt_pk_bf16_f32 v83, v90, v94
v_cvt_pk_bf16_f32 v87, v91, v95
buffer_store_dwordx4 v[40:43], v248, s[16:19], s32 offen offset:3328
s_cmp_lg_u32 s36, 2
s_cbranch_scc1 L_qh2
v_add_u32 v243, 61440, v255
ds_read_b128 a[96:99], v243 offset:0
ds_read_b128 a[100:103], v243 offset:1024
ds_read_b128 a[104:107], v243 offset:2048
ds_read_b128 a[108:111], v243 offset:3072
ds_read_b128 a[112:115], v243 offset:4096
ds_read_b128 a[116:119], v243 offset:5120
ds_read_b128 a[120:123], v243 offset:6144
ds_read_b128 a[124:127], v243 offset:7168
ds_read_b128 a[128:131], v243 offset:8192
ds_read_b128 a[132:135], v243 offset:9216
ds_read_b128 a[136:139], v243 offset:10240
ds_read_b128 a[140:143], v243 offset:11264
s_waitcnt lgkmcnt(0)
L_qh2:
s_add_u32 m0, s46, s42
s_nop 0
buffer_load_dwordx4 v236, s[8:11], s45 offen offset:256  lds
buffer_load_dwordx4 v237, s[8:11], s45 offen offset:3328  lds
s_cmp_lg_u32 s36, 3
s_cbranch_scc1 L_qh3
v_add_u32 v243, 98304, v255
ds_read_b128 a[144:147], v243 offset:0
ds_read_b128 a[148:151], v243 offset:1024
ds_read_b128 a[152:155], v243 offset:2048
ds_read_b128 a[156:159], v243 offset:3072
ds_read_b128 a[160:163], v243 offset:4096
ds_read_b128 a[164:167], v243 offset:5120
ds_read_b128 a[168:171], v243 offset:6144
ds_read_b128 a[172:175], v243 offset:7168
ds_read_b128 a[176:179], v243 offset:8192
ds_read_b128 a[180:183], v243 offset:9216
ds_read_b128 a[184:187], v243 offset:10240
ds_read_b128 a[188:191], v243 offset:11264
s_waitcnt lgkmcnt(0)
L_qh3:
s_cmp_eq_u32 s34, 34
s_cbranch_scc1 L_lastx
ds_write_b64 v253, v[48:49] offset:36864
ds_write_b64 v253, v[52:53] offset:37280
ds_write_b64 v253, v[50:51] offset:37696
ds_write_b64 v253, v[54:55] offset:38112
s_waitcnt vmcnt(18) lgkmcnt(4)
s_barrier
v_add_u32 v234, v232, v234
v_xor_b32 v235, v232, v235
s_add_u32 m0, s44, s40
ds_write_b64 v253, v[64:65] offset:36992
buffer_load_dwordx4 v234, s[4:7], s43 offen offset:0  lds
buffer_load_dwordx4 v235, s[4:7], s43 offen offset:3072  lds
ds_write_b64 v253, v[68:69] offset:37408
ds_write_b64 v253, v[66:67] offset:37824
ds_write_b64 v253, v[70:71] offset:38240
ds_write_b64 v253, v[80:81] offset:37120
v_readlane_b32 s48, v239, s34
ds_write_b64 v253, v[84:85] offset:37536
ds_write_b64 v253, v[82:83] offset:37952
ds_write_b64 v253, v[86:87] offset:38368
s_and_b32 s79, s48, s70
s_and_b32 s46, s48, s71
s_lshr_b32 s45, s48, 8
s_and_b32 s45, s45, s71
s_bitcmp1_b32 s48, 28
s_cselect_b64 s[50:51], s[30:31], s[28:29]
s_bitcmp1_b32 s48, 29
s_cselect_b64 s[8:9], s[50:51], s[26:27]
ds_read_b64_tr_b16 v[48:49], v254 offset:36864
ds_read_b64_tr_b16 v[50:51], v254 offset:36896
ds_read_b64_tr_b16 v[56:57], v254 offset:40192
ds_read_b64_tr_b16 v[58:59], v254 offset:40224
ds_read_b64_tr_b16 v[64:65], v254 offset:36992
ds_read_b64_tr_b16 v[66:67], v254 offset:37024
ds_read_b64_tr_b16 v[72:73], v254 offset:40320
ds_read_b64_tr_b16 v[74:75], v254 offset:40352
ds_read_b64_tr_b16 v[80:81], v254 offset:37120
ds_read_b64_tr_b16 v[82:83], v254 offset:37152
ds_read_b64_tr_b16 v[88:89], v254 offset:40448
ds_read_b64_tr_b16 v[90:91], v254 offset:40480
s_add_u32 m0, s44, s41
s_nop 0
buffer_load_dwordx4 v234, s[4:7], s43 offen offset:128  lds
buffer_load_dwordx4 v235, s[4:7], s43 offen offset:3200  lds
s_add_u32 s32, s85, 18432
v_cvt_pk_bf16_f32 v144, v144, v148
v_cvt_pk_bf16_f32 v148, v145, v149
v_cvt_pk_bf16_f32 v145, v152, v156
v_cvt_pk_bf16_f32 v149, v153, v157
v_cvt_pk_bf16_f32 v146, v146, v150
v_cvt_pk_bf16_f32 v150, v147, v151
s_waitcnt lgkmcnt(0)
buffer_store_dwordx4 v[48:51], v248, s[16:19], s33 offen offset:0
v_cvt_pk_bf16_f32 v147, v154, v158
v_cvt_pk_bf16_f32 v151, v155, v159
v_cvt_pk_bf16_f32 v160, v160, v164
v_cvt_pk_bf16_f32 v164, v161, v165
buffer_store_dwordx4 v[56:59], v248, s[16:19], s33 offen offset:3072
v_add_u32 v236, s79, v233
ds_read_b64 v[236:237], v236
v_cvt_pk_bf16_f32 v161, v168, v172
v_cvt_pk_bf16_f32 v165, v169, v173
v_cvt_pk_bf16_f32 v162, v162, v166
v_cvt_pk_bf16_f32 v166, v163, v167
buffer_store_dwordx4 v[64:67], v248, s[16:19], s33 offen offset:128
v_cvt_pk_bf16_f32 v163, v170, v174
v_cvt_pk_bf16_f32 v167, v171, v175
v_cvt_pk_bf16_f32 v176, v176, v180
v_cvt_pk_bf16_f32 v180, v177, v181
buffer_store_dwordx4 v[72:75], v248, s[16:19], s33 offen offset:3200
v_cvt_pk_bf16_f32 v177, v184, v188
v_cvt_pk_bf16_f32 v181, v185, v189
v_cvt_pk_bf16_f32 v178, v178, v182
buffer_store_dwordx4 v[80:83], v248, s[16:19], s33 offen offset:256
v_cvt_pk_bf16_f32 v182, v179, v183
v_cvt_pk_bf16_f32 v179, v186, v190
v_cvt_pk_bf16_f32 v183, v187, v191
s_add_u32 m0, s44, s42
buffer_store_dwordx4 v[88:91], v248, s[16:19], s33 offen offset:3328
buffer_load_dwordx4 v234, s[4:7], s43 offen offset:256  lds
buffer_load_dwordx4 v235, s[4:7], s43 offen offset:3328  lds
ds_write_b64 v253, v[144:145] offset:36864
ds_write_b64 v253, v[148:149] offset:37280
ds_write_b64 v253, v[146:147] offset:37696
ds_write_b64 v253, v[150:151] offset:38112
ds_write_b64 v253, v[160:161] offset:36992
ds_write_b64 v253, v[164:165] offset:37408
v_readlane_b32 s47, v238, s34
ds_write_b64 v253, v[162:163] offset:37824
ds_write_b64 v253, v[166:167] offset:38240
ds_write_b64 v253, v[176:177] offset:37120
ds_write_b64 v253, v[180:181] offset:37536
ds_write_b64 v253, v[178:179] offset:37952
s_waitcnt vmcnt(24) lgkmcnt(11)
s_barrier
v_add_u32 v236, v232, v236
v_xor_b32 v237, v232, v237
s_add_u32 m0, s46, s40
ds_write_b64 v253, v[182:183] offset:38368
buffer_load_dwordx4 v236, s[8:11], s45 offen offset:0  lds
buffer_load_dwordx4 v237, s[8:11], s45 offen offset:3072  lds
ds_read_b64_tr_b16 v[144:145], v254 offset:36864
ds_read_b64_tr_b16 v[146:147], v254 offset:36896
ds_read_b64_tr_b16 v[152:153], v254 offset:40192
ds_read_b64_tr_b16 v[154:155], v254 offset:40224
ds_read_b64_tr_b16 v[160:161], v254 offset:36992
ds_read_b64_tr_b16 v[162:163], v254 offset:37024
ds_read_b64_tr_b16 v[168:169], v254 offset:40320
ds_read_b64_tr_b16 v[170:171], v254 offset:40352
ds_read_b64_tr_b16 v[176:177], v254 offset:37120
ds_read_b64_tr_b16 v[178:179], v254 offset:37152
ds_read_b64_tr_b16 v[184:185], v254 offset:40448
ds_read_b64_tr_b16 v[186:187], v254 offset:40480
s_and_b32 s49, s47, s70
s_and_b32 s44, s47, s71
s_lshr_b32 s43, s47, 8
s_and_b32 s43, s43, s71
s_bitcmp1_b32 s47, 28
s_cselect_b64 s[50:51], s[30:31], s[28:29]
s_bitcmp1_b32 s47, 29
s_cselect_b64 s[4:5], s[50:51], s[24:25]
s_add_u32 s34, s34, 1
s_add_u32 s33, s85, 12288
v_cvt_pk_bf16_f32 v96, v96, v100
v_cvt_pk_bf16_f32 v100, v97, v101
v_cvt_pk_bf16_f32 v97, v104, v108
v_cvt_pk_bf16_f32 v101, v105, v109
v_cvt_pk_bf16_f32 v98, v98, v102
s_add_u32 m0, s46, s41
v_cvt_pk_bf16_f32 v102, v99, v103
buffer_load_dwordx4 v236, s[8:11], s45 offen offset:128  lds
buffer_load_dwordx4 v237, s[8:11], s45 offen offset:3200  lds
s_waitcnt lgkmcnt(0)
buffer_store_dwordx4 v[144:147], v248, s[16:19], s32 offen offset:0
v_cvt_pk_bf16_f32 v99, v106, v110
v_cvt_pk_bf16_f32 v103, v107, v111
v_cvt_pk_bf16_f32 v112, v112, v116
v_cvt_pk_bf16_f32 v116, v113, v117
buffer_store_dwordx4 v[152:155], v248, s[16:19], s32 offen offset:3072
v_add_u32 v234, s49, v233
ds_read_b64 v[234:235], v234
v_cvt_pk_bf16_f32 v113, v120, v124
v_cvt_pk_bf16_f32 v117, v121, v125
v_cvt_pk_bf16_f32 v114, v114, v118
v_cvt_pk_bf16_f32 v118, v115, v119
buffer_store_dwordx4 v[160:163], v248, s[16:19], s32 offen offset:128
v_cvt_pk_bf16_f32 v115, v122, v126
s_add_u32 m0, s46, s42
v_cvt_pk_bf16_f32 v119, v123, v127
buffer_load_dwordx4 v236, s[8:11], s45 offen offset:256  lds
buffer_load_dwordx4 v237, s[8:11], s45 offen offset:3328  lds
v_cvt_pk_bf16_f32 v128, v128, v132
v_cvt_pk_bf16_f32 v132, v129, v133
buffer_store_dwordx4 v[168:171], v248, s[16:19], s32 offen offset:3200
v_cvt_pk_bf16_f32 v129, v136, v140
v_cvt_pk_bf16_f32 v133, v137, v141
v_cvt_pk_bf16_f32 v130, v130, v134
buffer_store_dwordx4 v[176:179], v248, s[16:19], s32 offen offset:256
v_cvt_pk_bf16_f32 v134, v131, v135
v_cvt_pk_bf16_f32 v131, v138, v142
v_cvt_pk_bf16_f32 v135, v139, v143
buffer_store_dwordx4 v[184:187], v248, s[16:19], s32 offen offset:3328
s_lshl_b32 s86, s36, 8
s_sub_u32 s86, 163712, s86
v_bfe_u32 v249, v255, 4, 4
v_lshl_add_u32 v249, v249, 2, s86
ds_read2_b32 v[192:193], v249 offset0:32 offset1:32
ds_read2_b32 v[194:195], v249 offset0:32 offset1:32
ds_read2_b32 v[196:197], v249 offset0:48 offset1:48
ds_read2_b32 v[198:199], v249 offset0:48 offset1:48
ds_read2_b32 v[200:201], v249 offset0:0 offset1:0
ds_read2_b32 v[202:203], v249 offset0:0 offset1:0
ds_read2_b32 v[204:205], v249 offset0:16 offset1:16
ds_read2_b32 v[206:207], v249 offset0:16 offset1:16
ds_read_b128 a[224:227], v226 offset:0
ds_read_b128 a[228:231], v227 offset:0
ds_read_b128 a[232:235], v226 offset:1024
ds_read_b128 a[236:239], v227 offset:1024
ds_read_b128 a[240:243], v226 offset:2048
ds_read_b128 a[244:247], v227 offset:2048
ds_read_b128 a[248:251], v226 offset:6144
ds_read_b128 a[252:255], v227 offset:6144
ds_read_b128 a[192:195], v226 offset:7168
ds_read_b128 a[196:199], v227 offset:7168
ds_read_b128 a[200:203], v226 offset:8192
ds_read_b128 a[204:207], v227 offset:8192
s_waitcnt vmcnt(24) lgkmcnt(0)
s_barrier
v_add_u32 v234, v232, v234
s_add_u32 m0, s44, s40
v_xor_b32 v235, v232, v235
buffer_load_dwordx4 v234, s[4:7], s43 offen offset:0  lds
buffer_load_dwordx4 v235, s[4:7], s43 offen offset:3072  lds
ds_write_b64 v253, v[96:97] offset:36864
ds_write_b64 v253, v[100:101] offset:37280
ds_write_b64 v253, v[98:99] offset:37696
ds_write_b64 v253, v[102:103] offset:38112
v_readlane_b32 s48, v239, s34
ds_write_b64 v253, v[112:113] offset:36992
ds_write_b64 v253, v[116:117] offset:37408
s_and_b32 s79, s48, s70
s_and_b32 s46, s48, s71
s_lshr_b32 s45, s48, 8
s_and_b32 s45, s45, s71
s_bitcmp1_b32 s48, 28
s_cselect_b64 s[50:51], s[30:31], s[28:29]
s_bitcmp1_b32 s48, 29
s_cselect_b64 s[8:9], s[50:51], s[26:27]
ds_write_b64 v253, v[114:115] offset:37824
ds_write_b64 v253, v[118:119] offset:38240
s_add_u32 m0, s44, s41
ds_write_b64 v253, v[128:129] offset:37120
buffer_load_dwordx4 v234, s[4:7], s43 offen offset:128  lds
buffer_load_dwordx4 v235, s[4:7], s43 offen offset:3200  lds
ds_write_b64 v253, v[132:133] offset:37536
ds_write_b64 v253, v[130:131] offset:37952
ds_write_b64 v253, v[134:135] offset:38368
ds_read_b64_tr_b16 v[96:97], v254 offset:36864
ds_read_b64_tr_b16 v[98:99], v254 offset:36896
ds_read_b64_tr_b16 v[104:105], v254 offset:40192
ds_read_b64_tr_b16 v[106:107], v254 offset:40224
ds_read_b64_tr_b16 v[112:113], v254 offset:36992
ds_read_b64_tr_b16 v[114:115], v254 offset:37024
ds_read_b64_tr_b16 v[120:121], v254 offset:40320
ds_read_b64_tr_b16 v[122:123], v254 offset:40352
ds_read_b64_tr_b16 v[128:129], v254 offset:37120
ds_read_b64_tr_b16 v[130:131], v254 offset:37152
ds_read_b64_tr_b16 v[136:137], v254 offset:40448
ds_read_b64_tr_b16 v[138:139], v254 offset:40480
v_add_u32 v236, s79, v233
ds_read_b64 v[236:237], v236
s_cmp_lg_u32 s36, 2
s_cbranch_scc1 L_qh4
v_add_u32 v243, 147456, v255
ds_read_b128 a[144:147], v243 offset:0
ds_read_b128 a[148:151], v243 offset:1024
ds_read_b128 a[152:155], v243 offset:2048
ds_read_b128 a[156:159], v243 offset:3072
ds_read_b128 a[160:163], v243 offset:4096
ds_read_b128 a[164:167], v243 offset:5120
ds_read_b128 a[168:171], v243 offset:6144
ds_read_b128 a[172:175], v243 offset:7168
ds_read_b128 a[176:179], v243 offset:8192
ds_read_b128 a[180:183], v243 offset:9216
ds_read_b128 a[184:187], v243 offset:10240
ds_read_b128 a[188:191], v243 offset:11264
s_waitcnt lgkmcnt(0)
L_qh4:
s_add_u32 m0, s44, s42
s_nop 0
buffer_load_dwordx4 v234, s[4:7], s43 offen offset:256  lds
buffer_load_dwordx4 v235, s[4:7], s43 offen offset:3328  lds
s_waitcnt lgkmcnt(1)
buffer_store_dwordx4 v[96:99], v248, s[16:19], s33 offen offset:0
buffer_store_dwordx4 v[104:107], v248, s[16:19], s33 offen offset:3072
buffer_store_dwordx4 v[112:115], v248, s[16:19], s33 offen offset:128
buffer_store_dwordx4 v[120:123], v248, s[16:19], s33 offen offset:3200
v_readlane_b32 s47, v238, s34
buffer_store_dwordx4 v[128:131], v248, s[16:19], s33 offen offset:256
buffer_store_dwordx4 v[136:139], v248, s[16:19], s33 offen offset:3328
v_mfma_f32_16x16x32_bf16 v[128:131], a[244:247], a[116:119], v[192:195]
v_mov_b32 v243, 0xff800000
v_mov_b32 v144, 0xff800000
v_mfma_f32_16x16x32_bf16 v[128:131], a[240:243], a[112:115], v[128:131]
v_mov_b32 v145, 0xff800000
v_mov_b32 v146, 0xff800000
v_mfma_f32_16x16x32_bf16 v[128:131], a[236:239], a[108:111], v[128:131]
v_mov_b32 v147, 0xff800000
v_mov_b32 v178, 0
v_mfma_f32_16x16x32_bf16 v[128:131], a[232:235], a[104:107], v[128:131]
v_mov_b32 v179, 0
s_waitcnt vmcnt(24) lgkmcnt(0)
s_barrier
v_add_u32 v236, v232, v236
v_xor_b32 v237, v232, v237
v_mov_b32 v184, 0
v_mfma_f32_16x16x32_bf16 v[128:131], a[228:231], a[100:103], v[128:131]
s_add_u32 m0, s46, s40
v_mov_b32 v185, 0
buffer_load_dwordx4 v236, s[8:11], s45 offen offset:0  lds
buffer_load_dwordx4 v237, s[8:11], s45 offen offset:3072  lds
v_mov_b32 v186, 0
v_mfma_f32_16x16x32_bf16 v[128:131], a[224:227], a[96:99], v[128:131]
v_mov_b32 v187, 0
v_mov_b32 v188, 0
v_mfma_f32_16x16x32_bf16 v[132:135], a[224:227], a[120:123], v[196:199]
v_mov_b32 v189, 0
v_mov_b32 v190, 0
v_mfma_f32_16x16x32_bf16 v[132:135], a[228:231], a[124:127], v[132:135]
v_mov_b32 v191, 0
s_and_b32 s49, s47, s70
s_and_b32 s44, s47, s71
s_lshr_b32 s43, s47, 8
s_and_b32 s43, s43, s71
s_bitcmp1_b32 s47, 28
s_cselect_b64 s[50:51], s[30:31], s[28:29]
s_bitcmp1_b32 s47, 29
s_cselect_b64 s[4:5], s[50:51], s[24:25]
s_add_u32 s34, s34, 1
v_mov_b32 v208, 0
v_mfma_f32_16x16x32_bf16 v[132:135], a[232:235], a[128:131], v[132:135]
v_mov_b32 v209, 0
v_mov_b32 v210, 0
v_mfma_f32_16x16x32_bf16 v[132:135], a[236:239], a[132:135], v[132:135]
v_mov_b32 v211, 0
v_mov_b32 v214, 0
v_mfma_f32_16x16x32_bf16 v[132:135], a[240:243], a[136:139], v[132:135]
s_add_u32 m0, s46, s41
v_mov_b32 v215, 0
buffer_load_dwordx4 v236, s[8:11], s45 offen offset:128  lds
buffer_load_dwordx4 v237, s[8:11], s45 offen offset:3200  lds
v_mfma_f32_16x16x32_bf16 v[132:135], a[244:247], a[140:143], v[132:135]
v_cndmask_b32 v128, v128, v243, s[56:57]
v_cndmask_b32 v129, v129, v243, s[58:59]
v_mfma_f32_16x16x32_bf16 v[148:151], a[248:251], a[120:123], v[196:199]
v_cndmask_b32 v130, v130, v243, s[60:61]
v_cndmask_b32 v131, v131, v243, s[62:63]
v_mfma_f32_16x16x32_bf16 v[148:151], a[252:255], a[124:127], v[148:151]
v_mfma_f32_16x16x32_bf16 v[148:151], a[192:195], a[128:131], v[148:151]
v_mfma_f32_16x16x32_bf16 v[148:151], a[196:199], a[132:135], v[148:151]
v_mfma_f32_16x16x32_bf16 v[148:151], a[200:203], a[136:139], v[148:151]
v_mfma_f32_16x16x32_bf16 v[148:151], a[204:207], a[140:143], v[148:151]
ds_read_b128 a[192:195], v226 offset:12288
ds_read_b128 a[196:199], v227 offset:12288
ds_read_b128 a[200:203], v226 offset:13312
ds_read_b128 a[204:207], v227 offset:13312
ds_read_b128 a[208:211], v226 offset:14336
ds_read_b128 a[212:215], v227 offset:14336
ds_read_b128 a[216:219], v226 offset:18432
ds_read_b128 a[220:223], v227 offset:18432
ds_read_b128 a[224:227], v226 offset:19456
ds_read_b128 a[228:231], v227 offset:19456
ds_read_b128 a[232:235], v226 offset:20480
ds_read_b128 a[236:239], v227 offset:20480
v_add_u32 v234, s49, v233
ds_read_b64 v[234:235], v234
s_add_u32 m0, s46, s42
s_nop 0
buffer_load_dwordx4 v236, s[8:11], s45 offen offset:256  lds
buffer_load_dwordx4 v237, s[8:11], s45 offen offset:3328  lds
v_cndmask_b32 v148, v148, v243, s[56:57]
v_cndmask_b32 v149, v149, v243, s[58:59]
v_cndmask_b32 v150, v150, v243, s[60:61]
v_cndmask_b32 v151, v151, v243, s[62:63]
s_waitcnt lgkmcnt(7)
s_cmp_eq_u32 s34, 34
s_cbranch_scc1 L_last2
L_w6:
v_mfma_f32_16x16x32_bf16 v[104:107], a[212:215], a[164:167], v[200:203]
v_exp_f32 v216, v128
v_mfma_f32_16x16x32_bf16 v[104:107], a[208:211], a[160:163], v[104:107]
v_exp_f32 v217, v129
v_mfma_f32_16x16x32_bf16 v[104:107], a[204:207], a[156:159], v[104:107]
v_readlane_b32 s48, v239, s34
v_mov_b32 v243, 0xff800000
v_mfma_f32_16x16x32_bf16 v[104:107], a[200:203], a[152:155], v[104:107]
v_exp_f32 v218, v130
v_mfma_f32_16x16x32_bf16 v[104:107], a[196:199], a[148:151], v[104:107]
v_exp_f32 v219, v131
v_mfma_f32_16x16x32_bf16 v[104:107], a[192:195], a[144:147], v[104:107]
s_and_b32 s79, s48, s70
v_add_f32 v212, v216, v217
v_mov_b32 v120, 0xff800000
v_mfma_f32_16x16x32_bf16 v[108:111], a[192:195], a[168:171], v[204:207]
s_waitcnt vmcnt(18) lgkmcnt(0)
s_barrier
v_mfma_f32_16x16x32_bf16 v[108:111], a[196:199], a[172:175], v[108:111]
v_cvt_pk_bf16_f32 v176, v216, v217
v_mov_b32 v121, 0xff800000
v_mfma_f32_16x16x32_bf16 v[108:111], a[200:203], a[176:179], v[108:111]
ds_read_b64_tr_b16 a[240:241], v228 offset:0
v_mov_b32 v122, 0xff800000
v_mfma_f32_16x16x32_bf16 v[108:111], a[204:207], a[180:183], v[108:111]
s_add_u32 m0, s44, s40
v_mov_b32 v123, 0xff800000
v_add_f32 v212, v212, v218
v_mfma_f32_16x16x32_bf16 v[108:111], a[208:211], a[184:187], v[108:111]
ds_read_b64_tr_b16 a[242:243], v228 offset:6144
v_add_f32 v212, v212, v219
v_mfma_f32_16x16x32_bf16 v[108:111], a[212:215], a[188:191], v[108:111]
s_and_b32 s46, s48, s71
v_cvt_pk_bf16_f32 v177, v218, v219
v_add_u32 v234, v232, v234
v_mfma_f32_16x16x32_bf16 v[96:99], a[212:215], a[116:119], v[192:195]
buffer_load_dwordx4 v234, s[4:7], s43 offen offset:0  lds
v_mfma_f32_16x16x32_bf16 v[96:99], a[208:211], a[112:115], v[96:99]
s_lshr_b32 s45, s48, 8
v_exp_f32 v220, v132
v_mfma_f32_16x16x32_bf16 v[96:99], a[204:207], a[108:111], v[96:99]
ds_read_b64_tr_b16 a[244:245], v229 offset:0
v_xor_b32 v235, v232, v235
v_mfma_f32_16x16x32_bf16 v[96:99], a[200:203], a[104:107], v[96:99]
ds_read_b64_tr_b16 a[246:247], v229 offset:6144
v_cndmask_b32 v104, v104, v243, s[56:57]
v_mfma_f32_16x16x32_bf16 v[96:99], a[196:199], a[100:103], v[96:99]
v_cndmask_b32 v105, v105, v243, s[58:59]
v_cndmask_b32 v106, v106, v243, s[60:61]
v_mfma_f32_16x16x32_bf16 v[96:99], a[192:195], a[96:99], v[96:99]
s_and_b32 s45, s45, s71
v_cndmask_b32 v107, v107, v243, s[62:63]
v_mfma_f32_16x16x32_bf16 v[100:103], a[192:195], a[120:123], v[196:199]
v_exp_f32 v221, v133
v_mfma_f32_16x16x32_bf16 v[100:103], a[196:199], a[124:127], v[100:103]
ds_read_b64_tr_b16 a[248:249], v230 offset:0
v_add_f32 v213, v220, v221
v_mfma_f32_16x16x32_bf16 v[100:103], a[200:203], a[128:131], v[100:103]
v_exp_f32 v222, v134
v_mfma_f32_16x16x32_bf16 v[100:103], a[204:207], a[132:135], v[100:103]
ds_read_b64_tr_b16 a[250:251], v230 offset:6144
v_cvt_pk_bf16_f32 v180, v220, v221
v_mfma_f32_16x16x32_bf16 v[100:103], a[208:211], a[136:139], v[100:103]
buffer_load_dwordx4 v235, s[4:7], s43 offen offset:3072  lds
v_mfma_f32_16x16x32_bf16 v[100:103], a[212:215], a[140:143], v[100:103]
ds_read_b64_tr_b16 a[252:253], v231 offset:0
v_add_f32 v213, v213, v222
v_mfma_f32_16x16x32_bf16 v[124:127], a[216:219], a[168:171], v[204:207]
s_add_u32 s82, s82, 1
v_exp_f32 v223, v135
v_mfma_f32_16x16x32_bf16 v[124:127], a[220:223], a[172:175], v[124:127]
ds_read_b64_tr_b16 a[254:255], v231 offset:6144
v_readlane_b32 s83, v239, s82
v_mfma_f32_16x16x32_bf16 v[124:127], a[224:227], a[176:179], v[124:127]
ds_read_b64_tr_b16 a[192:193], v228 offset:1024
v_add_f32 v213, v213, v223
v_mfma_f32_16x16x32_bf16 v[124:127], a[228:231], a[180:183], v[124:127]
s_bitcmp1_b32 s48, 28
v_exp_f32 v216, v148
v_mfma_f32_16x16x32_bf16 v[124:127], a[232:235], a[184:187], v[124:127]
ds_read_b64_tr_b16 a[194:195], v228 offset:7168
v_cvt_pk_bf16_f32 v181, v222, v223
v_mfma_f32_16x16x32_bf16 v[124:127], a[236:239], a[188:191], v[124:127]
ds_read_b64_tr_b16 a[196:197], v229 offset:1024
v_add_f32 v213, v213, v216
v_mfma_f32_16x16x32_bf16 v[112:115], a[236:239], a[116:119], v[192:195]
s_cselect_b64 s[50:51], s[30:31], s[28:29]
v_exp_f32 v217, v149
v_mfma_f32_16x16x32_bf16 v[112:115], a[232:235], a[112:115], v[112:115]
ds_read_b64_tr_b16 a[198:199], v229 offset:7168
v_add_f32 v213, v213, v217
v_mfma_f32_16x16x32_bf16 v[112:115], a[228:231], a[108:111], v[112:115]
ds_read_b64_tr_b16 a[200:201], v230 offset:1024
v_cvt_pk_bf16_f32 v182, v216, v217
v_mfma_f32_16x16x32_bf16 v[112:115], a[224:227], a[104:107], v[112:115]
s_and_b32 s35, s83, 63
v_exp_f32 v218, v150
v_mfma_f32_16x16x32_bf16 v[112:115], a[220:223], a[100:103], v[112:115]
ds_read_b64_tr_b16 a[202:203], v230 offset:7168
v_cndmask_b32 v124, v124, v243, s[56:57]
v_mfma_f32_16x16x32_bf16 v[112:115], a[216:219], a[96:99], v[112:115]
s_add_u32 m0, s44, s41
v_cndmask_b32 v125, v125, v243, s[58:59]
v_cndmask_b32 v126, v126, v243, s[60:61]
v_mfma_f32_16x16x32_bf16 v[116:119], a[216:219], a[120:123], v[196:199]
buffer_load_dwordx4 v234, s[4:7], s43 offen offset:128  lds
v_mfma_f32_16x16x32_bf16 v[116:119], a[220:223], a[124:127], v[116:119]
ds_read_b64_tr_b16 a[204:205], v231 offset:1024
v_cndmask_b32 v127, v127, v243, s[62:63]
v_mfma_f32_16x16x32_bf16 v[116:119], a[224:227], a[128:131], v[116:119]
s_bitcmp1_b32 s48, 29
v_exp_f32 v219, v151
v_mfma_f32_16x16x32_bf16 v[116:119], a[228:231], a[132:135], v[116:119]
s_cselect_b64 s[8:9], s[50:51], s[26:27]
v_add_f32 v213, v213, v218
v_add_u32 v236, s79, v233
v_mfma_f32_16x16x32_bf16 v[116:119], a[232:235], a[136:139], v[116:119]
buffer_load_dwordx4 v235, s[4:7], s43 offen offset:3200  lds
v_mfma_f32_16x16x32_bf16 v[116:119], a[236:239], a[140:143], v[116:119]
s_lshr_b32 s95, s95, 4
s_mov_b64 s[12:13], s[28:29]
v_add_f32 v213, v213, v219
v_cvt_pk_bf16_f32 v183, v218, v219
ds_read_b64_tr_b16 a[206:207], v231 offset:7168
ds_read_b64_tr_b16 a[208:209], v228 offset:2048
ds_read_b64 v[236:237], v236
ds_read_b64_tr_b16 a[210:211], v228 offset:8192
s_waitcnt lgkmcnt(9)
ds_read_b64_tr_b16 a[212:213], v229 offset:2048
v_max_f32 v240, v212, v213
v_cmp_lt_f32 vcc, s52, v240
s_add_u32 m0, s44, s42
ds_read_b64_tr_b16 a[214:215], v229 offset:8192
s_cbranch_vccnz L_stub12
L_back12:
v_add_f32 v208, v208, v212
v_mfma_f32_16x16x32_bf16 v[0:3], v[176:179], a[240:243], 0
buffer_load_dwordx4 v234, s[4:7], s43 offen offset:256  lds
v_mfma_f32_16x16x32_bf16 v[4:7], v[176:179], a[244:247], 0
ds_read_b64_tr_b16 a[216:217], v230 offset:2048
v_add_f32 v209, v209, v213
v_mfma_f32_16x16x32_bf16 v[52:55], v[180:183], a[244:247], 0
v_exp_f32 v216, v96
v_mfma_f32_16x16x32_bf16 v[48:51], v[180:183], a[240:243], 0
ds_read_b64_tr_b16 a[218:219], v230 offset:8192
v_mfma_f32_16x16x32_bf16 a[0:3], v[184:187], a[240:243], 0
v_exp_f32 v217, v97
v_mfma_f32_16x16x32_bf16 a[4:7], v[184:187], a[244:247], 0
ds_read_b64_tr_b16 a[220:221], v231 offset:2048
v_add_f32 v212, v216, v217
v_mfma_f32_16x16x32_bf16 a[52:55], v[188:191], a[244:247], 0
v_exp_f32 v218, v98
v_mfma_f32_16x16x32_bf16 a[48:51], v[188:191], a[240:243], 0
ds_read_b64_tr_b16 a[222:223], v231 offset:8192
v_cvt_pk_bf16_f32 v160, v216, v217
v_mfma_f32_16x16x32_bf16 a[56:59], v[188:191], a[248:251], 0
v_exp_f32 v219, v99
v_mfma_f32_16x16x32_bf16 a[60:63], v[188:191], a[252:255], 0
v_add_f32 v212, v212, v218
v_cvt_pk_bf16_f32 v161, v218, v219
v_mfma_f32_16x16x32_bf16 a[12:15], v[184:187], a[252:255], 0
buffer_load_dwordx4 v235, s[4:7], s43 offen offset:3328  lds
v_mfma_f32_16x16x32_bf16 a[8:11], v[184:187], a[248:251], 0
v_exp_f32 v220, v100
v_mfma_f32_16x16x32_bf16 v[56:59], v[180:183], a[248:251], 0
v_add_f32 v212, v212, v219
v_mfma_f32_16x16x32_bf16 v[60:63], v[180:183], a[252:255], 0
v_exp_f32 v221, v101
v_mfma_f32_16x16x32_bf16 v[12:15], v[176:179], a[252:255], 0
v_exp_f32 v222, v102
v_mfma_f32_16x16x32_bf16 v[8:11], v[176:179], a[248:251], 0
v_add_f32 v213, v220, v221
v_cvt_pk_bf16_f32 v164, v220, v221
v_mfma_f32_16x16x32_bf16 v[16:19], v[176:179], a[192:195], 0
s_waitcnt vmcnt(12) lgkmcnt(0)
s_barrier
v_mfma_f32_16x16x32_bf16 v[20:23], v[176:179], a[196:199], 0
v_readlane_b32 s47, v238, s34
v_add_f32 v213, v213, v222
v_mfma_f32_16x16x32_bf16 v[68:71], v[180:183], a[196:199], 0
ds_read_b128 a[224:227], v226 offset:0
v_add_u32 v236, v232, v236
v_mfma_f32_16x16x32_bf16 v[64:67], v[180:183], a[192:195], 0
s_and_b32 s49, s47, s70
v_exp_f32 v223, v103
v_mfma_f32_16x16x32_bf16 a[16:19], v[184:187], a[192:195], 0
ds_read_b128 a[228:231], v227 offset:0
v_xor_b32 v237, v232, v237
v_mfma_f32_16x16x32_bf16 a[20:23], v[184:187], a[196:199], 0
s_add_u32 m0, s46, s40
v_add_f32 v213, v213, v223
v_cvt_pk_bf16_f32 v165, v222, v223
v_mfma_f32_16x16x32_bf16 a[68:71], v[188:191], a[196:199], 0
buffer_load_dwordx4 v236, s[8:11], s45 offen offset:0  lds
v_mfma_f32_16x16x32_bf16 a[64:67], v[188:191], a[192:195], 0
s_and_b32 s44, s47, s71
v_exp_f32 v216, v104
v_mfma_f32_16x16x32_bf16 a[72:75], v[188:191], a[200:203], 0
ds_read_b128 a[232:235], v226 offset:1024
s_lshr_b32 s43, s47, 8
v_mfma_f32_16x16x32_bf16 a[76:79], v[188:191], a[204:207], 0
buffer_load_dwordx4 v237, s[8:11], s45 offen offset:3072  lds
v_mfma_f32_16x16x32_bf16 a[28:31], v[184:187], a[204:207], 0
s_and_b32 s43, s43, s71
v_exp_f32 v217, v105
v_mfma_f32_16x16x32_bf16 a[24:27], v[184:187], a[200:203], 0
ds_read_b128 a[236:239], v227 offset:1024
v_add_f32 v214, v216, v217
v_mfma_f32_16x16x32_bf16 v[72:75], v[180:183], a[200:203], 0
ds_read_b128 a[240:243], v226 offset:2048
v_cvt_pk_bf16_f32 v168, v216, v217
v_mfma_f32_16x16x32_bf16 v[76:79], v[180:183], a[204:207], 0
s_add_u32 m0, s46, s41
v_exp_f32 v218, v106
v_mfma_f32_16x16x32_bf16 v[28:31], v[176:179], a[204:207], 0
buffer_load_dwordx4 v236, s[8:11], s45 offen offset:128  lds
v_mfma_f32_16x16x32_bf16 v[24:27], v[176:179], a[200:203], 0
ds_read_b128 a[244:247], v227 offset:2048
v_add_f32 v214, v214, v218
v_mfma_f32_16x16x32_bf16 v[32:35], v[176:179], a[208:211], 0
s_bitcmp1_b32 s47, 28
v_exp_f32 v219, v107
v_mfma_f32_16x16x32_bf16 v[36:39], v[176:179], a[212:215], 0
ds_read_b128 a[248:251], v226 offset:6144
v_add_f32 v214, v214, v219
v_mfma_f32_16x16x32_bf16 v[84:87], v[180:183], a[212:215], 0
buffer_load_dwordx4 v237, s[8:11], s45 offen offset:3200  lds
v_mfma_f32_16x16x32_bf16 v[80:83], v[180:183], a[208:211], 0
s_cselect_b64 s[50:51], s[30:31], s[28:29]
v_exp_f32 v220, v108
v_mfma_f32_16x16x32_bf16 a[32:35], v[184:187], a[208:211], 0
ds_read_b128 a[252:255], v227 offset:6144
v_cvt_pk_bf16_f32 v169, v218, v219
v_mfma_f32_16x16x32_bf16 a[36:39], v[184:187], a[212:215], 0
s_bitcmp1_b32 s47, 29
v_exp_f32 v221, v109
v_mfma_f32_16x16x32_bf16 a[84:87], v[188:191], a[212:215], 0
ds_read_b128 a[192:195], v226 offset:7168
v_add_f32 v215, v220, v221
v_mfma_f32_16x16x32_bf16 a[80:83], v[188:191], a[208:211], 0
ds_read_b128 a[196:199], v227 offset:7168
v_cvt_pk_bf16_f32 v172, v220, v221
v_mfma_f32_16x16x32_bf16 a[88:91], v[188:191], a[216:219], 0
s_cselect_b64 s[4:5], s[50:51], s[24:25]
v_exp_f32 v222, v110
v_mfma_f32_16x16x32_bf16 a[92:95], v[188:191], a[220:223], 0
s_add_u32 m0, s46, s42
v_add_u32 v234, s49, v233
v_add_f32 v215, v215, v222
v_mfma_f32_16x16x32_bf16 a[44:47], v[184:187], a[220:223], 0
buffer_load_dwordx4 v236, s[8:11], s45 offen offset:256  lds
v_mfma_f32_16x16x32_bf16 a[40:43], v[184:187], a[216:219], 0
ds_read_b64 v[234:235], v234
ds_read_b128 a[200:203], v226 offset:8192
v_mfma_f32_16x16x32_bf16 v[88:91], v[180:183], a[216:219], 0
s_add_u32 s34, s34, 1
v_exp_f32 v223, v111
v_mfma_f32_16x16x32_bf16 v[92:95], v[180:183], a[220:223], 0
buffer_load_dwordx4 v237, s[8:11], s45 offen offset:3328  lds
v_mfma_f32_16x16x32_bf16 v[44:47], v[176:179], a[220:223], 0
ds_read_b128 a[204:207], v227 offset:8192
v_add_f32 v215, v215, v223
v_mfma_f32_16x16x32_bf16 v[40:43], v[176:179], a[216:219], 0
s_waitcnt lgkmcnt(7)
v_cvt_pk_bf16_f32 v173, v222, v223
s_bitcmp1_b32 s95, 5
s_cbranch_scc1 L_loopc1
s_bitcmp1_b32 s95, 6
s_cbranch_scc0 L_loop1
s_branch L_loopb1
L_wf:
v_max_f32 v240, v214, v215
v_cmp_lt_f32 vcc, s52, v240
s_nop 0
s_cbranch_vccnz L_stub11
L_back11:
v_add_f32 v210, v210, v214
v_add_f32 v211, v211, v215
s_lshl_b32 s88, s36, 8
v_add_u32 v249, s77, v226
v_add_u32 v250, s77, v227
v_add_u32 v251, s88, v242
s_waitcnt vmcnt(12) lgkmcnt(0)
s_barrier
v_add_u32 v234, v232, v234
v_xor_b32 v235, v232, v235
ds_read_b64_tr_b16 a[208:209], v228 offset:12288
ds_read_b64_tr_b16 a[210:211], v228 offset:18432
ds_read_b64_tr_b16 a[212:213], v229 offset:12288
ds_read_b64_tr_b16 a[214:215], v229 offset:18432
ds_read_b64_tr_b16 a[216:217], v230 offset:12288
ds_read_b64_tr_b16 a[218:219], v230 offset:18432
ds_read_b64_tr_b16 a[220:221], v231 offset:12288
ds_read_b64_tr_b16 a[222:223], v231 offset:18432
ds_read_b64_tr_b16 a[224:225], v228 offset:13312
ds_read_b64_tr_b16 a[226:227], v228 offset:19456
ds_read_b64_tr_b16 a[228:229], v229 offset:13312
ds_read_b64_tr_b16 a[230:231], v229 offset:19456
ds_read_b64_tr_b16 a[232:233], v230 offset:13312
ds_read_b64_tr_b16 a[234:235], v230 offset:19456
ds_read_b64_tr_b16 a[236:237], v231 offset:13312
ds_read_b64_tr_b16 a[238:239], v231 offset:19456
ds_read_b64_tr_b16 a[240:241], v228 offset:14336
ds_read_b64_tr_b16 a[242:243], v228 offset:20480
ds_read_b64_tr_b16 a[244:245], v229 offset:14336
ds_read_b64_tr_b16 a[246:247], v229 offset:20480
ds_read_b64_tr_b16 a[248:249], v230 offset:14336
ds_read_b64_tr_b16 a[250:251], v230 offset:20480
ds_read_b64_tr_b16 a[252:253], v231 offset:14336
ds_read_b64_tr_b16 a[254:255], v231 offset:20480
ds_read_b128 v[128:131], v249 offset:0
ds_read_b128 v[132:135], v250 offset:0
ds_read_b128 v[136:139], v249 offset:1024
ds_read_b128 v[140:143], v250 offset:1024
ds_read_b128 v[144:147], v249 offset:2048
ds_read_b128 v[148:151], v250 offset:2048
ds_read_b128 v[152:155], v249 offset:6144
ds_read_b128 v[156:159], v250 offset:6144
ds_read_b128 v[176:179], v249 offset:7168
ds_read_b128 v[180:183], v250 offset:7168
ds_read_b128 v[184:187], v249 offset:8192
ds_read_b128 v[188:191], v250 offset:8192
s_add_u32 m0, s44, s40
s_nop 0
buffer_load_dwordx4 v234, s[4:7], s43 offen offset:0  lds
buffer_load_dwordx4 v235, s[4:7], s43 offen offset:3072  lds
v_readlane_b32 s48, v239, s34
s_and_b32 s79, s48, s70
s_and_b32 s46, s48, s71
s_lshr_b32 s45, s48, 8
s_and_b32 s45, s45, s71
s_bitcmp1_b32 s48, 28
s_cselect_b64 s[50:51], s[30:31], s[28:29]
s_bitcmp1_b32 s48, 29
s_cselect_b64 s[8:9], s[50:51], s[26:27]
s_add_u32 m0, s44, s41
s_nop 0
buffer_load_dwordx4 v234, s[4:7], s43 offen offset:128  lds
buffer_load_dwordx4 v235, s[4:7], s43 offen offset:3200  lds
v_permlane16_swap_b32 v210, v211
v_add_f32 v210, v210, v211
v_mov_b32 v211, v210
s_waitcnt lgkmcnt(15)
v_mfma_f32_16x16x32_bf16 a[0:3], v[168:171], a[208:211], a[0:3]
v_permlane32_swap_b32 v210, v211
v_mfma_f32_16x16x32_bf16 a[48:51], v[172:175], a[208:211], a[48:51]
v_mfma_f32_16x16x32_bf16 a[52:55], v[172:175], a[212:215], a[52:55]
v_add_f32 v210, v210, v211
v_mfma_f32_16x16x32_bf16 a[4:7], v[168:171], a[212:215], a[4:7]
v_mfma_f32_16x16x32_bf16 a[8:11], v[168:171], a[216:219], a[8:11]
v_rcp_f32 v246, v210
v_add_u32 v236, s79, v233
ds_read_b64 v[236:237], v236
v_mfma_f32_16x16x32_bf16 a[56:59], v[172:175], a[216:219], a[56:59]
v_mfma_f32_16x16x32_bf16 a[60:63], v[172:175], a[220:223], a[60:63]
v_mul_f32 v246, s55, v246
v_mfma_f32_16x16x32_bf16 a[12:15], v[168:171], a[220:223], a[12:15]
v_mfma_f32_16x16x32_bf16 a[16:19], v[168:171], a[224:227], a[16:19]
v_mfma_f32_16x16x32_bf16 a[64:67], v[172:175], a[224:227], a[64:67]
v_mfma_f32_16x16x32_bf16 a[68:71], v[172:175], a[228:231], a[68:71]
v_mfma_f32_16x16x32_bf16 a[20:23], v[168:171], a[228:231], a[20:23]
v_mfma_f32_16x16x32_bf16 a[24:27], v[168:171], a[232:235], a[24:27]
v_mfma_f32_16x16x32_bf16 a[72:75], v[172:175], a[232:235], a[72:75]
v_mfma_f32_16x16x32_bf16 a[76:79], v[172:175], a[236:239], a[76:79]
v_mfma_f32_16x16x32_bf16 a[28:31], v[168:171], a[236:239], a[28:31]
v_mfma_f32_16x16x32_bf16 a[32:35], v[168:171], a[240:243], a[32:35]
v_mfma_f32_16x16x32_bf16 a[80:83], v[172:175], a[240:243], a[80:83]
v_mfma_f32_16x16x32_bf16 a[84:87], v[172:175], a[244:247], a[84:87]
v_mfma_f32_16x16x32_bf16 a[36:39], v[168:171], a[244:247], a[36:39]
s_waitcnt lgkmcnt(13)
v_mfma_f32_16x16x32_bf16 a[40:43], v[168:171], a[248:251], a[40:43]
v_mfma_f32_16x16x32_bf16 a[88:91], v[172:175], a[248:251], a[88:91]
v_mfma_f32_16x16x32_bf16 a[92:95], v[172:175], a[252:255], a[92:95]
v_mfma_f32_16x16x32_bf16 a[44:47], v[168:171], a[252:255], a[44:47]
s_waitcnt lgkmcnt(9)
v_mfma_f32_16x16x32_bf16 v[216:219], v[128:131], a[96:99], 0
ds_read_b128 v[128:131], v249 offset:12288
s_add_u32 m0, s44, s42
s_nop 0
buffer_load_dwordx4 v234, s[4:7], s43 offen offset:256  lds
buffer_load_dwordx4 v235, s[4:7], s43 offen offset:3328  lds
v_readlane_b32 s47, v238, s34
v_mfma_f32_16x16x32_bf16 v[216:219], v[132:135], a[100:103], v[216:219]
ds_read_b128 v[132:135], v250 offset:12288
v_mfma_f32_16x16x32_bf16 v[216:219], v[136:139], a[104:107], v[216:219]
ds_read_b128 v[136:139], v249 offset:13312
v_mfma_f32_16x16x32_bf16 v[216:219], v[140:143], a[108:111], v[216:219]
ds_read_b128 v[140:143], v250 offset:13312
s_waitcnt lgkmcnt(9)
v_mfma_f32_16x16x32_bf16 v[216:219], v[144:147], a[112:115], v[216:219]
ds_read_b128 v[144:147], v249 offset:14336
v_mfma_f32_16x16x32_bf16 v[216:219], v[148:151], a[116:119], v[216:219]
ds_read_b128 v[148:151], v250 offset:14336
v_mfma_f32_16x16x32_bf16 v[220:223], v[152:155], a[96:99], 0
ds_read_b128 v[152:155], v249 offset:18432
v_mfma_f32_16x16x32_bf16 v[220:223], v[156:159], a[100:103], v[220:223]
ds_read_b128 v[156:159], v250 offset:18432
s_waitcnt lgkmcnt(9)
v_mfma_f32_16x16x32_bf16 v[220:223], v[176:179], a[104:107], v[220:223]
ds_read_b128 v[176:179], v249 offset:19456
v_mfma_f32_16x16x32_bf16 v[220:223], v[180:183], a[108:111], v[220:223]
ds_read_b128 v[180:183], v250 offset:19456
v_mfma_f32_16x16x32_bf16 v[220:223], v[184:187], a[112:115], v[220:223]
ds_read_b128 v[184:187], v249 offset:20480
v_mfma_f32_16x16x32_bf16 v[220:223], v[188:191], a[116:119], v[220:223]
ds_read_b128 v[188:191], v250 offset:20480
s_waitcnt vmcnt(12) lgkmcnt(12)
s_barrier
v_add_u32 v236, v232, v236
s_add_u32 m0, s46, s40
v_xor_b32 v237, v232, v237
buffer_load_dwordx4 v236, s[8:11], s45 offen offset:0  lds
buffer_load_dwordx4 v237, s[8:11], s45 offen offset:3072  lds
s_and_b32 s49, s47, s70
s_and_b32 s44, s47, s71
s_lshr_b32 s43, s47, 8
s_and_b32 s43, s43, s71
s_bitcmp1_b32 s47, 28
s_cselect_b64 s[50:51], s[30:31], s[28:29]
s_bitcmp1_b32 s47, 29
s_cselect_b64 s[4:5], s[50:51], s[24:25]
s_add_u32 s34, s34, 1
s_waitcnt lgkmcnt(8)
v_mfma_f32_16x16x32_bf16 v[192:195], v[128:131], a[120:123], 0
ds_read_b128 v[128:131], v249 offset:24576
s_add_u32 m0, s46, s41
s_nop 0
buffer_load_dwordx4 v236, s[8:11], s45 offen offset:128  lds
buffer_load_dwordx4 v237, s[8:11], s45 offen offset:3200  lds
v_mfma_f32_16x16x32_bf16 v[192:195], v[132:135], a[124:127], v[192:195]
ds_read_b128 v[132:135], v250 offset:24576
v_mfma_f32_16x16x32_bf16 v[192:195], v[136:139], a[128:131], v[192:195]
ds_read_b128 v[136:139], v249 offset:25600
v_mfma_f32_16x16x32_bf16 v[192:195], v[140:143], a[132:135], v[192:195]
ds_read_b128 v[140:143], v250 offset:25600
v_add_u32 v234, s49, v233
ds_read_b64 v[234:235], v234
s_waitcnt lgkmcnt(9)
v_mfma_f32_16x16x32_bf16 v[192:195], v[144:147], a[136:139], v[192:195]
ds_read_b128 v[144:147], v249 offset:26624
v_sub_f32 v216, v216, v220
v_mfma_f32_16x16x32_bf16 v[192:195], v[148:151], a[140:143], v[192:195]
ds_read_b128 v[148:151], v250 offset:26624
v_sub_f32 v217, v217, v221
v_mfma_f32_16x16x32_bf16 v[196:199], v[152:155], a[120:123], 0
ds_read_b128 v[152:155], v249 offset:30720
v_sub_f32 v218, v218, v222
v_mfma_f32_16x16x32_bf16 v[196:199], v[156:159], a[124:127], v[196:199]
ds_read_b128 v[156:159], v250 offset:30720
s_add_u32 m0, s46, s42
s_nop 0
buffer_load_dwordx4 v236, s[8:11], s45 offen offset:256  lds
buffer_load_dwordx4 v237, s[8:11], s45 offen offset:3328  lds
v_sub_f32 v219, v219, v223
s_waitcnt lgkmcnt(9)
v_mfma_f32_16x16x32_bf16 v[196:199], v[176:179], a[128:131], v[196:199]
ds_read_b128 v[176:179], v249 offset:31744
v_cndmask_b32 v216, v216, v217, s[64:65]
v_mfma_f32_16x16x32_bf16 v[196:199], v[180:183], a[132:135], v[196:199]
ds_read_b128 v[180:183], v250 offset:31744
v_cndmask_b32 v216, v216, v218, s[66:67]
v_mfma_f32_16x16x32_bf16 v[196:199], v[184:187], a[136:139], v[196:199]
ds_read_b128 v[184:187], v249 offset:32768
v_cndmask_b32 v216, v216, v219, s[68:69]
v_mfma_f32_16x16x32_bf16 v[196:199], v[188:191], a[140:143], v[196:199]
ds_read_b128 v[188:191], v250 offset:32768
ds_write_b32 v251, v216 offset:0
s_waitcnt lgkmcnt(10)
v_mfma_f32_16x16x32_bf16 v[216:219], v[128:131], a[144:147], 0
ds_read_b128 v[128:131], v249 offset:36864
v_mfma_f32_16x16x32_bf16 v[216:219], v[132:135], a[148:151], v[216:219]
ds_read_b128 v[132:135], v250 offset:36864
v_mfma_f32_16x16x32_bf16 v[216:219], v[136:139], a[152:155], v[216:219]
ds_read_b128 v[136:139], v249 offset:37888
v_mfma_f32_16x16x32_bf16 v[216:219], v[140:143], a[156:159], v[216:219]
ds_read_b128 v[140:143], v250 offset:37888
s_waitcnt lgkmcnt(9)
v_mfma_f32_16x16x32_bf16 v[216:219], v[144:147], a[160:163], v[216:219]
ds_read_b128 v[144:147], v249 offset:38912
v_sub_f32 v192, v192, v196
v_mfma_f32_16x16x32_bf16 v[216:219], v[148:151], a[164:167], v[216:219]
ds_read_b128 v[148:151], v250 offset:38912
s_waitcnt vmcnt(12) lgkmcnt(15)
s_barrier
v_add_u32 v234, v232, v234
v_xor_b32 v235, v232, v235
v_sub_f32 v193, v193, v197
v_mfma_f32_16x16x32_bf16 v[220:223], v[152:155], a[144:147], 0
ds_read_b128 v[152:155], v249 offset:43008
s_add_u32 m0, s44, s40
s_nop 0
buffer_load_dwordx4 v234, s[4:7], s43 offen offset:0  lds
buffer_load_dwordx4 v235, s[4:7], s43 offen offset:3072  lds
v_sub_f32 v194, v194, v198
v_mfma_f32_16x16x32_bf16 v[220:223], v[156:159], a[148:151], v[220:223]
ds_read_b128 v[156:159], v250 offset:43008
v_sub_f32 v195, v195, v199
s_waitcnt lgkmcnt(9)
v_mfma_f32_16x16x32_bf16 v[220:223], v[176:179], a[152:155], v[220:223]
ds_read_b128 v[176:179], v249 offset:44032
v_cndmask_b32 v192, v192, v193, s[64:65]
v_mfma_f32_16x16x32_bf16 v[220:223], v[180:183], a[156:159], v[220:223]
ds_read_b128 v[180:183], v250 offset:44032
v_cndmask_b32 v192, v192, v194, s[66:67]
v_mfma_f32_16x16x32_bf16 v[220:223], v[184:187], a[160:163], v[220:223]
ds_read_b128 v[184:187], v249 offset:45056
v_cndmask_b32 v192, v192, v195, s[68:69]
v_mfma_f32_16x16x32_bf16 v[220:223], v[188:191], a[164:167], v[220:223]
ds_read_b128 v[188:191], v250 offset:45056
ds_write_b32 v251, v192 offset:64
v_readlane_b32 s48, v239, s34
s_waitcnt lgkmcnt(9)
v_mfma_f32_16x16x32_bf16 v[192:195], v[128:131], a[168:171], 0
v_mfma_f32_16x16x32_bf16 v[192:195], v[132:135], a[172:175], v[192:195]
v_mfma_f32_16x16x32_bf16 v[192:195], v[136:139], a[176:179], v[192:195]
v_mfma_f32_16x16x32_bf16 v[192:195], v[140:143], a[180:183], v[192:195]
s_waitcnt lgkmcnt(5)
v_mfma_f32_16x16x32_bf16 v[192:195], v[144:147], a[184:187], v[192:195]
v_sub_f32 v216, v216, v220
s_and_b32 s79, s48, s70
s_and_b32 s46, s48, s71
s_lshr_b32 s45, s48, 8
s_and_b32 s45, s45, s71
s_bitcmp1_b32 s48, 28
s_cselect_b64 s[50:51], s[30:31], s[28:29]
s_bitcmp1_b32 s48, 29
s_cselect_b64 s[8:9], s[50:51], s[26:27]
v_sub_f32 v217, v217, v221
v_mfma_f32_16x16x32_bf16 v[192:195], v[148:151], a[188:191], v[192:195]
v_sub_f32 v218, v218, v222
v_sub_f32 v219, v219, v223
v_mfma_f32_16x16x32_bf16 v[196:199], v[152:155], a[168:171], 0
s_add_u32 m0, s44, s41
v_cndmask_b32 v216, v216, v217, s[64:65]
buffer_load_dwordx4 v234, s[4:7], s43 offen offset:128  lds
buffer_load_dwordx4 v235, s[4:7], s43 offen offset:3200  lds
v_cndmask_b32 v216, v216, v218, s[66:67]
v_mfma_f32_16x16x32_bf16 v[196:199], v[156:159], a[172:175], v[196:199]
v_cndmask_b32 v216, v216, v219, s[68:69]
s_waitcnt lgkmcnt(1)
v_mfma_f32_16x16x32_bf16 v[196:199], v[176:179], a[176:179], v[196:199]
ds_write_b32 v251, v216 offset:128
v_mfma_f32_16x16x32_bf16 v[196:199], v[180:183], a[180:183], v[196:199]
v_mfma_f32_16x16x32_bf16 v[196:199], v[184:187], a[184:187], v[196:199]
v_mfma_f32_16x16x32_bf16 v[196:199], v[188:191], a[188:191], v[196:199]
s_nop 7
v_sub_f32 v192, v192, v196
v_add_u32 v236, s79, v233
ds_read_b64 v[236:237], v236
v_sub_f32 v193, v193, v197
v_sub_f32 v194, v194, v198
v_sub_f32 v195, v195, v199
v_cndmask_b32 v192, v192, v193, s[64:65]
v_cndmask_b32 v192, v192, v194, s[66:67]
v_cndmask_b32 v192, v192, v195, s[68:69]
ds_write_b32 v251, v192 offset:192
v_bfe_u32 v245, v255, 2, 7
v_add_u32 v245, 163456, v245
v_lshrrev_b32 v247, 4, v255
v_and_b32 v247, 48, v247
v_add_u32 v247, 163456, v247
s_lshl_b32 s88, s36, 8
s_add_u32 s86, s77, -24576
v_add_u32 v144, s88, v242
ds_read_b32 v128, v144 offset:0
ds_read_b32 v132, v144 offset:64
ds_read_b32 v136, v144 offset:128
ds_read_b32 v140, v144 offset:192
s_add_u32 m0, s44, s42
ds_write2_b32 v245, v244, v246 offset0:0 offset1:32
buffer_load_dwordx4 v234, s[4:7], s43 offen offset:256  lds
buffer_load_dwordx4 v235, s[4:7], s43 offen offset:3328  lds
ds_read_b128 v[216:219], v247 offset:0
ds_read_b128 v[220:223], v247 offset:64
ds_read_b128 v[208:211], v247 offset:128
ds_read_b128 v[212:215], v247 offset:192
v_add_u32 v249, s86, v228
v_add_u32 v250, s86, v229
v_add_u32 v251, s86, v230
v_add_u32 v252, s86, v231
v_add_u32 v226, 49152, v226
v_add_u32 v227, 49152, v227
v_add_u32 v228, 49152, v228
v_add_u32 v229, 49152, v229
v_add_u32 v230, 49152, v230
v_add_u32 v231, 49152, v231
s_mov_b32 s84, 49152
v_lshlrev_b32 v145, 2, v242
v_and_b32 v145, 16, v145
v_mov_b32 v144, 0xffff
v_lshlrev_b32 v145, v145, v144
s_waitcnt lgkmcnt(5)
v_exp_f32 v129, -|v128|
v_exp_f32 v133, -|v132|
v_readlane_b32 s47, v238, s34
v_exp_f32 v137, -|v136|
v_exp_f32 v141, -|v140|
v_add_f32 v130, 1.0, v129
v_add_f32 v134, 1.0, v133
v_add_f32 v138, 1.0, v137
v_add_f32 v142, 1.0, v141
v_rcp_f32 v130, v130
v_rcp_f32 v134, v134
v_rcp_f32 v138, v138
v_rcp_f32 v142, v142
v_mul_f32 v130, s54, v130
v_mul_f32 v134, s54, v134
v_mul_f32 v138, s54, v138
v_mul_f32 v142, s54, v142
v_mul_f32 v129, v129, v130
v_mul_f32 v133, v133, v134
v_mul_f32 v137, v137, v138
v_mul_f32 v141, v141, v142
v_cvt_pk_bf16_f32 v130, v130, v130
v_cvt_pk_bf16_f32 v134, v134, v134
v_cvt_pk_bf16_f32 v138, v138, v138
v_cvt_pk_bf16_f32 v142, v142, v142
v_cvt_pk_bf16_f32 v129, v129, v129
v_cvt_pk_bf16_f32 v133, v133, v133
s_waitcnt vmcnt(63) lgkmcnt(10)
s_barrier
v_add_u32 v236, v232, v236
v_xor_b32 v237, v232, v237
v_cvt_pk_bf16_f32 v137, v137, v137
v_cvt_pk_bf16_f32 v141, v141, v141
s_add_u32 m0, s46, s40
v_and_b32 v130, v145, v130
buffer_load_dwordx4 v236, s[8:11], s45 offen offset:0  lds
buffer_load_dwordx4 v237, s[8:11], s45 offen offset:3072  lds
v_and_b32 v134, v145, v134
v_and_b32 v138, v145, v138
v_and_b32 v142, v145, v142
v_and_b32 v129, v145, v129
v_and_b32 v133, v145, v133
v_and_b32 v137, v145, v137
v_and_b32 v141, v145, v141
v_cmp_le_f32 vcc, 0, v128
s_nop 1
v_cndmask_b32 v128, v129, v130, vcc
v_cndmask_b32 v131, v130, v129, vcc
v_cndmask_b32 v192, 0, v128, s[72:73]
s_and_b32 s49, s47, s70
s_and_b32 s44, s47, s71
s_lshr_b32 s43, s47, 8
s_and_b32 s43, s43, s71
s_bitcmp1_b32 s47, 28
s_cselect_b64 s[50:51], s[30:31], s[28:29]
s_bitcmp1_b32 s47, 29
s_cselect_b64 s[4:5], s[50:51], s[24:25]
s_add_u32 s34, s34, 1
v_cndmask_b32 v193, 0, v128, s[74:75]
v_cndmask_b32 v194, 0, v131, s[72:73]
v_cndmask_b32 v195, 0, v131, s[74:75]
v_cmp_le_f32 vcc, 0, v132
s_nop 1
v_cndmask_b32 v132, v133, v134, vcc
v_cndmask_b32 v135, v134, v133, vcc
v_cndmask_b32 v196, 0, v132, s[72:73]
v_cndmask_b32 v197, 0, v132, s[74:75]
v_cndmask_b32 v198, 0, v135, s[72:73]
s_add_u32 m0, s46, s41
v_cndmask_b32 v199, 0, v135, s[74:75]
buffer_load_dwordx4 v236, s[8:11], s45 offen offset:128  lds
buffer_load_dwordx4 v237, s[8:11], s45 offen offset:3200  lds
v_cmp_le_f32 vcc, 0, v136
s_nop 1
v_cndmask_b32 v136, v137, v138, vcc
v_cndmask_b32 v139, v138, v137, vcc
v_cndmask_b32 v200, 0, v136, s[72:73]
v_cndmask_b32 v201, 0, v136, s[74:75]
v_cndmask_b32 v202, 0, v139, s[72:73]
v_cndmask_b32 v203, 0, v139, s[74:75]
v_cmp_le_f32 vcc, 0, v140
s_nop 1
v_cndmask_b32 v140, v141, v142, vcc
v_cndmask_b32 v143, v142, v141, vcc
v_add_u32 v234, s49, v233
ds_read_b64 v[234:235], v234
v_cndmask_b32 v204, 0, v140, s[72:73]
v_cndmask_b32 v205, 0, v140, s[74:75]
v_cndmask_b32 v206, 0, v143, s[72:73]
v_cndmask_b32 v207, 0, v143, s[74:75]
s_waitcnt lgkmcnt(1)
v_pk_mul_f32 v[0:1], v[0:1], v[216:217]
v_pk_mul_f32 v[2:3], v[2:3], v[218:219]
v_pk_mul_f32 v[4:5], v[4:5], v[216:217]
v_pk_mul_f32 v[6:7], v[6:7], v[218:219]
v_pk_mul_f32 v[8:9], v[8:9], v[216:217]
v_pk_mul_f32 v[10:11], v[10:11], v[218:219]
v_pk_mul_f32 v[12:13], v[12:13], v[216:217]
v_pk_mul_f32 v[14:15], v[14:15], v[218:219]
v_pk_mul_f32 v[16:17], v[16:17], v[216:217]
v_pk_mul_f32 v[18:19], v[18:19], v[218:219]
v_pk_mul_f32 v[20:21], v[20:21], v[216:217]
s_add_u32 m0, s46, s42
v_pk_mul_f32 v[22:23], v[22:23], v[218:219]
buffer_load_dwordx4 v236, s[8:11], s45 offen offset:256  lds
buffer_load_dwordx4 v237, s[8:11], s45 offen offset:3328  lds
v_pk_mul_f32 v[24:25], v[24:25], v[216:217]
v_pk_mul_f32 v[26:27], v[26:27], v[218:219]
v_pk_mul_f32 v[28:29], v[28:29], v[216:217]
v_pk_mul_f32 v[30:31], v[30:31], v[218:219]
v_pk_mul_f32 v[32:33], v[32:33], v[216:217]
v_pk_mul_f32 v[34:35], v[34:35], v[218:219]
v_pk_mul_f32 v[36:37], v[36:37], v[216:217]
v_pk_mul_f32 v[38:39], v[38:39], v[218:219]
v_pk_mul_f32 v[40:41], v[40:41], v[216:217]
v_pk_mul_f32 v[42:43], v[42:43], v[218:219]
v_pk_mul_f32 v[44:45], v[44:45], v[216:217]
v_pk_mul_f32 v[46:47], v[46:47], v[218:219]
v_pk_mul_f32 v[48:49], v[48:49], v[220:221]
v_pk_mul_f32 v[50:51], v[50:51], v[222:223]
v_pk_mul_f32 v[52:53], v[52:53], v[220:221]
v_pk_mul_f32 v[54:55], v[54:55], v[222:223]
v_pk_mul_f32 v[56:57], v[56:57], v[220:221]
v_pk_mul_f32 v[58:59], v[58:59], v[222:223]
v_pk_mul_f32 v[60:61], v[60:61], v[220:221]
v_pk_mul_f32 v[62:63], v[62:63], v[222:223]
v_pk_mul_f32 v[64:65], v[64:65], v[220:221]
v_pk_mul_f32 v[66:67], v[66:67], v[222:223]
v_pk_mul_f32 v[68:69], v[68:69], v[220:221]
v_pk_mul_f32 v[70:71], v[70:71], v[222:223]
v_pk_mul_f32 v[72:73], v[72:73], v[220:221]
v_pk_mul_f32 v[74:75], v[74:75], v[222:223]
v_pk_mul_f32 v[76:77], v[76:77], v[220:221]
v_pk_mul_f32 v[78:79], v[78:79], v[222:223]
v_pk_mul_f32 v[80:81], v[80:81], v[220:221]
v_pk_mul_f32 v[82:83], v[82:83], v[222:223]
v_pk_mul_f32 v[84:85], v[84:85], v[220:221]
v_pk_mul_f32 v[86:87], v[86:87], v[222:223]
v_pk_mul_f32 v[88:89], v[88:89], v[220:221]
v_pk_mul_f32 v[90:91], v[90:91], v[222:223]
v_pk_mul_f32 v[92:93], v[92:93], v[220:221]
v_pk_mul_f32 v[94:95], v[94:95], v[222:223]
v_accvgpr_read_b32 v168, a72
v_accvgpr_read_b32 v169, a73
v_accvgpr_read_b32 v170, a74
v_accvgpr_read_b32 v171, a75
v_pk_mul_f32 v[168:169], v[168:169], v[212:213]
v_accvgpr_read_b32 v172, a76
v_accvgpr_read_b32 v173, a77
v_pk_mul_f32 v[170:171], v[170:171], v[214:215]
v_accvgpr_read_b32 v174, a78
s_waitcnt vmcnt(12) lgkmcnt(0)
s_barrier
v_add_u32 v234, v232, v234
v_xor_b32 v235, v232, v235
v_accvgpr_read_b32 v175, a79
v_pk_mul_f32 v[172:173], v[172:173], v[212:213]
s_add_u32 m0, s44, s40
v_accvgpr_read_b32 v176, a80
buffer_load_dwordx4 v234, s[4:7], s43 offen offset:0  lds
buffer_load_dwordx4 v235, s[4:7], s43 offen offset:3072  lds
v_accvgpr_read_b32 v177, a81
v_pk_mul_f32 v[174:175], v[174:175], v[214:215]
v_accvgpr_read_b32 v178, a82
v_accvgpr_read_b32 v179, a83
v_pk_mul_f32 v[176:177], v[176:177], v[212:213]
v_accvgpr_read_b32 v180, a84
v_accvgpr_read_b32 v181, a85
v_pk_mul_f32 v[178:179], v[178:179], v[214:215]
v_accvgpr_read_b32 v182, a86
v_accvgpr_read_b32 v183, a87
v_pk_mul_f32 v[180:181], v[180:181], v[212:213]
v_accvgpr_read_b32 v184, a88
v_accvgpr_read_b32 v185, a89
v_pk_mul_f32 v[182:183], v[182:183], v[214:215]
v_accvgpr_read_b32 v186, a90
v_accvgpr_read_b32 v187, a91
v_pk_mul_f32 v[184:185], v[184:185], v[212:213]
v_accvgpr_read_b32 v188, a92
v_accvgpr_read_b32 v189, a93
v_pk_mul_f32 v[186:187], v[186:187], v[214:215]
v_accvgpr_read_b32 v190, a94
v_accvgpr_read_b32 v191, a95
v_readlane_b32 s48, v239, s34
v_pk_mul_f32 v[188:189], v[188:189], v[212:213]
v_accvgpr_read_b32 v96, a0
ds_read_b64_tr_b16 a[192:193], v249 offset:0
ds_read_b64_tr_b16 a[194:195], v249 offset:6144
ds_read_b64_tr_b16 a[196:197], v250 offset:0
ds_read_b64_tr_b16 a[198:199], v250 offset:6144
ds_read_b64_tr_b16 a[200:201], v251 offset:0
ds_read_b64_tr_b16 a[202:203], v251 offset:6144
ds_read_b64_tr_b16 a[204:205], v252 offset:0
ds_read_b64_tr_b16 a[206:207], v252 offset:6144
ds_read_b64_tr_b16 a[208:209], v249 offset:1024
ds_read_b64_tr_b16 a[210:211], v249 offset:7168
ds_read_b64_tr_b16 a[212:213], v250 offset:1024
ds_read_b64_tr_b16 a[214:215], v250 offset:7168
ds_read_b64_tr_b16 a[216:217], v251 offset:1024
ds_read_b64_tr_b16 a[218:219], v251 offset:7168
ds_read_b64_tr_b16 a[220:221], v252 offset:1024
ds_read_b64_tr_b16 a[222:223], v252 offset:7168
ds_read_b64_tr_b16 a[224:225], v249 offset:2048
ds_read_b64_tr_b16 a[226:227], v249 offset:8192
ds_read_b64_tr_b16 a[228:229], v250 offset:2048
ds_read_b64_tr_b16 a[230:231], v250 offset:8192
ds_read_b64_tr_b16 a[232:233], v251 offset:2048
ds_read_b64_tr_b16 a[234:235], v251 offset:8192
ds_read_b64_tr_b16 a[236:237], v252 offset:2048
ds_read_b64_tr_b16 a[238:239], v252 offset:8192
s_and_b32 s79, s48, s70
s_and_b32 s46, s48, s71
s_lshr_b32 s45, s48, 8
s_and_b32 s45, s45, s71
s_bitcmp1_b32 s48, 28
s_cselect_b64 s[50:51], s[30:31], s[28:29]
s_bitcmp1_b32 s48, 29
s_cselect_b64 s[8:9], s[50:51], s[26:27]
s_add_u32 m0, s44, s41
s_nop 0
buffer_load_dwordx4 v234, s[4:7], s43 offen offset:128  lds
buffer_load_dwordx4 v235, s[4:7], s43 offen offset:3200  lds
v_accvgpr_read_b32 v97, a1
v_pk_mul_f32 v[190:191], v[190:191], v[214:215]
v_accvgpr_read_b32 v98, a2
v_accvgpr_read_b32 v99, a3
v_pk_mul_f32 v[96:97], v[96:97], v[208:209]
v_accvgpr_read_b32 v100, a4
v_accvgpr_read_b32 v101, a5
v_pk_mul_f32 v[98:99], v[98:99], v[210:211]
v_accvgpr_read_b32 v102, a6
v_accvgpr_read_b32 v103, a7
v_pk_mul_f32 v[100:101], v[100:101], v[208:209]
v_accvgpr_read_b32 v104, a8
s_waitcnt lgkmcnt(15)
v_mfma_f32_16x16x32_bf16 v[0:3], v[192:195], a[192:195], v[0:3]
v_accvgpr_read_b32 v144, a48
v_accvgpr_read_b32 v145, a49
v_mfma_f32_16x16x32_bf16 v[4:7], v[192:195], a[196:199], v[4:7]
v_accvgpr_read_b32 v146, a50
v_add_u32 v236, s79, v233
ds_read_b64 v[236:237], v236
v_accvgpr_read_b32 v147, a51
v_mfma_f32_16x16x32_bf16 v[8:11], v[192:195], a[200:203], v[8:11]
v_accvgpr_read_b32 v148, a52
v_accvgpr_read_b32 v149, a53
v_mfma_f32_16x16x32_bf16 v[12:15], v[192:195], a[204:207], v[12:15]
v_accvgpr_read_b32 v150, a54
v_accvgpr_read_b32 v151, a55
s_waitcnt lgkmcnt(9)
v_mfma_f32_16x16x32_bf16 v[16:19], v[192:195], a[208:211], v[16:19]
v_accvgpr_read_b32 v152, a56
v_accvgpr_read_b32 v153, a57
v_mfma_f32_16x16x32_bf16 v[20:23], v[192:195], a[212:215], v[20:23]
v_accvgpr_read_b32 v154, a58
v_accvgpr_read_b32 v155, a59
v_mfma_f32_16x16x32_bf16 v[24:27], v[192:195], a[216:219], v[24:27]
v_accvgpr_read_b32 v156, a60
v_accvgpr_read_b32 v157, a61
v_mfma_f32_16x16x32_bf16 v[28:31], v[192:195], a[220:223], v[28:31]
v_accvgpr_read_b32 v158, a62
v_accvgpr_read_b32 v159, a63
s_waitcnt lgkmcnt(1)
v_mfma_f32_16x16x32_bf16 v[32:35], v[192:195], a[224:227], v[32:35]
v_accvgpr_read_b32 v160, a64
v_accvgpr_read_b32 v161, a65
v_mfma_f32_16x16x32_bf16 v[36:39], v[192:195], a[228:231], v[36:39]
v_accvgpr_read_b32 v162, a66
v_accvgpr_read_b32 v163, a67
v_mfma_f32_16x16x32_bf16 v[40:43], v[192:195], a[232:235], v[40:43]
s_add_u32 m0, s44, s42
v_accvgpr_read_b32 v164, a68
buffer_load_dwordx4 v234, s[4:7], s43 offen offset:256  lds
buffer_load_dwordx4 v235, s[4:7], s43 offen offset:3328  lds
v_accvgpr_read_b32 v165, a69
v_mfma_f32_16x16x32_bf16 v[44:47], v[192:195], a[236:239], v[44:47]
v_accvgpr_read_b32 v166, a70
v_accvgpr_read_b32 v167, a71
v_pk_mul_f32 v[144:145], v[144:145], v[212:213]
v_pk_mul_f32 v[146:147], v[146:147], v[214:215]
v_pk_mul_f32 v[148:149], v[148:149], v[212:213]
v_pk_mul_f32 v[150:151], v[150:151], v[214:215]
v_pk_mul_f32 v[152:153], v[152:153], v[212:213]
v_pk_mul_f32 v[154:155], v[154:155], v[214:215]
v_pk_mul_f32 v[156:157], v[156:157], v[212:213]
v_pk_mul_f32 v[158:159], v[158:159], v[214:215]
v_pk_mul_f32 v[160:161], v[160:161], v[212:213]
v_pk_mul_f32 v[162:163], v[162:163], v[214:215]
v_pk_mul_f32 v[164:165], v[164:165], v[212:213]
v_pk_mul_f32 v[166:167], v[166:167], v[214:215]
v_accvgpr_read_b32 v105, a9
v_pk_mul_f32 v[102:103], v[102:103], v[210:211]
v_accvgpr_read_b32 v106, a10
v_accvgpr_read_b32 v107, a11
v_pk_mul_f32 v[104:105], v[104:105], v[208:209]
v_accvgpr_read_b32 v108, a12
v_accvgpr_read_b32 v109, a13
v_readlane_b32 s47, v238, s34
v_pk_mul_f32 v[106:107], v[106:107], v[210:211]
v_accvgpr_read_b32 v110, a14
v_accvgpr_read_b32 v111, a15
v_pk_mul_f32 v[108:109], v[108:109], v[208:209]
v_accvgpr_read_b32 v112, a16
v_accvgpr_read_b32 v113, a17
v_pk_mul_f32 v[110:111], v[110:111], v[210:211]
v_accvgpr_read_b32 v114, a18
v_accvgpr_read_b32 v115, a19
v_pk_mul_f32 v[112:113], v[112:113], v[208:209]
v_accvgpr_read_b32 v116, a20
v_accvgpr_read_b32 v117, a21
v_pk_mul_f32 v[114:115], v[114:115], v[210:211]
v_accvgpr_read_b32 v118, a22
v_accvgpr_read_b32 v119, a23
v_pk_mul_f32 v[116:117], v[116:117], v[208:209]
v_accvgpr_read_b32 v120, a24
v_accvgpr_read_b32 v121, a25
v_pk_mul_f32 v[118:119], v[118:119], v[210:211]
v_accvgpr_read_b32 v122, a26
v_accvgpr_read_b32 v123, a27
v_pk_mul_f32 v[120:121], v[120:121], v[208:209]
v_accvgpr_read_b32 v124, a28
v_accvgpr_read_b32 v125, a29
v_pk_mul_f32 v[122:123], v[122:123], v[210:211]
v_accvgpr_read_b32 v126, a30
v_accvgpr_read_b32 v127, a31
v_pk_mul_f32 v[124:125], v[124:125], v[208:209]
v_accvgpr_read_b32 v128, a32
v_accvgpr_read_b32 v129, a33
s_waitcnt vmcnt(12) lgkmcnt(0)
s_barrier
v_add_u32 v236, v232, v236
v_xor_b32 v237, v232, v237
v_pk_mul_f32 v[126:127], v[126:127], v[210:211]
v_accvgpr_read_b32 v130, a34
s_add_u32 m0, s46, s40
v_accvgpr_read_b32 v131, a35
buffer_load_dwordx4 v236, s[8:11], s45 offen offset:0  lds
buffer_load_dwordx4 v237, s[8:11], s45 offen offset:3072  lds
s_cmp_lg_u32 s36, 3
s_cbranch_scc1 L_qh5
v_add_u32 v243, 147456, v255
ds_read_b128 a[96:99], v243 offset:0
ds_read_b128 a[100:103], v243 offset:1024
ds_read_b128 a[104:107], v243 offset:2048
ds_read_b128 a[108:111], v243 offset:3072
ds_read_b128 a[112:115], v243 offset:4096
ds_read_b128 a[116:119], v243 offset:5120
ds_read_b128 a[120:123], v243 offset:6144
ds_read_b128 a[124:127], v243 offset:7168
ds_read_b128 a[128:131], v243 offset:8192
ds_read_b128 a[132:135], v243 offset:9216
ds_read_b128 a[136:139], v243 offset:10240
ds_read_b128 a[140:143], v243 offset:11264
s_waitcnt lgkmcnt(0)
L_qh5:
s_and_b32 s49, s47, s70
s_and_b32 s44, s47, s71
s_lshr_b32 s43, s47, 8
s_and_b32 s43, s43, s71
s_bitcmp1_b32 s47, 28
s_cselect_b64 s[50:51], s[30:31], s[28:29]
s_bitcmp1_b32 s47, 29
s_cselect_b64 s[4:5], s[50:51], s[24:25]
s_add_u32 s34, s34, 1
s_add_u32 m0, s46, s41
s_nop 0
buffer_load_dwordx4 v236, s[8:11], s45 offen offset:128  lds
buffer_load_dwordx4 v237, s[8:11], s45 offen offset:3200  lds
v_add_u32 v234, s49, v233
ds_read_b64 v[234:235], v234
v_pk_mul_f32 v[128:129], v[128:129], v[208:209]
v_accvgpr_read_b32 v132, a36
v_accvgpr_read_b32 v133, a37
v_pk_mul_f32 v[130:131], v[130:131], v[210:211]
v_accvgpr_read_b32 v134, a38
v_accvgpr_read_b32 v135, a39
v_pk_mul_f32 v[132:133], v[132:133], v[208:209]
v_accvgpr_read_b32 v136, a40
v_accvgpr_read_b32 v137, a41
v_pk_mul_f32 v[134:135], v[134:135], v[210:211]
v_accvgpr_read_b32 v138, a42
v_accvgpr_read_b32 v139, a43
v_pk_mul_f32 v[136:137], v[136:137], v[208:209]
s_add_u32 m0, s46, s42
v_accvgpr_read_b32 v140, a44
buffer_load_dwordx4 v236, s[8:11], s45 offen offset:256  lds
buffer_load_dwordx4 v237, s[8:11], s45 offen offset:3328  lds
v_accvgpr_read_b32 v141, a45
v_pk_mul_f32 v[138:139], v[138:139], v[210:211]
v_accvgpr_read_b32 v142, a46
v_accvgpr_read_b32 v143, a47
v_pk_mul_f32 v[140:141], v[140:141], v[208:209]
v_pk_mul_f32 v[142:143], v[142:143], v[210:211]
ds_read_b64_tr_b16 a[240:241], v249 offset:12288
ds_read_b64_tr_b16 a[242:243], v249 offset:18432
ds_read_b64_tr_b16 a[244:245], v250 offset:12288
ds_read_b64_tr_b16 a[246:247], v250 offset:18432
ds_read_b64_tr_b16 a[248:249], v251 offset:12288
ds_read_b64_tr_b16 a[250:251], v251 offset:18432
ds_read_b64_tr_b16 a[252:253], v252 offset:12288
ds_read_b64_tr_b16 a[254:255], v252 offset:18432
ds_read_b64_tr_b16 a[192:193], v249 offset:13312
ds_read_b64_tr_b16 a[194:195], v249 offset:19456
ds_read_b64_tr_b16 a[196:197], v250 offset:13312
ds_read_b64_tr_b16 a[198:199], v250 offset:19456
ds_read_b64_tr_b16 a[200:201], v251 offset:13312
ds_read_b64_tr_b16 a[202:203], v251 offset:19456
ds_read_b64_tr_b16 a[204:205], v252 offset:13312
ds_read_b64_tr_b16 a[206:207], v252 offset:19456
ds_read_b64_tr_b16 a[208:209], v249 offset:14336
ds_read_b64_tr_b16 a[210:211], v249 offset:20480
ds_read_b64_tr_b16 a[212:213], v250 offset:14336
ds_read_b64_tr_b16 a[214:215], v250 offset:20480
ds_read_b64_tr_b16 a[216:217], v251 offset:14336
ds_read_b64_tr_b16 a[218:219], v251 offset:20480
ds_read_b64_tr_b16 a[220:221], v252 offset:14336
ds_read_b64_tr_b16 a[222:223], v252 offset:20480
s_add_u32 s32, s85, 0
v_cvt_pk_bf16_f32 v0, v0, v4
v_cvt_pk_bf16_f32 v4, v1, v5
v_cvt_pk_bf16_f32 v1, v8, v12
v_cvt_pk_bf16_f32 v5, v9, v13
v_cvt_pk_bf16_f32 v2, v2, v6
s_waitcnt vmcnt(12) lgkmcnt(15)
s_barrier
v_add_u32 v234, v232, v234
v_xor_b32 v235, v232, v235
v_cvt_pk_bf16_f32 v6, v3, v7
v_cvt_pk_bf16_f32 v3, v10, v14
s_add_u32 m0, s44, s40
v_cvt_pk_bf16_f32 v7, v11, v15
buffer_load_dwordx4 v234, s[4:7], s43 offen offset:0  lds
buffer_load_dwordx4 v235, s[4:7], s43 offen offset:3072  lds
v_mfma_f32_16x16x32_bf16 v[48:51], v[196:199], a[240:243], v[48:51]
v_cvt_pk_bf16_f32 v16, v16, v20
v_cvt_pk_bf16_f32 v20, v17, v21
v_mfma_f32_16x16x32_bf16 v[52:55], v[196:199], a[244:247], v[52:55]
v_cvt_pk_bf16_f32 v17, v24, v28
v_cvt_pk_bf16_f32 v21, v25, v29
v_mfma_f32_16x16x32_bf16 v[56:59], v[196:199], a[248:251], v[56:59]
v_cvt_pk_bf16_f32 v18, v18, v22
v_cvt_pk_bf16_f32 v22, v19, v23
v_mfma_f32_16x16x32_bf16 v[60:63], v[196:199], a[252:255], v[60:63]
v_cvt_pk_bf16_f32 v19, v26, v30
v_cvt_pk_bf16_f32 v23, v27, v31
s_waitcnt lgkmcnt(8)
v_mfma_f32_16x16x32_bf16 v[64:67], v[196:199], a[192:195], v[64:67]
v_cvt_pk_bf16_f32 v32, v32, v36
v_cvt_pk_bf16_f32 v36, v33, v37
v_mfma_f32_16x16x32_bf16 v[68:71], v[196:199], a[196:199], v[68:71]
v_cvt_pk_bf16_f32 v33, v40, v44
v_readlane_b32 s48, v239, s34
v_cvt_pk_bf16_f32 v37, v41, v45
v_mfma_f32_16x16x32_bf16 v[72:75], v[196:199], a[200:203], v[72:75]
v_cvt_pk_bf16_f32 v34, v34, v38
v_cvt_pk_bf16_f32 v38, v35, v39
v_mfma_f32_16x16x32_bf16 v[76:79], v[196:199], a[204:207], v[76:79]
v_cvt_pk_bf16_f32 v35, v42, v46
v_cvt_pk_bf16_f32 v39, v43, v47
s_waitcnt lgkmcnt(0)
v_mfma_f32_16x16x32_bf16 v[80:83], v[196:199], a[208:211], v[80:83]
v_mfma_f32_16x16x32_bf16 v[84:87], v[196:199], a[212:215], v[84:87]
v_mfma_f32_16x16x32_bf16 v[88:91], v[196:199], a[216:219], v[88:91]
v_mfma_f32_16x16x32_bf16 v[92:95], v[196:199], a[220:223], v[92:95]
ds_write_b64 v253, v[0:1] offset:12288
s_and_b32 s79, s48, s70
s_and_b32 s46, s48, s71
s_lshr_b32 s45, s48, 8
s_and_b32 s45, s45, s71
s_bitcmp1_b32 s48, 28
s_cselect_b64 s[50:51], s[30:31], s[28:29]
s_bitcmp1_b32 s48, 29
s_cselect_b64 s[8:9], s[50:51], s[26:27]
s_add_u32 m0, s44, s41
s_nop 0
buffer_load_dwordx4 v234, s[4:7], s43 offen offset:128  lds
buffer_load_dwordx4 v235, s[4:7], s43 offen offset:3200  lds
ds_write_b64 v253, v[4:5] offset:12704
ds_write_b64 v253, v[2:3] offset:13120
ds_write_b64 v253, v[6:7] offset:13536
ds_write_b64 v253, v[16:17] offset:12416
v_add_u32 v236, s79, v233
ds_read_b64 v[236:237], v236
ds_write_b64 v253, v[20:21] offset:12832
ds_write_b64 v253, v[18:19] offset:13248
ds_write_b64 v253, v[22:23] offset:13664
ds_write_b64 v253, v[32:33] offset:12544
s_add_u32 m0, s44, s42
ds_write_b64 v253, v[36:37] offset:12960
buffer_load_dwordx4 v234, s[4:7], s43 offen offset:256  lds
buffer_load_dwordx4 v235, s[4:7], s43 offen offset:3328  lds
ds_write_b64 v253, v[34:35] offset:13376
ds_write_b64 v253, v[38:39] offset:13792
ds_read_b64_tr_b16 v[0:1], v254 offset:12288
ds_read_b64_tr_b16 v[2:3], v254 offset:12320
ds_read_b64_tr_b16 v[8:9], v254 offset:15616
ds_read_b64_tr_b16 v[10:11], v254 offset:15648
ds_read_b64_tr_b16 v[16:17], v254 offset:12416
ds_read_b64_tr_b16 v[18:19], v254 offset:12448
ds_read_b64_tr_b16 v[24:25], v254 offset:15744
ds_read_b64_tr_b16 v[26:27], v254 offset:15776
ds_read_b64_tr_b16 v[32:33], v254 offset:12544
ds_read_b64_tr_b16 v[34:35], v254 offset:12576
ds_read_b64_tr_b16 v[40:41], v254 offset:15872
ds_read_b64_tr_b16 v[42:43], v254 offset:15904
ds_read_b64_tr_b16 a[224:225], v249 offset:24576
ds_read_b64_tr_b16 a[226:227], v249 offset:30720
ds_read_b64_tr_b16 a[228:229], v250 offset:24576
ds_read_b64_tr_b16 a[230:231], v250 offset:30720
ds_read_b64_tr_b16 a[232:233], v251 offset:24576
ds_read_b64_tr_b16 a[234:235], v251 offset:30720
ds_read_b64_tr_b16 a[236:237], v252 offset:24576
ds_read_b64_tr_b16 a[238:239], v252 offset:30720
ds_read_b64_tr_b16 a[240:241], v249 offset:25600
ds_read_b64_tr_b16 a[242:243], v249 offset:31744
ds_read_b64_tr_b16 a[244:245], v250 offset:25600
ds_read_b64_tr_b16 a[246:247], v250 offset:31744
ds_read_b64_tr_b16 a[248:249], v251 offset:25600
ds_read_b64_tr_b16 a[250:251], v251 offset:31744
ds_read_b64_tr_b16 a[252:253], v252 offset:25600
ds_read_b64_tr_b16 a[254:255], v252 offset:31744
ds_read_b64_tr_b16 a[192:193], v249 offset:26624
ds_read_b64_tr_b16 a[194:195], v249 offset:32768
ds_read_b64_tr_b16 a[196:197], v250 offset:26624
ds_read_b64_tr_b16 a[198:199], v250 offset:32768
ds_read_b64_tr_b16 a[200:201], v251 offset:26624
ds_read_b64_tr_b16 a[202:203], v251 offset:32768
ds_read_b64_tr_b16 a[204:205], v252 offset:26624
ds_read_b64_tr_b16 a[206:207], v252 offset:32768
v_readlane_b32 s47, v238, s34
s_waitcnt vmcnt(12) lgkmcnt(15)
s_barrier
v_add_u32 v236, v232, v236
v_xor_b32 v237, v232, v237
s_add_u32 s33, s85, 6144
v_cvt_pk_bf16_f32 v48, v48, v52
s_add_u32 m0, s46, s40
v_cvt_pk_bf16_f32 v52, v49, v53
buffer_load_dwordx4 v236, s[8:11], s45 offen offset:0  lds
buffer_load_dwordx4 v237, s[8:11], s45 offen offset:3072  lds
v_cvt_pk_bf16_f32 v49, v56, v60
v_cvt_pk_bf16_f32 v53, v57, v61
v_cvt_pk_bf16_f32 v50, v50, v54
v_cvt_pk_bf16_f32 v54, v51, v55
buffer_store_dwordx4 v[0:3], v248, s[16:19], s32 offen offset:0
s_and_b32 s49, s47, s70
s_and_b32 s44, s47, s71
s_lshr_b32 s43, s47, 8
s_and_b32 s43, s43, s71
s_bitcmp1_b32 s47, 28
s_cselect_b64 s[50:51], s[30:31], s[28:29]
s_bitcmp1_b32 s47, 29
s_cselect_b64 s[4:5], s[50:51], s[24:25]
s_add_u32 s34, s34, 1
v_cvt_pk_bf16_f32 v51, v58, v62
v_cvt_pk_bf16_f32 v55, v59, v63
v_cvt_pk_bf16_f32 v64, v64, v68
v_cvt_pk_bf16_f32 v68, v65, v69
s_add_u32 m0, s46, s41
buffer_store_dwordx4 v[8:11], v248, s[16:19], s32 offen offset:3072
buffer_load_dwordx4 v236, s[8:11], s45 offen offset:128  lds
buffer_load_dwordx4 v237, s[8:11], s45 offen offset:3200  lds
v_cvt_pk_bf16_f32 v65, v72, v76
v_cvt_pk_bf16_f32 v69, v73, v77
v_cvt_pk_bf16_f32 v66, v66, v70
v_cvt_pk_bf16_f32 v70, v67, v71
buffer_store_dwordx4 v[16:19], v248, s[16:19], s32 offen offset:128
v_add_u32 v234, s49, v233
ds_read_b64 v[234:235], v234
v_cvt_pk_bf16_f32 v67, v74, v78
v_cvt_pk_bf16_f32 v71, v75, v79
v_cvt_pk_bf16_f32 v80, v80, v84
v_cvt_pk_bf16_f32 v84, v81, v85
buffer_store_dwordx4 v[24:27], v248, s[16:19], s32 offen offset:3200
v_cvt_pk_bf16_f32 v81, v88, v92
v_cvt_pk_bf16_f32 v85, v89, v93
v_cvt_pk_bf16_f32 v82, v82, v86
s_add_u32 m0, s46, s42
buffer_store_dwordx4 v[32:35], v248, s[16:19], s32 offen offset:256
buffer_load_dwordx4 v236, s[8:11], s45 offen offset:256  lds
buffer_load_dwordx4 v237, s[8:11], s45 offen offset:3328  lds
v_cvt_pk_bf16_f32 v86, v83, v87
v_cvt_pk_bf16_f32 v83, v90, v94
v_cvt_pk_bf16_f32 v87, v91, v95
buffer_store_dwordx4 v[40:43], v248, s[16:19], s32 offen offset:3328
v_mfma_f32_16x16x32_bf16 v[144:147], v[204:207], a[224:227], v[144:147]
ds_write_b64 v253, v[48:49] offset:24576
v_mfma_f32_16x16x32_bf16 v[148:151], v[204:207], a[228:231], v[148:151]
ds_write_b64 v253, v[52:53] offset:24992
v_mfma_f32_16x16x32_bf16 v[152:155], v[204:207], a[232:235], v[152:155]
ds_write_b64 v253, v[50:51] offset:25408
v_mfma_f32_16x16x32_bf16 v[156:159], v[204:207], a[236:239], v[156:159]
ds_write_b64 v253, v[54:55] offset:25824
s_waitcnt vmcnt(18) lgkmcnt(4)
s_barrier
v_add_u32 v234, v232, v234
v_xor_b32 v235, v232, v235
v_mfma_f32_16x16x32_bf16 v[160:163], v[204:207], a[240:243], v[160:163]
s_add_u32 m0, s44, s40
ds_write_b64 v253, v[64:65] offset:24704
buffer_load_dwordx4 v234, s[4:7], s43 offen offset:0  lds
buffer_load_dwordx4 v235, s[4:7], s43 offen offset:3072  lds
v_mfma_f32_16x16x32_bf16 v[164:167], v[204:207], a[244:247], v[164:167]
ds_write_b64 v253, v[68:69] offset:25120
v_mfma_f32_16x16x32_bf16 v[168:171], v[204:207], a[248:251], v[168:171]
ds_write_b64 v253, v[66:67] offset:25536
v_mfma_f32_16x16x32_bf16 v[172:175], v[204:207], a[252:255], v[172:175]
ds_write_b64 v253, v[70:71] offset:25952
v_readlane_b32 s48, v239, s34
v_mfma_f32_16x16x32_bf16 v[176:179], v[204:207], a[192:195], v[176:179]
ds_write_b64 v253, v[80:81] offset:24832
s_and_b32 s79, s48, s70
s_and_b32 s46, s48, s71
s_lshr_b32 s45, s48, 8
s_and_b32 s45, s45, s71
s_bitcmp1_b32 s48, 28
s_cselect_b64 s[50:51], s[30:31], s[28:29]
s_bitcmp1_b32 s48, 29
s_cselect_b64 s[8:9], s[50:51], s[26:27]
v_mfma_f32_16x16x32_bf16 v[180:183], v[204:207], a[196:199], v[180:183]
ds_write_b64 v253, v[84:85] offset:25248
v_mfma_f32_16x16x32_bf16 v[184:187], v[204:207], a[200:203], v[184:187]
s_add_u32 m0, s44, s41
ds_write_b64 v253, v[82:83] offset:25664
buffer_load_dwordx4 v234, s[4:7], s43 offen offset:128  lds
buffer_load_dwordx4 v235, s[4:7], s43 offen offset:3200  lds
v_mfma_f32_16x16x32_bf16 v[188:191], v[204:207], a[204:207], v[188:191]
ds_write_b64 v253, v[86:87] offset:26080
ds_read_b64_tr_b16 v[48:49], v254 offset:24576
ds_read_b64_tr_b16 v[50:51], v254 offset:24608
ds_read_b64_tr_b16 v[56:57], v254 offset:27904
ds_read_b64_tr_b16 v[58:59], v254 offset:27936
ds_read_b64_tr_b16 v[64:65], v254 offset:24704
ds_read_b64_tr_b16 v[66:67], v254 offset:24736
ds_read_b64_tr_b16 v[72:73], v254 offset:28032
ds_read_b64_tr_b16 v[74:75], v254 offset:28064
ds_read_b64_tr_b16 v[80:81], v254 offset:24832
ds_read_b64_tr_b16 v[82:83], v254 offset:24864
ds_read_b64_tr_b16 v[88:89], v254 offset:28160
ds_read_b64_tr_b16 v[90:91], v254 offset:28192
v_add_u32 v236, s79, v233
ds_read_b64 v[236:237], v236
s_add_u32 s32, s85, 18432
v_cvt_pk_bf16_f32 v144, v144, v148
v_cvt_pk_bf16_f32 v148, v145, v149
v_cvt_pk_bf16_f32 v145, v152, v156
v_cvt_pk_bf16_f32 v149, v153, v157
v_cvt_pk_bf16_f32 v146, v146, v150
v_cvt_pk_bf16_f32 v150, v147, v151
s_waitcnt lgkmcnt(1)
buffer_store_dwordx4 v[48:51], v248, s[16:19], s33 offen offset:0
v_cvt_pk_bf16_f32 v147, v154, v158
v_cvt_pk_bf16_f32 v151, v155, v159
v_cvt_pk_bf16_f32 v160, v160, v164
v_cvt_pk_bf16_f32 v164, v161, v165
buffer_store_dwordx4 v[56:59], v248, s[16:19], s33 offen offset:3072
v_cvt_pk_bf16_f32 v161, v168, v172
v_cvt_pk_bf16_f32 v165, v169, v173
v_cvt_pk_bf16_f32 v162, v162, v166
v_cvt_pk_bf16_f32 v166, v163, v167
s_add_u32 m0, s44, s42
buffer_store_dwordx4 v[64:67], v248, s[16:19], s33 offen offset:128
buffer_load_dwordx4 v234, s[4:7], s43 offen offset:256  lds
buffer_load_dwordx4 v235, s[4:7], s43 offen offset:3328  lds
v_cvt_pk_bf16_f32 v163, v170, v174
v_cvt_pk_bf16_f32 v167, v171, v175
v_cvt_pk_bf16_f32 v176, v176, v180
v_cvt_pk_bf16_f32 v180, v177, v181
buffer_store_dwordx4 v[72:75], v248, s[16:19], s33 offen offset:3200
v_cvt_pk_bf16_f32 v177, v184, v188
v_cvt_pk_bf16_f32 v181, v185, v189
v_cvt_pk_bf16_f32 v178, v178, v182
buffer_store_dwordx4 v[80:83], v248, s[16:19], s33 offen offset:256
v_cvt_pk_bf16_f32 v182, v179, v183
v_cvt_pk_bf16_f32 v179, v186, v190
v_cvt_pk_bf16_f32 v183, v187, v191
buffer_store_dwordx4 v[88:91], v248, s[16:19], s33 offen offset:3328
v_readlane_b32 s47, v238, s34
ds_write_b64 v253, v[144:145] offset:24576
ds_write_b64 v253, v[148:149] offset:24992
ds_write_b64 v253, v[146:147] offset:25408
ds_write_b64 v253, v[150:151] offset:25824
s_waitcnt vmcnt(24) lgkmcnt(4)
s_barrier
v_add_u32 v236, v232, v236
v_xor_b32 v237, v232, v237
s_add_u32 m0, s46, s40
ds_write_b64 v253, v[160:161] offset:24704
buffer_load_dwordx4 v236, s[8:11], s45 offen offset:0  lds
buffer_load_dwordx4 v237, s[8:11], s45 offen offset:3072  lds
s_cmp_lg_u32 s36, 2
s_cbranch_scc1 L_qh6
v_add_u32 v243, 61440, v255
ds_read_b128 a[96:99], v243 offset:0
ds_read_b128 a[100:103], v243 offset:1024
ds_read_b128 a[104:107], v243 offset:2048
ds_read_b128 a[108:111], v243 offset:3072
ds_read_b128 a[112:115], v243 offset:4096
ds_read_b128 a[116:119], v243 offset:5120
ds_read_b128 a[120:123], v243 offset:6144
ds_read_b128 a[124:127], v243 offset:7168
ds_read_b128 a[128:131], v243 offset:8192
ds_read_b128 a[132:135], v243 offset:9216
ds_read_b128 a[136:139], v243 offset:10240
ds_read_b128 a[140:143], v243 offset:11264
s_waitcnt lgkmcnt(0)
L_qh6:
s_cmp_lg_u32 s36, 3
s_cbranch_scc1 L_qh7
v_add_u32 v243, 98304, v255
ds_read_b128 a[144:147], v243 offset:0
ds_read_b128 a[148:151], v243 offset:1024
ds_read_b128 a[152:155], v243 offset:2048
ds_read_b128 a[156:159], v243 offset:3072
ds_read_b128 a[160:163], v243 offset:4096
ds_read_b128 a[164:167], v243 offset:5120
ds_read_b128 a[168:171], v243 offset:6144
ds_read_b128 a[172:175], v243 offset:7168
ds_read_b128 a[176:179], v243 offset:8192
ds_read_b128 a[180:183], v243 offset:9216
ds_read_b128 a[184:187], v243 offset:10240
ds_read_b128 a[188:191], v243 offset:11264
s_waitcnt lgkmcnt(0)
L_qh7:
s_and_b32 s49, s47, s70
s_and_b32 s44, s47, s71
s_lshr_b32 s43, s47, 8
s_and_b32 s43, s43, s71
s_bitcmp1_b32 s47, 28
s_cselect_b64 s[50:51], s[30:31], s[28:29]
s_bitcmp1_b32 s47, 29
s_cselect_b64 s[4:5], s[50:51], s[24:25]
s_add_u32 s34, s34, 1
s_add_u32 m0, s46, s41
s_nop 0
buffer_load_dwordx4 v236, s[8:11], s45 offen offset:128  lds
buffer_load_dwordx4 v237, s[8:11], s45 offen offset:3200  lds
v_add_u32 v234, s49, v233
ds_read_b64 v[234:235], v234
ds_write_b64 v253, v[164:165] offset:25120
s_add_u32 m0, s46, s42
ds_write_b64 v253, v[162:163] offset:25536
buffer_load_dwordx4 v236, s[8:11], s45 offen offset:256  lds
buffer_load_dwordx4 v237, s[8:11], s45 offen offset:3328  lds
ds_write_b64 v253, v[166:167] offset:25952
ds_write_b64 v253, v[176:177] offset:24832
ds_write_b64 v253, v[180:181] offset:25248
ds_write_b64 v253, v[178:179] offset:25664
ds_write_b64 v253, v[182:183] offset:26080
ds_read_b64_tr_b16 v[144:145], v254 offset:24576
ds_read_b64_tr_b16 v[146:147], v254 offset:24608
ds_read_b64_tr_b16 v[152:153], v254 offset:27904
ds_read_b64_tr_b16 v[154:155], v254 offset:27936
ds_read_b64_tr_b16 v[160:161], v254 offset:24704
ds_read_b64_tr_b16 v[162:163], v254 offset:24736
ds_read_b64_tr_b16 v[168:169], v254 offset:28032
ds_read_b64_tr_b16 v[170:171], v254 offset:28064
ds_read_b64_tr_b16 v[176:177], v254 offset:24832
ds_read_b64_tr_b16 v[178:179], v254 offset:24864
ds_read_b64_tr_b16 v[184:185], v254 offset:28160
ds_read_b64_tr_b16 v[186:187], v254 offset:28192
ds_read_b64_tr_b16 a[208:209], v249 offset:36864
ds_read_b64_tr_b16 a[210:211], v249 offset:43008
ds_read_b64_tr_b16 a[212:213], v250 offset:36864
ds_read_b64_tr_b16 a[214:215], v250 offset:43008
ds_read_b64_tr_b16 a[216:217], v251 offset:36864
ds_read_b64_tr_b16 a[218:219], v251 offset:43008
ds_read_b64_tr_b16 a[220:221], v252 offset:36864
ds_read_b64_tr_b16 a[222:223], v252 offset:43008
ds_read_b64_tr_b16 a[224:225], v249 offset:37888
ds_read_b64_tr_b16 a[226:227], v249 offset:44032
ds_read_b64_tr_b16 a[228:229], v250 offset:37888
ds_read_b64_tr_b16 a[230:231], v250 offset:44032
ds_read_b64_tr_b16 a[232:233], v251 offset:37888
ds_read_b64_tr_b16 a[234:235], v251 offset:44032
ds_read_b64_tr_b16 a[236:237], v252 offset:37888
ds_read_b64_tr_b16 a[238:239], v252 offset:44032
ds_read_b64_tr_b16 a[240:241], v249 offset:38912
ds_read_b64_tr_b16 a[242:243], v249 offset:45056
ds_read_b64_tr_b16 a[244:245], v250 offset:38912
ds_read_b64_tr_b16 a[246:247], v250 offset:45056
ds_read_b64_tr_b16 a[248:249], v251 offset:38912
ds_read_b64_tr_b16 a[250:251], v251 offset:45056
ds_read_b64_tr_b16 a[252:253], v252 offset:38912
ds_read_b64_tr_b16 a[254:255], v252 offset:45056
s_waitcnt vmcnt(19) lgkmcnt(15)
s_barrier
v_add_u32 v234, v232, v234
s_add_u32 m0, s44, s40
v_xor_b32 v235, v232, v235
buffer_load_dwordx4 v234, s[4:7], s43 offen offset:0  lds
buffer_load_dwordx4 v235, s[4:7], s43 offen offset:3072  lds
v_readlane_b32 s48, v239, s34
buffer_store_dwordx4 v[144:147], v248, s[16:19], s32 offen offset:0
v_mfma_f32_16x16x32_bf16 v[96:99], v[200:203], a[208:211], v[96:99]
v_mfma_f32_16x16x32_bf16 v[100:103], v[200:203], a[212:215], v[100:103]
buffer_store_dwordx4 v[152:155], v248, s[16:19], s32 offen offset:3072
s_and_b32 s79, s48, s70
s_and_b32 s46, s48, s71
s_lshr_b32 s45, s48, 8
s_and_b32 s45, s45, s71
s_bitcmp1_b32 s48, 28
s_cselect_b64 s[50:51], s[30:31], s[28:29]
s_bitcmp1_b32 s48, 29
s_cselect_b64 s[8:9], s[50:51], s[26:27]
v_mfma_f32_16x16x32_bf16 v[104:107], v[200:203], a[216:219], v[104:107]
v_mfma_f32_16x16x32_bf16 v[108:111], v[200:203], a[220:223], v[108:111]
s_add_u32 m0, s44, s41
buffer_store_dwordx4 v[160:163], v248, s[16:19], s32 offen offset:128
buffer_load_dwordx4 v234, s[4:7], s43 offen offset:128  lds
buffer_load_dwordx4 v235, s[4:7], s43 offen offset:3200  lds
s_waitcnt lgkmcnt(8)
v_mfma_f32_16x16x32_bf16 v[112:115], v[200:203], a[224:227], v[112:115]
v_mfma_f32_16x16x32_bf16 v[116:119], v[200:203], a[228:231], v[116:119]
buffer_store_dwordx4 v[168:171], v248, s[16:19], s32 offen offset:3200
v_mfma_f32_16x16x32_bf16 v[120:123], v[200:203], a[232:235], v[120:123]
v_mfma_f32_16x16x32_bf16 v[124:127], v[200:203], a[236:239], v[124:127]
buffer_store_dwordx4 v[176:179], v248, s[16:19], s32 offen offset:256
v_add_u32 v236, s79, v233
ds_read_b64 v[236:237], v236
s_waitcnt lgkmcnt(1)
v_mfma_f32_16x16x32_bf16 v[128:131], v[200:203], a[240:243], v[128:131]
v_mfma_f32_16x16x32_bf16 v[132:135], v[200:203], a[244:247], v[132:135]
buffer_store_dwordx4 v[184:187], v248, s[16:19], s32 offen offset:3328
v_mfma_f32_16x16x32_bf16 v[136:139], v[200:203], a[248:251], v[136:139]
v_mfma_f32_16x16x32_bf16 v[140:143], v[200:203], a[252:255], v[140:143]
s_add_u32 s33, s85, 12288
v_cvt_pk_bf16_f32 v96, v96, v100
v_cvt_pk_bf16_f32 v100, v97, v101
v_cvt_pk_bf16_f32 v97, v104, v108
v_cvt_pk_bf16_f32 v101, v105, v109
v_cvt_pk_bf16_f32 v98, v98, v102
v_cvt_pk_bf16_f32 v102, v99, v103
v_cvt_pk_bf16_f32 v99, v106, v110
v_cvt_pk_bf16_f32 v103, v107, v111
v_cvt_pk_bf16_f32 v112, v112, v116
v_cvt_pk_bf16_f32 v116, v113, v117
v_cvt_pk_bf16_f32 v113, v120, v124
v_cvt_pk_bf16_f32 v117, v121, v125
s_add_u32 m0, s44, s42
v_cvt_pk_bf16_f32 v114, v114, v118
buffer_load_dwordx4 v234, s[4:7], s43 offen offset:256  lds
buffer_load_dwordx4 v235, s[4:7], s43 offen offset:3328  lds
v_cvt_pk_bf16_f32 v118, v115, v119
v_cvt_pk_bf16_f32 v115, v122, v126
v_cvt_pk_bf16_f32 v119, v123, v127
v_cvt_pk_bf16_f32 v128, v128, v132
v_cvt_pk_bf16_f32 v132, v129, v133
v_cvt_pk_bf16_f32 v129, v136, v140
v_cvt_pk_bf16_f32 v133, v137, v141
v_cvt_pk_bf16_f32 v130, v130, v134
v_cvt_pk_bf16_f32 v134, v131, v135
v_cvt_pk_bf16_f32 v131, v138, v142
v_cvt_pk_bf16_f32 v135, v139, v143
ds_write_b64 v253, v[96:97] offset:36864
ds_write_b64 v253, v[100:101] offset:37280
ds_write_b64 v253, v[98:99] offset:37696
v_readlane_b32 s47, v238, s34
ds_write_b64 v253, v[102:103] offset:38112
ds_write_b64 v253, v[112:113] offset:36992
ds_write_b64 v253, v[116:117] offset:37408
ds_write_b64 v253, v[114:115] offset:37824
s_waitcnt vmcnt(21) lgkmcnt(7)
s_barrier
v_add_u32 v236, v232, v236
v_xor_b32 v237, v232, v237
s_add_u32 m0, s46, s40
ds_write_b64 v253, v[118:119] offset:38240
buffer_load_dwordx4 v236, s[8:11], s45 offen offset:0  lds
buffer_load_dwordx4 v237, s[8:11], s45 offen offset:3072  lds
s_cmp_lg_u32 s36, 2
s_cbranch_scc1 L_qh8
v_add_u32 v243, 147456, v255
ds_read_b128 a[144:147], v243 offset:0
ds_read_b128 a[148:151], v243 offset:1024
ds_read_b128 a[152:155], v243 offset:2048
ds_read_b128 a[156:159], v243 offset:3072
ds_read_b128 a[160:163], v243 offset:4096
ds_read_b128 a[164:167], v243 offset:5120
ds_read_b128 a[168:171], v243 offset:6144
ds_read_b128 a[172:175], v243 offset:7168
ds_read_b128 a[176:179], v243 offset:8192
ds_read_b128 a[180:183], v243 offset:9216
ds_read_b128 a[184:187], v243 offset:10240
ds_read_b128 a[188:191], v243 offset:11264
s_waitcnt lgkmcnt(0)
L_qh8:
s_and_b32 s49, s47, s70
s_and_b32 s44, s47, s71
s_lshr_b32 s43, s47, 8
s_and_b32 s43, s43, s71
s_bitcmp1_b32 s47, 28
s_cselect_b64 s[50:51], s[30:31], s[28:29]
s_bitcmp1_b32 s47, 29
s_cselect_b64 s[4:5], s[50:51], s[24:25]
s_add_u32 s34, s34, 1
s_lshl_b32 s86, s36, 8
s_sub_u32 s86, 163712, s86
v_bfe_u32 v249, v255, 4, 4
v_lshl_add_u32 v249, v249, 2, s86
ds_read2_b32 v[192:193], v249 offset0:32 offset1:32
ds_read2_b32 v[194:195], v249 offset0:32 offset1:32
ds_read2_b32 v[196:197], v249 offset0:48 offset1:48
ds_read2_b32 v[198:199], v249 offset0:48 offset1:48
ds_read2_b32 v[200:201], v249 offset0:0 offset1:0
ds_read2_b32 v[202:203], v249 offset0:0 offset1:0
ds_read2_b32 v[204:205], v249 offset0:16 offset1:16
ds_read2_b32 v[206:207], v249 offset0:16 offset1:16
ds_read_b128 a[224:227], v226 offset:0
ds_read_b128 a[228:231], v227 offset:0
ds_read_b128 a[232:235], v226 offset:1024
ds_read_b128 a[236:239], v227 offset:1024
ds_read_b128 a[240:243], v226 offset:2048
ds_read_b128 a[244:247], v227 offset:2048
ds_read_b128 a[248:251], v226 offset:6144
ds_read_b128 a[252:255], v227 offset:6144
ds_read_b128 a[192:195], v226 offset:7168
ds_read_b128 a[196:199], v227 offset:7168
ds_read_b128 a[200:203], v226 offset:8192
ds_read_b128 a[204:207], v227 offset:8192
s_add_u32 m0, s46, s41
s_nop 0
buffer_load_dwordx4 v236, s[8:11], s45 offen offset:128  lds
buffer_load_dwordx4 v237, s[8:11], s45 offen offset:3200  lds
v_add_u32 v234, s49, v233
ds_read_b64 v[234:235], v234
s_add_u32 m0, s46, s42
s_nop 0
buffer_load_dwordx4 v236, s[8:11], s45 offen offset:256  lds
buffer_load_dwordx4 v237, s[8:11], s45 offen offset:3328  lds
ds_write_b64 v253, v[128:129] offset:37120
ds_write_b64 v253, v[132:133] offset:37536
ds_write_b64 v253, v[130:131] offset:37952
s_waitcnt vmcnt(18) lgkmcnt(3)
s_barrier
v_add_u32 v234, v232, v234
v_xor_b32 v235, v232, v235
s_add_u32 m0, s44, s40
ds_write_b64 v253, v[134:135] offset:38368
buffer_load_dwordx4 v234, s[4:7], s43 offen offset:0  lds
buffer_load_dwordx4 v235, s[4:7], s43 offen offset:3072  lds
ds_read_b64_tr_b16 v[96:97], v254 offset:36864
ds_read_b64_tr_b16 v[98:99], v254 offset:36896
ds_read_b64_tr_b16 v[104:105], v254 offset:40192
ds_read_b64_tr_b16 v[106:107], v254 offset:40224
ds_read_b64_tr_b16 v[112:113], v254 offset:36992
ds_read_b64_tr_b16 v[114:115], v254 offset:37024
ds_read_b64_tr_b16 v[120:121], v254 offset:40320
ds_read_b64_tr_b16 v[122:123], v254 offset:40352
ds_read_b64_tr_b16 v[128:129], v254 offset:37120
ds_read_b64_tr_b16 v[130:131], v254 offset:37152
ds_read_b64_tr_b16 v[136:137], v254 offset:40448
ds_read_b64_tr_b16 v[138:139], v254 offset:40480
s_waitcnt lgkmcnt(0)
buffer_store_dwordx4 v[96:99], v248, s[16:19], s33 offen offset:0
v_readlane_b32 s48, v239, s34
buffer_store_dwordx4 v[104:107], v248, s[16:19], s33 offen offset:3072
buffer_store_dwordx4 v[112:115], v248, s[16:19], s33 offen offset:128
s_and_b32 s79, s48, s70
s_and_b32 s46, s48, s71
s_lshr_b32 s45, s48, 8
s_and_b32 s45, s45, s71
s_bitcmp1_b32 s48, 28
s_cselect_b64 s[50:51], s[30:31], s[28:29]
s_bitcmp1_b32 s48, 29
s_cselect_b64 s[8:9], s[50:51], s[26:27]
buffer_store_dwordx4 v[120:123], v248, s[16:19], s33 offen offset:3200
s_add_u32 m0, s44, s41
buffer_store_dwordx4 v[128:131], v248, s[16:19], s33 offen offset:256
buffer_load_dwordx4 v234, s[4:7], s43 offen offset:128  lds
buffer_load_dwordx4 v235, s[4:7], s43 offen offset:3200  lds
buffer_store_dwordx4 v[136:139], v248, s[16:19], s33 offen offset:3328
v_mfma_f32_16x16x32_bf16 v[128:131], a[244:247], a[116:119], v[192:195]
v_mov_b32 v243, 0xff800000
v_mov_b32 v144, 0xff800000
v_mfma_f32_16x16x32_bf16 v[128:131], a[240:243], a[112:115], v[128:131]
v_mov_b32 v145, 0xff800000
v_mov_b32 v146, 0xff800000
v_mfma_f32_16x16x32_bf16 v[128:131], a[236:239], a[108:111], v[128:131]
v_mov_b32 v147, 0xff800000
v_mov_b32 v178, 0
v_mfma_f32_16x16x32_bf16 v[128:131], a[232:235], a[104:107], v[128:131]
v_mov_b32 v179, 0
v_add_u32 v236, s79, v233
ds_read_b64 v[236:237], v236
v_mov_b32 v184, 0
v_mfma_f32_16x16x32_bf16 v[128:131], a[228:231], a[100:103], v[128:131]
v_mov_b32 v185, 0
v_mov_b32 v186, 0
v_mfma_f32_16x16x32_bf16 v[128:131], a[224:227], a[96:99], v[128:131]
v_mov_b32 v187, 0
v_mov_b32 v188, 0
v_mfma_f32_16x16x32_bf16 v[132:135], a[224:227], a[120:123], v[196:199]
v_mov_b32 v189, 0
v_mov_b32 v190, 0
v_mfma_f32_16x16x32_bf16 v[132:135], a[228:231], a[124:127], v[132:135]
v_mov_b32 v191, 0
v_mov_b32 v208, 0
v_mfma_f32_16x16x32_bf16 v[132:135], a[232:235], a[128:131], v[132:135]
v_mov_b32 v209, 0
v_mov_b32 v210, 0
v_mfma_f32_16x16x32_bf16 v[132:135], a[236:239], a[132:135], v[132:135]
v_mov_b32 v211, 0
v_mov_b32 v214, 0
v_mfma_f32_16x16x32_bf16 v[132:135], a[240:243], a[136:139], v[132:135]
v_mov_b32 v215, 0
v_mfma_f32_16x16x32_bf16 v[132:135], a[244:247], a[140:143], v[132:135]
v_cndmask_b32 v128, v128, v243, s[56:57]
v_cndmask_b32 v129, v129, v243, s[58:59]
v_mfma_f32_16x16x32_bf16 v[148:151], a[248:251], a[120:123], v[196:199]
s_add_u32 m0, s44, s42
v_cndmask_b32 v130, v130, v243, s[60:61]
buffer_load_dwordx4 v234, s[4:7], s43 offen offset:256  lds
buffer_load_dwordx4 v235, s[4:7], s43 offen offset:3328  lds
v_cndmask_b32 v131, v131, v243, s[62:63]
v_mfma_f32_16x16x32_bf16 v[148:151], a[252:255], a[124:127], v[148:151]
v_mfma_f32_16x16x32_bf16 v[148:151], a[192:195], a[128:131], v[148:151]
v_mfma_f32_16x16x32_bf16 v[148:151], a[196:199], a[132:135], v[148:151]
v_mfma_f32_16x16x32_bf16 v[148:151], a[200:203], a[136:139], v[148:151]
v_mfma_f32_16x16x32_bf16 v[148:151], a[204:207], a[140:143], v[148:151]
v_readlane_b32 s47, v238, s34
s_waitcnt vmcnt(18) lgkmcnt(0)
s_barrier
v_add_u32 v236, v232, v236
v_xor_b32 v237, v232, v237
ds_read_b128 a[192:195], v226 offset:12288
ds_read_b128 a[196:199], v227 offset:12288
ds_read_b128 a[200:203], v226 offset:13312
ds_read_b128 a[204:207], v227 offset:13312
ds_read_b128 a[208:211], v226 offset:14336
ds_read_b128 a[212:215], v227 offset:14336
ds_read_b128 a[216:219], v226 offset:18432
ds_read_b128 a[220:223], v227 offset:18432
ds_read_b128 a[224:227], v226 offset:19456
ds_read_b128 a[228:231], v227 offset:19456
ds_read_b128 a[232:235], v226 offset:20480
ds_read_b128 a[236:239], v227 offset:20480
s_add_u32 m0, s46, s40
s_nop 0
buffer_load_dwordx4 v236, s[8:11], s45 offen offset:0  lds
buffer_load_dwordx4 v237, s[8:11], s45 offen offset:3072  lds
s_and_b32 s49, s47, s70
s_and_b32 s44, s47, s71
s_lshr_b32 s43, s47, 8
s_and_b32 s43, s43, s71
s_bitcmp1_b32 s47, 28
s_cselect_b64 s[50:51], s[30:31], s[28:29]
s_bitcmp1_b32 s47, 29
s_cselect_b64 s[4:5], s[50:51], s[24:25]
s_add_u32 s34, s34, 1
s_add_u32 m0, s46, s41
s_nop 0
buffer_load_dwordx4 v236, s[8:11], s45 offen offset:128  lds
buffer_load_dwordx4 v237, s[8:11], s45 offen offset:3200  lds
v_cndmask_b32 v148, v148, v243, s[56:57]
v_cndmask_b32 v149, v149, v243, s[58:59]
v_cndmask_b32 v150, v150, v243, s[60:61]
v_cndmask_b32 v151, v151, v243, s[62:63]
s_waitcnt lgkmcnt(6)
v_add_u32 v234, s49, v233
ds_read_b64 v[234:235], v234
s_add_u32 m0, s46, s42
s_nop 0
buffer_load_dwordx4 v236, s[8:11], s45 offen offset:256  lds
buffer_load_dwordx4 v237, s[8:11], s45 offen offset:3328  lds
s_branch L_w6
L_qs:
v_mfma_f32_16x16x32_bf16 v[128:131], a[244:247], a[116:119], v[192:195]
v_exp_f32 v216, v112
v_mfma_f32_16x16x32_bf16 v[128:131], a[240:243], a[112:115], v[128:131]
s_and_b32 s86, s83, s71
v_exp_f32 v217, v113
v_mfma_f32_16x16x32_bf16 v[128:131], a[236:239], a[108:111], v[128:131]
v_mbcnt_lo_u32_b32 v254, -1, 0
v_readlane_b32 s48, v239, s34
v_mfma_f32_16x16x32_bf16 v[128:131], a[232:235], a[104:107], v[128:131]
v_mbcnt_hi_u32_b32 v254, -1, v254
v_add_f32 v212, v212, v216
v_mfma_f32_16x16x32_bf16 v[128:131], a[228:231], a[100:103], v[128:131]
v_exp_f32 v218, v114
v_mfma_f32_16x16x32_bf16 v[128:131], a[224:227], a[96:99], v[128:131]
s_and_b32 s79, s48, s70
v_lshlrev_b32 v254, 4, v254
v_add_f32 v212, v212, v217
v_mfma_f32_16x16x32_bf16 v[132:135], a[224:227], a[120:123], v[196:199]
s_waitcnt vmcnt(12) lgkmcnt(0)
s_barrier
v_mfma_f32_16x16x32_bf16 v[132:135], a[228:231], a[124:127], v[132:135]
v_add_u32 v253, s86, v254
v_cvt_pk_bf16_f32 v162, v216, v217
v_mfma_f32_16x16x32_bf16 v[132:135], a[232:235], a[128:131], v[132:135]
s_add_u32 m0, s44, s40
v_exp_f32 v219, v115
v_mfma_f32_16x16x32_bf16 v[132:135], a[236:239], a[132:135], v[132:135]
s_and_b32 s46, s48, s71
v_exp_f32 v220, v116
v_mfma_f32_16x16x32_bf16 v[132:135], a[240:243], a[136:139], v[132:135]
ds_read_b64_tr_b16 a[208:209], v228 offset:12288
v_add_f32 v212, v212, v218
v_mfma_f32_16x16x32_bf16 v[132:135], a[244:247], a[140:143], v[132:135]
ds_write_b128 v253, a[144:147] offset:0
v_mfma_f32_16x16x32_bf16 v[136:139], a[244:247], a[164:167], v[200:203]
ds_read_b64_tr_b16 a[210:211], v228 offset:18432
v_add_f32 v212, v212, v219
v_mfma_f32_16x16x32_bf16 v[136:139], a[240:243], a[160:163], v[136:139]
s_lshr_b32 s45, s48, 8
v_cvt_pk_bf16_f32 v163, v218, v219
v_add_f32 v213, v213, v220
v_mfma_f32_16x16x32_bf16 v[136:139], a[236:239], a[156:159], v[136:139]
v_add_u32 v234, v232, v234
v_xor_b32 v235, v232, v235
v_mfma_f32_16x16x32_bf16 v[136:139], a[232:235], a[152:155], v[136:139]
buffer_load_dwordx4 v234, s[4:7], s43 offen offset:0  lds
v_mfma_f32_16x16x32_bf16 v[136:139], a[228:231], a[148:151], v[136:139]
s_and_b32 s45, s45, s71
v_exp_f32 v221, v117
v_mfma_f32_16x16x32_bf16 v[136:139], a[224:227], a[144:147], v[136:139]
ds_read_b64_tr_b16 a[212:213], v229 offset:12288
v_add_f32 v213, v213, v221
v_mfma_f32_16x16x32_bf16 v[140:143], a[224:227], a[168:171], v[204:207]
ds_write_b128 v253, a[148:151] offset:1024
v_mfma_f32_16x16x32_bf16 v[140:143], a[228:231], a[172:175], v[140:143]
s_bitcmp1_b32 s48, 28
v_exp_f32 v222, v118
v_mfma_f32_16x16x32_bf16 v[140:143], a[232:235], a[176:179], v[140:143]
ds_read_b64_tr_b16 a[214:215], v229 offset:18432
v_cvt_pk_bf16_f32 v166, v220, v221
v_mfma_f32_16x16x32_bf16 v[140:143], a[236:239], a[180:183], v[140:143]
s_cselect_b64 s[50:51], s[30:31], s[28:29]
v_exp_f32 v223, v119
v_mfma_f32_16x16x32_bf16 v[140:143], a[240:243], a[184:187], v[140:143]
ds_read_b64_tr_b16 a[216:217], v230 offset:12288
v_add_f32 v213, v213, v222
v_mfma_f32_16x16x32_bf16 v[140:143], a[244:247], a[188:191], v[140:143]
ds_write_b128 v253, a[152:155] offset:2048
v_mfma_f32_16x16x32_bf16 v[144:147], a[204:207], a[116:119], v[192:195]
ds_read_b64_tr_b16 a[218:219], v230 offset:18432
v_add_f32 v213, v213, v223
v_mfma_f32_16x16x32_bf16 v[144:147], a[200:203], a[112:115], v[144:147]
v_exp_f32 v216, v120
v_mfma_f32_16x16x32_bf16 v[144:147], a[196:199], a[108:111], v[144:147]
buffer_load_dwordx4 v235, s[4:7], s43 offen offset:3072  lds
v_mfma_f32_16x16x32_bf16 v[144:147], a[192:195], a[104:107], v[144:147]
ds_read_b64_tr_b16 a[220:221], v231 offset:12288
v_cvt_pk_bf16_f32 v167, v222, v223
v_mfma_f32_16x16x32_bf16 v[144:147], a[252:255], a[100:103], v[144:147]
ds_write_b128 v253, a[156:159] offset:3072
v_exp_f32 v217, v121
v_mfma_f32_16x16x32_bf16 v[144:147], a[248:251], a[96:99], v[144:147]
ds_read_b64_tr_b16 a[222:223], v231 offset:18432
v_add_f32 v214, v214, v216
v_mfma_f32_16x16x32_bf16 v[148:151], a[248:251], a[120:123], v[196:199]
s_add_u32 m0, s44, s41
v_exp_f32 v218, v122
v_mfma_f32_16x16x32_bf16 v[148:151], a[252:255], a[124:127], v[148:151]
ds_read_b64_tr_b16 a[224:225], v228 offset:13312
v_add_f32 v214, v214, v217
v_mfma_f32_16x16x32_bf16 v[148:151], a[192:195], a[128:131], v[148:151]
ds_write_b128 v253, a[160:163] offset:4096
v_exp_f32 v219, v123
v_mfma_f32_16x16x32_bf16 v[148:151], a[196:199], a[132:135], v[148:151]
ds_read_b64_tr_b16 a[226:227], v228 offset:19456
v_cvt_pk_bf16_f32 v170, v216, v217
v_mfma_f32_16x16x32_bf16 v[148:151], a[200:203], a[136:139], v[148:151]
ds_read_b64_tr_b16 a[228:229], v229 offset:13312
v_add_f32 v214, v214, v218
v_mfma_f32_16x16x32_bf16 v[148:151], a[204:207], a[140:143], v[148:151]
ds_write_b128 v253, a[164:167] offset:5120
v_exp_f32 v220, v124
v_mfma_f32_16x16x32_bf16 v[152:155], a[204:207], a[164:167], v[200:203]
buffer_load_dwordx4 v234, s[4:7], s43 offen offset:128  lds
v_mfma_f32_16x16x32_bf16 v[152:155], a[200:203], a[160:163], v[152:155]
ds_read_b64_tr_b16 a[230:231], v229 offset:19456
v_add_f32 v214, v214, v219
v_mfma_f32_16x16x32_bf16 v[152:155], a[196:199], a[156:159], v[152:155]
ds_read_b64_tr_b16 a[232:233], v230 offset:13312
v_cvt_pk_bf16_f32 v171, v218, v219
v_mfma_f32_16x16x32_bf16 v[152:155], a[192:195], a[152:155], v[152:155]
ds_write_b128 v253, a[168:171] offset:6144
s_bitcmp1_b32 s48, 29
v_mfma_f32_16x16x32_bf16 v[152:155], a[252:255], a[148:151], v[152:155]
s_cselect_b64 s[8:9], s[50:51], s[26:27]
v_exp_f32 v221, v125
v_mfma_f32_16x16x32_bf16 v[152:155], a[248:251], a[144:147], v[152:155]
ds_read_b64_tr_b16 a[234:235], v230 offset:19456
v_add_f32 v215, v215, v220
v_mfma_f32_16x16x32_bf16 v[156:159], a[248:251], a[168:171], v[204:207]
s_waitcnt lgkmcnt(6)
v_exp_f32 v222, v126
v_mfma_f32_16x16x32_bf16 v[156:159], a[252:255], a[172:175], v[156:159]
ds_read_b64_tr_b16 a[236:237], v231 offset:13312
v_add_f32 v215, v215, v221
v_mfma_f32_16x16x32_bf16 v[156:159], a[192:195], a[176:179], v[156:159]
v_cvt_pk_bf16_f32 v174, v220, v221
v_add_f32 v215, v215, v222
v_mfma_f32_16x16x32_bf16 v[156:159], a[196:199], a[180:183], v[156:159]
v_exp_f32 v223, v127
v_mfma_f32_16x16x32_bf16 v[156:159], a[200:203], a[184:187], v[156:159]
buffer_load_dwordx4 v235, s[4:7], s43 offen offset:3200  lds
v_mfma_f32_16x16x32_bf16 v[156:159], a[204:207], a[188:191], v[156:159]
ds_read_b64_tr_b16 a[238:239], v231 offset:19456
ds_write_b128 v253, a[172:175] offset:7168
ds_read_b64_tr_b16 a[240:241], v228 offset:14336
v_add_u32 v236, s79, v233
v_add_f32 v215, v215, v223
v_cvt_pk_bf16_f32 v175, v222, v223
v_max3_f32 v240, v212, v213, v214
s_add_u32 m0, s44, s42
ds_read_b64 v[236:237], v236
ds_read_b64_tr_b16 a[242:243], v228 offset:20480
ds_write_b128 v253, a[176:179] offset:8192
ds_read_b64_tr_b16 a[244:245], v229 offset:14336
ds_read_b64_tr_b16 a[246:247], v229 offset:20480
ds_write_b128 v253, a[180:183] offset:9216
v_max_f32 v240, v240, v215
v_cmp_lt_f32 vcc, s52, v240
s_nop 0
s_cbranch_vccnz L_stub6
L_back6:
v_mfma_f32_16x16x32_bf16 v[0:3], v[160:163], a[208:211], v[0:3]
buffer_load_dwordx4 v234, s[4:7], s43 offen offset:256  lds
v_mfma_f32_16x16x32_bf16 v[4:7], v[160:163], a[212:215], v[4:7]
ds_read_b64_tr_b16 a[248:249], v230 offset:14336
v_add_f32 v208, v208, v212
v_mfma_f32_16x16x32_bf16 v[52:55], v[164:167], a[212:215], v[52:55]
s_lshr_b32 s88, s83, 8
v_exp_f32 v216, v128
v_mfma_f32_16x16x32_bf16 v[48:51], v[164:167], a[208:211], v[48:51]
ds_read_b64_tr_b16 a[250:251], v230 offset:20480
v_add_f32 v209, v209, v213
v_mfma_f32_16x16x32_bf16 a[0:3], v[168:171], a[208:211], a[0:3]
ds_write_b128 v253, a[184:187] offset:10240
v_mfma_f32_16x16x32_bf16 a[4:7], v[168:171], a[212:215], a[4:7]
s_and_b32 s88, s88, s71
v_add_f32 v210, v210, v214
v_add_f32 v211, v211, v215
v_mfma_f32_16x16x32_bf16 a[52:55], v[172:175], a[212:215], a[52:55]
v_exp_f32 v217, v129
v_mfma_f32_16x16x32_bf16 a[48:51], v[172:175], a[208:211], a[48:51]
ds_read_b64_tr_b16 a[252:253], v231 offset:14336
v_add_f32 v212, v216, v217
v_mfma_f32_16x16x32_bf16 a[56:59], v[172:175], a[216:219], a[56:59]
v_exp_f32 v218, v130
v_mfma_f32_16x16x32_bf16 a[60:63], v[172:175], a[220:223], a[60:63]
ds_read_b64_tr_b16 a[254:255], v231 offset:20480
v_cvt_pk_bf16_f32 v176, v216, v217
v_mfma_f32_16x16x32_bf16 a[12:15], v[168:171], a[220:223], a[12:15]
ds_write_b128 v253, a[188:191] offset:11264
buffer_load_dwordx4 v235, s[4:7], s43 offen offset:3328  lds
v_mfma_f32_16x16x32_bf16 a[8:11], v[168:171], a[216:219], a[8:11]
v_exp_f32 v219, v131
v_mfma_f32_16x16x32_bf16 v[56:59], v[164:167], a[216:219], v[56:59]
v_add_f32 v212, v212, v218
v_cvt_pk_bf16_f32 v177, v218, v219
v_mfma_f32_16x16x32_bf16 v[60:63], v[164:167], a[220:223], v[60:63]
v_exp_f32 v220, v132
v_mfma_f32_16x16x32_bf16 v[12:15], v[160:163], a[220:223], v[12:15]
v_add_f32 v212, v212, v219
v_add_u32 v254, s88, v254
v_mfma_f32_16x16x32_bf16 v[8:11], v[160:163], a[216:219], v[8:11]
v_exp_f32 v221, v133
v_mfma_f32_16x16x32_bf16 v[16:19], v[160:163], a[224:227], v[16:19]
s_waitcnt vmcnt(12) lgkmcnt(0)
s_barrier
v_mfma_f32_16x16x32_bf16 v[20:23], v[160:163], a[228:231], v[20:23]
v_exp_f32 v222, v134
v_mfma_f32_16x16x32_bf16 v[68:71], v[164:167], a[228:231], v[68:71]
ds_read_b128 a[192:195], v226 offset:12288
v_add_f32 v213, v220, v221
v_mfma_f32_16x16x32_bf16 v[64:67], v[164:167], a[224:227], v[64:67]
v_cvt_pk_bf16_f32 v180, v220, v221
v_readlane_b32 s47, v238, s34
v_mfma_f32_16x16x32_bf16 a[16:19], v[168:171], a[224:227], a[16:19]
v_add_f32 v213, v213, v222
v_add_u32 v236, v232, v236
v_mfma_f32_16x16x32_bf16 a[20:23], v[168:171], a[228:231], a[20:23]
s_and_b32 s49, s47, s70
v_exp_f32 v223, v135
v_mfma_f32_16x16x32_bf16 a[68:71], v[172:175], a[228:231], a[68:71]
ds_read_b128 a[196:199], v227 offset:12288
v_xor_b32 v237, v232, v237
v_mfma_f32_16x16x32_bf16 a[64:67], v[172:175], a[224:227], a[64:67]
s_add_u32 m0, s46, s40
v_exp_f32 v216, v136
v_mfma_f32_16x16x32_bf16 a[72:75], v[172:175], a[232:235], a[72:75]
buffer_load_dwordx4 v236, s[8:11], s45 offen offset:0  lds
v_mfma_f32_16x16x32_bf16 a[76:79], v[172:175], a[236:239], a[76:79]
ds_read_b128 a[200:203], v226 offset:13312
v_add_f32 v213, v213, v223
v_mfma_f32_16x16x32_bf16 a[28:31], v[168:171], a[236:239], a[28:31]
s_add_u32 s82, s82, 1
v_cvt_pk_bf16_f32 v181, v222, v223
v_readlane_b32 s83, v239, s82
v_mfma_f32_16x16x32_bf16 a[24:27], v[168:171], a[232:235], a[24:27]
buffer_load_dwordx4 v237, s[8:11], s45 offen offset:3072  lds
v_mfma_f32_16x16x32_bf16 v[72:75], v[164:167], a[232:235], v[72:75]
s_and_b32 s44, s47, s71
v_exp_f32 v217, v137
v_mfma_f32_16x16x32_bf16 v[76:79], v[164:167], a[236:239], v[76:79]
ds_read_b128 a[204:207], v227 offset:13312
v_add_f32 v214, v216, v217
v_mfma_f32_16x16x32_bf16 v[28:31], v[160:163], a[236:239], v[28:31]
ds_read_b128 a[208:211], v226 offset:14336
v_cvt_pk_bf16_f32 v184, v216, v217
v_mfma_f32_16x16x32_bf16 v[24:27], v[160:163], a[232:235], v[24:27]
s_lshl_b32 s89, s36, 8
v_exp_f32 v218, v138
v_mfma_f32_16x16x32_bf16 v[32:35], v[160:163], a[240:243], v[32:35]
s_and_b32 s35, s83, 63
v_exp_f32 v219, v139
v_mfma_f32_16x16x32_bf16 v[36:39], v[160:163], a[244:247], v[36:39]
s_addk_i32 s89, 3200
v_add_u32 v252, s89, v242
v_add_f32 v214, v214, v218
v_mfma_f32_16x16x32_bf16 v[84:87], v[164:167], a[244:247], v[84:87]
ds_write2_b32 v252, v192, v196 offset0:0 offset1:16
v_exp_f32 v220, v140
v_mfma_f32_16x16x32_bf16 v[80:83], v[164:167], a[240:243], v[80:83]
ds_read_b128 a[212:215], v227 offset:14336
v_add_f32 v214, v214, v219
v_mfma_f32_16x16x32_bf16 a[32:35], v[168:171], a[240:243], a[32:35]
ds_read_b128 a[216:219], v226 offset:18432
v_cvt_pk_bf16_f32 v185, v218, v219
v_mfma_f32_16x16x32_bf16 a[36:39], v[168:171], a[244:247], a[36:39]
ds_write2_b32 v252, v200, v204 offset0:32 offset1:48
v_exp_f32 v221, v141
v_mfma_f32_16x16x32_bf16 a[84:87], v[172:175], a[244:247], a[84:87]
ds_read_b128 a[220:223], v227 offset:18432
v_add_f32 v215, v220, v221
v_mfma_f32_16x16x32_bf16 a[80:83], v[172:175], a[240:243], a[80:83]
ds_read_b128 a[224:227], v226 offset:19456
v_cvt_pk_bf16_f32 v188, v220, v221
v_mfma_f32_16x16x32_bf16 a[88:91], v[172:175], a[248:251], a[88:91]
ds_read_b128 a[228:231], v227 offset:19456
v_add_u32 v234, s49, v233
v_mfma_f32_16x16x32_bf16 a[92:95], v[172:175], a[252:255], a[92:95]
s_lshr_b32 s43, s47, 8
v_exp_f32 v222, v142
v_mfma_f32_16x16x32_bf16 a[44:47], v[168:171], a[252:255], a[44:47]
ds_read_b64 v[234:235], v234
v_add_f32 v215, v215, v222
v_mfma_f32_16x16x32_bf16 a[40:43], v[168:171], a[248:251], a[40:43]
ds_read_b128 a[232:235], v226 offset:20480
s_and_b32 s43, s43, s71
v_mfma_f32_16x16x32_bf16 v[88:91], v[164:167], a[248:251], v[88:91]
s_add_u32 m0, s46, s41
v_exp_f32 v223, v143
v_mfma_f32_16x16x32_bf16 v[92:95], v[164:167], a[252:255], v[92:95]
buffer_load_dwordx4 v236, s[8:11], s45 offen offset:128  lds
v_mfma_f32_16x16x32_bf16 v[44:47], v[160:163], a[252:255], v[44:47]
buffer_load_dwordx4 v237, s[8:11], s45 offen offset:3200  lds
v_mfma_f32_16x16x32_bf16 v[40:43], v[160:163], a[248:251], v[40:43]
s_bitcmp1_b32 s47, 28
s_cselect_b64 s[50:51], s[30:31], s[28:29]
s_bitcmp1_b32 s47, 29
s_cselect_b64 s[4:5], s[50:51], s[24:25]
s_add_u32 m0, s46, s42
s_add_u32 s34, s34, 1
buffer_load_dwordx4 v236, s[8:11], s45 offen offset:256  lds
s_waitcnt lgkmcnt(7)
buffer_load_dwordx4 v237, s[8:11], s45 offen offset:3328  lds
v_add_f32 v215, v215, v223
v_cvt_pk_bf16_f32 v189, v222, v223
ds_read_b128 a[236:239], v227 offset:20480
v_mfma_f32_16x16x32_bf16 v[96:99], a[212:215], a[116:119], v[192:195]
v_exp_f32 v216, v144
v_mfma_f32_16x16x32_bf16 v[96:99], a[208:211], a[112:115], v[96:99]
v_exp_f32 v217, v145
v_mfma_f32_16x16x32_bf16 v[96:99], a[204:207], a[108:111], v[96:99]
v_readlane_b32 s48, v239, s34
v_add_f32 v212, v212, v216
v_mfma_f32_16x16x32_bf16 v[96:99], a[200:203], a[104:107], v[96:99]
v_exp_f32 v218, v146
v_mfma_f32_16x16x32_bf16 v[96:99], a[196:199], a[100:103], v[96:99]
v_exp_f32 v219, v147
v_mfma_f32_16x16x32_bf16 v[96:99], a[192:195], a[96:99], v[96:99]
s_and_b32 s79, s48, s70
v_add_f32 v212, v212, v217
v_cvt_pk_bf16_f32 v178, v216, v217
v_mfma_f32_16x16x32_bf16 v[100:103], a[192:195], a[120:123], v[196:199]
s_waitcnt vmcnt(12) lgkmcnt(0)
s_barrier
v_mfma_f32_16x16x32_bf16 v[100:103], a[196:199], a[124:127], v[100:103]
v_exp_f32 v220, v148
v_mfma_f32_16x16x32_bf16 v[100:103], a[200:203], a[128:131], v[100:103]
ds_read_b64_tr_b16 a[240:241], v228 offset:0
v_add_f32 v212, v212, v218
v_mfma_f32_16x16x32_bf16 v[100:103], a[204:207], a[132:135], v[100:103]
ds_write_b128 v254, a[96:99] offset:0
v_mfma_f32_16x16x32_bf16 v[100:103], a[208:211], a[136:139], v[100:103]
ds_read_b64_tr_b16 a[242:243], v228 offset:6144
v_add_f32 v212, v212, v219
v_mfma_f32_16x16x32_bf16 v[100:103], a[212:215], a[140:143], v[100:103]
s_add_u32 m0, s44, s40
v_cvt_pk_bf16_f32 v179, v218, v219
v_add_f32 v213, v213, v220
v_mfma_f32_16x16x32_bf16 v[104:107], a[212:215], a[164:167], v[200:203]
s_and_b32 s46, s48, s71
v_add_u32 v234, v232, v234
v_xor_b32 v235, v232, v235
v_mfma_f32_16x16x32_bf16 v[104:107], a[208:211], a[160:163], v[104:107]
buffer_load_dwordx4 v234, s[4:7], s43 offen offset:0  lds
v_mfma_f32_16x16x32_bf16 v[104:107], a[204:207], a[156:159], v[104:107]
s_lshr_b32 s45, s48, 8
v_exp_f32 v221, v149
v_mfma_f32_16x16x32_bf16 v[104:107], a[200:203], a[152:155], v[104:107]
ds_read_b64_tr_b16 a[244:245], v229 offset:0
v_add_f32 v213, v213, v221
v_mfma_f32_16x16x32_bf16 v[104:107], a[196:199], a[148:151], v[104:107]
ds_write_b128 v254, a[100:103] offset:1024
v_mfma_f32_16x16x32_bf16 v[104:107], a[192:195], a[144:147], v[104:107]
s_and_b32 s45, s45, s71
v_exp_f32 v222, v150
v_mfma_f32_16x16x32_bf16 v[108:111], a[192:195], a[168:171], v[204:207]
ds_read_b64_tr_b16 a[246:247], v229 offset:6144
v_cvt_pk_bf16_f32 v182, v220, v221
v_mfma_f32_16x16x32_bf16 v[108:111], a[196:199], a[172:175], v[108:111]
s_bitcmp1_b32 s48, 28
v_exp_f32 v223, v151
v_mfma_f32_16x16x32_bf16 v[108:111], a[200:203], a[176:179], v[108:111]
ds_read_b64_tr_b16 a[248:249], v230 offset:0
v_add_f32 v213, v213, v222
v_mfma_f32_16x16x32_bf16 v[108:111], a[204:207], a[180:183], v[108:111]
ds_write_b128 v254, a[104:107] offset:2048
v_mfma_f32_16x16x32_bf16 v[108:111], a[208:211], a[184:187], v[108:111]
ds_read_b64_tr_b16 a[250:251], v230 offset:6144
v_add_f32 v213, v213, v223
v_mfma_f32_16x16x32_bf16 v[108:111], a[212:215], a[188:191], v[108:111]
s_cselect_b64 s[50:51], s[30:31], s[28:29]
v_exp_f32 v216, v152
v_mfma_f32_16x16x32_bf16 v[112:115], a[236:239], a[116:119], v[192:195]
buffer_load_dwordx4 v235, s[4:7], s43 offen offset:3072  lds
v_mfma_f32_16x16x32_bf16 v[112:115], a[232:235], a[112:115], v[112:115]
ds_read_b64_tr_b16 a[252:253], v231 offset:0
v_cvt_pk_bf16_f32 v183, v222, v223
v_mfma_f32_16x16x32_bf16 v[112:115], a[228:231], a[108:111], v[112:115]
ds_write_b128 v254, a[108:111] offset:3072
v_exp_f32 v217, v153
v_mfma_f32_16x16x32_bf16 v[112:115], a[224:227], a[104:107], v[112:115]
ds_read_b64_tr_b16 a[254:255], v231 offset:6144
v_add_f32 v214, v214, v216
v_mfma_f32_16x16x32_bf16 v[112:115], a[220:223], a[100:103], v[112:115]
s_add_u32 m0, s44, s41
v_exp_f32 v218, v154
v_mfma_f32_16x16x32_bf16 v[112:115], a[216:219], a[96:99], v[112:115]
ds_read_b64_tr_b16 a[192:193], v228 offset:1024
v_add_f32 v214, v214, v217
v_mfma_f32_16x16x32_bf16 v[116:119], a[216:219], a[120:123], v[196:199]
ds_write_b128 v254, a[112:115] offset:4096
v_exp_f32 v219, v155
v_mfma_f32_16x16x32_bf16 v[116:119], a[220:223], a[124:127], v[116:119]
ds_read_b64_tr_b16 a[194:195], v228 offset:7168
v_cvt_pk_bf16_f32 v186, v216, v217
v_mfma_f32_16x16x32_bf16 v[116:119], a[224:227], a[128:131], v[116:119]
ds_read_b64_tr_b16 a[196:197], v229 offset:1024
v_add_f32 v214, v214, v218
v_mfma_f32_16x16x32_bf16 v[116:119], a[228:231], a[132:135], v[116:119]
ds_write_b128 v254, a[116:119] offset:5120
v_exp_f32 v220, v156
v_mfma_f32_16x16x32_bf16 v[116:119], a[232:235], a[136:139], v[116:119]
buffer_load_dwordx4 v234, s[4:7], s43 offen offset:128  lds
v_mfma_f32_16x16x32_bf16 v[116:119], a[236:239], a[140:143], v[116:119]
ds_read_b64_tr_b16 a[198:199], v229 offset:7168
v_add_f32 v214, v214, v219
v_mfma_f32_16x16x32_bf16 v[120:123], a[236:239], a[164:167], v[200:203]
ds_read_b64_tr_b16 a[200:201], v230 offset:1024
v_cvt_pk_bf16_f32 v187, v218, v219
v_mfma_f32_16x16x32_bf16 v[120:123], a[232:235], a[160:163], v[120:123]
ds_write_b128 v254, a[120:123] offset:6144
s_bitcmp1_b32 s48, 29
v_mfma_f32_16x16x32_bf16 v[120:123], a[228:231], a[156:159], v[120:123]
s_cselect_b64 s[8:9], s[50:51], s[26:27]
v_exp_f32 v221, v157
v_mfma_f32_16x16x32_bf16 v[120:123], a[224:227], a[152:155], v[120:123]
ds_read_b64_tr_b16 a[202:203], v230 offset:7168
v_add_f32 v215, v215, v220
v_mfma_f32_16x16x32_bf16 v[120:123], a[220:223], a[148:151], v[120:123]
s_waitcnt lgkmcnt(6)
v_exp_f32 v222, v158
v_mfma_f32_16x16x32_bf16 v[120:123], a[216:219], a[144:147], v[120:123]
ds_read_b64_tr_b16 a[204:205], v231 offset:1024
v_add_f32 v215, v215, v221
v_mfma_f32_16x16x32_bf16 v[124:127], a[216:219], a[168:171], v[204:207]
v_cvt_pk_bf16_f32 v190, v220, v221
v_add_f32 v215, v215, v222
v_mfma_f32_16x16x32_bf16 v[124:127], a[220:223], a[172:175], v[124:127]
v_exp_f32 v223, v159
v_mfma_f32_16x16x32_bf16 v[124:127], a[224:227], a[176:179], v[124:127]
buffer_load_dwordx4 v235, s[4:7], s43 offen offset:3200  lds
v_mfma_f32_16x16x32_bf16 v[124:127], a[228:231], a[180:183], v[124:127]
ds_read_b64_tr_b16 a[206:207], v231 offset:7168
v_add_u32 v236, s79, v233
v_mfma_f32_16x16x32_bf16 v[124:127], a[232:235], a[184:187], v[124:127]
ds_write_b128 v254, a[124:127] offset:7168
v_max3_f32 v240, v212, v213, v214
v_mfma_f32_16x16x32_bf16 v[124:127], a[236:239], a[188:191], v[124:127]
ds_read_b64_tr_b16 a[208:209], v228 offset:2048
ds_read_b64 v[236:237], v236
ds_read_b64_tr_b16 a[210:211], v228 offset:8192
ds_write_b128 v254, a[128:131] offset:8192
ds_read_b64_tr_b16 a[212:213], v229 offset:2048
v_add_f32 v215, v215, v223
v_cvt_pk_bf16_f32 v191, v222, v223
v_max_f32 v240, v240, v215
s_add_u32 m0, s44, s42
v_cmp_lt_f32 vcc, s52, v240
ds_read_b64_tr_b16 a[214:215], v229 offset:8192
ds_write_b128 v254, a[132:135] offset:9216
s_cbranch_vccnz L_stub7
L_back7:
v_mfma_f32_16x16x32_bf16 v[0:3], v[176:179], a[240:243], v[0:3]
buffer_load_dwordx4 v234, s[4:7], s43 offen offset:256  lds
v_mfma_f32_16x16x32_bf16 v[4:7], v[176:179], a[244:247], v[4:7]
ds_read_b64_tr_b16 a[216:217], v230 offset:2048
v_add_f32 v208, v208, v212
v_mfma_f32_16x16x32_bf16 v[52:55], v[180:183], a[244:247], v[52:55]
v_exp_f32 v216, v96
v_mfma_f32_16x16x32_bf16 v[48:51], v[180:183], a[240:243], v[48:51]
ds_read_b64_tr_b16 a[218:219], v230 offset:8192
v_add_f32 v209, v209, v213
v_mfma_f32_16x16x32_bf16 a[0:3], v[184:187], a[240:243], a[0:3]
ds_write_b128 v254, a[136:139] offset:10240
v_mfma_f32_16x16x32_bf16 a[4:7], v[184:187], a[244:247], a[4:7]
v_add_f32 v210, v210, v214
v_add_f32 v211, v211, v215
v_mfma_f32_16x16x32_bf16 a[52:55], v[188:191], a[244:247], a[52:55]
v_exp_f32 v217, v97
v_mfma_f32_16x16x32_bf16 a[48:51], v[188:191], a[240:243], a[48:51]
ds_read_b64_tr_b16 a[220:221], v231 offset:2048
v_add_f32 v212, v216, v217
v_mfma_f32_16x16x32_bf16 a[56:59], v[188:191], a[248:251], a[56:59]
v_exp_f32 v218, v98
v_mfma_f32_16x16x32_bf16 a[60:63], v[188:191], a[252:255], a[60:63]
ds_read_b64_tr_b16 a[222:223], v231 offset:8192
v_cvt_pk_bf16_f32 v160, v216, v217
v_mfma_f32_16x16x32_bf16 a[12:15], v[184:187], a[252:255], a[12:15]
ds_write_b128 v254, a[140:143] offset:11264
buffer_load_dwordx4 v235, s[4:7], s43 offen offset:3328  lds
v_mfma_f32_16x16x32_bf16 a[8:11], v[184:187], a[248:251], a[8:11]
v_exp_f32 v219, v99
v_mfma_f32_16x16x32_bf16 v[56:59], v[180:183], a[248:251], v[56:59]
v_add_f32 v212, v212, v218
v_cvt_pk_bf16_f32 v161, v218, v219
v_mfma_f32_16x16x32_bf16 v[60:63], v[180:183], a[252:255], v[60:63]
v_exp_f32 v220, v100
v_mfma_f32_16x16x32_bf16 v[12:15], v[176:179], a[252:255], v[12:15]
v_add_f32 v212, v212, v219
v_readlane_b32 s47, v238, s34
v_mfma_f32_16x16x32_bf16 v[8:11], v[176:179], a[248:251], v[8:11]
v_exp_f32 v221, v101
v_mfma_f32_16x16x32_bf16 v[16:19], v[176:179], a[192:195], v[16:19]
s_waitcnt vmcnt(12) lgkmcnt(0)
s_barrier
v_mfma_f32_16x16x32_bf16 v[20:23], v[176:179], a[196:199], v[20:23]
s_and_b32 s49, s47, s70
v_exp_f32 v222, v102
v_mfma_f32_16x16x32_bf16 v[68:71], v[180:183], a[196:199], v[68:71]
ds_read_b128 a[224:227], v226 offset:0
v_add_f32 v213, v220, v221
v_mfma_f32_16x16x32_bf16 v[64:67], v[180:183], a[192:195], v[64:67]
s_add_u32 m0, s46, s40
v_cvt_pk_bf16_f32 v164, v220, v221
v_add_f32 v213, v213, v222
v_mfma_f32_16x16x32_bf16 a[16:19], v[184:187], a[192:195], a[16:19]
s_lshr_b32 s95, s95, 4
v_exp_f32 v223, v103
v_mfma_f32_16x16x32_bf16 a[20:23], v[184:187], a[196:199], a[20:23]
ds_read_b128 a[228:231], v227 offset:0
v_add_u32 v236, v232, v236
v_mfma_f32_16x16x32_bf16 a[68:71], v[188:191], a[196:199], a[68:71]
buffer_load_dwordx4 v236, s[8:11], s45 offen offset:0  lds
v_mfma_f32_16x16x32_bf16 a[64:67], v[188:191], a[192:195], a[64:67]
s_and_b32 s44, s47, s71
v_xor_b32 v237, v232, v237
v_add_f32 v213, v213, v223
v_mfma_f32_16x16x32_bf16 a[72:75], v[188:191], a[200:203], a[72:75]
s_lshr_b32 s43, s47, 8
v_exp_f32 v216, v104
v_mfma_f32_16x16x32_bf16 a[76:79], v[188:191], a[204:207], a[76:79]
ds_read_b128 a[232:235], v226 offset:1024
v_cvt_pk_bf16_f32 v165, v222, v223
v_mfma_f32_16x16x32_bf16 a[28:31], v[184:187], a[204:207], a[28:31]
buffer_load_dwordx4 v237, s[8:11], s45 offen offset:3072  lds
v_mfma_f32_16x16x32_bf16 a[24:27], v[184:187], a[200:203], a[24:27]
s_and_b32 s43, s43, s71
v_exp_f32 v217, v105
v_mfma_f32_16x16x32_bf16 v[72:75], v[180:183], a[200:203], v[72:75]
ds_read_b128 a[236:239], v227 offset:1024
v_add_f32 v214, v216, v217
v_mfma_f32_16x16x32_bf16 v[76:79], v[180:183], a[204:207], v[76:79]
ds_read_b128 a[240:243], v226 offset:2048
v_cvt_pk_bf16_f32 v168, v216, v217
v_mfma_f32_16x16x32_bf16 v[28:31], v[176:179], a[204:207], v[28:31]
s_add_u32 m0, s46, s41
v_exp_f32 v218, v106
v_mfma_f32_16x16x32_bf16 v[24:27], v[176:179], a[200:203], v[24:27]
buffer_load_dwordx4 v236, s[8:11], s45 offen offset:128  lds
v_mfma_f32_16x16x32_bf16 v[32:35], v[176:179], a[208:211], v[32:35]
ds_read_b128 a[244:247], v227 offset:2048
v_add_f32 v214, v214, v218
v_mfma_f32_16x16x32_bf16 v[36:39], v[176:179], a[212:215], v[36:39]
s_bitcmp1_b32 s47, 28
v_exp_f32 v219, v107
v_mfma_f32_16x16x32_bf16 v[84:87], v[180:183], a[212:215], v[84:87]
ds_read_b128 a[248:251], v226 offset:6144
v_add_f32 v214, v214, v219
v_mfma_f32_16x16x32_bf16 v[80:83], v[180:183], a[208:211], v[80:83]
buffer_load_dwordx4 v237, s[8:11], s45 offen offset:3200  lds
v_mfma_f32_16x16x32_bf16 a[32:35], v[184:187], a[208:211], a[32:35]
s_cselect_b64 s[50:51], s[30:31], s[28:29]
v_exp_f32 v220, v108
v_mfma_f32_16x16x32_bf16 a[36:39], v[184:187], a[212:215], a[36:39]
ds_read_b128 a[252:255], v227 offset:6144
v_cvt_pk_bf16_f32 v169, v218, v219
v_mfma_f32_16x16x32_bf16 a[84:87], v[188:191], a[212:215], a[84:87]
s_bitcmp1_b32 s47, 29
v_exp_f32 v221, v109
v_mfma_f32_16x16x32_bf16 a[80:83], v[188:191], a[208:211], a[80:83]
ds_read_b128 a[192:195], v226 offset:7168
v_add_f32 v215, v220, v221
v_mfma_f32_16x16x32_bf16 a[88:91], v[188:191], a[216:219], a[88:91]
ds_read_b128 a[196:199], v227 offset:7168
v_cvt_pk_bf16_f32 v172, v220, v221
v_mfma_f32_16x16x32_bf16 a[92:95], v[188:191], a[220:223], a[92:95]
s_cselect_b64 s[4:5], s[50:51], s[24:25]
v_exp_f32 v222, v110
v_mfma_f32_16x16x32_bf16 a[44:47], v[184:187], a[220:223], a[44:47]
s_add_u32 m0, s46, s42
v_add_u32 v234, s49, v233
v_add_f32 v215, v215, v222
v_mfma_f32_16x16x32_bf16 a[40:43], v[184:187], a[216:219], a[40:43]
buffer_load_dwordx4 v236, s[8:11], s45 offen offset:256  lds
v_mfma_f32_16x16x32_bf16 v[88:91], v[180:183], a[216:219], v[88:91]
ds_read_b64 v[234:235], v234
ds_read_b128 a[200:203], v226 offset:8192
v_exp_f32 v223, v111
v_mfma_f32_16x16x32_bf16 v[92:95], v[180:183], a[220:223], v[92:95]
buffer_load_dwordx4 v237, s[8:11], s45 offen offset:3328  lds
v_mfma_f32_16x16x32_bf16 v[44:47], v[176:179], a[220:223], v[44:47]
ds_read_b128 a[204:207], v227 offset:8192
v_add_f32 v215, v215, v223
v_mfma_f32_16x16x32_bf16 v[40:43], v[176:179], a[216:219], v[40:43]
s_add_u32 s34, s34, 1
s_waitcnt lgkmcnt(7)
v_cvt_pk_bf16_f32 v173, v222, v223
s_cmp_eq_u32 s34, s35
s_cbranch_scc1 L_exit
s_bitcmp1_b32 s95, 5
s_cbranch_scc1 L_loopc1
s_branch L_loopb1
L_exa:
s_bitcmp1_b32 s83, 9
s_cbranch_scc1 L_ev1
s_bitcmp1_b32 s83, 11
s_cbranch_scc1 L_qs
v_mfma_f32_16x16x32_bf16 v[128:131], a[244:247], a[116:119], v[192:195]
v_exp_f32 v216, v112
v_mfma_f32_16x16x32_bf16 v[128:131], a[240:243], a[112:115], v[128:131]
v_exp_f32 v217, v113
v_mfma_f32_16x16x32_bf16 v[128:131], a[236:239], a[108:111], v[128:131]
v_readlane_b32 s48, v239, s34
v_add_f32 v212, v212, v216
v_mfma_f32_16x16x32_bf16 v[128:131], a[232:235], a[104:107], v[128:131]
v_exp_f32 v218, v114
v_mfma_f32_16x16x32_bf16 v[128:131], a[228:231], a[100:103], v[128:131]
v_exp_f32 v219, v115
v_mfma_f32_16x16x32_bf16 v[128:131], a[224:227], a[96:99], v[128:131]
s_and_b32 s79, s48, s70
v_exp_f32 v220, v116
v_mfma_f32_16x16x32_bf16 v[132:135], a[224:227], a[120:123], v[196:199]
s_waitcnt vmcnt(12) lgkmcnt(0)
s_barrier
v_mfma_f32_16x16x32_bf16 v[132:135], a[228:231], a[124:127], v[132:135]
v_add_f32 v212, v212, v217
v_cvt_pk_bf16_f32 v162, v216, v217
v_mfma_f32_16x16x32_bf16 v[132:135], a[232:235], a[128:131], v[132:135]
ds_read_b64_tr_b16 a[208:209], v228 offset:12288
v_add_f32 v212, v212, v218
v_mfma_f32_16x16x32_bf16 v[132:135], a[236:239], a[132:135], v[132:135]
s_add_u32 m0, s44, s40
v_add_f32 v212, v212, v219
v_cvt_pk_bf16_f32 v163, v218, v219
v_mfma_f32_16x16x32_bf16 v[132:135], a[240:243], a[136:139], v[132:135]
ds_read_b64_tr_b16 a[210:211], v228 offset:18432
v_add_f32 v213, v213, v220
v_mfma_f32_16x16x32_bf16 v[132:135], a[244:247], a[140:143], v[132:135]
s_and_b32 s46, s48, s71
v_exp_f32 v221, v117
v_mfma_f32_16x16x32_bf16 v[136:139], a[244:247], a[164:167], v[200:203]
ds_read_b64_tr_b16 a[212:213], v229 offset:12288
v_add_u32 v234, v232, v234
v_mfma_f32_16x16x32_bf16 v[136:139], a[240:243], a[160:163], v[136:139]
buffer_load_dwordx4 v234, s[4:7], s43 offen offset:0  lds
v_mfma_f32_16x16x32_bf16 v[136:139], a[236:239], a[156:159], v[136:139]
s_and_b32 s86, s83, s71
v_xor_b32 v235, v232, v235
v_add_f32 v213, v213, v221
v_mfma_f32_16x16x32_bf16 v[136:139], a[232:235], a[152:155], v[136:139]
s_lshr_b32 s45, s48, 8
v_exp_f32 v222, v118
v_mfma_f32_16x16x32_bf16 v[136:139], a[228:231], a[148:151], v[136:139]
ds_read_b64_tr_b16 a[214:215], v229 offset:18432
v_cvt_pk_bf16_f32 v166, v220, v221
v_mfma_f32_16x16x32_bf16 v[136:139], a[224:227], a[144:147], v[136:139]
s_sub_u32 s86, s86, s84
v_exp_f32 v223, v119
v_mfma_f32_16x16x32_bf16 v[140:143], a[224:227], a[168:171], v[204:207]
ds_read_b64_tr_b16 a[216:217], v230 offset:12288
v_add_f32 v213, v213, v222
v_mfma_f32_16x16x32_bf16 v[140:143], a[228:231], a[172:175], v[140:143]
ds_read_b64_tr_b16 a[218:219], v230 offset:18432
v_add_f32 v213, v213, v223
v_mfma_f32_16x16x32_bf16 v[140:143], a[232:235], a[176:179], v[140:143]
s_lshr_b32 s88, s83, 20
v_exp_f32 v216, v120
v_mfma_f32_16x16x32_bf16 v[140:143], a[236:239], a[180:183], v[140:143]
ds_read_b64_tr_b16 a[220:221], v231 offset:12288
v_cvt_pk_bf16_f32 v167, v222, v223
v_mfma_f32_16x16x32_bf16 v[140:143], a[240:243], a[184:187], v[140:143]
s_and_b32 s45, s45, s71
v_exp_f32 v217, v121
v_mfma_f32_16x16x32_bf16 v[140:143], a[244:247], a[188:191], v[140:143]
ds_read_b64_tr_b16 a[222:223], v231 offset:18432
v_add_f32 v214, v214, v216
v_mfma_f32_16x16x32_bf16 v[144:147], a[204:207], a[116:119], v[192:195]
buffer_load_dwordx4 v235, s[4:7], s43 offen offset:3072  lds
v_mfma_f32_16x16x32_bf16 v[144:147], a[200:203], a[112:115], v[144:147]
s_lshl_b32 s88, s88, 6
v_exp_f32 v218, v122
v_mfma_f32_16x16x32_bf16 v[144:147], a[196:199], a[108:111], v[144:147]
ds_read_b64_tr_b16 a[224:225], v228 offset:13312
v_add_f32 v214, v214, v217
v_mfma_f32_16x16x32_bf16 v[144:147], a[192:195], a[104:107], v[144:147]
ds_read_b64_tr_b16 a[226:227], v228 offset:19456
v_cvt_pk_bf16_f32 v170, v216, v217
v_mfma_f32_16x16x32_bf16 v[144:147], a[252:255], a[100:103], v[144:147]
s_bitcmp1_b32 s48, 28
v_exp_f32 v219, v123
v_mfma_f32_16x16x32_bf16 v[144:147], a[248:251], a[96:99], v[144:147]
ds_read_b64_tr_b16 a[228:229], v229 offset:13312
v_add_f32 v214, v214, v218
v_mfma_f32_16x16x32_bf16 v[148:151], a[248:251], a[120:123], v[196:199]
s_cselect_b64 s[50:51], s[30:31], s[28:29]
v_exp_f32 v220, v124
v_mfma_f32_16x16x32_bf16 v[148:151], a[252:255], a[124:127], v[148:151]
ds_read_b64_tr_b16 a[230:231], v229 offset:19456
v_add_f32 v214, v214, v219
v_mfma_f32_16x16x32_bf16 v[148:151], a[192:195], a[128:131], v[148:151]
ds_read_b64_tr_b16 a[232:233], v230 offset:13312
v_cvt_pk_bf16_f32 v171, v218, v219
v_mfma_f32_16x16x32_bf16 v[148:151], a[196:199], a[132:135], v[148:151]
s_bitcmp1_b32 s48, 29
v_exp_f32 v221, v125
v_mfma_f32_16x16x32_bf16 v[148:151], a[200:203], a[136:139], v[148:151]
ds_read_b64_tr_b16 a[234:235], v230 offset:19456
v_add_f32 v215, v215, v220
v_mfma_f32_16x16x32_bf16 v[148:151], a[204:207], a[140:143], v[148:151]
s_cselect_b64 s[8:9], s[50:51], s[26:27]
v_exp_f32 v222, v126
v_mfma_f32_16x16x32_bf16 v[152:155], a[204:207], a[164:167], v[200:203]
ds_read_b64_tr_b16 a[236:237], v231 offset:13312
v_add_u32 v249, s86, v226
v_mfma_f32_16x16x32_bf16 v[152:155], a[200:203], a[160:163], v[152:155]
s_add_u32 m0, s44, s41
v_add_u32 v250, s86, v227
v_add_f32 v215, v215, v221
v_mfma_f32_16x16x32_bf16 v[152:155], a[196:199], a[156:159], v[152:155]
v_exp_f32 v223, v127
v_mfma_f32_16x16x32_bf16 v[152:155], a[192:195], a[152:155], v[152:155]
buffer_load_dwordx4 v234, s[4:7], s43 offen offset:128  lds
v_mfma_f32_16x16x32_bf16 v[152:155], a[252:255], a[148:151], v[152:155]
ds_read_b64_tr_b16 a[238:239], v231 offset:19456
v_cvt_pk_bf16_f32 v174, v220, v221
v_mfma_f32_16x16x32_bf16 v[152:155], a[248:251], a[144:147], v[152:155]
ds_read_b64_tr_b16 a[240:241], v228 offset:14336
v_add_f32 v215, v215, v222
v_mfma_f32_16x16x32_bf16 v[156:159], a[248:251], a[168:171], v[204:207]
s_waitcnt lgkmcnt(7)
v_add_u32 v236, s79, v233
v_add_f32 v215, v215, v223
v_mfma_f32_16x16x32_bf16 v[156:159], a[252:255], a[172:175], v[156:159]
ds_read_b64 v[236:237], v236
v_cvt_pk_bf16_f32 v175, v222, v223
v_mfma_f32_16x16x32_bf16 v[156:159], a[192:195], a[176:179], v[156:159]
ds_read_b64_tr_b16 a[242:243], v228 offset:20480
v_max3_f32 v240, v212, v213, v214
v_mfma_f32_16x16x32_bf16 v[156:159], a[196:199], a[180:183], v[156:159]
ds_read_b64_tr_b16 a[244:245], v229 offset:14336
v_max_f32 v240, v240, v215
v_mfma_f32_16x16x32_bf16 v[156:159], a[200:203], a[184:187], v[156:159]
ds_read_b64_tr_b16 a[246:247], v229 offset:20480
v_cmp_lt_f32 vcc, s52, v240
v_mfma_f32_16x16x32_bf16 v[156:159], a[204:207], a[188:191], v[156:159]
s_cbranch_vccnz L_stub13
L_back13:
v_mfma_f32_16x16x32_bf16 v[0:3], v[160:163], a[208:211], v[0:3]
ds_read_b128 v[96:99], v249 offset:0
v_add_f32 v208, v208, v212
v_mfma_f32_16x16x32_bf16 v[4:7], v[160:163], a[212:215], v[4:7]
ds_read_b128 v[100:103], v250 offset:0
v_add_f32 v209, v209, v213
v_mfma_f32_16x16x32_bf16 v[52:55], v[164:167], a[212:215], v[52:55]
ds_read_b128 v[104:107], v249 offset:1024
v_add_f32 v210, v210, v214
v_mfma_f32_16x16x32_bf16 v[48:51], v[164:167], a[208:211], v[48:51]
ds_read_b128 v[108:111], v250 offset:1024
v_add_f32 v211, v211, v215
v_mfma_f32_16x16x32_bf16 a[0:3], v[168:171], a[208:211], a[0:3]
ds_read_b128 v[112:115], v249 offset:2048
v_add_u32 v251, s88, v242
v_mfma_f32_16x16x32_bf16 a[4:7], v[168:171], a[212:215], a[4:7]
buffer_load_dwordx4 v235, s[4:7], s43 offen offset:3200  lds
v_mfma_f32_16x16x32_bf16 a[52:55], v[172:175], a[212:215], a[52:55]
ds_read_b128 v[116:119], v250 offset:2048
s_add_u32 s82, s82, 1
v_mfma_f32_16x16x32_bf16 a[48:51], v[172:175], a[208:211], a[48:51]
v_exp_f32 v216, v136
v_mfma_f32_16x16x32_bf16 a[56:59], v[172:175], a[216:219], a[56:59]
ds_read_b128 v[120:123], v249 offset:6144
v_readlane_b32 s83, v239, s82
v_exp_f32 v217, v137
s_and_b32 s35, s83, 63
ds_read_b128 v[124:127], v250 offset:6144
s_waitcnt lgkmcnt(5)
v_mfma_f32_16x16x32_bf16 v[176:179], v[96:99], a[96:99], 0
ds_read_b128 v[96:99], v249 offset:7168
v_add_f32 v214, v216, v217
v_mfma_f32_16x16x32_bf16 v[176:179], v[100:103], a[100:103], v[176:179]
ds_read_b128 v[100:103], v250 offset:7168
v_cvt_pk_bf16_f32 v184, v216, v217
v_mfma_f32_16x16x32_bf16 a[60:63], v[172:175], a[220:223], a[60:63]
s_waitcnt lgkmcnt(10)
v_exp_f32 v218, v138
v_mfma_f32_16x16x32_bf16 v[176:179], v[104:107], a[104:107], v[176:179]
s_waitcnt lgkmcnt(4)
v_exp_f32 v219, v139
v_mfma_f32_16x16x32_bf16 v[176:179], v[108:111], a[108:111], v[176:179]
ds_read_b128 v[104:107], v249 offset:8192
v_add_f32 v214, v214, v218
v_mfma_f32_16x16x32_bf16 a[12:15], v[168:171], a[220:223], a[12:15]
ds_read_b128 v[108:111], v250 offset:8192
v_add_f32 v214, v214, v219
v_mfma_f32_16x16x32_bf16 v[176:179], v[112:115], a[112:115], v[176:179]
ds_read_b128 v[112:115], v249 offset:12288
v_cvt_pk_bf16_f32 v185, v218, v219
v_mfma_f32_16x16x32_bf16 v[176:179], v[116:119], a[116:119], v[176:179]
s_add_u32 m0, s44, s42
v_exp_f32 v220, v140
v_mfma_f32_16x16x32_bf16 a[8:11], v[168:171], a[216:219], a[8:11]
ds_read_b128 v[116:119], v250 offset:12288
buffer_load_dwordx4 v234, s[4:7], s43 offen offset:256  lds
s_waitcnt lgkmcnt(5)
v_mfma_f32_16x16x32_bf16 v[180:183], v[120:123], a[96:99], 0
ds_read_b128 v[120:123], v249 offset:13312
v_mfma_f32_16x16x32_bf16 v[180:183], v[124:127], a[100:103], v[180:183]
v_exp_f32 v221, v141
v_mfma_f32_16x16x32_bf16 v[56:59], v[164:167], a[216:219], v[56:59]
ds_read_b128 v[124:127], v250 offset:13312
v_add_f32 v215, v220, v221
v_mfma_f32_16x16x32_bf16 v[180:183], v[96:99], a[104:107], v[180:183]
ds_read_b64_tr_b16 a[248:249], v230 offset:14336
ds_read_b128 v[96:99], v249 offset:14336
v_cvt_pk_bf16_f32 v188, v220, v221
s_waitcnt lgkmcnt(6)
v_mfma_f32_16x16x32_bf16 v[180:183], v[100:103], a[108:111], v[180:183]
v_exp_f32 v222, v142
v_mfma_f32_16x16x32_bf16 v[60:63], v[164:167], a[220:223], v[60:63]
ds_read_b128 v[100:103], v250 offset:14336
v_add_f32 v215, v215, v222
v_mfma_f32_16x16x32_bf16 v[180:183], v[104:107], a[112:115], v[180:183]
ds_read_b64_tr_b16 a[250:251], v230 offset:20480
ds_read_b128 v[104:107], v249 offset:18432
v_mfma_f32_16x16x32_bf16 v[180:183], v[108:111], a[116:119], v[180:183]
s_waitcnt lgkmcnt(6)
v_exp_f32 v223, v143
v_mfma_f32_16x16x32_bf16 v[12:15], v[160:163], a[220:223], v[12:15]
ds_read_b128 v[108:111], v250 offset:18432
v_add_f32 v215, v215, v223
v_mfma_f32_16x16x32_bf16 v[244:247], v[112:115], a[120:123], 0
ds_read_b128 v[112:115], v249 offset:19456
v_cvt_pk_bf16_f32 v189, v222, v223
v_mfma_f32_16x16x32_bf16 v[244:247], v[116:119], a[124:127], v[244:247]
ds_read_b64_tr_b16 a[252:253], v231 offset:14336
ds_read_b128 v[116:119], v250 offset:19456
v_mfma_f32_16x16x32_bf16 v[8:11], v[160:163], a[216:219], v[8:11]
v_exp_f32 v216, v128
v_mfma_f32_16x16x32_bf16 v[244:247], v[120:123], a[128:131], v[244:247]
ds_read_b128 v[120:123], v249 offset:20480
buffer_load_dwordx4 v235, s[4:7], s43 offen offset:3328  lds
s_waitcnt lgkmcnt(7)
v_mfma_f32_16x16x32_bf16 v[244:247], v[124:127], a[132:135], v[244:247]
ds_read_b128 v[124:127], v250 offset:20480
v_sub_f32 v176, v176, v180
v_mfma_f32_16x16x32_bf16 v[16:19], v[160:163], a[224:227], v[16:19]
ds_read_b64_tr_b16 a[254:255], v231 offset:20480
v_sub_f32 v177, v177, v181
v_mfma_f32_16x16x32_bf16 v[244:247], v[96:99], a[136:139], v[244:247]
v_exp_f32 v217, v129
v_mfma_f32_16x16x32_bf16 v[244:247], v[100:103], a[140:143], v[244:247]
s_waitcnt lgkmcnt(5)
v_sub_f32 v178, v178, v182
v_sub_f32 v179, v179, v183
v_mfma_f32_16x16x32_bf16 v[20:23], v[160:163], a[228:231], v[20:23]
v_cndmask_b32 v176, v176, v177, s[64:65]
v_add_f32 v212, v216, v217
v_mfma_f32_16x16x32_bf16 v[252:255], v[104:107], a[120:123], 0
v_cndmask_b32 v176, v176, v178, s[66:67]
v_readlane_b32 s47, v238, s34
v_mfma_f32_16x16x32_bf16 v[252:255], v[108:111], a[124:127], v[252:255]
v_cndmask_b32 v176, v176, v179, s[68:69]
s_and_b32 s49, s47, s70
v_mfma_f32_16x16x32_bf16 v[68:71], v[164:167], a[228:231], v[68:71]
ds_write_b32 v251, v176 offset:0
v_mfma_f32_16x16x32_bf16 v[252:255], v[112:115], a[128:131], v[252:255]
s_waitcnt lgkmcnt(2)
v_cvt_pk_bf16_f32 v176, v216, v217
s_add_u32 m0, s46, s40
v_mfma_f32_16x16x32_bf16 v[252:255], v[116:119], a[132:135], v[252:255]
s_waitcnt vmcnt(12) lgkmcnt(1)
s_barrier
v_mfma_f32_16x16x32_bf16 v[64:67], v[164:167], a[224:227], v[64:67]
ds_read_b128 a[192:195], v226 offset:12288
v_add_u32 v236, v232, v236
v_mfma_f32_16x16x32_bf16 v[252:255], v[120:123], a[136:139], v[252:255]
buffer_load_dwordx4 v236, s[8:11], s45 offen offset:0  lds
v_mfma_f32_16x16x32_bf16 v[252:255], v[124:127], a[140:143], v[252:255]
ds_read_b128 a[196:199], v227 offset:12288
v_xor_b32 v237, v232, v237
v_mfma_f32_16x16x32_bf16 a[16:19], v[168:171], a[224:227], a[16:19]
s_and_b32 s44, s47, s71
v_exp_f32 v218, v130
v_mfma_f32_16x16x32_bf16 a[20:23], v[168:171], a[228:231], a[20:23]
ds_read_b128 a[200:203], v226 offset:13312
v_add_f32 v212, v212, v218
v_mfma_f32_16x16x32_bf16 a[68:71], v[172:175], a[228:231], a[68:71]
buffer_load_dwordx4 v237, s[8:11], s45 offen offset:3072  lds
v_mfma_f32_16x16x32_bf16 a[64:67], v[172:175], a[224:227], a[64:67]
ds_read_b128 a[204:207], v227 offset:13312
v_sub_f32 v244, v244, v252
v_mfma_f32_16x16x32_bf16 a[72:75], v[172:175], a[232:235], a[72:75]
s_lshr_b32 s43, s47, 8
v_exp_f32 v219, v131
v_mfma_f32_16x16x32_bf16 a[76:79], v[172:175], a[236:239], a[76:79]
s_and_b32 s43, s43, s71
v_exp_f32 v220, v132
v_mfma_f32_16x16x32_bf16 a[28:31], v[168:171], a[236:239], a[28:31]
s_add_u32 m0, s46, s41
v_sub_f32 v245, v245, v253
v_sub_f32 v246, v246, v254
v_mfma_f32_16x16x32_bf16 a[24:27], v[168:171], a[232:235], a[24:27]
buffer_load_dwordx4 v236, s[8:11], s45 offen offset:128  lds
v_mfma_f32_16x16x32_bf16 v[72:75], v[164:167], a[232:235], v[72:75]
s_bitcmp1_b32 s47, 28
v_sub_f32 v247, v247, v255
v_cndmask_b32 v244, v244, v245, s[64:65]
v_mfma_f32_16x16x32_bf16 v[76:79], v[164:167], a[236:239], v[76:79]
s_cselect_b64 s[50:51], s[30:31], s[28:29]
v_cndmask_b32 v244, v244, v246, s[66:67]
v_add_f32 v212, v212, v219
v_mfma_f32_16x16x32_bf16 v[28:31], v[160:163], a[236:239], v[28:31]
s_bitcmp1_b32 s47, 29
v_cndmask_b32 v244, v244, v247, s[68:69]
v_cvt_pk_bf16_f32 v177, v218, v219
v_mfma_f32_16x16x32_bf16 v[24:27], v[160:163], a[232:235], v[24:27]
ds_write_b32 v251, v244 offset:64
v_mfma_f32_16x16x32_bf16 v[32:35], v[160:163], a[240:243], v[32:35]
ds_read_b128 a[208:211], v226 offset:14336
s_cselect_b64 s[4:5], s[50:51], s[24:25]
v_mfma_f32_16x16x32_bf16 v[36:39], v[160:163], a[244:247], v[36:39]
ds_read_b128 a[212:215], v227 offset:14336
v_mfma_f32_16x16x32_bf16 v[84:87], v[164:167], a[244:247], v[84:87]
ds_read_b128 a[216:219], v226 offset:18432
v_add_u32 v234, s49, v233
v_mfma_f32_16x16x32_bf16 v[80:83], v[164:167], a[240:243], v[80:83]
v_exp_f32 v221, v133
v_mfma_f32_16x16x32_bf16 a[32:35], v[168:171], a[240:243], a[32:35]
buffer_load_dwordx4 v237, s[8:11], s45 offen offset:3200  lds
v_mfma_f32_16x16x32_bf16 a[36:39], v[168:171], a[244:247], a[36:39]
ds_read_b128 a[220:223], v227 offset:18432
v_add_f32 v213, v220, v221
v_mfma_f32_16x16x32_bf16 a[84:87], v[172:175], a[244:247], a[84:87]
s_add_u32 m0, s46, s42
v_exp_f32 v222, v134
v_mfma_f32_16x16x32_bf16 a[80:83], v[172:175], a[240:243], a[80:83]
ds_read_b128 a[224:227], v226 offset:19456
v_cvt_pk_bf16_f32 v180, v220, v221
v_mfma_f32_16x16x32_bf16 a[88:91], v[172:175], a[248:251], a[88:91]
buffer_load_dwordx4 v236, s[8:11], s45 offen offset:256  lds
v_mfma_f32_16x16x32_bf16 a[92:95], v[172:175], a[252:255], a[92:95]
ds_read_b128 a[228:231], v227 offset:19456
v_add_f32 v213, v213, v222
v_mfma_f32_16x16x32_bf16 a[44:47], v[168:171], a[252:255], a[44:47]
s_add_u32 s34, s34, 1
v_exp_f32 v223, v135
v_mfma_f32_16x16x32_bf16 a[40:43], v[168:171], a[248:251], a[40:43]
ds_read_b64 v[234:235], v234
v_add_f32 v213, v213, v223
v_mfma_f32_16x16x32_bf16 v[88:91], v[164:167], a[248:251], v[88:91]
ds_read_b128 a[232:235], v226 offset:20480
v_cvt_pk_bf16_f32 v181, v222, v223
v_mfma_f32_16x16x32_bf16 v[92:95], v[164:167], a[252:255], v[92:95]
buffer_load_dwordx4 v237, s[8:11], s45 offen offset:3328  lds
v_mfma_f32_16x16x32_bf16 v[44:47], v[160:163], a[252:255], v[44:47]
ds_read_b128 a[236:239], v227 offset:20480
s_waitcnt lgkmcnt(7)
v_mfma_f32_16x16x32_bf16 v[40:43], v[160:163], a[248:251], v[40:43]
s_bitcmp1_b32 s95, 5
s_cbranch_scc1 L_loopc0
s_bitcmp1_b32 s95, 6
s_cbranch_scc0 L_loop0
s_branch L_loopb0
L_ev1:
v_mfma_f32_16x16x32_bf16 v[128:131], a[244:247], a[116:119], v[192:195]
v_exp_f32 v216, v112
v_mfma_f32_16x16x32_bf16 v[128:131], a[240:243], a[112:115], v[128:131]
v_exp_f32 v217, v113
v_mfma_f32_16x16x32_bf16 v[128:131], a[236:239], a[108:111], v[128:131]
v_readlane_b32 s48, v239, s34
v_add_f32 v212, v212, v216
v_mfma_f32_16x16x32_bf16 v[128:131], a[232:235], a[104:107], v[128:131]
v_exp_f32 v218, v114
v_mfma_f32_16x16x32_bf16 v[128:131], a[228:231], a[100:103], v[128:131]
v_exp_f32 v219, v115
v_mfma_f32_16x16x32_bf16 v[128:131], a[224:227], a[96:99], v[128:131]
s_and_b32 s79, s48, s70
v_exp_f32 v220, v116
v_mfma_f32_16x16x32_bf16 v[132:135], a[224:227], a[120:123], v[196:199]
s_waitcnt vmcnt(12) lgkmcnt(0)
s_barrier
v_mfma_f32_16x16x32_bf16 v[132:135], a[228:231], a[124:127], v[132:135]
v_add_f32 v212, v212, v217
v_cvt_pk_bf16_f32 v162, v216, v217
v_mfma_f32_16x16x32_bf16 v[132:135], a[232:235], a[128:131], v[132:135]
ds_read_b64_tr_b16 a[208:209], v228 offset:12288
v_add_f32 v212, v212, v218
v_mfma_f32_16x16x32_bf16 v[132:135], a[236:239], a[132:135], v[132:135]
s_add_u32 m0, s44, s40
v_add_f32 v212, v212, v219
v_cvt_pk_bf16_f32 v163, v218, v219
v_mfma_f32_16x16x32_bf16 v[132:135], a[240:243], a[136:139], v[132:135]
ds_read_b64_tr_b16 a[210:211], v228 offset:18432
v_add_f32 v213, v213, v220
v_mfma_f32_16x16x32_bf16 v[132:135], a[244:247], a[140:143], v[132:135]
s_and_b32 s46, s48, s71
v_exp_f32 v221, v117
v_mfma_f32_16x16x32_bf16 v[136:139], a[244:247], a[164:167], v[200:203]
ds_read_b64_tr_b16 a[212:213], v229 offset:12288
v_add_u32 v234, v232, v234
v_mfma_f32_16x16x32_bf16 v[136:139], a[240:243], a[160:163], v[136:139]
buffer_load_dwordx4 v234, s[4:7], s43 offen offset:0  lds
v_mfma_f32_16x16x32_bf16 v[136:139], a[236:239], a[156:159], v[136:139]
s_and_b32 s86, s83, s71
v_xor_b32 v235, v232, v235
v_add_f32 v213, v213, v221
v_mfma_f32_16x16x32_bf16 v[136:139], a[232:235], a[152:155], v[136:139]
s_lshr_b32 s45, s48, 8
v_exp_f32 v222, v118
v_mfma_f32_16x16x32_bf16 v[136:139], a[228:231], a[148:151], v[136:139]
ds_read_b64_tr_b16 a[214:215], v229 offset:18432
v_cvt_pk_bf16_f32 v166, v220, v221
v_mfma_f32_16x16x32_bf16 v[136:139], a[224:227], a[144:147], v[136:139]
s_sub_u32 s86, s86, s84
v_exp_f32 v223, v119
v_mfma_f32_16x16x32_bf16 v[140:143], a[224:227], a[168:171], v[204:207]
ds_read_b64_tr_b16 a[216:217], v230 offset:12288
v_add_f32 v213, v213, v222
v_mfma_f32_16x16x32_bf16 v[140:143], a[228:231], a[172:175], v[140:143]
ds_read_b64_tr_b16 a[218:219], v230 offset:18432
v_add_f32 v213, v213, v223
v_mfma_f32_16x16x32_bf16 v[140:143], a[232:235], a[176:179], v[140:143]
s_lshr_b32 s88, s83, 20
v_exp_f32 v216, v120
v_mfma_f32_16x16x32_bf16 v[140:143], a[236:239], a[180:183], v[140:143]
ds_read_b64_tr_b16 a[220:221], v231 offset:12288
v_cvt_pk_bf16_f32 v167, v222, v223
v_mfma_f32_16x16x32_bf16 v[140:143], a[240:243], a[184:187], v[140:143]
s_and_b32 s45, s45, s71
v_exp_f32 v217, v121
v_mfma_f32_16x16x32_bf16 v[140:143], a[244:247], a[188:191], v[140:143]
ds_read_b64_tr_b16 a[222:223], v231 offset:18432
v_add_f32 v214, v214, v216
v_mfma_f32_16x16x32_bf16 v[144:147], a[204:207], a[116:119], v[192:195]
buffer_load_dwordx4 v235, s[4:7], s43 offen offset:3072  lds
v_mfma_f32_16x16x32_bf16 v[144:147], a[200:203], a[112:115], v[144:147]
s_lshl_b32 s88, s88, 6
v_exp_f32 v218, v122
v_mfma_f32_16x16x32_bf16 v[144:147], a[196:199], a[108:111], v[144:147]
ds_read_b64_tr_b16 a[224:225], v228 offset:13312
v_add_f32 v214, v214, v217
v_mfma_f32_16x16x32_bf16 v[144:147], a[192:195], a[104:107], v[144:147]
ds_read_b64_tr_b16 a[226:227], v228 offset:19456
v_cvt_pk_bf16_f32 v170, v216, v217
v_mfma_f32_16x16x32_bf16 v[144:147], a[252:255], a[100:103], v[144:147]
s_bitcmp1_b32 s48, 28
v_exp_f32 v219, v123
v_mfma_f32_16x16x32_bf16 v[144:147], a[248:251], a[96:99], v[144:147]
ds_read_b64_tr_b16 a[228:229], v229 offset:13312
v_add_f32 v214, v214, v218
v_mfma_f32_16x16x32_bf16 v[148:151], a[248:251], a[120:123], v[196:199]
s_cselect_b64 s[50:51], s[30:31], s[28:29]
v_exp_f32 v220, v124
v_mfma_f32_16x16x32_bf16 v[148:151], a[252:255], a[124:127], v[148:151]
ds_read_b64_tr_b16 a[230:231], v229 offset:19456
v_add_f32 v214, v214, v219
v_mfma_f32_16x16x32_bf16 v[148:151], a[192:195], a[128:131], v[148:151]
ds_read_b64_tr_b16 a[232:233], v230 offset:13312
v_cvt_pk_bf16_f32 v171, v218, v219
v_mfma_f32_16x16x32_bf16 v[148:151], a[196:199], a[132:135], v[148:151]
s_bitcmp1_b32 s48, 29
v_exp_f32 v221, v125
v_mfma_f32_16x16x32_bf16 v[148:151], a[200:203], a[136:139], v[148:151]
ds_read_b64_tr_b16 a[234:235], v230 offset:19456
v_add_f32 v215, v215, v220
v_mfma_f32_16x16x32_bf16 v[148:151], a[204:207], a[140:143], v[148:151]
s_cselect_b64 s[8:9], s[50:51], s[26:27]
v_exp_f32 v222, v126
v_mfma_f32_16x16x32_bf16 v[152:155], a[204:207], a[164:167], v[200:203]
ds_read_b64_tr_b16 a[236:237], v231 offset:13312
v_add_u32 v249, s86, v226
v_mfma_f32_16x16x32_bf16 v[152:155], a[200:203], a[160:163], v[152:155]
s_add_u32 m0, s44, s41
v_add_u32 v250, s86, v227
v_add_f32 v215, v215, v221
v_mfma_f32_16x16x32_bf16 v[152:155], a[196:199], a[156:159], v[152:155]
v_exp_f32 v223, v127
v_mfma_f32_16x16x32_bf16 v[152:155], a[192:195], a[152:155], v[152:155]
buffer_load_dwordx4 v234, s[4:7], s43 offen offset:128  lds
v_mfma_f32_16x16x32_bf16 v[152:155], a[252:255], a[148:151], v[152:155]
ds_read_b64_tr_b16 a[238:239], v231 offset:19456
v_cvt_pk_bf16_f32 v174, v220, v221
v_mfma_f32_16x16x32_bf16 v[152:155], a[248:251], a[144:147], v[152:155]
ds_read_b64_tr_b16 a[240:241], v228 offset:14336
v_add_f32 v215, v215, v222
v_mfma_f32_16x16x32_bf16 v[156:159], a[248:251], a[168:171], v[204:207]
s_waitcnt lgkmcnt(7)
v_add_u32 v236, s79, v233
v_add_f32 v215, v215, v223
v_mfma_f32_16x16x32_bf16 v[156:159], a[252:255], a[172:175], v[156:159]
ds_read_b64 v[236:237], v236
v_cvt_pk_bf16_f32 v175, v222, v223
v_mfma_f32_16x16x32_bf16 v[156:159], a[192:195], a[176:179], v[156:159]
ds_read_b64_tr_b16 a[242:243], v228 offset:20480
v_max3_f32 v240, v212, v213, v214
v_mfma_f32_16x16x32_bf16 v[156:159], a[196:199], a[180:183], v[156:159]
ds_read_b64_tr_b16 a[244:245], v229 offset:14336
v_max_f32 v240, v240, v215
v_mfma_f32_16x16x32_bf16 v[156:159], a[200:203], a[184:187], v[156:159]
ds_read_b64_tr_b16 a[246:247], v229 offset:20480
v_cmp_lt_f32 vcc, s52, v240
v_mfma_f32_16x16x32_bf16 v[156:159], a[204:207], a[188:191], v[156:159]
s_cbranch_vccnz L_stub14
L_back14:
v_mfma_f32_16x16x32_bf16 v[0:3], v[160:163], a[208:211], v[0:3]
ds_read_b128 v[96:99], v249 offset:0
v_add_f32 v208, v208, v212
v_mfma_f32_16x16x32_bf16 v[4:7], v[160:163], a[212:215], v[4:7]
ds_read_b128 v[100:103], v250 offset:0
v_add_f32 v209, v209, v213
v_mfma_f32_16x16x32_bf16 v[52:55], v[164:167], a[212:215], v[52:55]
ds_read_b128 v[104:107], v249 offset:1024
v_add_f32 v210, v210, v214
v_mfma_f32_16x16x32_bf16 v[48:51], v[164:167], a[208:211], v[48:51]
ds_read_b128 v[108:111], v250 offset:1024
v_add_f32 v211, v211, v215
v_mfma_f32_16x16x32_bf16 a[0:3], v[168:171], a[208:211], a[0:3]
ds_read_b128 v[112:115], v249 offset:2048
v_add_u32 v251, s88, v242
v_mfma_f32_16x16x32_bf16 a[4:7], v[168:171], a[212:215], a[4:7]
buffer_load_dwordx4 v235, s[4:7], s43 offen offset:3200  lds
v_mfma_f32_16x16x32_bf16 a[52:55], v[172:175], a[212:215], a[52:55]
ds_read_b128 v[116:119], v250 offset:2048
s_add_u32 s82, s82, 1
v_mfma_f32_16x16x32_bf16 a[48:51], v[172:175], a[208:211], a[48:51]
v_exp_f32 v216, v136
v_mfma_f32_16x16x32_bf16 a[56:59], v[172:175], a[216:219], a[56:59]
ds_read_b128 v[120:123], v249 offset:6144
v_readlane_b32 s83, v239, s82
v_exp_f32 v217, v137
s_and_b32 s35, s83, 63
ds_read_b128 v[124:127], v250 offset:6144
s_waitcnt lgkmcnt(5)
v_mfma_f32_16x16x32_bf16 v[176:179], v[96:99], a[144:147], 0
ds_read_b128 v[96:99], v249 offset:7168
v_add_f32 v214, v216, v217
v_mfma_f32_16x16x32_bf16 v[176:179], v[100:103], a[148:151], v[176:179]
ds_read_b128 v[100:103], v250 offset:7168
v_cvt_pk_bf16_f32 v184, v216, v217
v_mfma_f32_16x16x32_bf16 a[60:63], v[172:175], a[220:223], a[60:63]
s_waitcnt lgkmcnt(10)
v_exp_f32 v218, v138
v_mfma_f32_16x16x32_bf16 v[176:179], v[104:107], a[152:155], v[176:179]
s_waitcnt lgkmcnt(4)
v_exp_f32 v219, v139
v_mfma_f32_16x16x32_bf16 v[176:179], v[108:111], a[156:159], v[176:179]
ds_read_b128 v[104:107], v249 offset:8192
v_add_f32 v214, v214, v218
v_mfma_f32_16x16x32_bf16 a[12:15], v[168:171], a[220:223], a[12:15]
ds_read_b128 v[108:111], v250 offset:8192
v_add_f32 v214, v214, v219
v_mfma_f32_16x16x32_bf16 v[176:179], v[112:115], a[160:163], v[176:179]
ds_read_b128 v[112:115], v249 offset:12288
v_cvt_pk_bf16_f32 v185, v218, v219
v_mfma_f32_16x16x32_bf16 v[176:179], v[116:119], a[164:167], v[176:179]
s_add_u32 m0, s44, s42
v_exp_f32 v220, v140
v_mfma_f32_16x16x32_bf16 a[8:11], v[168:171], a[216:219], a[8:11]
ds_read_b128 v[116:119], v250 offset:12288
buffer_load_dwordx4 v234, s[4:7], s43 offen offset:256  lds
s_waitcnt lgkmcnt(5)
v_mfma_f32_16x16x32_bf16 v[180:183], v[120:123], a[144:147], 0
ds_read_b128 v[120:123], v249 offset:13312
v_mfma_f32_16x16x32_bf16 v[180:183], v[124:127], a[148:151], v[180:183]
v_exp_f32 v221, v141
v_mfma_f32_16x16x32_bf16 v[56:59], v[164:167], a[216:219], v[56:59]
ds_read_b128 v[124:127], v250 offset:13312
v_add_f32 v215, v220, v221
v_mfma_f32_16x16x32_bf16 v[180:183], v[96:99], a[152:155], v[180:183]
ds_read_b64_tr_b16 a[248:249], v230 offset:14336
ds_read_b128 v[96:99], v249 offset:14336
v_cvt_pk_bf16_f32 v188, v220, v221
s_waitcnt lgkmcnt(6)
v_mfma_f32_16x16x32_bf16 v[180:183], v[100:103], a[156:159], v[180:183]
v_exp_f32 v222, v142
v_mfma_f32_16x16x32_bf16 v[60:63], v[164:167], a[220:223], v[60:63]
ds_read_b128 v[100:103], v250 offset:14336
v_add_f32 v215, v215, v222
v_mfma_f32_16x16x32_bf16 v[180:183], v[104:107], a[160:163], v[180:183]
ds_read_b64_tr_b16 a[250:251], v230 offset:20480
ds_read_b128 v[104:107], v249 offset:18432
v_mfma_f32_16x16x32_bf16 v[180:183], v[108:111], a[164:167], v[180:183]
s_waitcnt lgkmcnt(6)
v_exp_f32 v223, v143
v_mfma_f32_16x16x32_bf16 v[12:15], v[160:163], a[220:223], v[12:15]
ds_read_b128 v[108:111], v250 offset:18432
v_add_f32 v215, v215, v223
v_mfma_f32_16x16x32_bf16 v[244:247], v[112:115], a[168:171], 0
ds_read_b128 v[112:115], v249 offset:19456
v_cvt_pk_bf16_f32 v189, v222, v223
v_mfma_f32_16x16x32_bf16 v[244:247], v[116:119], a[172:175], v[244:247]
ds_read_b64_tr_b16 a[252:253], v231 offset:14336
ds_read_b128 v[116:119], v250 offset:19456
v_mfma_f32_16x16x32_bf16 v[8:11], v[160:163], a[216:219], v[8:11]
v_exp_f32 v216, v128
v_mfma_f32_16x16x32_bf16 v[244:247], v[120:123], a[176:179], v[244:247]
ds_read_b128 v[120:123], v249 offset:20480
buffer_load_dwordx4 v235, s[4:7], s43 offen offset:3328  lds
s_waitcnt lgkmcnt(7)
v_mfma_f32_16x16x32_bf16 v[244:247], v[124:127], a[180:183], v[244:247]
ds_read_b128 v[124:127], v250 offset:20480
v_sub_f32 v176, v176, v180
v_mfma_f32_16x16x32_bf16 v[16:19], v[160:163], a[224:227], v[16:19]
ds_read_b64_tr_b16 a[254:255], v231 offset:20480
v_sub_f32 v177, v177, v181
v_mfma_f32_16x16x32_bf16 v[244:247], v[96:99], a[184:187], v[244:247]
v_exp_f32 v217, v129
v_mfma_f32_16x16x32_bf16 v[244:247], v[100:103], a[188:191], v[244:247]
s_waitcnt lgkmcnt(5)
v_sub_f32 v178, v178, v182
v_sub_f32 v179, v179, v183
v_mfma_f32_16x16x32_bf16 v[20:23], v[160:163], a[228:231], v[20:23]
v_cndmask_b32 v176, v176, v177, s[64:65]
v_add_f32 v212, v216, v217
v_mfma_f32_16x16x32_bf16 v[252:255], v[104:107], a[168:171], 0
v_cndmask_b32 v176, v176, v178, s[66:67]
v_readlane_b32 s47, v238, s34
v_mfma_f32_16x16x32_bf16 v[252:255], v[108:111], a[172:175], v[252:255]
v_cndmask_b32 v176, v176, v179, s[68:69]
s_and_b32 s49, s47, s70
v_mfma_f32_16x16x32_bf16 v[68:71], v[164:167], a[228:231], v[68:71]
ds_write_b32 v251, v176 offset:0
v_mfma_f32_16x16x32_bf16 v[252:255], v[112:115], a[176:179], v[252:255]
s_waitcnt lgkmcnt(2)
v_cvt_pk_bf16_f32 v176, v216, v217
s_add_u32 m0, s46, s40
v_mfma_f32_16x16x32_bf16 v[252:255], v[116:119], a[180:183], v[252:255]
s_waitcnt vmcnt(12) lgkmcnt(1)
s_barrier
v_mfma_f32_16x16x32_bf16 v[64:67], v[164:167], a[224:227], v[64:67]
ds_read_b128 a[192:195], v226 offset:12288
v_add_u32 v236, v232, v236
v_mfma_f32_16x16x32_bf16 v[252:255], v[120:123], a[184:187], v[252:255]
buffer_load_dwordx4 v236, s[8:11], s45 offen offset:0  lds
v_mfma_f32_16x16x32_bf16 v[252:255], v[124:127], a[188:191], v[252:255]
ds_read_b128 a[196:199], v227 offset:12288
v_xor_b32 v237, v232, v237
v_mfma_f32_16x16x32_bf16 a[16:19], v[168:171], a[224:227], a[16:19]
s_and_b32 s44, s47, s71
v_exp_f32 v218, v130
v_mfma_f32_16x16x32_bf16 a[20:23], v[168:171], a[228:231], a[20:23]
ds_read_b128 a[200:203], v226 offset:13312
v_add_f32 v212, v212, v218
v_mfma_f32_16x16x32_bf16 a[68:71], v[172:175], a[228:231], a[68:71]
buffer_load_dwordx4 v237, s[8:11], s45 offen offset:3072  lds
v_mfma_f32_16x16x32_bf16 a[64:67], v[172:175], a[224:227], a[64:67]
ds_read_b128 a[204:207], v227 offset:13312
v_sub_f32 v244, v244, v252
v_mfma_f32_16x16x32_bf16 a[72:75], v[172:175], a[232:235], a[72:75]
s_lshr_b32 s43, s47, 8
v_exp_f32 v219, v131
v_mfma_f32_16x16x32_bf16 a[76:79], v[172:175], a[236:239], a[76:79]
s_and_b32 s43, s43, s71
v_exp_f32 v220, v132
v_mfma_f32_16x16x32_bf16 a[28:31], v[168:171], a[236:239], a[28:31]
s_add_u32 m0, s46, s41
v_sub_f32 v245, v245, v253
v_sub_f32 v246, v246, v254
v_mfma_f32_16x16x32_bf16 a[24:27], v[168:171], a[232:235], a[24:27]
buffer_load_dwordx4 v236, s[8:11], s45 offen offset:128  lds
v_mfma_f32_16x16x32_bf16 v[72:75], v[164:167], a[232:235], v[72:75]
s_bitcmp1_b32 s47, 28
v_sub_f32 v247, v247, v255
v_cndmask_b32 v244, v244, v245, s[64:65]
v_mfma_f32_16x16x32_bf16 v[76:79], v[164:167], a[236:239], v[76:79]
s_cselect_b64 s[50:51], s[30:31], s[28:29]
v_cndmask_b32 v244, v244, v246, s[66:67]
v_add_f32 v212, v212, v219
v_mfma_f32_16x16x32_bf16 v[28:31], v[160:163], a[236:239], v[28:31]
s_bitcmp1_b32 s47, 29
v_cndmask_b32 v244, v244, v247, s[68:69]
v_cvt_pk_bf16_f32 v177, v218, v219
v_mfma_f32_16x16x32_bf16 v[24:27], v[160:163], a[232:235], v[24:27]
ds_write_b32 v251, v244 offset:64
v_mfma_f32_16x16x32_bf16 v[32:35], v[160:163], a[240:243], v[32:35]
ds_read_b128 a[208:211], v226 offset:14336
s_cselect_b64 s[4:5], s[50:51], s[24:25]
v_mfma_f32_16x16x32_bf16 v[36:39], v[160:163], a[244:247], v[36:39]
ds_read_b128 a[212:215], v227 offset:14336
v_mfma_f32_16x16x32_bf16 v[84:87], v[164:167], a[244:247], v[84:87]
ds_read_b128 a[216:219], v226 offset:18432
v_add_u32 v234, s49, v233
v_mfma_f32_16x16x32_bf16 v[80:83], v[164:167], a[240:243], v[80:83]
v_exp_f32 v221, v133
v_mfma_f32_16x16x32_bf16 a[32:35], v[168:171], a[240:243], a[32:35]
buffer_load_dwordx4 v237, s[8:11], s45 offen offset:3200  lds
v_mfma_f32_16x16x32_bf16 a[36:39], v[168:171], a[244:247], a[36:39]
ds_read_b128 a[220:223], v227 offset:18432
v_add_f32 v213, v220, v221
v_mfma_f32_16x16x32_bf16 a[84:87], v[172:175], a[244:247], a[84:87]
s_add_u32 m0, s46, s42
v_exp_f32 v222, v134
v_mfma_f32_16x16x32_bf16 a[80:83], v[172:175], a[240:243], a[80:83]
ds_read_b128 a[224:227], v226 offset:19456
v_cvt_pk_bf16_f32 v180, v220, v221
v_mfma_f32_16x16x32_bf16 a[88:91], v[172:175], a[248:251], a[88:91]
buffer_load_dwordx4 v236, s[8:11], s45 offen offset:256  lds
v_mfma_f32_16x16x32_bf16 a[92:95], v[172:175], a[252:255], a[92:95]
ds_read_b128 a[228:231], v227 offset:19456
v_add_f32 v213, v213, v222
v_mfma_f32_16x16x32_bf16 a[44:47], v[168:171], a[252:255], a[44:47]
s_add_u32 s34, s34, 1
v_exp_f32 v223, v135
v_mfma_f32_16x16x32_bf16 a[40:43], v[168:171], a[248:251], a[40:43]
ds_read_b64 v[234:235], v234
v_add_f32 v213, v213, v223
v_mfma_f32_16x16x32_bf16 v[88:91], v[164:167], a[248:251], v[88:91]
ds_read_b128 a[232:235], v226 offset:20480
v_cvt_pk_bf16_f32 v181, v222, v223
v_mfma_f32_16x16x32_bf16 v[92:95], v[164:167], a[252:255], v[92:95]
buffer_load_dwordx4 v237, s[8:11], s45 offen offset:3328  lds
v_mfma_f32_16x16x32_bf16 v[44:47], v[160:163], a[252:255], v[44:47]
ds_read_b128 a[236:239], v227 offset:20480
s_waitcnt lgkmcnt(7)
v_mfma_f32_16x16x32_bf16 v[40:43], v[160:163], a[248:251], v[40:43]
s_bitcmp1_b32 s95, 5
s_cbranch_scc1 L_loopc0
s_bitcmp1_b32 s95, 6
s_cbranch_scc0 L_loop0
s_branch L_loopb0
L_d1x:
s_cmp_eq_u32 s34, 34
s_cbranch_scc1 L_last
v_mov_b32 v96, 0xff800000
v_mov_b32 v97, 0xff800000
v_mov_b32 v98, 0xff800000
v_mov_b32 v99, 0xff800000
v_exp_f32 v216, v144
v_readlane_b32 s48, v239, s34
v_mov_b32 v243, 0xff800000
v_exp_f32 v217, v145
v_add_f32 v212, v212, v216
v_exp_f32 v218, v146
v_add_f32 v212, v212, v217
v_cvt_pk_bf16_f32 v178, v216, v217
v_exp_f32 v219, v147
v_add_f32 v212, v212, v218
s_and_b32 s79, s48, s70
v_add_f32 v212, v212, v219
v_cvt_pk_bf16_f32 v179, v218, v219
v_exp_f32 v220, v148
v_mov_b32 v100, 0xff800000
s_waitcnt vmcnt(12) lgkmcnt(0)
s_barrier
v_add_f32 v213, v213, v220
v_mov_b32 v101, 0xff800000
v_mov_b32 v102, 0xff800000
v_mov_b32 v103, 0xff800000
v_add_u32 v234, v232, v234
v_xor_b32 v235, v232, v235
s_add_u32 m0, s44, s40
ds_read_b64_tr_b16 a[240:241], v228 offset:0
buffer_load_dwordx4 v234, s[4:7], s43 offen offset:0  lds
s_and_b32 s46, s48, s71
ds_read_b64_tr_b16 a[242:243], v228 offset:6144
v_exp_f32 v221, v149
s_nop 0
v_add_f32 v213, v213, v221
v_mfma_f32_16x16x32_bf16 v[104:107], a[212:215], a[164:167], v[200:203]
ds_read_b64_tr_b16 a[244:245], v229 offset:0
v_cvt_pk_bf16_f32 v182, v220, v221
v_mfma_f32_16x16x32_bf16 v[104:107], a[208:211], a[160:163], v[104:107]
s_lshr_b32 s45, s48, 8
v_exp_f32 v222, v150
v_mfma_f32_16x16x32_bf16 v[104:107], a[204:207], a[156:159], v[104:107]
ds_read_b64_tr_b16 a[246:247], v229 offset:6144
v_add_f32 v213, v213, v222
v_mfma_f32_16x16x32_bf16 v[104:107], a[200:203], a[152:155], v[104:107]
v_mfma_f32_16x16x32_bf16 v[104:107], a[196:199], a[148:151], v[104:107]
v_exp_f32 v223, v151
v_mfma_f32_16x16x32_bf16 v[104:107], a[192:195], a[144:147], v[104:107]
ds_read_b64_tr_b16 a[248:249], v230 offset:0
v_add_f32 v213, v213, v223
v_mfma_f32_16x16x32_bf16 v[108:111], a[192:195], a[168:171], v[204:207]
ds_read_b64_tr_b16 a[250:251], v230 offset:6144
v_cvt_pk_bf16_f32 v183, v222, v223
v_mfma_f32_16x16x32_bf16 v[108:111], a[196:199], a[172:175], v[108:111]
s_and_b32 s45, s45, s71
v_exp_f32 v216, v152
v_mfma_f32_16x16x32_bf16 v[108:111], a[200:203], a[176:179], v[108:111]
buffer_load_dwordx4 v235, s[4:7], s43 offen offset:3072  lds
v_mfma_f32_16x16x32_bf16 v[108:111], a[204:207], a[180:183], v[108:111]
ds_read_b64_tr_b16 a[252:253], v231 offset:0
v_add_f32 v214, v214, v216
v_mfma_f32_16x16x32_bf16 v[108:111], a[208:211], a[184:187], v[108:111]
s_bitcmp1_b32 s48, 28
v_exp_f32 v217, v153
v_mfma_f32_16x16x32_bf16 v[108:111], a[212:215], a[188:191], v[108:111]
s_cselect_b64 s[50:51], s[30:31], s[28:29]
v_cndmask_b32 v104, v104, v243, s[56:57]
v_cndmask_b32 v105, v105, v243, s[58:59]
v_cndmask_b32 v106, v106, v243, s[60:61]
v_cndmask_b32 v107, v107, v243, s[62:63]
v_add_f32 v214, v214, v217
v_cvt_pk_bf16_f32 v186, v216, v217
v_exp_f32 v218, v154
v_mov_b32 v112, 0xff800000
v_mov_b32 v113, 0xff800000
v_mov_b32 v114, 0xff800000
v_mov_b32 v115, 0xff800000
v_add_f32 v214, v214, v218
v_exp_f32 v219, v155
s_add_u32 m0, s44, s41
ds_read_b64_tr_b16 a[254:255], v231 offset:6144
ds_read_b64_tr_b16 a[192:193], v228 offset:1024
ds_read_b64_tr_b16 a[194:195], v228 offset:7168
ds_read_b64_tr_b16 a[196:197], v229 offset:1024
buffer_load_dwordx4 v234, s[4:7], s43 offen offset:128  lds
v_add_f32 v214, v214, v219
v_cvt_pk_bf16_f32 v187, v218, v219
s_bitcmp1_b32 s48, 29
s_cselect_b64 s[8:9], s[50:51], s[26:27]
v_exp_f32 v220, v156
v_mov_b32 v116, 0xff800000
v_mov_b32 v117, 0xff800000
v_mov_b32 v118, 0xff800000
v_mov_b32 v119, 0xff800000
v_add_f32 v215, v215, v220
ds_read_b64_tr_b16 a[198:199], v229 offset:7168
ds_read_b64_tr_b16 a[200:201], v230 offset:1024
v_exp_f32 v221, v157
ds_read_b64_tr_b16 a[202:203], v230 offset:7168
v_add_f32 v215, v215, v221
v_cvt_pk_bf16_f32 v190, v220, v221
v_exp_f32 v222, v158
ds_read_b64_tr_b16 a[204:205], v231 offset:1024
v_add_f32 v215, v215, v222
v_mov_b32 v120, 0xff800000
v_mov_b32 v121, 0xff800000
v_mov_b32 v122, 0xff800000
v_mov_b32 v123, 0xff800000
v_add_u32 v236, s79, v233
v_exp_f32 v223, v159
buffer_load_dwordx4 v235, s[4:7], s43 offen offset:3200  lds
ds_read_b64_tr_b16 a[206:207], v231 offset:7168
v_add_f32 v215, v215, v223
v_cvt_pk_bf16_f32 v191, v222, v223
s_waitcnt lgkmcnt(6)
ds_read_b64_tr_b16 a[208:209], v228 offset:2048
ds_read_b64 v[236:237], v236
v_mfma_f32_16x16x32_bf16 v[124:127], a[216:219], a[168:171], v[204:207]
ds_read_b64_tr_b16 a[210:211], v228 offset:8192
v_mfma_f32_16x16x32_bf16 v[124:127], a[220:223], a[172:175], v[124:127]
v_mfma_f32_16x16x32_bf16 v[124:127], a[224:227], a[176:179], v[124:127]
ds_read_b64_tr_b16 a[212:213], v229 offset:2048
v_max3_f32 v240, v212, v213, v214
v_mfma_f32_16x16x32_bf16 v[124:127], a[228:231], a[180:183], v[124:127]
v_max_f32 v240, v240, v215
s_add_u32 m0, s44, s42
v_mfma_f32_16x16x32_bf16 v[124:127], a[232:235], a[184:187], v[124:127]
ds_read_b64_tr_b16 a[214:215], v229 offset:8192
v_cmp_lt_f32 vcc, s52, v240
v_mfma_f32_16x16x32_bf16 v[124:127], a[236:239], a[188:191], v[124:127]
s_cbranch_vccnz L_stub15
L_back15:
v_mfma_f32_16x16x32_bf16 v[0:3], v[176:179], a[240:243], v[0:3]
buffer_load_dwordx4 v234, s[4:7], s43 offen offset:256  lds
v_mfma_f32_16x16x32_bf16 v[4:7], v[176:179], a[244:247], v[4:7]
ds_read_b64_tr_b16 a[216:217], v230 offset:2048
v_add_f32 v208, v208, v212
v_mfma_f32_16x16x32_bf16 v[52:55], v[180:183], a[244:247], v[52:55]
v_exp_f32 v216, v96
v_mfma_f32_16x16x32_bf16 v[48:51], v[180:183], a[240:243], v[48:51]
ds_read_b64_tr_b16 a[218:219], v230 offset:8192
v_add_f32 v209, v209, v213
v_mfma_f32_16x16x32_bf16 a[0:3], v[184:187], a[240:243], a[0:3]
v_add_f32 v210, v210, v214
v_add_f32 v211, v211, v215
v_mfma_f32_16x16x32_bf16 a[4:7], v[184:187], a[244:247], a[4:7]
v_exp_f32 v217, v97
v_mfma_f32_16x16x32_bf16 a[52:55], v[188:191], a[244:247], a[52:55]
ds_read_b64_tr_b16 a[220:221], v231 offset:2048
v_cndmask_b32 v124, v124, v243, s[56:57]
v_mfma_f32_16x16x32_bf16 a[48:51], v[188:191], a[240:243], a[48:51]
v_exp_f32 v218, v98
v_mfma_f32_16x16x32_bf16 a[56:59], v[188:191], a[248:251], a[56:59]
ds_read_b64_tr_b16 a[222:223], v231 offset:8192
v_cndmask_b32 v125, v125, v243, s[58:59]
v_mfma_f32_16x16x32_bf16 a[60:63], v[188:191], a[252:255], a[60:63]
v_cndmask_b32 v126, v126, v243, s[60:61]
v_cndmask_b32 v127, v127, v243, s[62:63]
v_mfma_f32_16x16x32_bf16 a[12:15], v[184:187], a[252:255], a[12:15]
v_add_f32 v212, v216, v217
v_cvt_pk_bf16_f32 v160, v216, v217
v_mfma_f32_16x16x32_bf16 a[8:11], v[184:187], a[248:251], a[8:11]
v_exp_f32 v219, v99
v_mfma_f32_16x16x32_bf16 v[56:59], v[180:183], a[248:251], v[56:59]
v_add_f32 v212, v212, v218
v_cvt_pk_bf16_f32 v161, v218, v219
v_mfma_f32_16x16x32_bf16 v[60:63], v[180:183], a[252:255], v[60:63]
buffer_load_dwordx4 v235, s[4:7], s43 offen offset:3328  lds
v_mfma_f32_16x16x32_bf16 v[12:15], v[176:179], a[252:255], v[12:15]
v_exp_f32 v220, v100
v_mfma_f32_16x16x32_bf16 v[8:11], v[176:179], a[248:251], v[8:11]
v_add_f32 v212, v212, v219
v_readlane_b32 s47, v238, s34
v_mfma_f32_16x16x32_bf16 v[16:19], v[176:179], a[192:195], v[16:19]
s_waitcnt vmcnt(12) lgkmcnt(0)
s_barrier
v_mfma_f32_16x16x32_bf16 v[20:23], v[176:179], a[196:199], v[20:23]
s_and_b32 s49, s47, s70
v_exp_f32 v221, v101
v_mfma_f32_16x16x32_bf16 v[68:71], v[180:183], a[196:199], v[68:71]
s_add_u32 m0, s46, s40
v_exp_f32 v222, v102
v_mfma_f32_16x16x32_bf16 v[64:67], v[180:183], a[192:195], v[64:67]
ds_read_b128 a[224:227], v226 offset:0
v_add_f32 v213, v220, v221
v_mfma_f32_16x16x32_bf16 a[16:19], v[184:187], a[192:195], a[16:19]
s_and_b32 s44, s47, s71
v_cvt_pk_bf16_f32 v164, v220, v221
v_add_f32 v213, v213, v222
v_mfma_f32_16x16x32_bf16 a[20:23], v[184:187], a[196:199], a[20:23]
v_exp_f32 v223, v103
v_mfma_f32_16x16x32_bf16 a[68:71], v[188:191], a[196:199], a[68:71]
ds_read_b128 a[228:231], v227 offset:0
v_add_u32 v236, v232, v236
v_mfma_f32_16x16x32_bf16 a[64:67], v[188:191], a[192:195], a[64:67]
buffer_load_dwordx4 v236, s[8:11], s45 offen offset:0  lds
v_mfma_f32_16x16x32_bf16 a[72:75], v[188:191], a[200:203], a[72:75]
s_lshr_b32 s43, s47, 8
v_xor_b32 v237, v232, v237
v_add_f32 v213, v213, v223
v_mfma_f32_16x16x32_bf16 a[76:79], v[188:191], a[204:207], a[76:79]
s_and_b32 s43, s43, s71
v_exp_f32 v216, v104
v_mfma_f32_16x16x32_bf16 a[28:31], v[184:187], a[204:207], a[28:31]
ds_read_b128 a[232:235], v226 offset:1024
v_cvt_pk_bf16_f32 v165, v222, v223
v_mfma_f32_16x16x32_bf16 a[24:27], v[184:187], a[200:203], a[24:27]
buffer_load_dwordx4 v237, s[8:11], s45 offen offset:3072  lds
v_mfma_f32_16x16x32_bf16 v[72:75], v[180:183], a[200:203], v[72:75]
s_add_u32 m0, s46, s41
v_exp_f32 v217, v105
v_mfma_f32_16x16x32_bf16 v[76:79], v[180:183], a[204:207], v[76:79]
ds_read_b128 a[236:239], v227 offset:1024
v_add_f32 v214, v216, v217
v_mfma_f32_16x16x32_bf16 v[28:31], v[176:179], a[204:207], v[28:31]
ds_read_b128 a[240:243], v226 offset:2048
v_cvt_pk_bf16_f32 v168, v216, v217
v_mfma_f32_16x16x32_bf16 v[24:27], v[176:179], a[200:203], v[24:27]
s_bitcmp1_b32 s47, 28
v_exp_f32 v218, v106
v_mfma_f32_16x16x32_bf16 v[32:35], v[176:179], a[208:211], v[32:35]
buffer_load_dwordx4 v236, s[8:11], s45 offen offset:128  lds
v_mfma_f32_16x16x32_bf16 v[36:39], v[176:179], a[212:215], v[36:39]
ds_read_b128 a[244:247], v227 offset:2048
v_add_f32 v214, v214, v218
v_mfma_f32_16x16x32_bf16 v[84:87], v[180:183], a[212:215], v[84:87]
s_cselect_b64 s[50:51], s[30:31], s[28:29]
v_exp_f32 v219, v107
v_mfma_f32_16x16x32_bf16 v[80:83], v[180:183], a[208:211], v[80:83]
ds_read_b128 a[248:251], v226 offset:6144
v_add_f32 v214, v214, v219
v_mfma_f32_16x16x32_bf16 a[32:35], v[184:187], a[208:211], a[32:35]
buffer_load_dwordx4 v237, s[8:11], s45 offen offset:3200  lds
v_mfma_f32_16x16x32_bf16 a[36:39], v[184:187], a[212:215], a[36:39]
s_bitcmp1_b32 s47, 29
v_exp_f32 v220, v108
v_mfma_f32_16x16x32_bf16 a[84:87], v[188:191], a[212:215], a[84:87]
ds_read_b128 a[252:255], v227 offset:6144
v_cvt_pk_bf16_f32 v169, v218, v219
v_mfma_f32_16x16x32_bf16 a[80:83], v[188:191], a[208:211], a[80:83]
s_cselect_b64 s[4:5], s[50:51], s[24:25]
v_exp_f32 v221, v109
v_mfma_f32_16x16x32_bf16 a[88:91], v[188:191], a[216:219], a[88:91]
ds_read_b128 a[192:195], v226 offset:7168
v_add_f32 v215, v220, v221
v_mfma_f32_16x16x32_bf16 a[92:95], v[188:191], a[220:223], a[92:95]
ds_read_b128 a[196:199], v227 offset:7168
v_cvt_pk_bf16_f32 v172, v220, v221
v_mfma_f32_16x16x32_bf16 a[44:47], v[184:187], a[220:223], a[44:47]
s_add_u32 m0, s46, s42
v_exp_f32 v222, v110
v_mfma_f32_16x16x32_bf16 a[40:43], v[184:187], a[216:219], a[40:43]
buffer_load_dwordx4 v236, s[8:11], s45 offen offset:256  lds
v_mfma_f32_16x16x32_bf16 v[88:91], v[180:183], a[216:219], v[88:91]
s_add_u32 s34, s34, 1
v_add_u32 v234, s49, v233
v_add_f32 v215, v215, v222
v_mfma_f32_16x16x32_bf16 v[92:95], v[180:183], a[220:223], v[92:95]
ds_read_b64 v[234:235], v234
ds_read_b128 a[200:203], v226 offset:8192
v_mfma_f32_16x16x32_bf16 v[44:47], v[176:179], a[220:223], v[44:47]
s_waitcnt lgkmcnt(6)
v_exp_f32 v223, v111
v_mfma_f32_16x16x32_bf16 v[40:43], v[176:179], a[216:219], v[40:43]
buffer_load_dwordx4 v237, s[8:11], s45 offen offset:3328  lds
v_add_f32 v215, v215, v223
v_cvt_pk_bf16_f32 v173, v222, v223
ds_read_b128 a[204:207], v227 offset:8192
v_mov_b32 v128, 0xff800000
v_mov_b32 v129, 0xff800000
v_mov_b32 v130, 0xff800000
v_mov_b32 v131, 0xff800000
v_exp_f32 v216, v112
v_readlane_b32 s48, v239, s34
v_exp_f32 v217, v113
v_add_f32 v212, v212, v216
v_exp_f32 v218, v114
v_add_f32 v212, v212, v217
v_cvt_pk_bf16_f32 v162, v216, v217
v_exp_f32 v219, v115
v_add_f32 v212, v212, v218
s_and_b32 s79, s48, s70
v_add_f32 v212, v212, v219
v_cvt_pk_bf16_f32 v163, v218, v219
v_exp_f32 v220, v116
v_mov_b32 v132, 0xff800000
s_waitcnt vmcnt(12) lgkmcnt(0)
s_barrier
v_add_f32 v213, v213, v220
v_mov_b32 v133, 0xff800000
v_mov_b32 v134, 0xff800000
v_mov_b32 v135, 0xff800000
v_add_u32 v234, v232, v234
v_xor_b32 v235, v232, v235
s_add_u32 m0, s44, s40
ds_read_b64_tr_b16 a[208:209], v228 offset:12288
buffer_load_dwordx4 v234, s[4:7], s43 offen offset:0  lds
s_and_b32 s46, s48, s71
ds_read_b64_tr_b16 a[210:211], v228 offset:18432
v_exp_f32 v221, v117
s_nop 0
v_add_f32 v213, v213, v221
v_cvt_pk_bf16_f32 v166, v220, v221
v_mov_b32 v136, 0xff800000
v_mov_b32 v137, 0xff800000
v_mov_b32 v138, 0xff800000
v_mov_b32 v139, 0xff800000
s_lshr_b32 s45, s48, 8
ds_read_b64_tr_b16 a[212:213], v229 offset:12288
v_exp_f32 v222, v118
ds_read_b64_tr_b16 a[214:215], v229 offset:18432
v_add_f32 v213, v213, v222
v_exp_f32 v223, v119
ds_read_b64_tr_b16 a[216:217], v230 offset:12288
v_add_f32 v213, v213, v223
v_cvt_pk_bf16_f32 v167, v222, v223
s_and_b32 s45, s45, s71
ds_read_b64_tr_b16 a[218:219], v230 offset:18432
v_mov_b32 v140, 0xff800000
v_mov_b32 v141, 0xff800000
v_mov_b32 v142, 0xff800000
v_mov_b32 v143, 0xff800000
v_exp_f32 v216, v120
buffer_load_dwordx4 v235, s[4:7], s43 offen offset:3072  lds
v_add_f32 v214, v214, v216
s_bitcmp1_b32 s48, 28
ds_read_b64_tr_b16 a[220:221], v231 offset:12288
s_cselect_b64 s[50:51], s[30:31], s[28:29]
v_exp_f32 v217, v121
ds_read_b64_tr_b16 a[222:223], v231 offset:18432
v_add_f32 v214, v214, v217
v_cvt_pk_bf16_f32 v170, v216, v217
v_exp_f32 v218, v122
v_mov_b32 v144, 0xff800000
v_mov_b32 v145, 0xff800000
v_mov_b32 v146, 0xff800000
v_mov_b32 v147, 0xff800000
v_add_f32 v214, v214, v218
ds_read_b64_tr_b16 a[224:225], v228 offset:13312
ds_read_b64_tr_b16 a[226:227], v228 offset:19456
v_exp_f32 v219, v123
s_add_u32 m0, s44, s41
v_add_f32 v214, v214, v219
v_cvt_pk_bf16_f32 v171, v218, v219
ds_read_b64_tr_b16 a[228:229], v229 offset:13312
buffer_load_dwordx4 v234, s[4:7], s43 offen offset:128  lds
s_bitcmp1_b32 s48, 29
s_cselect_b64 s[8:9], s[50:51], s[26:27]
v_exp_f32 v220, v124
v_mov_b32 v148, 0xff800000
v_mov_b32 v149, 0xff800000
v_mov_b32 v150, 0xff800000
v_mov_b32 v151, 0xff800000
v_add_f32 v215, v215, v220
ds_read_b64_tr_b16 a[230:231], v229 offset:19456
ds_read_b64_tr_b16 a[232:233], v230 offset:13312
v_exp_f32 v221, v125
ds_read_b64_tr_b16 a[234:235], v230 offset:19456
v_add_f32 v215, v215, v221
v_cvt_pk_bf16_f32 v174, v220, v221
v_exp_f32 v222, v126
ds_read_b64_tr_b16 a[236:237], v231 offset:13312
v_add_f32 v215, v215, v222
v_mov_b32 v152, 0xff800000
v_mov_b32 v153, 0xff800000
v_mov_b32 v154, 0xff800000
v_mov_b32 v155, 0xff800000
v_add_u32 v236, s79, v233
v_exp_f32 v223, v127
buffer_load_dwordx4 v235, s[4:7], s43 offen offset:3200  lds
ds_read_b64_tr_b16 a[238:239], v231 offset:19456
v_add_f32 v215, v215, v223
v_cvt_pk_bf16_f32 v175, v222, v223
s_waitcnt lgkmcnt(6)
ds_read_b64_tr_b16 a[240:241], v228 offset:14336
ds_read_b64 v[236:237], v236
v_mov_b32 v156, 0xff800000
v_mov_b32 v157, 0xff800000
v_mov_b32 v158, 0xff800000
v_mov_b32 v159, 0xff800000
ds_read_b64_tr_b16 a[242:243], v228 offset:20480
v_max3_f32 v240, v212, v213, v214
ds_read_b64_tr_b16 a[244:245], v229 offset:14336
v_max_f32 v240, v240, v215
v_cmp_lt_f32 vcc, s52, v240
s_add_u32 m0, s44, s42
ds_read_b64_tr_b16 a[246:247], v229 offset:20480
s_cbranch_vccnz L_stub16
L_back16:
v_add_f32 v208, v208, v212
v_mfma_f32_16x16x32_bf16 v[0:3], v[160:163], a[208:211], v[0:3]
buffer_load_dwordx4 v234, s[4:7], s43 offen offset:256  lds
v_mfma_f32_16x16x32_bf16 v[4:7], v[160:163], a[212:215], v[4:7]
ds_read_b64_tr_b16 a[248:249], v230 offset:14336
v_add_f32 v209, v209, v213
v_mfma_f32_16x16x32_bf16 v[52:55], v[164:167], a[212:215], v[52:55]
v_exp_f32 v216, v128
v_mfma_f32_16x16x32_bf16 v[48:51], v[164:167], a[208:211], v[48:51]
ds_read_b64_tr_b16 a[250:251], v230 offset:20480
v_add_f32 v210, v210, v214
v_mfma_f32_16x16x32_bf16 a[0:3], v[168:171], a[208:211], a[0:3]
v_add_f32 v211, v211, v215
v_mfma_f32_16x16x32_bf16 a[4:7], v[168:171], a[212:215], a[4:7]
v_exp_f32 v217, v129
v_mfma_f32_16x16x32_bf16 a[52:55], v[172:175], a[212:215], a[52:55]
ds_read_b64_tr_b16 a[252:253], v231 offset:14336
v_add_f32 v212, v216, v217
v_mfma_f32_16x16x32_bf16 a[48:51], v[172:175], a[208:211], a[48:51]
v_exp_f32 v218, v130
v_mfma_f32_16x16x32_bf16 a[56:59], v[172:175], a[216:219], a[56:59]
ds_read_b64_tr_b16 a[254:255], v231 offset:20480
v_cvt_pk_bf16_f32 v176, v216, v217
v_mfma_f32_16x16x32_bf16 a[60:63], v[172:175], a[220:223], a[60:63]
v_exp_f32 v219, v131
v_mfma_f32_16x16x32_bf16 a[12:15], v[168:171], a[220:223], a[12:15]
v_add_f32 v212, v212, v218
v_cvt_pk_bf16_f32 v177, v218, v219
v_mfma_f32_16x16x32_bf16 a[8:11], v[168:171], a[216:219], a[8:11]
buffer_load_dwordx4 v235, s[4:7], s43 offen offset:3328  lds
v_mfma_f32_16x16x32_bf16 v[56:59], v[164:167], a[216:219], v[56:59]
v_exp_f32 v220, v132
v_mfma_f32_16x16x32_bf16 v[60:63], v[164:167], a[220:223], v[60:63]
v_add_f32 v212, v212, v219
v_readlane_b32 s47, v238, s34
v_mfma_f32_16x16x32_bf16 v[12:15], v[160:163], a[220:223], v[12:15]
v_exp_f32 v221, v133
v_mfma_f32_16x16x32_bf16 v[8:11], v[160:163], a[216:219], v[8:11]
v_exp_f32 v222, v134
v_mfma_f32_16x16x32_bf16 v[16:19], v[160:163], a[224:227], v[16:19]
s_waitcnt vmcnt(63) lgkmcnt(0)
s_barrier
v_mfma_f32_16x16x32_bf16 v[20:23], v[160:163], a[228:231], v[20:23]
s_and_b32 s49, s47, s70
v_add_f32 v213, v220, v221
v_cvt_pk_bf16_f32 v180, v220, v221
v_mfma_f32_16x16x32_bf16 v[68:71], v[164:167], a[228:231], v[68:71]
ds_read_b128 a[192:195], v226 offset:12288
v_add_f32 v213, v213, v222
v_mfma_f32_16x16x32_bf16 v[64:67], v[164:167], a[224:227], v[64:67]
s_add_u32 m0, s46, s40
v_exp_f32 v223, v135
v_mfma_f32_16x16x32_bf16 a[16:19], v[168:171], a[224:227], a[16:19]
ds_read_b128 a[196:199], v227 offset:12288
v_add_u32 v236, v232, v236
v_mfma_f32_16x16x32_bf16 a[20:23], v[168:171], a[228:231], a[20:23]
buffer_load_dwordx4 v236, s[8:11], s45 offen offset:0  lds
v_mfma_f32_16x16x32_bf16 a[68:71], v[172:175], a[228:231], a[68:71]
s_and_b32 s44, s47, s71
v_xor_b32 v237, v232, v237
v_add_f32 v213, v213, v223
v_mfma_f32_16x16x32_bf16 a[64:67], v[172:175], a[224:227], a[64:67]
s_lshr_b32 s43, s47, 8
v_exp_f32 v216, v136
v_mfma_f32_16x16x32_bf16 a[72:75], v[172:175], a[232:235], a[72:75]
ds_read_b128 a[200:203], v226 offset:13312
v_cvt_pk_bf16_f32 v181, v222, v223
v_mfma_f32_16x16x32_bf16 a[76:79], v[172:175], a[236:239], a[76:79]
buffer_load_dwordx4 v237, s[8:11], s45 offen offset:3072  lds
v_mfma_f32_16x16x32_bf16 a[28:31], v[168:171], a[236:239], a[28:31]
s_and_b32 s43, s43, s71
v_exp_f32 v217, v137
v_mfma_f32_16x16x32_bf16 a[24:27], v[168:171], a[232:235], a[24:27]
ds_read_b128 a[204:207], v227 offset:13312
v_add_f32 v214, v216, v217
v_mfma_f32_16x16x32_bf16 v[72:75], v[164:167], a[232:235], v[72:75]
ds_read_b128 a[208:211], v226 offset:14336
v_cvt_pk_bf16_f32 v184, v216, v217
v_mfma_f32_16x16x32_bf16 v[76:79], v[164:167], a[236:239], v[76:79]
s_add_u32 m0, s46, s41
v_exp_f32 v218, v138
v_mfma_f32_16x16x32_bf16 v[28:31], v[160:163], a[236:239], v[28:31]
buffer_load_dwordx4 v236, s[8:11], s45 offen offset:128  lds
v_mfma_f32_16x16x32_bf16 v[24:27], v[160:163], a[232:235], v[24:27]
ds_read_b128 a[212:215], v227 offset:14336
v_add_f32 v214, v214, v218
v_mfma_f32_16x16x32_bf16 v[32:35], v[160:163], a[240:243], v[32:35]
s_bitcmp1_b32 s47, 28
v_exp_f32 v219, v139
v_mfma_f32_16x16x32_bf16 v[36:39], v[160:163], a[244:247], v[36:39]
ds_read_b128 a[216:219], v226 offset:18432
v_add_f32 v214, v214, v219
v_mfma_f32_16x16x32_bf16 v[84:87], v[164:167], a[244:247], v[84:87]
buffer_load_dwordx4 v237, s[8:11], s45 offen offset:3200  lds
v_mfma_f32_16x16x32_bf16 v[80:83], v[164:167], a[240:243], v[80:83]
s_cselect_b64 s[50:51], s[30:31], s[28:29]
v_exp_f32 v220, v140
v_mfma_f32_16x16x32_bf16 a[32:35], v[168:171], a[240:243], a[32:35]
ds_read_b128 a[220:223], v227 offset:18432
v_cvt_pk_bf16_f32 v185, v218, v219
v_mfma_f32_16x16x32_bf16 a[36:39], v[168:171], a[244:247], a[36:39]
s_bitcmp1_b32 s47, 29
v_exp_f32 v221, v141
v_mfma_f32_16x16x32_bf16 a[84:87], v[172:175], a[244:247], a[84:87]
ds_read_b128 a[224:227], v226 offset:19456
v_add_f32 v215, v220, v221
v_mfma_f32_16x16x32_bf16 a[80:83], v[172:175], a[240:243], a[80:83]
ds_read_b128 a[228:231], v227 offset:19456
v_cvt_pk_bf16_f32 v188, v220, v221
v_mfma_f32_16x16x32_bf16 a[88:91], v[172:175], a[248:251], a[88:91]
s_cselect_b64 s[4:5], s[50:51], s[24:25]
v_exp_f32 v222, v142
v_mfma_f32_16x16x32_bf16 a[92:95], v[172:175], a[252:255], a[92:95]
s_add_u32 m0, s46, s42
v_add_u32 v234, s49, v233
v_add_f32 v215, v215, v222
v_mfma_f32_16x16x32_bf16 a[44:47], v[168:171], a[252:255], a[44:47]
buffer_load_dwordx4 v236, s[8:11], s45 offen offset:256  lds
v_mfma_f32_16x16x32_bf16 a[40:43], v[168:171], a[248:251], a[40:43]
ds_read_b64 v[234:235], v234
ds_read_b128 a[232:235], v226 offset:20480
v_mfma_f32_16x16x32_bf16 v[88:91], v[164:167], a[248:251], v[88:91]
s_add_u32 s34, s34, 1
v_exp_f32 v223, v143
v_mfma_f32_16x16x32_bf16 v[92:95], v[164:167], a[252:255], v[92:95]
buffer_load_dwordx4 v237, s[8:11], s45 offen offset:3328  lds
v_mfma_f32_16x16x32_bf16 v[44:47], v[160:163], a[252:255], v[44:47]
ds_read_b128 a[236:239], v227 offset:20480
v_add_f32 v215, v215, v223
v_mfma_f32_16x16x32_bf16 v[40:43], v[160:163], a[248:251], v[40:43]
s_waitcnt lgkmcnt(7)
v_cvt_pk_bf16_f32 v189, v222, v223
s_branch L_last
L_last1:
s_lshl_b32 s86, s36, 8
s_add_u32 s88, s86, 160768
s_sub_u32 s89, 161536, s86
s_add_u32 s50, s86, 161792
s_mov_b32 s90, 0xffff0000
s_mov_b32 s91, 0xffff0000
v_exp_f32 v216, v112
v_exp_f32 v217, v113
v_exp_f32 v218, v114
v_exp_f32 v219, v115
v_add_f32 v212, v212, v216
v_add_f32 v212, v212, v217
v_cvt_pk_bf16_f32 v162, v216, v217
v_exp_f32 v220, v116
s_waitcnt vmcnt(12) lgkmcnt(0)
s_barrier
ds_read_b64_tr_b16 a[208:209], v228 offset:12288
ds_read_b64_tr_b16 a[210:211], v228 offset:18432
ds_read_b64_tr_b16 a[212:213], v229 offset:12288
ds_read_b64_tr_b16 a[214:215], v229 offset:18432
v_add_u32 v234, v232, v234
v_xor_b32 v235, v232, v235
v_exp_f32 v221, v117
v_add_f32 v212, v212, v218
v_add_f32 v212, v212, v219
v_cvt_pk_bf16_f32 v163, v218, v219
v_exp_f32 v222, v118
ds_read_b64_tr_b16 a[216:217], v230 offset:12288
ds_read_b64_tr_b16 a[218:219], v230 offset:18432
ds_read_b64_tr_b16 a[220:221], v231 offset:12288
ds_read_b64_tr_b16 a[222:223], v231 offset:18432
v_exp_f32 v223, v119
v_add_f32 v213, v213, v220
v_add_f32 v213, v213, v221
v_cvt_pk_bf16_f32 v166, v220, v221
s_add_u32 m0, s44, s40
v_exp_f32 v216, v120
buffer_load_dwordx4 v234, s[4:7], s43 offen offset:0  lds
ds_read_b64_tr_b16 a[224:225], v228 offset:13312
ds_read_b64_tr_b16 a[226:227], v228 offset:19456
ds_read_b64_tr_b16 a[228:229], v229 offset:13312
ds_read_b64_tr_b16 a[230:231], v229 offset:19456
v_exp_f32 v217, v121
v_add_f32 v213, v213, v222
v_add_f32 v213, v213, v223
v_cvt_pk_bf16_f32 v167, v222, v223
v_exp_f32 v218, v122
buffer_load_dwordx4 v235, s[4:7], s43 offen offset:3072  lds
ds_read_b64_tr_b16 a[232:233], v230 offset:13312
ds_read_b64_tr_b16 a[234:235], v230 offset:19456
ds_read_b64_tr_b16 a[236:237], v231 offset:13312
ds_read_b64_tr_b16 a[238:239], v231 offset:19456
v_exp_f32 v219, v123
v_add_f32 v214, v214, v216
v_add_f32 v214, v214, v217
v_cvt_pk_bf16_f32 v170, v216, v217
s_add_u32 m0, s44, s41
v_exp_f32 v220, v124
buffer_load_dwordx4 v234, s[4:7], s43 offen offset:128  lds
ds_read_b64_tr_b16 a[240:241], v228 offset:14336
ds_read_b64_tr_b16 a[242:243], v228 offset:20480
ds_read_b64_tr_b16 a[244:245], v229 offset:14336
ds_read_b64_tr_b16 a[246:247], v229 offset:20480
v_exp_f32 v221, v125
v_add_f32 v214, v214, v218
v_add_f32 v214, v214, v219
v_cvt_pk_bf16_f32 v171, v218, v219
v_exp_f32 v222, v126
buffer_load_dwordx4 v235, s[4:7], s43 offen offset:3200  lds
ds_read_b64_tr_b16 a[248:249], v230 offset:14336
ds_read_b64_tr_b16 a[250:251], v230 offset:20480
ds_read_b64_tr_b16 a[252:253], v231 offset:14336
ds_read_b64_tr_b16 a[254:255], v231 offset:20480
v_exp_f32 v223, v127
v_add_f32 v215, v215, v220
v_add_f32 v215, v215, v221
v_cvt_pk_bf16_f32 v174, v220, v221
v_add_f32 v215, v215, v222
v_add_f32 v215, v215, v223
s_add_u32 m0, s44, s42
v_cvt_pk_bf16_f32 v175, v222, v223
buffer_load_dwordx4 v234, s[4:7], s43 offen offset:256  lds
v_mbcnt_lo_u32_b32 v255, -1, 0
v_mbcnt_hi_u32_b32 v255, -1, v255
v_and_b32 v251, 31, v255
v_lshlrev_b32 v251, 2, v251
v_max3_f32 v240, v212, v213, v214
v_max_f32 v240, v240, v215
buffer_load_dwordx4 v235, s[4:7], s43 offen offset:3328  lds
v_add_u32 v250, s88, v251
v_add_u32 v251, s89, v251
v_lshlrev_b32 v255, 4, v255
v_add_u32 v249, s76, v255
v_cmp_lt_f32 vcc, s52, v240
s_waitcnt lgkmcnt(0)
s_cbranch_vccnz L_stub18
L_back18:
v_mfma_f32_16x16x32_bf16 a[0:3], v[168:171], a[208:211], a[0:3]
v_add_f32 v210, v210, v214
v_add_f32 v211, v211, v215
v_mfma_f32_16x16x32_bf16 a[4:7], v[168:171], a[212:215], a[4:7]
v_cndmask_b32 v240, v200, v204, s[90:91]
v_add_f32 v208, v208, v212
v_mfma_f32_16x16x32_bf16 a[8:11], v[168:171], a[216:219], a[8:11]
v_permlane16_swap_b32 v210, v211
v_mfma_f32_16x16x32_bf16 a[12:15], v[168:171], a[220:223], a[12:15]
v_add_f32 v210, v210, v211
v_add_f32 v209, v209, v213
v_mfma_f32_16x16x32_bf16 a[16:19], v[168:171], a[224:227], a[16:19]
v_mov_b32 v211, v210
v_cndmask_b32 v252, v192, v196, s[90:91]
v_mfma_f32_16x16x32_bf16 a[20:23], v[168:171], a[228:231], a[20:23]
v_permlane32_swap_b32 v210, v211
v_mfma_f32_16x16x32_bf16 a[24:27], v[168:171], a[232:235], a[24:27]
v_add_f32 v210, v210, v211
v_add_u32 v152, s94, v242
v_mfma_f32_16x16x32_bf16 a[28:31], v[168:171], a[236:239], a[28:31]
ds_write2_b32 v250, v240, v210 offset0:0 offset1:32
v_mfma_f32_16x16x32_bf16 a[32:35], v[168:171], a[240:243], a[32:35]
v_permlane16_swap_b32 v208, v209
v_mfma_f32_16x16x32_bf16 a[36:39], v[168:171], a[244:247], a[36:39]
s_sub_u32 s86, s92, s84
v_add_f32 v208, v208, v209
v_lshlrev_b32 v153, 2, v242
v_mfma_f32_16x16x32_bf16 a[40:43], v[168:171], a[248:251], a[40:43]
s_addk_i32 s86, -24576
v_mov_b32 v209, v208
v_mfma_f32_16x16x32_bf16 a[44:47], v[168:171], a[252:255], a[44:47]
ds_read_b32 v144, v152 offset:0
ds_read_b32 v148, v152 offset:64
v_mfma_f32_16x16x32_bf16 a[48:51], v[172:175], a[208:211], a[48:51]
s_sub_u32 s89, s93, s84
v_permlane32_swap_b32 v208, v209
v_mfma_f32_16x16x32_bf16 a[52:55], v[172:175], a[212:215], a[52:55]
s_addk_i32 s89, -24576
v_add_f32 v208, v208, v209
v_and_b32 v153, 16, v153
v_mfma_f32_16x16x32_bf16 a[56:59], v[172:175], a[216:219], a[56:59]
v_add_u32 v120, s86, v228
v_add_u32 v121, s86, v229
v_mfma_f32_16x16x32_bf16 a[60:63], v[172:175], a[220:223], a[60:63]
v_add_u32 v122, s86, v230
v_add_u32 v123, s86, v231
v_mfma_f32_16x16x32_bf16 a[64:67], v[172:175], a[224:227], a[64:67]
v_mov_b32 v152, 0xffff
v_lshlrev_b32 v153, v153, v152
v_mfma_f32_16x16x32_bf16 a[68:71], v[172:175], a[228:231], a[68:71]
s_waitcnt vmcnt(12) lgkmcnt(0)
s_barrier
v_mfma_f32_16x16x32_bf16 a[72:75], v[172:175], a[232:235], a[72:75]
ds_read2_b32 v[216:217], v251 offset0:0 offset1:32
v_mfma_f32_16x16x32_bf16 a[76:79], v[172:175], a[236:239], a[76:79]
ds_read_b64_tr_b16 a[96:97], v120 offset:0
ds_read_b64_tr_b16 a[98:99], v120 offset:6144
v_mfma_f32_16x16x32_bf16 a[80:83], v[172:175], a[240:243], a[80:83]
ds_read_b64_tr_b16 a[100:101], v121 offset:0
ds_read_b64_tr_b16 a[102:103], v121 offset:6144
v_mfma_f32_16x16x32_bf16 a[84:87], v[172:175], a[244:247], a[84:87]
ds_read_b64_tr_b16 a[104:105], v122 offset:0
ds_read_b64_tr_b16 a[106:107], v122 offset:6144
v_mfma_f32_16x16x32_bf16 a[88:91], v[172:175], a[248:251], a[88:91]
ds_read_b64_tr_b16 a[108:109], v123 offset:0
ds_read_b64_tr_b16 a[110:111], v123 offset:6144
v_mfma_f32_16x16x32_bf16 a[92:95], v[172:175], a[252:255], a[92:95]
ds_read_b64_tr_b16 a[112:113], v120 offset:1024
ds_read_b64_tr_b16 a[114:115], v120 offset:7168
v_mfma_f32_16x16x32_bf16 v[0:3], v[160:163], a[208:211], v[0:3]
ds_read_b64_tr_b16 a[116:117], v121 offset:1024
ds_read_b64_tr_b16 a[118:119], v121 offset:7168
v_mfma_f32_16x16x32_bf16 v[4:7], v[160:163], a[212:215], v[4:7]
ds_read_b64_tr_b16 a[120:121], v122 offset:1024
ds_read_b64_tr_b16 a[122:123], v122 offset:7168
v_mfma_f32_16x16x32_bf16 v[8:11], v[160:163], a[216:219], v[8:11]
ds_read_b64_tr_b16 a[124:125], v123 offset:1024
ds_read_b64_tr_b16 a[126:127], v123 offset:7168
v_mfma_f32_16x16x32_bf16 v[12:15], v[160:163], a[220:223], v[12:15]
ds_read_b64_tr_b16 a[128:129], v120 offset:2048
ds_read_b64_tr_b16 a[130:131], v120 offset:8192
v_mfma_f32_16x16x32_bf16 v[16:19], v[160:163], a[224:227], v[16:19]
ds_read_b64_tr_b16 a[132:133], v121 offset:2048
ds_read_b64_tr_b16 a[134:135], v121 offset:8192
v_mfma_f32_16x16x32_bf16 v[20:23], v[160:163], a[228:231], v[20:23]
ds_read_b64_tr_b16 a[136:137], v122 offset:2048
ds_read_b64_tr_b16 a[138:139], v122 offset:8192
v_mfma_f32_16x16x32_bf16 v[24:27], v[160:163], a[232:235], v[24:27]
ds_read_b64_tr_b16 a[140:141], v123 offset:2048
ds_read_b64_tr_b16 a[142:143], v123 offset:8192
v_mfma_f32_16x16x32_bf16 v[28:31], v[160:163], a[236:239], v[28:31]
ds_write_b128 v249, a[0:3] offset:0
v_mfma_f32_16x16x32_bf16 v[32:35], v[160:163], a[240:243], v[32:35]
v_exp_f32 v145, -|v144|
v_mfma_f32_16x16x32_bf16 v[36:39], v[160:163], a[244:247], v[36:39]
v_exp_f32 v149, -|v148|
v_mfma_f32_16x16x32_bf16 v[40:43], v[160:163], a[248:251], v[40:43]
ds_write_b128 v249, a[4:7] offset:1024
v_mfma_f32_16x16x32_bf16 v[44:47], v[160:163], a[252:255], v[44:47]
v_add_f32 v146, 1.0, v145
v_add_f32 v150, 1.0, v149
v_mfma_f32_16x16x32_bf16 v[48:51], v[164:167], a[208:211], v[48:51]
v_rcp_f32 v146, v146
v_mfma_f32_16x16x32_bf16 v[52:55], v[164:167], a[212:215], v[52:55]
ds_write_b128 v249, a[8:11] offset:2048
v_mfma_f32_16x16x32_bf16 v[56:59], v[164:167], a[216:219], v[56:59]
v_rcp_f32 v150, v150
v_mfma_f32_16x16x32_bf16 v[60:63], v[164:167], a[220:223], v[60:63]
s_waitcnt lgkmcnt(15)
v_min_f32 v218, v252, v216
v_sub_f32 v244, v218, v252
v_mfma_f32_16x16x32_bf16 v[64:67], v[164:167], a[224:227], v[64:67]
ds_write_b128 v249, a[12:15] offset:3072
v_mfma_f32_16x16x32_bf16 v[68:71], v[164:167], a[228:231], v[68:71]
v_sub_f32 v246, v218, v216
v_mul_f32 v146, s54, v146
v_mfma_f32_16x16x32_bf16 v[72:75], v[164:167], a[232:235], v[72:75]
v_exp_f32 v244, v244
v_mfma_f32_16x16x32_bf16 v[76:79], v[164:167], a[236:239], v[76:79]
ds_write_b128 v249, a[16:19] offset:4096
v_mfma_f32_16x16x32_bf16 v[80:83], v[164:167], a[240:243], v[80:83]
v_exp_f32 v246, v246
v_mfma_f32_16x16x32_bf16 v[84:87], v[164:167], a[244:247], v[84:87]
v_mul_f32 v218, v244, v208
v_fma_f32 v218, v246, v217, v218
v_mfma_f32_16x16x32_bf16 v[88:91], v[164:167], a[248:251], v[88:91]
ds_write_b128 v249, a[20:23] offset:5120
v_mfma_f32_16x16x32_bf16 v[92:95], v[164:167], a[252:255], v[92:95]
v_mul_f32 v150, s54, v150
v_mul_f32 v145, v145, v146
v_rcp_f32 v218, v218
ds_write_b128 v249, a[24:27] offset:6144
s_sub_u32 s87, 15, s37
s_mul_i32 s87, s87, 49152
s_mov_b32 s88, -24576
v_mul_f32 v149, v149, v150
v_cvt_pk_bf16_f32 v146, v146, v146
v_cvt_pk_bf16_f32 v150, v150, v150
v_cvt_pk_bf16_f32 v145, v145, v145
v_mul_f32 v218, s55, v218
v_mul_f32 v244, v244, v218
ds_write_b128 v249, a[28:31] offset:7168
s_cmp_lt_u32 s36, 2
s_cselect_b32 s96, 0, 86016
s_cselect_b32 s88, 24576, s88
s_mul_i32 s88, s88, s36
s_add_u32 s87, s87, s96
v_cvt_pk_bf16_f32 v149, v149, v149
v_and_b32 v146, v153, v146
v_and_b32 v150, v153, v150
v_and_b32 v145, v153, v145
v_mul_f32 v246, v246, v218
v_bfe_u32 v245, v255, 2, 7
ds_write_b128 v249, a[32:35] offset:8192
v_and_b32 v149, v153, v149
v_cmp_le_f32 vcc, 0, v144
s_nop 1
v_cndmask_b32 v144, v145, v146, vcc
v_add_u32 v124, s89, v228
v_cndmask_b32 v147, v146, v145, vcc
v_cndmask_b32 v112, 0, v144, s[72:73]
v_cndmask_b32 v113, 0, v144, s[74:75]
ds_write_b128 v249, a[36:39] offset:9216
v_add_u32 v245, s50, v245
v_lshrrev_b32 v247, 4, v255
v_and_b32 v247, 48, v247
v_add_u32 v247, s50, v247
v_cndmask_b32 v114, 0, v147, s[72:73]
v_cndmask_b32 v115, 0, v147, s[74:75]
v_cmp_le_f32 vcc, 0, v148
s_nop 1
v_cndmask_b32 v148, v149, v150, vcc
ds_write_b128 v249, a[40:43] offset:10240
v_cndmask_b32 v151, v150, v149, vcc
v_cndmask_b32 v116, 0, v148, s[72:73]
v_add_u32 v125, s89, v229
v_cndmask_b32 v117, 0, v148, s[74:75]
v_cndmask_b32 v118, 0, v151, s[72:73]
v_cndmask_b32 v119, 0, v151, s[74:75]
ds_write_b128 v249, a[44:47] offset:11264
ds_write2_b32 v245, v244, v246 offset0:0 offset1:32
ds_read_b128 v[208:211], v247 offset:0
ds_read_b128 v[212:215], v247 offset:64
ds_read_b128 v[232:235], v247 offset:128
ds_read_b128 v[236:239], v247 offset:192
v_add_u32 v126, s89, v230
v_add_u32 v127, s89, v231
v_add_u32 v250, s92, v255
s_add_u32 s87, s87, s88
s_add_u32 s88, s87, 6144
s_add_u32 s34, s34, 1
s_branch L_final
L_lastx:
s_lshl_b32 s86, s36, 8
s_add_u32 s88, s86, 160768
s_sub_u32 s89, 161536, s86
s_add_u32 s50, s86, 161792
s_mov_b32 s90, 0xffff0000
s_mov_b32 s91, 0xffff0000
v_mbcnt_lo_u32_b32 v255, -1, 0
v_mbcnt_hi_u32_b32 v255, -1, v255
v_and_b32 v251, 31, v255
v_lshlrev_b32 v251, 2, v251
v_add_u32 v250, s88, v251
v_add_u32 v251, s89, v251
v_lshlrev_b32 v255, 4, v255
v_add_u32 v249, s76, v255
v_mov_b32 v192, 0x7149f2ca
v_mov_b32 v196, 0x7149f2ca
v_mov_b32 v200, 0x7149f2ca
v_mov_b32 v204, 0x7149f2ca
v_mov_b32 v208, 0
v_mov_b32 v210, 0
v_cndmask_b32 v240, v200, v204, s[90:91]
v_cndmask_b32 v252, v192, v196, s[90:91]
s_waitcnt vmcnt(18) lgkmcnt(0)
s_barrier
ds_write2_b32 v250, v240, v210 offset0:0 offset1:32
v_add_u32 v234, v232, v234
s_add_u32 m0, s44, s40
v_xor_b32 v235, v232, v235
buffer_load_dwordx4 v234, s[4:7], s43 offen offset:0  lds
buffer_load_dwordx4 v235, s[4:7], s43 offen offset:3072  lds
s_add_u32 m0, s44, s41
s_nop 0
buffer_load_dwordx4 v234, s[4:7], s43 offen offset:128  lds
buffer_load_dwordx4 v235, s[4:7], s43 offen offset:3200  lds
s_add_u32 m0, s44, s42
s_nop 0
buffer_load_dwordx4 v234, s[4:7], s43 offen offset:256  lds
buffer_load_dwordx4 v235, s[4:7], s43 offen offset:3328  lds
ds_write_b64 v253, v[48:49] offset:36864
ds_write_b64 v253, v[52:53] offset:37280
ds_write_b64 v253, v[50:51] offset:37696
ds_write_b64 v253, v[54:55] offset:38112
ds_write_b64 v253, v[64:65] offset:36992
ds_write_b64 v253, v[68:69] offset:37408
ds_write_b64 v253, v[66:67] offset:37824
ds_write_b64 v253, v[70:71] offset:38240
ds_write_b64 v253, v[80:81] offset:37120
ds_write_b64 v253, v[84:85] offset:37536
ds_write_b64 v253, v[82:83] offset:37952
ds_write_b64 v253, v[86:87] offset:38368
ds_read_b64_tr_b16 v[48:49], v254 offset:36864
ds_read_b64_tr_b16 v[50:51], v254 offset:36896
ds_read_b64_tr_b16 v[56:57], v254 offset:40192
ds_read_b64_tr_b16 v[58:59], v254 offset:40224
ds_read_b64_tr_b16 v[64:65], v254 offset:36992
ds_read_b64_tr_b16 v[66:67], v254 offset:37024
ds_read_b64_tr_b16 v[72:73], v254 offset:40320
ds_read_b64_tr_b16 v[74:75], v254 offset:40352
ds_read_b64_tr_b16 v[80:81], v254 offset:37120
ds_read_b64_tr_b16 v[82:83], v254 offset:37152
ds_read_b64_tr_b16 v[88:89], v254 offset:40448
ds_read_b64_tr_b16 v[90:91], v254 offset:40480
s_add_u32 s32, s85, 18432
v_cvt_pk_bf16_f32 v144, v144, v148
v_cvt_pk_bf16_f32 v148, v145, v149
v_cvt_pk_bf16_f32 v145, v152, v156
v_cvt_pk_bf16_f32 v149, v153, v157
v_cvt_pk_bf16_f32 v146, v146, v150
v_cvt_pk_bf16_f32 v150, v147, v151
s_waitcnt vmcnt(18) lgkmcnt(15)
s_barrier
ds_read2_b32 v[216:217], v251 offset0:0 offset1:32
s_waitcnt lgkmcnt(1)
buffer_store_dwordx4 v[48:51], v248, s[16:19], s33 offen offset:0
v_cvt_pk_bf16_f32 v147, v154, v158
v_cvt_pk_bf16_f32 v151, v155, v159
v_cvt_pk_bf16_f32 v160, v160, v164
v_cvt_pk_bf16_f32 v164, v161, v165
buffer_store_dwordx4 v[56:59], v248, s[16:19], s33 offen offset:3072
v_cvt_pk_bf16_f32 v161, v168, v172
v_cvt_pk_bf16_f32 v165, v169, v173
v_cvt_pk_bf16_f32 v162, v162, v166
v_cvt_pk_bf16_f32 v166, v163, v167
buffer_store_dwordx4 v[64:67], v248, s[16:19], s33 offen offset:128
v_cvt_pk_bf16_f32 v163, v170, v174
v_cvt_pk_bf16_f32 v167, v171, v175
v_cvt_pk_bf16_f32 v176, v176, v180
v_cvt_pk_bf16_f32 v180, v177, v181
buffer_store_dwordx4 v[72:75], v248, s[16:19], s33 offen offset:3200
v_cvt_pk_bf16_f32 v177, v184, v188
v_cvt_pk_bf16_f32 v181, v185, v189
v_cvt_pk_bf16_f32 v178, v178, v182
buffer_store_dwordx4 v[80:83], v248, s[16:19], s33 offen offset:256
v_cvt_pk_bf16_f32 v182, v179, v183
v_cvt_pk_bf16_f32 v179, v186, v190
v_cvt_pk_bf16_f32 v183, v187, v191
buffer_store_dwordx4 v[88:91], v248, s[16:19], s33 offen offset:3328
ds_write_b64 v253, v[144:145] offset:36864
ds_write_b64 v253, v[148:149] offset:37280
ds_write_b64 v253, v[146:147] offset:37696
ds_write_b64 v253, v[150:151] offset:38112
ds_write_b64 v253, v[160:161] offset:36992
ds_write_b64 v253, v[164:165] offset:37408
ds_write_b64 v253, v[162:163] offset:37824
ds_write_b64 v253, v[166:167] offset:38240
ds_write_b64 v253, v[176:177] offset:37120
ds_write_b64 v253, v[180:181] offset:37536
ds_write_b64 v253, v[178:179] offset:37952
ds_write_b64 v253, v[182:183] offset:38368
ds_read_b64_tr_b16 v[144:145], v254 offset:36864
ds_read_b64_tr_b16 v[146:147], v254 offset:36896
ds_read_b64_tr_b16 v[152:153], v254 offset:40192
ds_read_b64_tr_b16 v[154:155], v254 offset:40224
ds_read_b64_tr_b16 v[160:161], v254 offset:36992
ds_read_b64_tr_b16 v[162:163], v254 offset:37024
ds_read_b64_tr_b16 v[168:169], v254 offset:40320
ds_read_b64_tr_b16 v[170:171], v254 offset:40352
ds_read_b64_tr_b16 v[176:177], v254 offset:37120
ds_read_b64_tr_b16 v[178:179], v254 offset:37152
ds_read_b64_tr_b16 v[184:185], v254 offset:40448
ds_read_b64_tr_b16 v[186:187], v254 offset:40480
s_add_u32 s33, s85, 12288
v_cvt_pk_bf16_f32 v96, v96, v100
v_cvt_pk_bf16_f32 v100, v97, v101
v_cvt_pk_bf16_f32 v97, v104, v108
v_cvt_pk_bf16_f32 v101, v105, v109
v_cvt_pk_bf16_f32 v98, v98, v102
v_cvt_pk_bf16_f32 v102, v99, v103
s_waitcnt lgkmcnt(0)
buffer_store_dwordx4 v[144:147], v248, s[16:19], s32 offen offset:0
v_cvt_pk_bf16_f32 v99, v106, v110
v_cvt_pk_bf16_f32 v103, v107, v111
v_cvt_pk_bf16_f32 v112, v112, v116
v_cvt_pk_bf16_f32 v116, v113, v117
buffer_store_dwordx4 v[152:155], v248, s[16:19], s32 offen offset:3072
v_cvt_pk_bf16_f32 v113, v120, v124
v_cvt_pk_bf16_f32 v117, v121, v125
v_cvt_pk_bf16_f32 v114, v114, v118
v_cvt_pk_bf16_f32 v118, v115, v119
buffer_store_dwordx4 v[160:163], v248, s[16:19], s32 offen offset:128
v_cvt_pk_bf16_f32 v115, v122, v126
v_cvt_pk_bf16_f32 v119, v123, v127
v_cvt_pk_bf16_f32 v128, v128, v132
v_cvt_pk_bf16_f32 v132, v129, v133
buffer_store_dwordx4 v[168:171], v248, s[16:19], s32 offen offset:3200
v_cvt_pk_bf16_f32 v129, v136, v140
v_cvt_pk_bf16_f32 v133, v137, v141
v_cvt_pk_bf16_f32 v130, v130, v134
buffer_store_dwordx4 v[176:179], v248, s[16:19], s32 offen offset:256
v_cvt_pk_bf16_f32 v134, v131, v135
v_cvt_pk_bf16_f32 v131, v138, v142
v_cvt_pk_bf16_f32 v135, v139, v143
buffer_store_dwordx4 v[184:187], v248, s[16:19], s32 offen offset:3328
ds_write_b64 v253, v[96:97] offset:36864
ds_write_b64 v253, v[100:101] offset:37280
ds_write_b64 v253, v[98:99] offset:37696
ds_write_b64 v253, v[102:103] offset:38112
ds_write_b64 v253, v[112:113] offset:36992
ds_write_b64 v253, v[116:117] offset:37408
ds_write_b64 v253, v[114:115] offset:37824
ds_write_b64 v253, v[118:119] offset:38240
ds_write_b64 v253, v[128:129] offset:37120
ds_write_b64 v253, v[132:133] offset:37536
ds_write_b64 v253, v[130:131] offset:37952
ds_write_b64 v253, v[134:135] offset:38368
ds_read_b64_tr_b16 v[96:97], v254 offset:36864
ds_read_b64_tr_b16 v[98:99], v254 offset:36896
ds_read_b64_tr_b16 v[104:105], v254 offset:40192
ds_read_b64_tr_b16 v[106:107], v254 offset:40224
ds_read_b64_tr_b16 v[112:113], v254 offset:36992
ds_read_b64_tr_b16 v[114:115], v254 offset:37024
ds_read_b64_tr_b16 v[120:121], v254 offset:40320
ds_read_b64_tr_b16 v[122:123], v254 offset:40352
ds_read_b64_tr_b16 v[128:129], v254 offset:37120
ds_read_b64_tr_b16 v[130:131], v254 offset:37152
ds_read_b64_tr_b16 v[136:137], v254 offset:40448
ds_read_b64_tr_b16 v[138:139], v254 offset:40480
v_min_f32 v218, v252, v216
v_sub_f32 v244, v218, v252
v_sub_f32 v246, v218, v216
v_exp_f32 v244, v244
v_exp_f32 v246, v246
v_mul_f32 v218, v244, v208
v_fma_f32 v218, v246, v217, v218
v_rcp_f32 v218, v218
s_nop 0
v_mul_f32 v218, s55, v218
v_mul_f32 v244, v244, v218
v_mul_f32 v246, v246, v218
v_bfe_u32 v245, v255, 2, 7
v_add_u32 v245, s50, v245
v_lshrrev_b32 v247, 4, v255
v_and_b32 v247, 48, v247
v_add_u32 v247, s50, v247
s_waitcnt lgkmcnt(0)
buffer_store_dwordx4 v[96:99], v248, s[16:19], s33 offen offset:0
buffer_store_dwordx4 v[104:107], v248, s[16:19], s33 offen offset:3072
buffer_store_dwordx4 v[112:115], v248, s[16:19], s33 offen offset:128
buffer_store_dwordx4 v[120:123], v248, s[16:19], s33 offen offset:3200
buffer_store_dwordx4 v[128:131], v248, s[16:19], s33 offen offset:256
buffer_store_dwordx4 v[136:139], v248, s[16:19], s33 offen offset:3328
s_sub_u32 s86, s92, s84
s_addk_i32 s86, -24576
s_sub_u32 s89, s93, s84
s_addk_i32 s89, -24576
v_add_u32 v152, s94, v242
ds_read_b32 v144, v152 offset:0
ds_read_b32 v148, v152 offset:64
v_add_u32 v120, s86, v228
v_add_u32 v121, s86, v229
v_add_u32 v122, s86, v230
v_add_u32 v123, s86, v231
v_add_u32 v124, s89, v228
v_add_u32 v125, s89, v229
v_add_u32 v126, s89, v230
v_add_u32 v127, s89, v231
v_add_u32 v250, s92, v255
ds_read_b64_tr_b16 a[96:97], v120 offset:0
ds_read_b64_tr_b16 a[98:99], v120 offset:6144
ds_read_b64_tr_b16 a[100:101], v121 offset:0
ds_read_b64_tr_b16 a[102:103], v121 offset:6144
ds_read_b64_tr_b16 a[104:105], v122 offset:0
ds_read_b64_tr_b16 a[106:107], v122 offset:6144
ds_read_b64_tr_b16 a[108:109], v123 offset:0
ds_read_b64_tr_b16 a[110:111], v123 offset:6144
ds_read_b64_tr_b16 a[112:113], v120 offset:1024
ds_read_b64_tr_b16 a[114:115], v120 offset:7168
ds_read_b64_tr_b16 a[116:117], v121 offset:1024
ds_read_b64_tr_b16 a[118:119], v121 offset:7168
ds_read_b64_tr_b16 a[120:121], v122 offset:1024
ds_read_b64_tr_b16 a[122:123], v122 offset:7168
ds_read_b64_tr_b16 a[124:125], v123 offset:1024
ds_read_b64_tr_b16 a[126:127], v123 offset:7168
ds_read_b64_tr_b16 a[128:129], v120 offset:2048
ds_read_b64_tr_b16 a[130:131], v120 offset:8192
ds_read_b64_tr_b16 a[132:133], v121 offset:2048
ds_read_b64_tr_b16 a[134:135], v121 offset:8192
ds_read_b64_tr_b16 a[136:137], v122 offset:2048
ds_read_b64_tr_b16 a[138:139], v122 offset:8192
ds_read_b64_tr_b16 a[140:141], v123 offset:2048
ds_read_b64_tr_b16 a[142:143], v123 offset:8192
ds_write2_b32 v245, v244, v246 offset0:0 offset1:32
ds_read_b128 v[208:211], v247 offset:0
ds_read_b128 v[212:215], v247 offset:64
ds_read_b128 v[232:235], v247 offset:128
ds_read_b128 v[236:239], v247 offset:192
v_lshlrev_b32 v153, 2, v242
v_and_b32 v153, 16, v153
v_mov_b32 v152, 0xffff
v_lshlrev_b32 v153, v153, v152
s_waitcnt lgkmcnt(15)
v_exp_f32 v145, -|v144|
v_exp_f32 v149, -|v148|
v_add_f32 v146, 1.0, v145
v_add_f32 v150, 1.0, v149
v_rcp_f32 v146, v146
v_rcp_f32 v150, v150
v_mul_f32 v146, s54, v146
v_mul_f32 v150, s54, v150
v_mul_f32 v145, v145, v146
v_mul_f32 v149, v149, v150
v_cvt_pk_bf16_f32 v146, v146, v146
v_cvt_pk_bf16_f32 v150, v150, v150
v_cvt_pk_bf16_f32 v145, v145, v145
v_cvt_pk_bf16_f32 v149, v149, v149
v_and_b32 v146, v153, v146
v_and_b32 v150, v153, v150
v_and_b32 v145, v153, v145
v_and_b32 v149, v153, v149
v_cmp_le_f32 vcc, 0, v144
s_nop 1
v_cndmask_b32 v144, v145, v146, vcc
v_cndmask_b32 v147, v146, v145, vcc
v_cndmask_b32 v112, 0, v144, s[72:73]
v_cndmask_b32 v113, 0, v144, s[74:75]
v_cndmask_b32 v114, 0, v147, s[72:73]
v_cndmask_b32 v115, 0, v147, s[74:75]
v_cmp_le_f32 vcc, 0, v148
s_nop 1
v_cndmask_b32 v148, v149, v150, vcc
v_cndmask_b32 v151, v150, v149, vcc
v_cndmask_b32 v116, 0, v148, s[72:73]
v_cndmask_b32 v117, 0, v148, s[74:75]
v_cndmask_b32 v118, 0, v151, s[72:73]
v_cndmask_b32 v119, 0, v151, s[74:75]
s_sub_u32 s87, 15, s37
s_mul_i32 s87, s87, 49152
s_mov_b32 s88, -24576
s_cmp_lt_u32 s36, 2
s_cselect_b32 s96, 0, 86016
s_cselect_b32 s88, 24576, s88
s_mul_i32 s88, s88, s36
s_add_u32 s87, s87, s96
s_add_u32 s87, s87, s88
s_add_u32 s88, s87, 6144
s_add_u32 s34, s34, 1
s_branch L_final
L_last2:
s_lshl_b32 s86, s36, 8
s_add_u32 s88, s86, 160768
s_sub_u32 s89, 161536, s86
s_add_u32 s50, s86, 161792
s_mov_b32 s90, 0xffff0000
s_mov_b32 s91, 0xffff0000
v_mbcnt_lo_u32_b32 v255, -1, 0
v_mbcnt_hi_u32_b32 v255, -1, v255
v_and_b32 v251, 31, v255
v_lshlrev_b32 v251, 2, v251
v_add_u32 v250, s88, v251
v_add_u32 v251, s89, v251
v_lshlrev_b32 v255, 4, v255
v_add_u32 v249, s76, v255
s_waitcnt vmcnt(21) lgkmcnt(0)
s_barrier
v_add_u32 v234, v232, v234
v_xor_b32 v235, v232, v235
ds_read_b64_tr_b16 a[240:241], v228 offset:0
ds_read_b64_tr_b16 a[242:243], v228 offset:6144
ds_read_b64_tr_b16 a[244:245], v229 offset:0
ds_read_b64_tr_b16 a[246:247], v229 offset:6144
ds_read_b64_tr_b16 a[248:249], v230 offset:0
ds_read_b64_tr_b16 a[250:251], v230 offset:6144
ds_read_b64_tr_b16 a[252:253], v231 offset:0
ds_read_b64_tr_b16 a[254:255], v231 offset:6144
ds_read_b64_tr_b16 a[192:193], v228 offset:1024
ds_read_b64_tr_b16 a[194:195], v228 offset:7168
ds_read_b64_tr_b16 a[196:197], v229 offset:1024
ds_read_b64_tr_b16 a[198:199], v229 offset:7168
ds_read_b64_tr_b16 a[200:201], v230 offset:1024
ds_read_b64_tr_b16 a[202:203], v230 offset:7168
ds_read_b64_tr_b16 a[204:205], v231 offset:1024
ds_read_b64_tr_b16 a[206:207], v231 offset:7168
ds_read_b64_tr_b16 a[208:209], v228 offset:2048
ds_read_b64_tr_b16 a[210:211], v228 offset:8192
ds_read_b64_tr_b16 a[212:213], v229 offset:2048
ds_read_b64_tr_b16 a[214:215], v229 offset:8192
ds_read_b64_tr_b16 a[216:217], v230 offset:2048
ds_read_b64_tr_b16 a[218:219], v230 offset:8192
ds_read_b64_tr_b16 a[220:221], v231 offset:2048
ds_read_b64_tr_b16 a[222:223], v231 offset:8192
v_exp_f32 v216, v128
v_exp_f32 v217, v129
v_exp_f32 v218, v130
v_exp_f32 v219, v131
v_add_f32 v212, v216, v217
v_cvt_pk_bf16_f32 v176, v216, v217
v_exp_f32 v220, v132
v_exp_f32 v221, v133
v_add_f32 v212, v212, v218
v_add_f32 v212, v212, v219
v_cvt_pk_bf16_f32 v177, v218, v219
v_exp_f32 v222, v134
v_exp_f32 v223, v135
s_add_u32 m0, s44, s40
v_add_f32 v213, v220, v221
buffer_load_dwordx4 v234, s[4:7], s43 offen offset:0  lds
buffer_load_dwordx4 v235, s[4:7], s43 offen offset:3072  lds
s_add_u32 m0, s44, s41
s_nop 0
buffer_load_dwordx4 v234, s[4:7], s43 offen offset:128  lds
buffer_load_dwordx4 v235, s[4:7], s43 offen offset:3200  lds
v_cvt_pk_bf16_f32 v180, v220, v221
v_exp_f32 v216, v148
v_exp_f32 v217, v149
v_add_f32 v213, v213, v222
v_add_f32 v213, v213, v223
v_cvt_pk_bf16_f32 v181, v222, v223
v_exp_f32 v218, v150
v_exp_f32 v219, v151
v_add_f32 v213, v213, v216
v_add_f32 v213, v213, v217
v_cvt_pk_bf16_f32 v182, v216, v217
v_add_f32 v213, v213, v218
v_add_f32 v213, v213, v219
s_add_u32 m0, s44, s42
v_cvt_pk_bf16_f32 v183, v218, v219
buffer_load_dwordx4 v234, s[4:7], s43 offen offset:256  lds
buffer_load_dwordx4 v235, s[4:7], s43 offen offset:3328  lds
v_max_f32 v240, v212, v213
v_cmp_lt_f32 vcc, s52, v240
s_nop 0
s_cbranch_vccnz L_stub19
L_back19:
v_add_f32 v208, v208, v212
v_add_f32 v209, v209, v213
s_waitcnt lgkmcnt(15)
v_mfma_f32_16x16x32_bf16 a[0:3], v[184:187], a[240:243], 0
v_cndmask_b32 v240, v200, v204, s[90:91]
v_mfma_f32_16x16x32_bf16 a[4:7], v[184:187], a[244:247], 0
v_cndmask_b32 v252, v192, v196, s[90:91]
v_mfma_f32_16x16x32_bf16 a[8:11], v[184:187], a[248:251], 0
v_permlane16_swap_b32 v210, v211
v_mfma_f32_16x16x32_bf16 a[12:15], v[184:187], a[252:255], 0
v_add_f32 v210, v210, v211
s_waitcnt lgkmcnt(8)
v_mfma_f32_16x16x32_bf16 a[16:19], v[184:187], a[192:195], 0
v_mov_b32 v211, v210
v_mfma_f32_16x16x32_bf16 a[20:23], v[184:187], a[196:199], 0
s_nop 0
v_permlane32_swap_b32 v210, v211
v_mfma_f32_16x16x32_bf16 a[24:27], v[184:187], a[200:203], 0
v_add_f32 v210, v210, v211
v_add_u32 v152, s94, v242
v_mfma_f32_16x16x32_bf16 a[28:31], v[184:187], a[204:207], 0
ds_write2_b32 v250, v240, v210 offset0:0 offset1:32
s_waitcnt lgkmcnt(1)
v_mfma_f32_16x16x32_bf16 a[32:35], v[184:187], a[208:211], 0
v_permlane16_swap_b32 v208, v209
v_mfma_f32_16x16x32_bf16 a[36:39], v[184:187], a[212:215], 0
s_sub_u32 s86, s92, s84
v_add_f32 v208, v208, v209
v_lshlrev_b32 v153, 2, v242
v_mfma_f32_16x16x32_bf16 a[40:43], v[184:187], a[216:219], 0
s_addk_i32 s86, -24576
v_mov_b32 v209, v208
v_mfma_f32_16x16x32_bf16 a[44:47], v[184:187], a[220:223], 0
ds_read_b32 v144, v152 offset:0
ds_read_b32 v148, v152 offset:64
v_mfma_f32_16x16x32_bf16 a[48:51], v[188:191], a[240:243], 0
s_sub_u32 s89, s93, s84
v_permlane32_swap_b32 v208, v209
v_mfma_f32_16x16x32_bf16 a[52:55], v[188:191], a[244:247], 0
s_addk_i32 s89, -24576
v_add_f32 v208, v208, v209
v_and_b32 v153, 16, v153
v_mfma_f32_16x16x32_bf16 a[56:59], v[188:191], a[248:251], 0
v_add_u32 v120, s86, v228
v_add_u32 v121, s86, v229
v_mfma_f32_16x16x32_bf16 a[60:63], v[188:191], a[252:255], 0
v_add_u32 v122, s86, v230
v_add_u32 v123, s86, v231
v_mfma_f32_16x16x32_bf16 a[64:67], v[188:191], a[192:195], 0
v_mov_b32 v152, 0xffff
v_lshlrev_b32 v153, v153, v152
v_mfma_f32_16x16x32_bf16 a[68:71], v[188:191], a[196:199], 0
s_waitcnt vmcnt(18) lgkmcnt(0)
s_barrier
v_mfma_f32_16x16x32_bf16 a[72:75], v[188:191], a[200:203], 0
ds_read2_b32 v[216:217], v251 offset0:0 offset1:32
v_mfma_f32_16x16x32_bf16 a[76:79], v[188:191], a[204:207], 0
ds_read_b64_tr_b16 a[96:97], v120 offset:0
ds_read_b64_tr_b16 a[98:99], v120 offset:6144
v_mfma_f32_16x16x32_bf16 a[80:83], v[188:191], a[208:211], 0
ds_read_b64_tr_b16 a[100:101], v121 offset:0
ds_read_b64_tr_b16 a[102:103], v121 offset:6144
v_mfma_f32_16x16x32_bf16 a[84:87], v[188:191], a[212:215], 0
ds_read_b64_tr_b16 a[104:105], v122 offset:0
ds_read_b64_tr_b16 a[106:107], v122 offset:6144
v_mfma_f32_16x16x32_bf16 a[88:91], v[188:191], a[216:219], 0
ds_read_b64_tr_b16 a[108:109], v123 offset:0
ds_read_b64_tr_b16 a[110:111], v123 offset:6144
v_mfma_f32_16x16x32_bf16 a[92:95], v[188:191], a[220:223], 0
ds_read_b64_tr_b16 a[112:113], v120 offset:1024
ds_read_b64_tr_b16 a[114:115], v120 offset:7168
v_mfma_f32_16x16x32_bf16 v[0:3], v[176:179], a[240:243], 0
ds_read_b64_tr_b16 a[116:117], v121 offset:1024
ds_read_b64_tr_b16 a[118:119], v121 offset:7168
v_mfma_f32_16x16x32_bf16 v[4:7], v[176:179], a[244:247], 0
ds_read_b64_tr_b16 a[120:121], v122 offset:1024
ds_read_b64_tr_b16 a[122:123], v122 offset:7168
v_mfma_f32_16x16x32_bf16 v[8:11], v[176:179], a[248:251], 0
ds_read_b64_tr_b16 a[124:125], v123 offset:1024
ds_read_b64_tr_b16 a[126:127], v123 offset:7168
v_mfma_f32_16x16x32_bf16 v[12:15], v[176:179], a[252:255], 0
ds_read_b64_tr_b16 a[128:129], v120 offset:2048
ds_read_b64_tr_b16 a[130:131], v120 offset:8192
v_mfma_f32_16x16x32_bf16 v[16:19], v[176:179], a[192:195], 0
ds_read_b64_tr_b16 a[132:133], v121 offset:2048
ds_read_b64_tr_b16 a[134:135], v121 offset:8192
v_mfma_f32_16x16x32_bf16 v[20:23], v[176:179], a[196:199], 0
ds_read_b64_tr_b16 a[136:137], v122 offset:2048
ds_read_b64_tr_b16 a[138:139], v122 offset:8192
v_mfma_f32_16x16x32_bf16 v[24:27], v[176:179], a[200:203], 0
ds_read_b64_tr_b16 a[140:141], v123 offset:2048
ds_read_b64_tr_b16 a[142:143], v123 offset:8192
v_mfma_f32_16x16x32_bf16 v[28:31], v[176:179], a[204:207], 0
ds_write_b128 v249, a[0:3] offset:0
v_mfma_f32_16x16x32_bf16 v[32:35], v[176:179], a[208:211], 0
v_exp_f32 v145, -|v144|
v_mfma_f32_16x16x32_bf16 v[36:39], v[176:179], a[212:215], 0
v_exp_f32 v149, -|v148|
v_mfma_f32_16x16x32_bf16 v[40:43], v[176:179], a[216:219], 0
ds_write_b128 v249, a[4:7] offset:1024
v_mfma_f32_16x16x32_bf16 v[44:47], v[176:179], a[220:223], 0
v_add_f32 v146, 1.0, v145
v_add_f32 v150, 1.0, v149
v_mfma_f32_16x16x32_bf16 v[48:51], v[180:183], a[240:243], 0
v_rcp_f32 v146, v146
v_mfma_f32_16x16x32_bf16 v[52:55], v[180:183], a[244:247], 0
ds_write_b128 v249, a[8:11] offset:2048
v_mfma_f32_16x16x32_bf16 v[56:59], v[180:183], a[248:251], 0
v_rcp_f32 v150, v150
v_mfma_f32_16x16x32_bf16 v[60:63], v[180:183], a[252:255], 0
s_waitcnt lgkmcnt(15)
v_min_f32 v218, v252, v216
v_sub_f32 v244, v218, v252
v_mfma_f32_16x16x32_bf16 v[64:67], v[180:183], a[192:195], 0
ds_write_b128 v249, a[12:15] offset:3072
v_mfma_f32_16x16x32_bf16 v[68:71], v[180:183], a[196:199], 0
v_sub_f32 v246, v218, v216
v_mul_f32 v146, s54, v146
v_mfma_f32_16x16x32_bf16 v[72:75], v[180:183], a[200:203], 0
v_exp_f32 v244, v244
v_mfma_f32_16x16x32_bf16 v[76:79], v[180:183], a[204:207], 0
ds_write_b128 v249, a[16:19] offset:4096
v_mfma_f32_16x16x32_bf16 v[80:83], v[180:183], a[208:211], 0
v_exp_f32 v246, v246
v_mfma_f32_16x16x32_bf16 v[84:87], v[180:183], a[212:215], 0
v_mul_f32 v218, v244, v208
v_fma_f32 v218, v246, v217, v218
v_mfma_f32_16x16x32_bf16 v[88:91], v[180:183], a[216:219], 0
ds_write_b128 v249, a[20:23] offset:5120
v_mfma_f32_16x16x32_bf16 v[92:95], v[180:183], a[220:223], 0
v_mul_f32 v150, s54, v150
v_mul_f32 v145, v145, v146
v_rcp_f32 v218, v218
ds_write_b128 v249, a[24:27] offset:6144
s_sub_u32 s87, 15, s37
s_mul_i32 s87, s87, 49152
s_mov_b32 s88, -24576
v_mul_f32 v149, v149, v150
v_cvt_pk_bf16_f32 v146, v146, v146
v_cvt_pk_bf16_f32 v150, v150, v150
v_cvt_pk_bf16_f32 v145, v145, v145
v_mul_f32 v218, s55, v218
v_mul_f32 v244, v244, v218
ds_write_b128 v249, a[28:31] offset:7168
s_cmp_lt_u32 s36, 2
s_cselect_b32 s96, 0, 86016
s_cselect_b32 s88, 24576, s88
s_mul_i32 s88, s88, s36
s_add_u32 s87, s87, s96
v_cvt_pk_bf16_f32 v149, v149, v149
v_and_b32 v146, v153, v146
v_and_b32 v150, v153, v150
v_and_b32 v145, v153, v145
v_mul_f32 v246, v246, v218
v_bfe_u32 v245, v255, 2, 7
ds_write_b128 v249, a[32:35] offset:8192
v_and_b32 v149, v153, v149
v_cmp_le_f32 vcc, 0, v144
s_nop 1
v_cndmask_b32 v144, v145, v146, vcc
v_add_u32 v124, s89, v228
v_cndmask_b32 v147, v146, v145, vcc
v_cndmask_b32 v112, 0, v144, s[72:73]
v_cndmask_b32 v113, 0, v144, s[74:75]
ds_write_b128 v249, a[36:39] offset:9216
v_add_u32 v245, s50, v245
v_lshrrev_b32 v247, 4, v255
v_and_b32 v247, 48, v247
v_add_u32 v247, s50, v247
v_cndmask_b32 v114, 0, v147, s[72:73]
v_cndmask_b32 v115, 0, v147, s[74:75]
v_cmp_le_f32 vcc, 0, v148
s_nop 1
v_cndmask_b32 v148, v149, v150, vcc
ds_write_b128 v249, a[40:43] offset:10240
v_cndmask_b32 v151, v150, v149, vcc
v_cndmask_b32 v116, 0, v148, s[72:73]
v_add_u32 v125, s89, v229
v_cndmask_b32 v117, 0, v148, s[74:75]
v_cndmask_b32 v118, 0, v151, s[72:73]
v_cndmask_b32 v119, 0, v151, s[74:75]
ds_write_b128 v249, a[44:47] offset:11264
ds_write2_b32 v245, v244, v246 offset0:0 offset1:32
ds_read_b128 v[208:211], v247 offset:0
ds_read_b128 v[212:215], v247 offset:64
ds_read_b128 v[232:235], v247 offset:128
ds_read_b128 v[236:239], v247 offset:192
v_add_u32 v126, s89, v230
v_add_u32 v127, s89, v231
v_add_u32 v250, s92, v255
s_add_u32 s87, s87, s88
s_add_u32 s88, s87, 6144
s_add_u32 s34, s34, 1
s_branch L_final
L_codeend:
L_stub0:
s_call_b64 s[80:81], L_rt0
s_branch L_back0
L_stub1:
s_call_b64 s[80:81], L_rt1
s_branch L_back1
L_stub2:
s_call_b64 s[80:81], L_rt0
s_branch L_back2
L_stub3:
s_call_b64 s[80:81], L_rt1
s_branch L_back3
L_stub4:
s_call_b64 s[80:81], L_rt0
s_branch L_back4
L_stub5:
s_call_b64 s[80:81], L_rt1
s_branch L_back5
L_stub6:
s_call_b64 s[80:81], L_rt1
s_branch L_back6
L_stub7:
s_call_b64 s[80:81], L_rt0
s_branch L_back7
L_stub8:
s_call_b64 s[80:81], L_rt1
s_branch L_back8
L_stub9:
s_call_b64 s[80:81], L_rt0
s_branch L_back9
L_stub10:
s_call_b64 s[80:81], L_rt1
s_branch L_back10
L_stub11:
s_call_b64 s[80:81], L_rt1
s_branch L_back11
L_stub12:
s_call_b64 s[80:81], L_rt0
s_branch L_back12
L_stub13:
s_call_b64 s[80:81], L_rt1
s_branch L_back13
L_stub14:
s_call_b64 s[80:81], L_rt1
s_branch L_back14
L_stub15:
s_call_b64 s[80:81], L_rt0
s_branch L_back15
L_stub16:
s_call_b64 s[80:81], L_rt1
s_branch L_back16
L_stub17:
s_call_b64 s[80:81], L_rt0
s_branch L_back17
L_stub18:
s_call_b64 s[80:81], L_rt1
s_branch L_back18
L_stub19:
s_call_b64 s[80:81], L_rt0
s_branch L_back19
L_rt0:
s_nop 7
v_cmp_lt_f32 vcc, s52, v212
s_nop 1
s_cbranch_vccz L_rs0_0
v_max3_f32 v240, v128, v129, v130
v_max3_f32 v243, v131, v144, v145
v_max3_f32 v240, v240, v146, v147
v_max3_f32 v240, v240, v243, 0
v_mov_b32 v243, v240
s_nop 1
v_permlane16_swap_b32 v240, v243
v_max_f32 v240, v240, v243
v_mov_b32 v243, v240
s_nop 1
v_permlane32_swap_b32 v240, v243
v_max_f32 v240, v240, v243
v_exp_f32 v247, -v240
v_sub_f32 v128, v128, v240
v_sub_f32 v129, v129, v240
v_sub_f32 v130, v130, v240
v_sub_f32 v131, v131, v240
v_sub_f32 v144, v144, v240
v_sub_f32 v145, v145, v240
v_sub_f32 v146, v146, v240
v_sub_f32 v147, v147, v240
v_sub_f32 v96, v96, v240
v_sub_f32 v97, v97, v240
v_sub_f32 v98, v98, v240
v_sub_f32 v99, v99, v240
v_sub_f32 v112, v112, v240
v_sub_f32 v113, v113, v240
v_sub_f32 v114, v114, v240
v_sub_f32 v115, v115, v240
v_sub_f32 v192, v192, v240
v_sub_f32 v193, v193, v240
v_sub_f32 v194, v194, v240
v_sub_f32 v195, v195, v240
v_mul_f32 v208, v208, v247
v_mbcnt_lo_u32_b32 v243, -1, 0
v_mbcnt_hi_u32_b32 v243, -1, v243
v_and_b32 v243, 48, v243
ds_bpermute_b32 v216, v243, v247 offset:0
ds_bpermute_b32 v217, v243, v247 offset:4
ds_bpermute_b32 v218, v243, v247 offset:8
ds_bpermute_b32 v219, v243, v247 offset:12
s_waitcnt lgkmcnt(0)
v_mul_f32 v0, v0, v216
v_mul_f32 v1, v1, v217
v_mul_f32 v2, v2, v218
v_mul_f32 v3, v3, v219
v_mul_f32 v4, v4, v216
v_mul_f32 v5, v5, v217
v_mul_f32 v6, v6, v218
v_mul_f32 v7, v7, v219
v_mul_f32 v8, v8, v216
v_mul_f32 v9, v9, v217
v_mul_f32 v10, v10, v218
v_mul_f32 v11, v11, v219
v_mul_f32 v12, v12, v216
v_mul_f32 v13, v13, v217
v_mul_f32 v14, v14, v218
v_mul_f32 v15, v15, v219
v_mul_f32 v16, v16, v216
v_mul_f32 v17, v17, v217
v_mul_f32 v18, v18, v218
v_mul_f32 v19, v19, v219
v_mul_f32 v20, v20, v216
v_mul_f32 v21, v21, v217
v_mul_f32 v22, v22, v218
v_mul_f32 v23, v23, v219
v_mul_f32 v24, v24, v216
v_mul_f32 v25, v25, v217
v_mul_f32 v26, v26, v218
v_mul_f32 v27, v27, v219
v_mul_f32 v28, v28, v216
v_mul_f32 v29, v29, v217
v_mul_f32 v30, v30, v218
v_mul_f32 v31, v31, v219
v_mul_f32 v32, v32, v216
v_mul_f32 v33, v33, v217
v_mul_f32 v34, v34, v218
v_mul_f32 v35, v35, v219
v_mul_f32 v36, v36, v216
v_mul_f32 v37, v37, v217
v_mul_f32 v38, v38, v218
v_mul_f32 v39, v39, v219
v_mul_f32 v40, v40, v216
v_mul_f32 v41, v41, v217
v_mul_f32 v42, v42, v218
v_mul_f32 v43, v43, v219
v_mul_f32 v44, v44, v216
v_mul_f32 v45, v45, v217
v_mul_f32 v46, v46, v218
v_mul_f32 v47, v47, v219
v_exp_f32 v216, v128
v_exp_f32 v217, v129
s_nop 0
v_add_f32 v212, v216, v217
v_cvt_pk_bf16_f32 v176, v216, v217
v_exp_f32 v218, v130
s_nop 0
v_add_f32 v212, v212, v218
v_exp_f32 v219, v131
s_nop 0
v_add_f32 v212, v212, v219
v_cvt_pk_bf16_f32 v177, v218, v219
v_exp_f32 v220, v144
s_nop 0
v_add_f32 v212, v212, v220
v_exp_f32 v221, v145
s_nop 0
v_add_f32 v212, v212, v221
v_cvt_pk_bf16_f32 v178, v220, v221
v_exp_f32 v222, v146
s_nop 0
v_add_f32 v212, v212, v222
v_exp_f32 v223, v147
s_nop 0
v_add_f32 v212, v212, v223
v_cvt_pk_bf16_f32 v179, v222, v223
L_rs0_0:
v_cmp_lt_f32 vcc, s52, v213
s_nop 1
s_cbranch_vccz L_rs0_1
v_max3_f32 v240, v132, v133, v134
v_max3_f32 v243, v135, v148, v149
v_max3_f32 v240, v240, v150, v151
v_max3_f32 v240, v240, v243, 0
v_mov_b32 v243, v240
s_nop 1
v_permlane16_swap_b32 v240, v243
v_max_f32 v240, v240, v243
v_mov_b32 v243, v240
s_nop 1
v_permlane32_swap_b32 v240, v243
v_max_f32 v240, v240, v243
v_exp_f32 v247, -v240
v_sub_f32 v132, v132, v240
v_sub_f32 v133, v133, v240
v_sub_f32 v134, v134, v240
v_sub_f32 v135, v135, v240
v_sub_f32 v148, v148, v240
v_sub_f32 v149, v149, v240
v_sub_f32 v150, v150, v240
v_sub_f32 v151, v151, v240
v_sub_f32 v100, v100, v240
v_sub_f32 v101, v101, v240
v_sub_f32 v102, v102, v240
v_sub_f32 v103, v103, v240
v_sub_f32 v116, v116, v240
v_sub_f32 v117, v117, v240
v_sub_f32 v118, v118, v240
v_sub_f32 v119, v119, v240
v_sub_f32 v196, v196, v240
v_sub_f32 v197, v197, v240
v_sub_f32 v198, v198, v240
v_sub_f32 v199, v199, v240
v_mul_f32 v209, v209, v247
v_mbcnt_lo_u32_b32 v243, -1, 0
v_mbcnt_hi_u32_b32 v243, -1, v243
v_and_b32 v243, 48, v243
ds_bpermute_b32 v216, v243, v247 offset:0
ds_bpermute_b32 v217, v243, v247 offset:4
ds_bpermute_b32 v218, v243, v247 offset:8
ds_bpermute_b32 v219, v243, v247 offset:12
s_waitcnt lgkmcnt(0)
v_mul_f32 v48, v48, v216
v_mul_f32 v49, v49, v217
v_mul_f32 v50, v50, v218
v_mul_f32 v51, v51, v219
v_mul_f32 v52, v52, v216
v_mul_f32 v53, v53, v217
v_mul_f32 v54, v54, v218
v_mul_f32 v55, v55, v219
v_mul_f32 v56, v56, v216
v_mul_f32 v57, v57, v217
v_mul_f32 v58, v58, v218
v_mul_f32 v59, v59, v219
v_mul_f32 v60, v60, v216
v_mul_f32 v61, v61, v217
v_mul_f32 v62, v62, v218
v_mul_f32 v63, v63, v219
v_mul_f32 v64, v64, v216
v_mul_f32 v65, v65, v217
v_mul_f32 v66, v66, v218
v_mul_f32 v67, v67, v219
v_mul_f32 v68, v68, v216
v_mul_f32 v69, v69, v217
v_mul_f32 v70, v70, v218
v_mul_f32 v71, v71, v219
v_mul_f32 v72, v72, v216
v_mul_f32 v73, v73, v217
v_mul_f32 v74, v74, v218
v_mul_f32 v75, v75, v219
v_mul_f32 v76, v76, v216
v_mul_f32 v77, v77, v217
v_mul_f32 v78, v78, v218
v_mul_f32 v79, v79, v219
v_mul_f32 v80, v80, v216
v_mul_f32 v81, v81, v217
v_mul_f32 v82, v82, v218
v_mul_f32 v83, v83, v219
v_mul_f32 v84, v84, v216
v_mul_f32 v85, v85, v217
v_mul_f32 v86, v86, v218
v_mul_f32 v87, v87, v219
v_mul_f32 v88, v88, v216
v_mul_f32 v89, v89, v217
v_mul_f32 v90, v90, v218
v_mul_f32 v91, v91, v219
v_mul_f32 v92, v92, v216
v_mul_f32 v93, v93, v217
v_mul_f32 v94, v94, v218
v_mul_f32 v95, v95, v219
v_exp_f32 v216, v132
v_exp_f32 v217, v133
s_nop 0
v_add_f32 v213, v216, v217
v_cvt_pk_bf16_f32 v180, v216, v217
v_exp_f32 v218, v134
s_nop 0
v_add_f32 v213, v213, v218
v_exp_f32 v219, v135
s_nop 0
v_add_f32 v213, v213, v219
v_cvt_pk_bf16_f32 v181, v218, v219
v_exp_f32 v220, v148
s_nop 0
v_add_f32 v213, v213, v220
v_exp_f32 v221, v149
s_nop 0
v_add_f32 v213, v213, v221
v_cvt_pk_bf16_f32 v182, v220, v221
v_exp_f32 v222, v150
s_nop 0
v_add_f32 v213, v213, v222
v_exp_f32 v223, v151
s_nop 0
v_add_f32 v213, v213, v223
v_cvt_pk_bf16_f32 v183, v222, v223
L_rs0_1:
v_cmp_lt_f32 vcc, s52, v214
s_nop 1
s_cbranch_vccz L_rs0_2
v_max3_f32 v240, v136, v137, v138
v_max3_f32 v243, v139, v152, v153
v_max3_f32 v240, v240, v154, v155
v_max3_f32 v240, v240, v243, 0
v_mov_b32 v243, v240
s_nop 1
v_permlane16_swap_b32 v240, v243
v_max_f32 v240, v240, v243
v_mov_b32 v243, v240
s_nop 1
v_permlane32_swap_b32 v240, v243
v_max_f32 v240, v240, v243
v_exp_f32 v247, -v240
v_sub_f32 v136, v136, v240
v_sub_f32 v137, v137, v240
v_sub_f32 v138, v138, v240
v_sub_f32 v139, v139, v240
v_sub_f32 v152, v152, v240
v_sub_f32 v153, v153, v240
v_sub_f32 v154, v154, v240
v_sub_f32 v155, v155, v240
v_sub_f32 v104, v104, v240
v_sub_f32 v105, v105, v240
v_sub_f32 v106, v106, v240
v_sub_f32 v107, v107, v240
v_sub_f32 v120, v120, v240
v_sub_f32 v121, v121, v240
v_sub_f32 v122, v122, v240
v_sub_f32 v123, v123, v240
v_sub_f32 v200, v200, v240
v_sub_f32 v201, v201, v240
v_sub_f32 v202, v202, v240
v_sub_f32 v203, v203, v240
v_mul_f32 v210, v210, v247
v_mbcnt_lo_u32_b32 v243, -1, 0
v_mbcnt_hi_u32_b32 v243, -1, v243
v_and_b32 v243, 48, v243
ds_bpermute_b32 v216, v243, v247 offset:0
ds_bpermute_b32 v217, v243, v247 offset:4
ds_bpermute_b32 v218, v243, v247 offset:8
ds_bpermute_b32 v219, v243, v247 offset:12
s_waitcnt lgkmcnt(0)
v_accvgpr_read_b32 v243, a0
v_mul_f32 v243, v243, v216
v_accvgpr_write_b32 a0, v243
v_accvgpr_read_b32 v243, a1
v_mul_f32 v243, v243, v217
v_accvgpr_write_b32 a1, v243
v_accvgpr_read_b32 v243, a2
v_mul_f32 v243, v243, v218
v_accvgpr_write_b32 a2, v243
v_accvgpr_read_b32 v243, a3
v_mul_f32 v243, v243, v219
v_accvgpr_write_b32 a3, v243
v_accvgpr_read_b32 v243, a4
v_mul_f32 v243, v243, v216
v_accvgpr_write_b32 a4, v243
v_accvgpr_read_b32 v243, a5
v_mul_f32 v243, v243, v217
v_accvgpr_write_b32 a5, v243
v_accvgpr_read_b32 v243, a6
v_mul_f32 v243, v243, v218
v_accvgpr_write_b32 a6, v243
v_accvgpr_read_b32 v243, a7
v_mul_f32 v243, v243, v219
v_accvgpr_write_b32 a7, v243
v_accvgpr_read_b32 v243, a8
v_mul_f32 v243, v243, v216
v_accvgpr_write_b32 a8, v243
v_accvgpr_read_b32 v243, a9
v_mul_f32 v243, v243, v217
v_accvgpr_write_b32 a9, v243
v_accvgpr_read_b32 v243, a10
v_mul_f32 v243, v243, v218
v_accvgpr_write_b32 a10, v243
v_accvgpr_read_b32 v243, a11
v_mul_f32 v243, v243, v219
v_accvgpr_write_b32 a11, v243
v_accvgpr_read_b32 v243, a12
v_mul_f32 v243, v243, v216
v_accvgpr_write_b32 a12, v243
v_accvgpr_read_b32 v243, a13
v_mul_f32 v243, v243, v217
v_accvgpr_write_b32 a13, v243
v_accvgpr_read_b32 v243, a14
v_mul_f32 v243, v243, v218
v_accvgpr_write_b32 a14, v243
v_accvgpr_read_b32 v243, a15
v_mul_f32 v243, v243, v219
v_accvgpr_write_b32 a15, v243
v_accvgpr_read_b32 v243, a16
v_mul_f32 v243, v243, v216
v_accvgpr_write_b32 a16, v243
v_accvgpr_read_b32 v243, a17
v_mul_f32 v243, v243, v217
v_accvgpr_write_b32 a17, v243
v_accvgpr_read_b32 v243, a18
v_mul_f32 v243, v243, v218
v_accvgpr_write_b32 a18, v243
v_accvgpr_read_b32 v243, a19
v_mul_f32 v243, v243, v219
v_accvgpr_write_b32 a19, v243
v_accvgpr_read_b32 v243, a20
v_mul_f32 v243, v243, v216
v_accvgpr_write_b32 a20, v243
v_accvgpr_read_b32 v243, a21
v_mul_f32 v243, v243, v217
v_accvgpr_write_b32 a21, v243
v_accvgpr_read_b32 v243, a22
v_mul_f32 v243, v243, v218
v_accvgpr_write_b32 a22, v243
v_accvgpr_read_b32 v243, a23
v_mul_f32 v243, v243, v219
v_accvgpr_write_b32 a23, v243
v_accvgpr_read_b32 v243, a24
v_mul_f32 v243, v243, v216
v_accvgpr_write_b32 a24, v243
v_accvgpr_read_b32 v243, a25
v_mul_f32 v243, v243, v217
v_accvgpr_write_b32 a25, v243
v_accvgpr_read_b32 v243, a26
v_mul_f32 v243, v243, v218
v_accvgpr_write_b32 a26, v243
v_accvgpr_read_b32 v243, a27
v_mul_f32 v243, v243, v219
v_accvgpr_write_b32 a27, v243
v_accvgpr_read_b32 v243, a28
v_mul_f32 v243, v243, v216
v_accvgpr_write_b32 a28, v243
v_accvgpr_read_b32 v243, a29
v_mul_f32 v243, v243, v217
v_accvgpr_write_b32 a29, v243
v_accvgpr_read_b32 v243, a30
v_mul_f32 v243, v243, v218
v_accvgpr_write_b32 a30, v243
v_accvgpr_read_b32 v243, a31
v_mul_f32 v243, v243, v219
v_accvgpr_write_b32 a31, v243
v_accvgpr_read_b32 v243, a32
v_mul_f32 v243, v243, v216
v_accvgpr_write_b32 a32, v243
v_accvgpr_read_b32 v243, a33
v_mul_f32 v243, v243, v217
v_accvgpr_write_b32 a33, v243
v_accvgpr_read_b32 v243, a34
v_mul_f32 v243, v243, v218
v_accvgpr_write_b32 a34, v243
v_accvgpr_read_b32 v243, a35
v_mul_f32 v243, v243, v219
v_accvgpr_write_b32 a35, v243
v_accvgpr_read_b32 v243, a36
v_mul_f32 v243, v243, v216
v_accvgpr_write_b32 a36, v243
v_accvgpr_read_b32 v243, a37
v_mul_f32 v243, v243, v217
v_accvgpr_write_b32 a37, v243
v_accvgpr_read_b32 v243, a38
v_mul_f32 v243, v243, v218
v_accvgpr_write_b32 a38, v243
v_accvgpr_read_b32 v243, a39
v_mul_f32 v243, v243, v219
v_accvgpr_write_b32 a39, v243
v_accvgpr_read_b32 v243, a40
v_mul_f32 v243, v243, v216
v_accvgpr_write_b32 a40, v243
v_accvgpr_read_b32 v243, a41
v_mul_f32 v243, v243, v217
v_accvgpr_write_b32 a41, v243
v_accvgpr_read_b32 v243, a42
v_mul_f32 v243, v243, v218
v_accvgpr_write_b32 a42, v243
v_accvgpr_read_b32 v243, a43
v_mul_f32 v243, v243, v219
v_accvgpr_write_b32 a43, v243
v_accvgpr_read_b32 v243, a44
v_mul_f32 v243, v243, v216
v_accvgpr_write_b32 a44, v243
v_accvgpr_read_b32 v243, a45
v_mul_f32 v243, v243, v217
v_accvgpr_write_b32 a45, v243
v_accvgpr_read_b32 v243, a46
v_mul_f32 v243, v243, v218
v_accvgpr_write_b32 a46, v243
v_accvgpr_read_b32 v243, a47
v_mul_f32 v243, v243, v219
v_accvgpr_write_b32 a47, v243
v_exp_f32 v216, v136
v_exp_f32 v217, v137
s_nop 0
v_add_f32 v214, v216, v217
v_cvt_pk_bf16_f32 v184, v216, v217
v_exp_f32 v218, v138
s_nop 0
v_add_f32 v214, v214, v218
v_exp_f32 v219, v139
s_nop 0
v_add_f32 v214, v214, v219
v_cvt_pk_bf16_f32 v185, v218, v219
v_exp_f32 v220, v152
s_nop 0
v_add_f32 v214, v214, v220
v_exp_f32 v221, v153
s_nop 0
v_add_f32 v214, v214, v221
v_cvt_pk_bf16_f32 v186, v220, v221
v_exp_f32 v222, v154
s_nop 0
v_add_f32 v214, v214, v222
v_exp_f32 v223, v155
s_nop 0
v_add_f32 v214, v214, v223
v_cvt_pk_bf16_f32 v187, v222, v223
L_rs0_2:
v_cmp_lt_f32 vcc, s52, v215
s_nop 1
s_cbranch_vccz L_rs0_3
v_max3_f32 v240, v140, v141, v142
v_max3_f32 v243, v143, v156, v157
v_max3_f32 v240, v240, v158, v159
v_max3_f32 v240, v240, v243, 0
v_mov_b32 v243, v240
s_nop 1
v_permlane16_swap_b32 v240, v243
v_max_f32 v240, v240, v243
v_mov_b32 v243, v240
s_nop 1
v_permlane32_swap_b32 v240, v243
v_max_f32 v240, v240, v243
v_exp_f32 v247, -v240
v_sub_f32 v140, v140, v240
v_sub_f32 v141, v141, v240
v_sub_f32 v142, v142, v240
v_sub_f32 v143, v143, v240
v_sub_f32 v156, v156, v240
v_sub_f32 v157, v157, v240
v_sub_f32 v158, v158, v240
v_sub_f32 v159, v159, v240
v_sub_f32 v108, v108, v240
v_sub_f32 v109, v109, v240
v_sub_f32 v110, v110, v240
v_sub_f32 v111, v111, v240
v_sub_f32 v124, v124, v240
v_sub_f32 v125, v125, v240
v_sub_f32 v126, v126, v240
v_sub_f32 v127, v127, v240
v_sub_f32 v204, v204, v240
v_sub_f32 v205, v205, v240
v_sub_f32 v206, v206, v240
v_sub_f32 v207, v207, v240
v_mul_f32 v211, v211, v247
v_mbcnt_lo_u32_b32 v243, -1, 0
v_mbcnt_hi_u32_b32 v243, -1, v243
v_and_b32 v243, 48, v243
ds_bpermute_b32 v216, v243, v247 offset:0
ds_bpermute_b32 v217, v243, v247 offset:4
ds_bpermute_b32 v218, v243, v247 offset:8
ds_bpermute_b32 v219, v243, v247 offset:12
s_waitcnt lgkmcnt(0)
v_accvgpr_read_b32 v243, a48
v_mul_f32 v243, v243, v216
v_accvgpr_write_b32 a48, v243
v_accvgpr_read_b32 v243, a49
v_mul_f32 v243, v243, v217
v_accvgpr_write_b32 a49, v243
v_accvgpr_read_b32 v243, a50
v_mul_f32 v243, v243, v218
v_accvgpr_write_b32 a50, v243
v_accvgpr_read_b32 v243, a51
v_mul_f32 v243, v243, v219
v_accvgpr_write_b32 a51, v243
v_accvgpr_read_b32 v243, a52
v_mul_f32 v243, v243, v216
v_accvgpr_write_b32 a52, v243
v_accvgpr_read_b32 v243, a53
v_mul_f32 v243, v243, v217
v_accvgpr_write_b32 a53, v243
v_accvgpr_read_b32 v243, a54
v_mul_f32 v243, v243, v218
v_accvgpr_write_b32 a54, v243
v_accvgpr_read_b32 v243, a55
v_mul_f32 v243, v243, v219
v_accvgpr_write_b32 a55, v243
v_accvgpr_read_b32 v243, a56
v_mul_f32 v243, v243, v216
v_accvgpr_write_b32 a56, v243
v_accvgpr_read_b32 v243, a57
v_mul_f32 v243, v243, v217
v_accvgpr_write_b32 a57, v243
v_accvgpr_read_b32 v243, a58
v_mul_f32 v243, v243, v218
v_accvgpr_write_b32 a58, v243
v_accvgpr_read_b32 v243, a59
v_mul_f32 v243, v243, v219
v_accvgpr_write_b32 a59, v243
v_accvgpr_read_b32 v243, a60
v_mul_f32 v243, v243, v216
v_accvgpr_write_b32 a60, v243
v_accvgpr_read_b32 v243, a61
v_mul_f32 v243, v243, v217
v_accvgpr_write_b32 a61, v243
v_accvgpr_read_b32 v243, a62
v_mul_f32 v243, v243, v218
v_accvgpr_write_b32 a62, v243
v_accvgpr_read_b32 v243, a63
v_mul_f32 v243, v243, v219
v_accvgpr_write_b32 a63, v243
v_accvgpr_read_b32 v243, a64
v_mul_f32 v243, v243, v216
v_accvgpr_write_b32 a64, v243
v_accvgpr_read_b32 v243, a65
v_mul_f32 v243, v243, v217
v_accvgpr_write_b32 a65, v243
v_accvgpr_read_b32 v243, a66
v_mul_f32 v243, v243, v218
v_accvgpr_write_b32 a66, v243
v_accvgpr_read_b32 v243, a67
v_mul_f32 v243, v243, v219
v_accvgpr_write_b32 a67, v243
v_accvgpr_read_b32 v243, a68
v_mul_f32 v243, v243, v216
v_accvgpr_write_b32 a68, v243
v_accvgpr_read_b32 v243, a69
v_mul_f32 v243, v243, v217
v_accvgpr_write_b32 a69, v243
v_accvgpr_read_b32 v243, a70
v_mul_f32 v243, v243, v218
v_accvgpr_write_b32 a70, v243
v_accvgpr_read_b32 v243, a71
v_mul_f32 v243, v243, v219
v_accvgpr_write_b32 a71, v243
v_accvgpr_read_b32 v243, a72
v_mul_f32 v243, v243, v216
v_accvgpr_write_b32 a72, v243
v_accvgpr_read_b32 v243, a73
v_mul_f32 v243, v243, v217
v_accvgpr_write_b32 a73, v243
v_accvgpr_read_b32 v243, a74
v_mul_f32 v243, v243, v218
v_accvgpr_write_b32 a74, v243
v_accvgpr_read_b32 v243, a75
v_mul_f32 v243, v243, v219
v_accvgpr_write_b32 a75, v243
v_accvgpr_read_b32 v243, a76
v_mul_f32 v243, v243, v216
v_accvgpr_write_b32 a76, v243
v_accvgpr_read_b32 v243, a77
v_mul_f32 v243, v243, v217
v_accvgpr_write_b32 a77, v243
v_accvgpr_read_b32 v243, a78
v_mul_f32 v243, v243, v218
v_accvgpr_write_b32 a78, v243
v_accvgpr_read_b32 v243, a79
v_mul_f32 v243, v243, v219
v_accvgpr_write_b32 a79, v243
v_accvgpr_read_b32 v243, a80
v_mul_f32 v243, v243, v216
v_accvgpr_write_b32 a80, v243
v_accvgpr_read_b32 v243, a81
v_mul_f32 v243, v243, v217
v_accvgpr_write_b32 a81, v243
v_accvgpr_read_b32 v243, a82
v_mul_f32 v243, v243, v218
v_accvgpr_write_b32 a82, v243
v_accvgpr_read_b32 v243, a83
v_mul_f32 v243, v243, v219
v_accvgpr_write_b32 a83, v243
v_accvgpr_read_b32 v243, a84
v_mul_f32 v243, v243, v216
v_accvgpr_write_b32 a84, v243
v_accvgpr_read_b32 v243, a85
v_mul_f32 v243, v243, v217
v_accvgpr_write_b32 a85, v243
v_accvgpr_read_b32 v243, a86
v_mul_f32 v243, v243, v218
v_accvgpr_write_b32 a86, v243
v_accvgpr_read_b32 v243, a87
v_mul_f32 v243, v243, v219
v_accvgpr_write_b32 a87, v243
v_accvgpr_read_b32 v243, a88
v_mul_f32 v243, v243, v216
v_accvgpr_write_b32 a88, v243
v_accvgpr_read_b32 v243, a89
v_mul_f32 v243, v243, v217
v_accvgpr_write_b32 a89, v243
v_accvgpr_read_b32 v243, a90
v_mul_f32 v243, v243, v218
v_accvgpr_write_b32 a90, v243
v_accvgpr_read_b32 v243, a91
v_mul_f32 v243, v243, v219
v_accvgpr_write_b32 a91, v243
v_accvgpr_read_b32 v243, a92
v_mul_f32 v243, v243, v216
v_accvgpr_write_b32 a92, v243
v_accvgpr_read_b32 v243, a93
v_mul_f32 v243, v243, v217
v_accvgpr_write_b32 a93, v243
v_accvgpr_read_b32 v243, a94
v_mul_f32 v243, v243, v218
v_accvgpr_write_b32 a94, v243
v_accvgpr_read_b32 v243, a95
v_mul_f32 v243, v243, v219
v_accvgpr_write_b32 a95, v243
v_exp_f32 v216, v140
v_exp_f32 v217, v141
s_nop 0
v_add_f32 v215, v216, v217
v_cvt_pk_bf16_f32 v188, v216, v217
v_exp_f32 v218, v142
s_nop 0
v_add_f32 v215, v215, v218
v_exp_f32 v219, v143
s_nop 0
v_add_f32 v215, v215, v219
v_cvt_pk_bf16_f32 v189, v218, v219
v_exp_f32 v220, v156
s_nop 0
v_add_f32 v215, v215, v220
v_exp_f32 v221, v157
s_nop 0
v_add_f32 v215, v215, v221
v_cvt_pk_bf16_f32 v190, v220, v221
v_exp_f32 v222, v158
s_nop 0
v_add_f32 v215, v215, v222
v_exp_f32 v223, v159
s_nop 0
v_add_f32 v215, v215, v223
v_cvt_pk_bf16_f32 v191, v222, v223
L_rs0_3:
v_mov_b32 v243, 0xff800000
s_nop 1
s_setpc_b64 s[80:81]
L_rt1:
s_nop 7
v_cmp_lt_f32 vcc, s52, v212
s_nop 1
s_cbranch_vccz L_rs1_0
v_max3_f32 v240, v96, v97, v98
v_max3_f32 v243, v99, v112, v113
v_max3_f32 v240, v240, v114, v115
v_max3_f32 v240, v240, v243, 0
v_mov_b32 v243, v240
s_nop 1
v_permlane16_swap_b32 v240, v243
v_max_f32 v240, v240, v243
v_mov_b32 v243, v240
s_nop 1
v_permlane32_swap_b32 v240, v243
v_max_f32 v240, v240, v243
v_exp_f32 v247, -v240
v_sub_f32 v96, v96, v240
v_sub_f32 v97, v97, v240
v_sub_f32 v98, v98, v240
v_sub_f32 v99, v99, v240
v_sub_f32 v112, v112, v240
v_sub_f32 v113, v113, v240
v_sub_f32 v114, v114, v240
v_sub_f32 v115, v115, v240
v_sub_f32 v128, v128, v240
v_sub_f32 v129, v129, v240
v_sub_f32 v130, v130, v240
v_sub_f32 v131, v131, v240
v_sub_f32 v144, v144, v240
v_sub_f32 v145, v145, v240
v_sub_f32 v146, v146, v240
v_sub_f32 v147, v147, v240
v_sub_f32 v192, v192, v240
v_sub_f32 v193, v193, v240
v_sub_f32 v194, v194, v240
v_sub_f32 v195, v195, v240
v_mul_f32 v208, v208, v247
v_mbcnt_lo_u32_b32 v243, -1, 0
v_mbcnt_hi_u32_b32 v243, -1, v243
v_and_b32 v243, 48, v243
ds_bpermute_b32 v216, v243, v247 offset:0
ds_bpermute_b32 v217, v243, v247 offset:4
ds_bpermute_b32 v218, v243, v247 offset:8
ds_bpermute_b32 v219, v243, v247 offset:12
s_waitcnt lgkmcnt(0)
v_mul_f32 v0, v0, v216
v_mul_f32 v1, v1, v217
v_mul_f32 v2, v2, v218
v_mul_f32 v3, v3, v219
v_mul_f32 v4, v4, v216
v_mul_f32 v5, v5, v217
v_mul_f32 v6, v6, v218
v_mul_f32 v7, v7, v219
v_mul_f32 v8, v8, v216
v_mul_f32 v9, v9, v217
v_mul_f32 v10, v10, v218
v_mul_f32 v11, v11, v219
v_mul_f32 v12, v12, v216
v_mul_f32 v13, v13, v217
v_mul_f32 v14, v14, v218
v_mul_f32 v15, v15, v219
v_mul_f32 v16, v16, v216
v_mul_f32 v17, v17, v217
v_mul_f32 v18, v18, v218
v_mul_f32 v19, v19, v219
v_mul_f32 v20, v20, v216
v_mul_f32 v21, v21, v217
v_mul_f32 v22, v22, v218
v_mul_f32 v23, v23, v219
v_mul_f32 v24, v24, v216
v_mul_f32 v25, v25, v217
v_mul_f32 v26, v26, v218
v_mul_f32 v27, v27, v219
v_mul_f32 v28, v28, v216
v_mul_f32 v29, v29, v217
v_mul_f32 v30, v30, v218
v_mul_f32 v31, v31, v219
v_mul_f32 v32, v32, v216
v_mul_f32 v33, v33, v217
v_mul_f32 v34, v34, v218
v_mul_f32 v35, v35, v219
v_mul_f32 v36, v36, v216
v_mul_f32 v37, v37, v217
v_mul_f32 v38, v38, v218
v_mul_f32 v39, v39, v219
v_mul_f32 v40, v40, v216
v_mul_f32 v41, v41, v217
v_mul_f32 v42, v42, v218
v_mul_f32 v43, v43, v219
v_mul_f32 v44, v44, v216
v_mul_f32 v45, v45, v217
v_mul_f32 v46, v46, v218
v_mul_f32 v47, v47, v219
v_exp_f32 v216, v96
v_exp_f32 v217, v97
s_nop 0
v_add_f32 v212, v216, v217
v_cvt_pk_bf16_f32 v160, v216, v217
v_exp_f32 v218, v98
s_nop 0
v_add_f32 v212, v212, v218
v_exp_f32 v219, v99
s_nop 0
v_add_f32 v212, v212, v219
v_cvt_pk_bf16_f32 v161, v218, v219
v_exp_f32 v220, v112
s_nop 0
v_add_f32 v212, v212, v220
v_exp_f32 v221, v113
s_nop 0
v_add_f32 v212, v212, v221
v_cvt_pk_bf16_f32 v162, v220, v221
v_exp_f32 v222, v114
s_nop 0
v_add_f32 v212, v212, v222
v_exp_f32 v223, v115
s_nop 0
v_add_f32 v212, v212, v223
v_cvt_pk_bf16_f32 v163, v222, v223
L_rs1_0:
v_cmp_lt_f32 vcc, s52, v213
s_nop 1
s_cbranch_vccz L_rs1_1
v_max3_f32 v240, v100, v101, v102
v_max3_f32 v243, v103, v116, v117
v_max3_f32 v240, v240, v118, v119
v_max3_f32 v240, v240, v243, 0
v_mov_b32 v243, v240
s_nop 1
v_permlane16_swap_b32 v240, v243
v_max_f32 v240, v240, v243
v_mov_b32 v243, v240
s_nop 1
v_permlane32_swap_b32 v240, v243
v_max_f32 v240, v240, v243
v_exp_f32 v247, -v240
v_sub_f32 v100, v100, v240
v_sub_f32 v101, v101, v240
v_sub_f32 v102, v102, v240
v_sub_f32 v103, v103, v240
v_sub_f32 v116, v116, v240
v_sub_f32 v117, v117, v240
v_sub_f32 v118, v118, v240
v_sub_f32 v119, v119, v240
v_sub_f32 v132, v132, v240
v_sub_f32 v133, v133, v240
v_sub_f32 v134, v134, v240
v_sub_f32 v135, v135, v240
v_sub_f32 v148, v148, v240
v_sub_f32 v149, v149, v240
v_sub_f32 v150, v150, v240
v_sub_f32 v151, v151, v240
v_sub_f32 v196, v196, v240
v_sub_f32 v197, v197, v240
v_sub_f32 v198, v198, v240
v_sub_f32 v199, v199, v240
v_mul_f32 v209, v209, v247
v_mbcnt_lo_u32_b32 v243, -1, 0
v_mbcnt_hi_u32_b32 v243, -1, v243
v_and_b32 v243, 48, v243
ds_bpermute_b32 v216, v243, v247 offset:0
ds_bpermute_b32 v217, v243, v247 offset:4
ds_bpermute_b32 v218, v243, v247 offset:8
ds_bpermute_b32 v219, v243, v247 offset:12
s_waitcnt lgkmcnt(0)
v_mul_f32 v48, v48, v216
v_mul_f32 v49, v49, v217
v_mul_f32 v50, v50, v218
v_mul_f32 v51, v51, v219
v_mul_f32 v52, v52, v216
v_mul_f32 v53, v53, v217
v_mul_f32 v54, v54, v218
v_mul_f32 v55, v55, v219
v_mul_f32 v56, v56, v216
v_mul_f32 v57, v57, v217
v_mul_f32 v58, v58, v218
v_mul_f32 v59, v59, v219
v_mul_f32 v60, v60, v216
v_mul_f32 v61, v61, v217
v_mul_f32 v62, v62, v218
v_mul_f32 v63, v63, v219
v_mul_f32 v64, v64, v216
v_mul_f32 v65, v65, v217
v_mul_f32 v66, v66, v218
v_mul_f32 v67, v67, v219
v_mul_f32 v68, v68, v216
v_mul_f32 v69, v69, v217
v_mul_f32 v70, v70, v218
v_mul_f32 v71, v71, v219
v_mul_f32 v72, v72, v216
v_mul_f32 v73, v73, v217
v_mul_f32 v74, v74, v218
v_mul_f32 v75, v75, v219
v_mul_f32 v76, v76, v216
v_mul_f32 v77, v77, v217
v_mul_f32 v78, v78, v218
v_mul_f32 v79, v79, v219
v_mul_f32 v80, v80, v216
v_mul_f32 v81, v81, v217
v_mul_f32 v82, v82, v218
v_mul_f32 v83, v83, v219
v_mul_f32 v84, v84, v216
v_mul_f32 v85, v85, v217
v_mul_f32 v86, v86, v218
v_mul_f32 v87, v87, v219
v_mul_f32 v88, v88, v216
v_mul_f32 v89, v89, v217
v_mul_f32 v90, v90, v218
v_mul_f32 v91, v91, v219
v_mul_f32 v92, v92, v216
v_mul_f32 v93, v93, v217
v_mul_f32 v94, v94, v218
v_mul_f32 v95, v95, v219
v_exp_f32 v216, v100
v_exp_f32 v217, v101
s_nop 0
v_add_f32 v213, v216, v217
v_cvt_pk_bf16_f32 v164, v216, v217
v_exp_f32 v218, v102
s_nop 0
v_add_f32 v213, v213, v218
v_exp_f32 v219, v103
s_nop 0
v_add_f32 v213, v213, v219
v_cvt_pk_bf16_f32 v165, v218, v219
v_exp_f32 v220, v116
s_nop 0
v_add_f32 v213, v213, v220
v_exp_f32 v221, v117
s_nop 0
v_add_f32 v213, v213, v221
v_cvt_pk_bf16_f32 v166, v220, v221
v_exp_f32 v222, v118
s_nop 0
v_add_f32 v213, v213, v222
v_exp_f32 v223, v119
s_nop 0
v_add_f32 v213, v213, v223
v_cvt_pk_bf16_f32 v167, v222, v223
L_rs1_1:
v_cmp_lt_f32 vcc, s52, v214
s_nop 1
s_cbranch_vccz L_rs1_2
v_max3_f32 v240, v104, v105, v106
v_max3_f32 v243, v107, v120, v121
v_max3_f32 v240, v240, v122, v123
v_max3_f32 v240, v240, v243, 0
v_mov_b32 v243, v240
s_nop 1
v_permlane16_swap_b32 v240, v243
v_max_f32 v240, v240, v243
v_mov_b32 v243, v240
s_nop 1
v_permlane32_swap_b32 v240, v243
v_max_f32 v240, v240, v243
v_exp_f32 v247, -v240
v_sub_f32 v104, v104, v240
v_sub_f32 v105, v105, v240
v_sub_f32 v106, v106, v240
v_sub_f32 v107, v107, v240
v_sub_f32 v120, v120, v240
v_sub_f32 v121, v121, v240
v_sub_f32 v122, v122, v240
v_sub_f32 v123, v123, v240
v_sub_f32 v136, v136, v240
v_sub_f32 v137, v137, v240
v_sub_f32 v138, v138, v240
v_sub_f32 v139, v139, v240
v_sub_f32 v152, v152, v240
v_sub_f32 v153, v153, v240
v_sub_f32 v154, v154, v240
v_sub_f32 v155, v155, v240
v_sub_f32 v200, v200, v240
v_sub_f32 v201, v201, v240
v_sub_f32 v202, v202, v240
v_sub_f32 v203, v203, v240
v_mul_f32 v210, v210, v247
v_mbcnt_lo_u32_b32 v243, -1, 0
v_mbcnt_hi_u32_b32 v243, -1, v243
v_and_b32 v243, 48, v243
ds_bpermute_b32 v216, v243, v247 offset:0
ds_bpermute_b32 v217, v243, v247 offset:4
ds_bpermute_b32 v218, v243, v247 offset:8
ds_bpermute_b32 v219, v243, v247 offset:12
s_waitcnt lgkmcnt(0)
v_accvgpr_read_b32 v243, a0
v_mul_f32 v243, v243, v216
v_accvgpr_write_b32 a0, v243
v_accvgpr_read_b32 v243, a1
v_mul_f32 v243, v243, v217
v_accvgpr_write_b32 a1, v243
v_accvgpr_read_b32 v243, a2
v_mul_f32 v243, v243, v218
v_accvgpr_write_b32 a2, v243
v_accvgpr_read_b32 v243, a3
v_mul_f32 v243, v243, v219
v_accvgpr_write_b32 a3, v243
v_accvgpr_read_b32 v243, a4
v_mul_f32 v243, v243, v216
v_accvgpr_write_b32 a4, v243
v_accvgpr_read_b32 v243, a5
v_mul_f32 v243, v243, v217
v_accvgpr_write_b32 a5, v243
v_accvgpr_read_b32 v243, a6
v_mul_f32 v243, v243, v218
v_accvgpr_write_b32 a6, v243
v_accvgpr_read_b32 v243, a7
v_mul_f32 v243, v243, v219
v_accvgpr_write_b32 a7, v243
v_accvgpr_read_b32 v243, a8
v_mul_f32 v243, v243, v216
v_accvgpr_write_b32 a8, v243
v_accvgpr_read_b32 v243, a9
v_mul_f32 v243, v243, v217
v_accvgpr_write_b32 a9, v243
v_accvgpr_read_b32 v243, a10
v_mul_f32 v243, v243, v218
v_accvgpr_write_b32 a10, v243
v_accvgpr_read_b32 v243, a11
v_mul_f32 v243, v243, v219
v_accvgpr_write_b32 a11, v243
v_accvgpr_read_b32 v243, a12
v_mul_f32 v243, v243, v216
v_accvgpr_write_b32 a12, v243
v_accvgpr_read_b32 v243, a13
v_mul_f32 v243, v243, v217
v_accvgpr_write_b32 a13, v243
v_accvgpr_read_b32 v243, a14
v_mul_f32 v243, v243, v218
v_accvgpr_write_b32 a14, v243
v_accvgpr_read_b32 v243, a15
v_mul_f32 v243, v243, v219
v_accvgpr_write_b32 a15, v243
v_accvgpr_read_b32 v243, a16
v_mul_f32 v243, v243, v216
v_accvgpr_write_b32 a16, v243
v_accvgpr_read_b32 v243, a17
v_mul_f32 v243, v243, v217
v_accvgpr_write_b32 a17, v243
v_accvgpr_read_b32 v243, a18
v_mul_f32 v243, v243, v218
v_accvgpr_write_b32 a18, v243
v_accvgpr_read_b32 v243, a19
v_mul_f32 v243, v243, v219
v_accvgpr_write_b32 a19, v243
v_accvgpr_read_b32 v243, a20
v_mul_f32 v243, v243, v216
v_accvgpr_write_b32 a20, v243
v_accvgpr_read_b32 v243, a21
v_mul_f32 v243, v243, v217
v_accvgpr_write_b32 a21, v243
v_accvgpr_read_b32 v243, a22
v_mul_f32 v243, v243, v218
v_accvgpr_write_b32 a22, v243
v_accvgpr_read_b32 v243, a23
v_mul_f32 v243, v243, v219
v_accvgpr_write_b32 a23, v243
v_accvgpr_read_b32 v243, a24
v_mul_f32 v243, v243, v216
v_accvgpr_write_b32 a24, v243
v_accvgpr_read_b32 v243, a25
v_mul_f32 v243, v243, v217
v_accvgpr_write_b32 a25, v243
v_accvgpr_read_b32 v243, a26
v_mul_f32 v243, v243, v218
v_accvgpr_write_b32 a26, v243
v_accvgpr_read_b32 v243, a27
v_mul_f32 v243, v243, v219
v_accvgpr_write_b32 a27, v243
v_accvgpr_read_b32 v243, a28
v_mul_f32 v243, v243, v216
v_accvgpr_write_b32 a28, v243
v_accvgpr_read_b32 v243, a29
v_mul_f32 v243, v243, v217
v_accvgpr_write_b32 a29, v243
v_accvgpr_read_b32 v243, a30
v_mul_f32 v243, v243, v218
v_accvgpr_write_b32 a30, v243
v_accvgpr_read_b32 v243, a31
v_mul_f32 v243, v243, v219
v_accvgpr_write_b32 a31, v243
v_accvgpr_read_b32 v243, a32
v_mul_f32 v243, v243, v216
v_accvgpr_write_b32 a32, v243
v_accvgpr_read_b32 v243, a33
v_mul_f32 v243, v243, v217
v_accvgpr_write_b32 a33, v243
v_accvgpr_read_b32 v243, a34
v_mul_f32 v243, v243, v218
v_accvgpr_write_b32 a34, v243
v_accvgpr_read_b32 v243, a35
v_mul_f32 v243, v243, v219
v_accvgpr_write_b32 a35, v243
v_accvgpr_read_b32 v243, a36
v_mul_f32 v243, v243, v216
v_accvgpr_write_b32 a36, v243
v_accvgpr_read_b32 v243, a37
v_mul_f32 v243, v243, v217
v_accvgpr_write_b32 a37, v243
v_accvgpr_read_b32 v243, a38
v_mul_f32 v243, v243, v218
v_accvgpr_write_b32 a38, v243
v_accvgpr_read_b32 v243, a39
v_mul_f32 v243, v243, v219
v_accvgpr_write_b32 a39, v243
v_accvgpr_read_b32 v243, a40
v_mul_f32 v243, v243, v216
v_accvgpr_write_b32 a40, v243
v_accvgpr_read_b32 v243, a41
v_mul_f32 v243, v243, v217
v_accvgpr_write_b32 a41, v243
v_accvgpr_read_b32 v243, a42
v_mul_f32 v243, v243, v218
v_accvgpr_write_b32 a42, v243
v_accvgpr_read_b32 v243, a43
v_mul_f32 v243, v243, v219
v_accvgpr_write_b32 a43, v243
v_accvgpr_read_b32 v243, a44
v_mul_f32 v243, v243, v216
v_accvgpr_write_b32 a44, v243
v_accvgpr_read_b32 v243, a45
v_mul_f32 v243, v243, v217
v_accvgpr_write_b32 a45, v243
v_accvgpr_read_b32 v243, a46
v_mul_f32 v243, v243, v218
v_accvgpr_write_b32 a46, v243
v_accvgpr_read_b32 v243, a47
v_mul_f32 v243, v243, v219
v_accvgpr_write_b32 a47, v243
v_exp_f32 v216, v104
v_exp_f32 v217, v105
s_nop 0
v_add_f32 v214, v216, v217
v_cvt_pk_bf16_f32 v168, v216, v217
v_exp_f32 v218, v106
s_nop 0
v_add_f32 v214, v214, v218
v_exp_f32 v219, v107
s_nop 0
v_add_f32 v214, v214, v219
v_cvt_pk_bf16_f32 v169, v218, v219
v_exp_f32 v220, v120
s_nop 0
v_add_f32 v214, v214, v220
v_exp_f32 v221, v121
s_nop 0
v_add_f32 v214, v214, v221
v_cvt_pk_bf16_f32 v170, v220, v221
v_exp_f32 v222, v122
s_nop 0
v_add_f32 v214, v214, v222
v_exp_f32 v223, v123
s_nop 0
v_add_f32 v214, v214, v223
v_cvt_pk_bf16_f32 v171, v222, v223
L_rs1_2:
v_cmp_lt_f32 vcc, s52, v215
s_nop 1
s_cbranch_vccz L_rs1_3
v_max3_f32 v240, v108, v109, v110
v_max3_f32 v243, v111, v124, v125
v_max3_f32 v240, v240, v126, v127
v_max3_f32 v240, v240, v243, 0
v_mov_b32 v243, v240
s_nop 1
v_permlane16_swap_b32 v240, v243
v_max_f32 v240, v240, v243
v_mov_b32 v243, v240
s_nop 1
v_permlane32_swap_b32 v240, v243
v_max_f32 v240, v240, v243
v_exp_f32 v247, -v240
v_sub_f32 v108, v108, v240
v_sub_f32 v109, v109, v240
v_sub_f32 v110, v110, v240
v_sub_f32 v111, v111, v240
v_sub_f32 v124, v124, v240
v_sub_f32 v125, v125, v240
v_sub_f32 v126, v126, v240
v_sub_f32 v127, v127, v240
v_sub_f32 v140, v140, v240
v_sub_f32 v141, v141, v240
v_sub_f32 v142, v142, v240
v_sub_f32 v143, v143, v240
v_sub_f32 v156, v156, v240
v_sub_f32 v157, v157, v240
v_sub_f32 v158, v158, v240
v_sub_f32 v159, v159, v240
v_sub_f32 v204, v204, v240
v_sub_f32 v205, v205, v240
v_sub_f32 v206, v206, v240
v_sub_f32 v207, v207, v240
v_mul_f32 v211, v211, v247
v_mbcnt_lo_u32_b32 v243, -1, 0
v_mbcnt_hi_u32_b32 v243, -1, v243
v_and_b32 v243, 48, v243
ds_bpermute_b32 v216, v243, v247 offset:0
ds_bpermute_b32 v217, v243, v247 offset:4
ds_bpermute_b32 v218, v243, v247 offset:8
ds_bpermute_b32 v219, v243, v247 offset:12
s_waitcnt lgkmcnt(0)
v_accvgpr_read_b32 v243, a48
v_mul_f32 v243, v243, v216
v_accvgpr_write_b32 a48, v243
v_accvgpr_read_b32 v243, a49
v_mul_f32 v243, v243, v217
v_accvgpr_write_b32 a49, v243
v_accvgpr_read_b32 v243, a50
v_mul_f32 v243, v243, v218
v_accvgpr_write_b32 a50, v243
v_accvgpr_read_b32 v243, a51
v_mul_f32 v243, v243, v219
v_accvgpr_write_b32 a51, v243
v_accvgpr_read_b32 v243, a52
v_mul_f32 v243, v243, v216
v_accvgpr_write_b32 a52, v243
v_accvgpr_read_b32 v243, a53
v_mul_f32 v243, v243, v217
v_accvgpr_write_b32 a53, v243
v_accvgpr_read_b32 v243, a54
v_mul_f32 v243, v243, v218
v_accvgpr_write_b32 a54, v243
v_accvgpr_read_b32 v243, a55
v_mul_f32 v243, v243, v219
v_accvgpr_write_b32 a55, v243
v_accvgpr_read_b32 v243, a56
v_mul_f32 v243, v243, v216
v_accvgpr_write_b32 a56, v243
v_accvgpr_read_b32 v243, a57
v_mul_f32 v243, v243, v217
v_accvgpr_write_b32 a57, v243
v_accvgpr_read_b32 v243, a58
v_mul_f32 v243, v243, v218
v_accvgpr_write_b32 a58, v243
v_accvgpr_read_b32 v243, a59
v_mul_f32 v243, v243, v219
v_accvgpr_write_b32 a59, v243
v_accvgpr_read_b32 v243, a60
v_mul_f32 v243, v243, v216
v_accvgpr_write_b32 a60, v243
v_accvgpr_read_b32 v243, a61
v_mul_f32 v243, v243, v217
v_accvgpr_write_b32 a61, v243
v_accvgpr_read_b32 v243, a62
v_mul_f32 v243, v243, v218
v_accvgpr_write_b32 a62, v243
v_accvgpr_read_b32 v243, a63
v_mul_f32 v243, v243, v219
v_accvgpr_write_b32 a63, v243
v_accvgpr_read_b32 v243, a64
v_mul_f32 v243, v243, v216
v_accvgpr_write_b32 a64, v243
v_accvgpr_read_b32 v243, a65
v_mul_f32 v243, v243, v217
v_accvgpr_write_b32 a65, v243
v_accvgpr_read_b32 v243, a66
v_mul_f32 v243, v243, v218
v_accvgpr_write_b32 a66, v243
v_accvgpr_read_b32 v243, a67
v_mul_f32 v243, v243, v219
v_accvgpr_write_b32 a67, v243
v_accvgpr_read_b32 v243, a68
v_mul_f32 v243, v243, v216
v_accvgpr_write_b32 a68, v243
v_accvgpr_read_b32 v243, a69
v_mul_f32 v243, v243, v217
v_accvgpr_write_b32 a69, v243
v_accvgpr_read_b32 v243, a70
v_mul_f32 v243, v243, v218
v_accvgpr_write_b32 a70, v243
v_accvgpr_read_b32 v243, a71
v_mul_f32 v243, v243, v219
v_accvgpr_write_b32 a71, v243
v_accvgpr_read_b32 v243, a72
v_mul_f32 v243, v243, v216
v_accvgpr_write_b32 a72, v243
v_accvgpr_read_b32 v243, a73
v_mul_f32 v243, v243, v217
v_accvgpr_write_b32 a73, v243
v_accvgpr_read_b32 v243, a74
v_mul_f32 v243, v243, v218
v_accvgpr_write_b32 a74, v243
v_accvgpr_read_b32 v243, a75
v_mul_f32 v243, v243, v219
v_accvgpr_write_b32 a75, v243
v_accvgpr_read_b32 v243, a76
v_mul_f32 v243, v243, v216
v_accvgpr_write_b32 a76, v243
v_accvgpr_read_b32 v243, a77
v_mul_f32 v243, v243, v217
v_accvgpr_write_b32 a77, v243
v_accvgpr_read_b32 v243, a78
v_mul_f32 v243, v243, v218
v_accvgpr_write_b32 a78, v243
v_accvgpr_read_b32 v243, a79
v_mul_f32 v243, v243, v219
v_accvgpr_write_b32 a79, v243
v_accvgpr_read_b32 v243, a80
v_mul_f32 v243, v243, v216
v_accvgpr_write_b32 a80, v243
v_accvgpr_read_b32 v243, a81
v_mul_f32 v243, v243, v217
v_accvgpr_write_b32 a81, v243
v_accvgpr_read_b32 v243, a82
v_mul_f32 v243, v243, v218
v_accvgpr_write_b32 a82, v243
v_accvgpr_read_b32 v243, a83
v_mul_f32 v243, v243, v219
v_accvgpr_write_b32 a83, v243
v_accvgpr_read_b32 v243, a84
v_mul_f32 v243, v243, v216
v_accvgpr_write_b32 a84, v243
v_accvgpr_read_b32 v243, a85
v_mul_f32 v243, v243, v217
v_accvgpr_write_b32 a85, v243
v_accvgpr_read_b32 v243, a86
v_mul_f32 v243, v243, v218
v_accvgpr_write_b32 a86, v243
v_accvgpr_read_b32 v243, a87
v_mul_f32 v243, v243, v219
v_accvgpr_write_b32 a87, v243
v_accvgpr_read_b32 v243, a88
v_mul_f32 v243, v243, v216
v_accvgpr_write_b32 a88, v243
v_accvgpr_read_b32 v243, a89
v_mul_f32 v243, v243, v217
v_accvgpr_write_b32 a89, v243
v_accvgpr_read_b32 v243, a90
v_mul_f32 v243, v243, v218
v_accvgpr_write_b32 a90, v243
v_accvgpr_read_b32 v243, a91
v_mul_f32 v243, v243, v219
v_accvgpr_write_b32 a91, v243
v_accvgpr_read_b32 v243, a92
v_mul_f32 v243, v243, v216
v_accvgpr_write_b32 a92, v243
v_accvgpr_read_b32 v243, a93
v_mul_f32 v243, v243, v217
v_accvgpr_write_b32 a93, v243
v_accvgpr_read_b32 v243, a94
v_mul_f32 v243, v243, v218
v_accvgpr_write_b32 a94, v243
v_accvgpr_read_b32 v243, a95
v_mul_f32 v243, v243, v219
v_accvgpr_write_b32 a95, v243
v_exp_f32 v216, v108
v_exp_f32 v217, v109
s_nop 0
v_add_f32 v215, v216, v217
v_cvt_pk_bf16_f32 v172, v216, v217
v_exp_f32 v218, v110
s_nop 0
v_add_f32 v215, v215, v218
v_exp_f32 v219, v111
s_nop 0
v_add_f32 v215, v215, v219
v_cvt_pk_bf16_f32 v173, v218, v219
v_exp_f32 v220, v124
s_nop 0
v_add_f32 v215, v215, v220
v_exp_f32 v221, v125
s_nop 0
v_add_f32 v215, v215, v221
v_cvt_pk_bf16_f32 v174, v220, v221
v_exp_f32 v222, v126
s_nop 0
v_add_f32 v215, v215, v222
v_exp_f32 v223, v127
s_nop 0
v_add_f32 v215, v215, v223
v_cvt_pk_bf16_f32 v175, v222, v223
L_rs1_3:
v_mov_b32 v243, 0xff800000
s_nop 1
s_setpc_b64 s[80:81]
.section .rodata,"a"
.p2align 6
.amdhsa_kernel standalone__memory_aug_memorizing_tr__prompt_kernel
  .amdhsa_next_free_vgpr 512
  .amdhsa_next_free_sgpr 102
  .amdhsa_accum_offset 256
  .amdhsa_group_segment_fixed_size 0
  .amdhsa_kernarg_size 80
  .amdhsa_user_sgpr_count 2
  .amdhsa_user_sgpr_kernarg_segment_ptr 1
  .amdhsa_system_sgpr_workgroup_id_x 1
.end_amdhsa_kernel
```
